```python
import torch

def _softmax(x, axis=-1):
    return torch.softmax(x, dim=axis)
def _gelu(x):
    return torch.nn.functional.gelu(x, approximate="tanh")
def _silu(x):
    return torch.nn.functional.silu(x)
def _sigmoid(x):
    return torch.sigmoid(x)
def _layernorm(x, axis=-1, eps=1e-5):
    m = x.mean(dim=axis, keepdim=True)
    v = x.var(dim=axis, keepdim=True, unbiased=False)
    return (x - m) / torch.sqrt(v + eps)
def _scatter_add(tgt, idx, src, axis=0):
    return tgt.clone().index_add_(axis, idx, src)
def _segment_sum(src, seg, n):
    out = torch.zeros((n,) + src.shape[1:], dtype=src.dtype)
    return out.index_add_(0, seg, src)
def _pad(x, pw):
    flat = tuple(v for pair in reversed(pw) for v in pair)
    return torch.nn.functional.pad(x, flat)

kernel_name = 'interleave_layers__grouped_kv_mqa__mixer_channel_mlp__prompt'

def setup_inputs():

    _w = (lambda a: (lambda t: t.to(torch.bfloat16) if t.is_floating_point() else t)(torch.as_tensor(a)))
    def _A_setup():
        B, S, D, H = 1, 2048, 1024, 32
        Dh = D // H
        return {
            "x": _w((lambda *s: torch.randn(*s, dtype=torch.bfloat16) * 0.05)(B, S, D)),
            "wq": _w((lambda *s: torch.randn(*s, dtype=torch.bfloat16) * 0.05)(D, H * Dh)),
            "wk": _w((lambda *s: torch.randn(*s, dtype=torch.bfloat16) * 0.05)(D, Dh)),
            "wv": _w((lambda *s: torch.randn(*s, dtype=torch.bfloat16) * 0.05)(D, Dh)),
            "wo": _w((lambda *s: torch.randn(*s, dtype=torch.bfloat16) * 0.05)(H * Dh, D)),
        }
    _A_in = _A_setup()

    def _B_setup():
        B, S, D, F = 1, 2048, 1024, 3584
        return {
            "x": _w((lambda *s: torch.randn(*s, dtype=torch.bfloat16) * 0.05)(B, S, D)),
            "w1": _w((lambda *s: torch.randn(*s, dtype=torch.bfloat16) * 3.2)(D, F) * (D ** -0.5)),
            "b1": _w((lambda *s: torch.randn(*s, dtype=torch.bfloat16) * 1.6)(F)),
            "w2": _w((lambda *s: torch.randn(*s, dtype=torch.bfloat16) * 0.8)(F, D) * (F ** -0.5)),
            "b2": _w((lambda *s: torch.randn(*s, dtype=torch.bfloat16) * 0.8)(D)),
        }
    _B_in = _B_setup()

    return {
        "A_x": _A_in["x"],
        "A_wq": _A_in["wq"],
        "A_wk": _A_in["wk"],
        "A_wv": _A_in["wv"],
        "A_wo": _A_in["wo"],
        "B_x": _B_in["x"],
        "B_w1": _B_in["w1"],
        "B_b1": _B_in["b1"],
        "B_w2": _B_in["w2"],
        "B_b2": _B_in["b2"],
    }

def reference(A_x, A_wq, A_wk, A_wv, A_wo, B_x, B_w1, B_b1, B_w2, B_b2):
    def _A_ref(x, wq, wk, wv, wo):
        B, S, D = x.shape
        H = 32
        Dh = D // H
        q = (lambda x, *d: x.permute(*d))((x @ wq).reshape(B, S, H, Dh), 0, 2, 1, 3)
        k = x @ wk
        v = x @ wv
        scores = torch.einsum("bhqd,bkd->bhqk", q, k) * (Dh ** -0.5)
        p = _softmax(scores, axis=-1)
        o = torch.einsum("bhqk,bkd->bhqd", p, v)
        return (lambda x, *d: x.permute(*d))(o, 0, 2, 1, 3).reshape(B, S, H * Dh) @ wo

    def _B_ref(x, w1, b1, w2, b2):
        y = _layernorm(x, axis=-1)
        h = _gelu(torch.einsum("bsd,df->bsf", y, w1) + b1)
        return torch.einsum("bsf,fd->bsd", h, w2) + b2

    x = A_x
    x = x + _A_ref(_layernorm(x, axis=-1), A_wq, A_wk, A_wv, A_wo)
    x = x + _B_ref(_layernorm(x, axis=-1), B_w1, B_b1, B_w2, B_b2)
    x = x + _A_ref(_layernorm(x, axis=-1), A_wq, A_wk, A_wv, A_wo)
    x = x + _B_ref(_layernorm(x, axis=-1), B_w1, B_b1, B_w2, B_b2)
    return x
```

```asm
; @launch grid=(256,1,1) block=(256,1,1) lds=163840
.amdgcn_target "amdgcn-amd-amdhsa--gfx950"
.text
.globl interleave_layers__grouped_kv_mqa__mixer_channel_mlp__prompt_kernel
.p2align 8
.type interleave_layers__grouped_kv_mqa__mixer_channel_mlp__prompt_kernel,@function
interleave_layers__grouped_kv_mqa__mixer_channel_mlp__prompt_kernel:
    s_cmp_ge_u32 s2, 256
    s_cbranch_scc1 L_end
    s_load_dwordx2 s[8:9], s[0:1], 0
    s_load_dwordx2 s[4:5], s[0:1], 96
    s_load_dwordx2 s[40:41], s[0:1], 88
    s_load_dwordx16 s[68:83], s[0:1], 0
    s_load_dwordx8 s[60:67], s[0:1], 64
    s_getpc_b64 s[44:45]
L_pc:
    s_mov_b32 s46, L_end-L_pc
    s_mov_b32 s47, 0x00020000
    s_lshr_b32 s58, s2, 3
    s_mul_i32 s58, s58, 3072
    v_mul_u32_u24 v2, 12, v0
    buffer_load_dwordx3 v[72:74], v2, s[44:47], s58 offen
    v_lshrrev_b32 v7, 6, v0
    v_and_b32 v0, 63, v0
    v_readfirstlane_b32 s48, v7
    s_mov_b32 s6, 268435456
    s_mov_b32 s7, 0x00020000
    s_mov_b32 s10, 4194304
    s_mov_b32 s11, 0x00020000
    s_and_b32 s51, s2, 1
    s_bfe_u32 s50, s2, 0x30003
    s_bfe_u32 s49, s2, 0x20001
    s_lshl_b32 s49, s49, 2
    s_lshr_b32 s52, s2, 6
    s_add_u32 s49, s49, s52
    s_lshl3_add_u32 s52, s51, s50
    s_and_b32 s53, s52, 3
    s_lshr_b32 s50, s50, 2
    s_lshl1_add_u32 s50, s53, s50
    s_and_b32 s3, s50, 1
    s_lshr_b32 s50, s52, 1
    s_and_b32 s51, s52, 1
    s_lshr_b32 s54, s52, 2
    s_lshl2_add_u32 s53, s53, s54
    s_lshl2_add_u32 s54, s49, s48
    s_mov_b32 s55, 0
    s_mov_b32 s56, 16777216
    s_mov_b32 s92, 1
    s_mul_i32 s59, s54, 2048
    s_mul_i32 s91, s49, 2048
    s_lshl_b32 s96, s48, 12
    v_lshlrev_b32 v1, 4, v0
    v_lshlrev_b32 v2, 2, v0
    v_mov_b32 v6, 0
    v_and_b32 v4, 15, v0
    v_lshlrev_b32 v4, 11, v4
    v_bfe_u32 v7, v0, 4, 1
    v_lshl_or_b32 v4, v7, 5, v4
    v_lshrrev_b32 v7, 5, v0
    v_lshl_or_b32 v4, v7, 4, v4
    s_lshl_b32 s93, s54, 16
    s_lshl_b32 s94, s53, 7
    s_add_u32 s93, s93, s94
    s_add_u32 s94, s93, 32768
    s_lshl2_add_u32 s57, s2, s48
    s_waitcnt lgkmcnt(0)
    s_cmp_lg_u32 s52, 0
    s_cbranch_scc1 L_nozero2
    v_mov_b32 v64, 0
    v_mov_b32 v65, 0
    v_mov_b32 v66, 0
    v_mov_b32 v67, 0
    v_cmp_gt_u32 vcc, 24, v0
    v_mov_b32 v11, 1073741824
    v_mul_u32_u24 v9, 2048, v0
    v_cndmask_b32 v11, v11, v1, vcc
    buffer_store_dwordx4 v[64:67], v11, s[4:7], s59 offen offset:128 sc1
    s_cmp_lg_u32 s57, 0
    s_cbranch_scc1 L_nozero2
    v_mul_u32_u24 v10, 2048, v0
    v_lshl_or_b32 v10, v7, 30, v10
    s_load_dword s1, s[40:41], 128
    s_mov_b32 s90, 131072
    buffer_store_dwordx4 v[64:67], v9, s[4:7], 0 offen sc1
    buffer_store_dwordx4 v[64:67], v9, s[4:7], 0 offen offset:16 sc1
    buffer_store_dwordx4 v[64:67], v10, s[4:7], s90 offen sc1
L_nozero2:
    buffer_load_dwordx4 v[48:51], v4, s[8:11], s93 offen offset:0
    buffer_load_dwordx4 v[52:55], v4, s[8:11], s94 offen offset:0
    buffer_load_dwordx4 v[56:59], v4, s[8:11], s93 offen offset:64
    buffer_load_dwordx4 v[60:63], v4, s[8:11], s94 offen offset:64
    s_cmp_eq_u32 s51, 0
    s_cselect_b64 s[16:17], s[72:73], s[74:75]
    s_cmp_lt_u32 s2, 112
    s_cselect_b64 s[24:25], s[80:81], s[60:61]
    s_mov_b64 s[12:13], s[70:71]
    s_mov_b64 s[20:21], s[76:77]
    s_mov_b64 s[28:29], s[82:83]
    s_mov_b64 s[32:33], s[62:63]
    s_mov_b64 s[36:37], s[64:65]
    s_mov_b32 s14, 2097152
    s_mov_b32 s15, 0x00020000
    s_mov_b32 s18, 65536
    s_mov_b32 s19, 0x00020000
    s_mov_b32 s22, 2097152
    s_mov_b32 s23, 0x00020000
    s_mov_b32 s26, 7340032
    s_mov_b32 s27, 0x00020000
    s_mov_b32 s30, 7168
    s_mov_b32 s31, 0x00020000
    s_mov_b32 s34, 2048
    s_mov_b32 s35, 0x00020000
    s_mov_b32 s38, 4194304
    s_mov_b32 s39, 0x00020000
    s_mov_b32 s42, 256
    s_mov_b32 s43, 0x00020000
    s_barrier
    s_cmp_lg_u32 s57, 0
    s_cbranch_scc1 L_noflag
    s_waitcnt vmcnt(4)
    s_atomic_add s92, s[40:41], 0
L_noflag:
    v_lshlrev_b32 v10, 10, v0
    v_lshrrev_b32 v11, 4, v0
    v_lshl_or_b32 v10, v11, 28, v10
    s_lshr_b32 s60, s2, 3
    s_lshl2_add_u32 s60, s60, s48
    s_lshl_b32 s60, s60, 14
    s_andn2_b32 s61, 8, s52
    s_lshl_b32 s61, s61, 27
    s_or_b32 s60, s60, s61
    buffer_load_dword v76, v10, s[12:15], s60 offen offset:384
    v_lshrrev_b32 v11, 4, v0
    v_lshlrev_b32 v10, 7, v0
    v_lshl_or_b32 v10, v11, 28, v10
    s_lshl_b32 s60, s57, 11
    buffer_load_dword v77, v10, s[12:15], s60 offen
    s_lshl_b32 s88, s48, 16
    s_lshl_b32 s60, s53, 7
    s_add_u32 s88, s88, s60
    s_add_u32 s87, s49, 0
    s_and_b32 s87, s87, 3
    s_lshl_b32 s87, s87, 12
    s_lshl2_add_u32 s86, s96, s87
    s_lshl2_add_u32 s87, s87, s96
    s_mov_b32 m0, s87
    s_nop 0
    buffer_load_dwordx4 v1, s[16:19], s86 offen offset:0 lds
    buffer_load_dwordx4 v1, s[16:19], s86 offen offset:1024 lds
    buffer_load_dwordx4 v1, s[16:19], s86 offen offset:2048 lds
    buffer_load_dwordx4 v1, s[16:19], s86 offen offset:3072 lds
    v_lshrrev_b32 v9, 2, v0
    v_lshlrev_b32 v3, 7, v9
    v_bfe_u32 v9, v0, 3, 2
    v_lshl_or_b32 v3, v9, 5, v3
    v_and_b32 v9, 3, v0
    v_lshl_or_b32 v3, v9, 3, v3
    s_lshl_b32 s60, s48, 15
    v_add_u32 v3, s60, v3
    v_lshrrev_b32 v9, 1, v0
    v_lshrrev_b32 v10, 4, v0
    v_xor_b32 v9, v9, v10
    v_and_b32 v9, 3, v9
    v_and_b32 v10, 1, v0
    v_lshlrev_b32 v10, 4, v10
    v_lshl_or_b32 v10, v9, 5, v10
    v_lshrrev_b32 v9, 3, v0
    v_lshl_or_b32 v5, v9, 11, v10
    s_lshl2_add_u32 s67, s2, s48
    s_cmp_ge_u32 s67, 448
    s_cbranch_scc1 L_pk2
    v_lshrrev_b32 v7, 3, v0
    v_mul_u32_u24 v7, 5120, v7
    v_add_u32 v212, v7, v5
    s_lshr_b32 s60, s67, 3
    s_and_b32 s61, s67, 7
    s_mul_i32 s84, s61, 917504
    s_lshl_b32 s62, s60, 7
    s_add_u32 s84, s84, s62
    s_mov_b32 s97, 57344
    s_lshl_b32 s95, s61, 7
    s_lshl4_add_u32 s95, s62, s95
    s_add_u32 s95, s95, 15728640
    s_bitcmp1_b32 s61, 0
    s_cselect_b32 s95, 1073741824, s95
    s_bitcmp1_b32 s61, 1
    s_cselect_b32 s62, 1073741824, s62
    v_lshrrev_b32 v7, 1, v2
    buffer_load_ushort v208, v7, s[28:31], s62 offen
    s_lshl1_add_u32 s62, s60, 0
    s_mul_i32 s63, s62, 9363
    s_lshr_b32 s63, s63, 16
    s_mul_i32 s64, s63, 7
    s_sub_u32 s62, s62, s64
    s_bfe_u32 s64, s63, 0x10002
    s_lshl1_add_u32 s64, s63, s64
    s_and_b32 s64, s64, 1
    s_lshl_b32 s64, s64, 1
    s_and_b32 s65, s63, 3
    s_lshr_b32 s66, s63, 2
    s_lshl2_add_u32 s65, s65, s66
    s_xor_b32 s65, s65, s64
    s_mul_i32 s63, s63, 896
    s_add_u32 s63, s63, 1024
    s_lshl2_add_u32 s58, s62, s63
    s_cmp_eq_u32 s62, 6
    s_cselect_b32 s66, 4, 2
    s_cselect_b32 s90, 2, 30
    s_cmp_lt_u32 s62, 2
    s_cselect_b32 s66, 8, s66
    s_cselect_b32 s90, 2, s90
    s_cselect_b32 s67, 4, 60
    s_mul_i32 s62, s62, s67
    s_add_u32 s62, s62, 28
    s_add_u32 s62, s62, s63
    s_lshl1_add_u32 s67, s61, 0
    s_xor_b32 s67, s67, s64
    s_cmp_eq_u32 s67, 15
    s_cselect_b32 s85, s65, s67
    s_mul_i32 s85, s85, s66
    s_add_u32 s85, s85, s62
    s_cmp_eq_u32 s67, s65
    s_cselect_b32 s44, s58, s85
    s_cselect_b32 s45, 2, s90
    s_add_u32 s45, s45, s44
    s_lshl_b32 s44, s44, 10
    s_lshl_b32 s45, s45, 10
    s_lshl1_add_u32 s67, s61, 1
    s_xor_b32 s67, s67, s64
    s_cmp_eq_u32 s67, 15
    s_cselect_b32 s85, s65, s67
    s_mul_i32 s85, s85, s66
    s_add_u32 s85, s85, s62
    s_cmp_eq_u32 s67, s65
    s_cselect_b32 s8, s58, s85
    s_cselect_b32 s9, 2, s90
    s_add_u32 s9, s9, s8
    s_lshl_b32 s8, s8, 10
    s_lshl_b32 s9, s9, 10
    s_lshl1_add_u32 s62, s60, 1
    s_mul_i32 s63, s62, 9363
    s_lshr_b32 s63, s63, 16
    s_mul_i32 s64, s63, 7
    s_sub_u32 s62, s62, s64
    s_bfe_u32 s64, s63, 0x10002
    s_lshl1_add_u32 s64, s63, s64
    s_and_b32 s64, s64, 1
    s_lshl_b32 s64, s64, 1
    s_and_b32 s65, s63, 3
    s_lshr_b32 s66, s63, 2
    s_lshl2_add_u32 s65, s65, s66
    s_xor_b32 s65, s65, s64
    s_mul_i32 s63, s63, 896
    s_add_u32 s63, s63, 1024
    s_lshl2_add_u32 s58, s62, s63
    s_cmp_eq_u32 s62, 6
    s_cselect_b32 s66, 4, 2
    s_cselect_b32 s90, 2, 30
    s_cmp_lt_u32 s62, 2
    s_cselect_b32 s66, 8, s66
    s_cselect_b32 s90, 2, s90
    s_cselect_b32 s67, 4, 60
    s_mul_i32 s62, s62, s67
    s_add_u32 s62, s62, 28
    s_add_u32 s62, s62, s63
    s_lshl1_add_u32 s67, s61, 0
    s_xor_b32 s67, s67, s64
    s_cmp_eq_u32 s67, 15
    s_cselect_b32 s85, s65, s67
    s_mul_i32 s85, s85, s66
    s_add_u32 s85, s85, s62
    s_cmp_eq_u32 s67, s65
    s_cselect_b32 s46, s58, s85
    s_cselect_b32 s47, 2, s90
    s_add_u32 s47, s47, s46
    s_lshl_b32 s46, s46, 10
    s_lshl_b32 s47, s47, 10
    s_lshl1_add_u32 s67, s61, 1
    s_xor_b32 s67, s67, s64
    s_cmp_eq_u32 s67, 15
    s_cselect_b32 s85, s65, s67
    s_mul_i32 s85, s85, s66
    s_add_u32 s85, s85, s62
    s_cmp_eq_u32 s67, s65
    s_cselect_b32 s10, s58, s85
    s_cselect_b32 s11, 2, s90
    s_add_u32 s11, s11, s10
    s_lshl_b32 s10, s10, 10
    s_lshl_b32 s11, s11, 10
    v_add_u32 v213, 1024, v1
    v_mov_b32 v214, v213
    s_branch L_pkdone
L_pk2:
    buffer_load_ushort v208, v2, s[28:31], 0 offen
    v_mov_b32 v212, v5
    s_sub_u32 s67, s67, 448
    s_and_b32 s60, s67, 15
    s_bfe_u32 s61, s67, 0x10004
    s_lshr_b32 s62, s67, 5
    s_mul_i32 s84, s62, 7
    s_lshl2_add_u32 s84, s61, s84
    s_lshl_b32 s84, s84, 16
    s_lshl_b32 s63, s60, 7
    s_add_u32 s84, s84, s63
    s_mov_b32 s97, 16384
    s_mov_b32 s95, 1073741824
    s_lshr_b32 s63, s60, 2
    s_sub_u32 s64, s62, s63
    s_and_b32 s64, s64, 3
    s_lshl4_add_u32 s64, s61, s64
    s_lshr_b32 s62, s62, 2
    s_sub_u32 s60, s60, s62
    s_sub_u32 s60, s60, 1
    s_and_b32 s60, s60, 3
    s_lshl2_add_u32 s63, s62, s63
    s_mul_i32 s63, s63, 917504
    s_add_u32 s63, s63, 1507328
    s_cmp_ge_u32 s67, 512
    s_cselect_b32 s63, 1073741824, s63
    s_lshr_b32 s65, s64, 1
    s_lshl1_add_u32 s65, s65, s60
    s_and_b32 s66, s64, 1
    s_lshl3_add_u32 s65, s65, s66
    s_mul_i32 s66, s60, 112
    s_add_u32 s66, s66, s64
    s_cmp_lt_u32 s60, 2
    s_cselect_b32 s65, s65, s66
    s_cselect_b32 s66, 32, 4
    s_cselect_b32 s67, 2, 28
    s_lshl_b32 s65, s65, 10
    s_lshl_b32 s66, s66, 10
    s_lshl_b32 s67, s67, 10
    s_add_u32 s44, s65, s63
    s_add_u32 s45, s44, s67
    s_add_u32 s46, s45, s67
    s_add_u32 s47, s46, s67
    s_lshl1_add_u32 s8, s66, s44
    s_lshl1_add_u32 s9, s66, s45
    s_lshl1_add_u32 s10, s66, s46
    s_lshl1_add_u32 s11, s66, s47
    v_add_u32 v213, s66, v1
    s_lshl_b32 s61, s61, 30
    v_or_b32 v214, s61, v213
L_pkdone:
    s_add_u32 s87, s49, 1
    s_and_b32 s87, s87, 3
    s_lshl_b32 s87, s87, 12
    s_lshl2_add_u32 s86, s96, s87
    s_lshl2_add_u32 s87, s87, s96
    s_mov_b32 m0, s87
    s_nop 0
    buffer_load_dwordx4 v1, s[16:19], s86 offen offset:0 lds
    buffer_load_dwordx4 v1, s[16:19], s86 offen offset:1024 lds
    buffer_load_dwordx4 v1, s[16:19], s86 offen offset:2048 lds
    buffer_load_dwordx4 v1, s[16:19], s86 offen offset:3072 lds
    s_lshl_b32 s93, s54, 16
    s_lshl_b32 s60, s53, 12
    s_add_u32 s93, s93, s60
    s_lshr_b32 s94, s93, 4
    s_add_u32 s93, s93, s56
    s_add_u32 s94, s94, s56
    s_add_u32 s94, s94, 47185920
    v_mov_b32 v9, 0
    s_mov_b64 exec, 0
    s_cmp_eq_u32 s48, 0
    s_cbranch_scc1 L_hop0
    s_cmp_eq_u32 s48, 1
    s_cbranch_scc1 L_hop1
    s_cmp_eq_u32 s48, 2
    s_cbranch_scc1 L_hop2
    s_branch L_hop3
.p2align 12
L_hopdone:
    s_mov_b64 exec, -1
    s_waitcnt vmcnt(11)
    v_permlane16_swap_b32 v48, v50
    v_permlane16_swap_b32 v49, v51
    v_permlane16_swap_b32 v52, v54
    v_permlane16_swap_b32 v53, v55
    v_permlane16_swap_b32 v56, v58
    v_permlane16_swap_b32 v57, v59
    v_permlane16_swap_b32 v60, v62
    v_permlane16_swap_b32 v61, v63
    buffer_store_dwordx4 v[48:51], v1, s[4:7], s93 offen offset:0 sc1
    buffer_store_dwordx4 v[52:55], v1, s[4:7], s93 offen offset:1024 sc1
    buffer_store_dwordx4 v[56:59], v1, s[4:7], s93 offen offset:2048 sc1
    buffer_store_dwordx4 v[60:63], v1, s[4:7], s93 offen offset:3072 sc1
    s_mov_b32 s66, 0x3f803f80
    v_and_b32 v107, 0xf0, v1
    v_lshrrev_b32 v106, 4, v0
    v_lshl_or_b32 v107, v106, 2, v107
    v_dot2_f32_bf16 v108, v48, s66, 0
    v_dot2_f32_bf16 v110, v48, v48, 0
    v_dot2_f32_bf16 v109, v52, s66, 0
    v_dot2_f32_bf16 v111, v52, v52, 0
    v_dot2_f32_bf16 v108, v49, s66, v108
    v_dot2_f32_bf16 v110, v49, v49, v110
    v_dot2_f32_bf16 v109, v53, s66, v109
    v_dot2_f32_bf16 v111, v53, v53, v111
    v_dot2_f32_bf16 v108, v50, s66, v108
    v_dot2_f32_bf16 v110, v50, v50, v110
    v_dot2_f32_bf16 v109, v54, s66, v109
    v_dot2_f32_bf16 v111, v54, v54, v111
    v_dot2_f32_bf16 v108, v51, s66, v108
    v_dot2_f32_bf16 v110, v51, v51, v110
    v_dot2_f32_bf16 v109, v55, s66, v109
    v_dot2_f32_bf16 v111, v55, v55, v111
    v_dot2_f32_bf16 v108, v56, s66, v108
    v_dot2_f32_bf16 v110, v56, v56, v110
    v_dot2_f32_bf16 v109, v60, s66, v109
    v_dot2_f32_bf16 v111, v60, v60, v111
    v_dot2_f32_bf16 v108, v57, s66, v108
    v_dot2_f32_bf16 v110, v57, v57, v110
    v_dot2_f32_bf16 v109, v61, s66, v109
    v_dot2_f32_bf16 v111, v61, v61, v111
    v_dot2_f32_bf16 v108, v58, s66, v108
    v_dot2_f32_bf16 v110, v58, v58, v110
    v_dot2_f32_bf16 v109, v62, s66, v109
    v_dot2_f32_bf16 v111, v62, v62, v111
    v_dot2_f32_bf16 v108, v59, s66, v108
    v_dot2_f32_bf16 v110, v59, v59, v110
    v_dot2_f32_bf16 v109, v63, s66, v109
    v_dot2_f32_bf16 v111, v63, v63, v111
    s_nop 0
    v_permlane32_swap_b32 v108, v110
    s_nop 0
    v_permlane32_swap_b32 v109, v111
    v_add_f32 v108, v108, v110
    v_add_f32 v109, v109, v111
    s_nop 1
    v_permlane16_swap_b32 v108, v109
    v_add_f32 v108, v108, v109
    buffer_store_dword v108, v107, s[4:7], s94 offen sc1
    buffer_load_dword v68, v9, s[40:43], 0 offen sc1
    s_add_u32 s87, s49, 2
    s_and_b32 s87, s87, 3
    s_lshl_b32 s87, s87, 12
    s_lshl2_add_u32 s86, s96, s87
    s_lshl2_add_u32 s87, s87, s96
    s_mov_b32 m0, s87
    s_nop 0
    buffer_load_dwordx4 v1, s[16:19], s86 offen offset:0 lds
    buffer_load_dwordx4 v1, s[16:19], s86 offen offset:1024 lds
    buffer_load_dwordx4 v1, s[16:19], s86 offen offset:2048 lds
    buffer_load_dwordx4 v1, s[16:19], s86 offen offset:3072 lds
    s_add_u32 s87, s49, 3
    s_and_b32 s87, s87, 3
    s_lshl_b32 s87, s87, 12
    s_lshl2_add_u32 s86, s96, s87
    s_lshl2_add_u32 s87, s87, s96
    s_mov_b32 m0, s87
    s_nop 0
    buffer_load_dwordx4 v1, s[16:19], s86 offen offset:0 lds
    buffer_load_dwordx4 v1, s[16:19], s86 offen offset:1024 lds
    buffer_load_dwordx4 v1, s[16:19], s86 offen offset:2048 lds
    buffer_load_dwordx4 v1, s[16:19], s86 offen offset:3072 lds
    s_add_u32 s87, s49, 0
    s_and_b32 s87, s87, 3
    s_or_b32 s87, s87, 4
    s_add_u32 s86, s87, s3
    s_lshl_b32 s87, s87, 14
    s_add_u32 s87, s87, s96
    s_and_b32 s86, s86, 7
    s_lshl_b32 s86, s86, 18
    s_add_u32 s86, s86, s88
    s_mov_b32 m0, s87
    s_nop 0
    buffer_load_dwordx4 v5, s[12:15], s86 offen offset:0 lds
    s_add_u32 s86, s86, 15360
    buffer_load_dwordx4 v5, s[12:15], s86 offen offset:1024 lds
    s_add_u32 s86, s86, 15360
    buffer_load_dwordx4 v5, s[12:15], s86 offen offset:2048 lds
    s_add_u32 s86, s86, 15360
    buffer_load_dwordx4 v5, s[12:15], s86 offen offset:3072 lds
    s_waitcnt vmcnt(12)
    s_mov_b32 s58, 0
L_dbg:
    v_readfirstlane_b32 s60, v68
    s_nop 0
    s_cmp_lg_u32 s60, 0
    s_cbranch_scc1 L_dbgok
    s_add_u32 s58, s58, 1
    s_cmp_ge_u32 s58, 0x20000
    s_cbranch_scc1 L_dbgok
    buffer_load_dword v68, v9, s[40:43], 0 offen sc1
    s_waitcnt vmcnt(0)
    s_branch L_dbg
L_dbgok:
    s_atomic_add s92, s[4:5], s59 offset:0
    s_add_u32 s87, s49, 1
    s_and_b32 s87, s87, 3
    s_or_b32 s87, s87, 4
    s_add_u32 s86, s87, s3
    s_lshl_b32 s87, s87, 14
    s_add_u32 s87, s87, s96
    s_and_b32 s86, s86, 7
    s_lshl_b32 s86, s86, 18
    s_add_u32 s86, s86, s88
    s_mov_b32 m0, s87
    s_nop 0
    buffer_load_dwordx4 v5, s[12:15], s86 offen offset:0 lds
    s_add_u32 s86, s86, 15360
    buffer_load_dwordx4 v5, s[12:15], s86 offen offset:1024 lds
    s_add_u32 s86, s86, 15360
    buffer_load_dwordx4 v5, s[12:15], s86 offen offset:2048 lds
    s_add_u32 s86, s86, 15360
    buffer_load_dwordx4 v5, s[12:15], s86 offen offset:3072 lds
    s_add_u32 s87, s49, 2
    s_and_b32 s87, s87, 3
    s_or_b32 s87, s87, 4
    s_add_u32 s86, s87, s3
    s_lshl_b32 s87, s87, 14
    s_add_u32 s87, s87, s96
    s_and_b32 s86, s86, 7
    s_lshl_b32 s86, s86, 18
    s_add_u32 s86, s86, s88
    s_mov_b32 m0, s87
    s_nop 0
    buffer_load_dwordx4 v5, s[12:15], s86 offen offset:0 lds
    s_add_u32 s86, s86, 15360
    buffer_load_dwordx4 v5, s[12:15], s86 offen offset:1024 lds
    s_add_u32 s86, s86, 15360
    buffer_load_dwordx4 v5, s[12:15], s86 offen offset:2048 lds
    s_add_u32 s86, s86, 15360
    buffer_load_dwordx4 v5, s[12:15], s86 offen offset:3072 lds
    s_add_u32 s87, s49, 3
    s_and_b32 s87, s87, 3
    s_or_b32 s87, s87, 4
    s_add_u32 s86, s87, s3
    s_lshl_b32 s87, s87, 14
    s_add_u32 s87, s87, s96
    s_and_b32 s86, s86, 7
    s_lshl_b32 s86, s86, 18
    s_add_u32 s86, s86, s88
    s_mov_b32 m0, s87
    s_nop 0
    buffer_load_dwordx4 v5, s[12:15], s86 offen offset:0 lds
    s_add_u32 s86, s86, 15360
    buffer_load_dwordx4 v5, s[12:15], s86 offen offset:1024 lds
    s_add_u32 s86, s86, 15360
    buffer_load_dwordx4 v5, s[12:15], s86 offen offset:2048 lds
    s_add_u32 s86, s86, 15360
    buffer_load_dwordx4 v5, s[12:15], s86 offen offset:3072 lds
    s_waitcnt vmcnt(16)
    v_lshrrev_b32 v13, 2, v0
    v_lshlrev_b32 v13, 6, v13
    v_and_b32 v7, 3, v0
    v_lshl_or_b32 v13, v7, 3, v13
    v_add_u32 v13, s96, v13
    ds_read_b64_tr_b16 a[224:225], v13 offset:0
    ds_read_b64_tr_b16 a[226:227], v13 offset:1024
    ds_read_b64_tr_b16 a[228:229], v13 offset:32
    ds_read_b64_tr_b16 a[230:231], v13 offset:1056
    ds_read_b64_tr_b16 a[232:233], v13 offset:2048
    ds_read_b64_tr_b16 a[234:235], v13 offset:3072
    ds_read_b64_tr_b16 a[236:237], v13 offset:2080
    ds_read_b64_tr_b16 a[238:239], v13 offset:3104
    ds_read_b64_tr_b16 a[240:241], v13 offset:16384
    ds_read_b64_tr_b16 a[242:243], v13 offset:17408
    ds_read_b64_tr_b16 a[244:245], v13 offset:16416
    ds_read_b64_tr_b16 a[246:247], v13 offset:17440
    s_waitcnt lgkmcnt(8)
    ds_read_b64_tr_b16 a[248:249], v13 offset:18432
    ds_read_b64_tr_b16 a[250:251], v13 offset:19456
    ds_read_b64_tr_b16 a[252:253], v13 offset:18464
    ds_read_b64_tr_b16 a[254:255], v13 offset:19488
    s_waitcnt lgkmcnt(8)
    ds_read_b64_tr_b16 v[64:65], v13 offset:32768
    ds_read_b64_tr_b16 v[66:67], v13 offset:33792
    ds_read_b64_tr_b16 v[68:69], v13 offset:32800
    ds_read_b64_tr_b16 v[70:71], v13 offset:33824
    s_waitcnt lgkmcnt(8)
    ds_read_b64_tr_b16 v[72:73], v13 offset:34816
    ds_read_b64_tr_b16 v[74:75], v13 offset:35840
    ds_read_b64_tr_b16 v[76:77], v13 offset:34848
    ds_read_b64_tr_b16 v[78:79], v13 offset:35872
    s_waitcnt lgkmcnt(8)
    ds_read_b64_tr_b16 v[80:81], v13 offset:49152
    ds_read_b64_tr_b16 v[82:83], v13 offset:50176
    ds_read_b64_tr_b16 v[84:85], v13 offset:49184
    ds_read_b64_tr_b16 v[86:87], v13 offset:50208
    s_waitcnt lgkmcnt(8)
    ds_read_b64_tr_b16 v[88:89], v13 offset:51200
    ds_read_b64_tr_b16 v[90:91], v13 offset:52224
    ds_read_b64_tr_b16 v[92:93], v13 offset:51232
    ds_read_b64_tr_b16 v[94:95], v13 offset:52256
    s_waitcnt lgkmcnt(8)
    s_waitcnt lgkmcnt(0)
    s_add_u32 s87, s49, 0
    s_and_b32 s87, s87, 3
    s_add_u32 s86, s87, s3
    s_lshl_b32 s87, s87, 14
    s_add_u32 s87, s87, s96
    s_and_b32 s86, s86, 7
    s_lshl_b32 s86, s86, 18
    s_add_u32 s86, s86, s88
    s_mov_b32 m0, s87
    s_nop 0
    buffer_load_dwordx4 v5, s[12:15], s86 offen offset:0 lds
    s_add_u32 s86, s86, 15360
    buffer_load_dwordx4 v5, s[12:15], s86 offen offset:1024 lds
    s_add_u32 s86, s86, 15360
    buffer_load_dwordx4 v5, s[12:15], s86 offen offset:2048 lds
    s_add_u32 s86, s86, 15360
    buffer_load_dwordx4 v5, s[12:15], s86 offen offset:3072 lds
    s_add_u32 s87, s49, 1
    s_and_b32 s87, s87, 3
    s_add_u32 s86, s87, s3
    s_lshl_b32 s87, s87, 14
    s_add_u32 s87, s87, s96
    s_and_b32 s86, s86, 7
    s_lshl_b32 s86, s86, 18
    s_add_u32 s86, s86, s88
    s_mov_b32 m0, s87
    s_nop 0
    buffer_load_dwordx4 v5, s[12:15], s86 offen offset:0 lds
    s_add_u32 s86, s86, 15360
    buffer_load_dwordx4 v5, s[12:15], s86 offen offset:1024 lds
    s_add_u32 s86, s86, 15360
    buffer_load_dwordx4 v5, s[12:15], s86 offen offset:2048 lds
    s_add_u32 s86, s86, 15360
    buffer_load_dwordx4 v5, s[12:15], s86 offen offset:3072 lds
    s_add_u32 s87, s49, 2
    s_and_b32 s87, s87, 3
    s_add_u32 s86, s87, s3
    s_lshl_b32 s87, s87, 14
    s_add_u32 s87, s87, s96
    s_and_b32 s86, s86, 7
    s_lshl_b32 s86, s86, 18
    s_add_u32 s86, s86, s88
    s_mov_b32 m0, s87
    s_nop 0
    buffer_load_dwordx4 v5, s[12:15], s86 offen offset:0 lds
    s_add_u32 s86, s86, 15360
    buffer_load_dwordx4 v5, s[12:15], s86 offen offset:1024 lds
    s_add_u32 s86, s86, 15360
    buffer_load_dwordx4 v5, s[12:15], s86 offen offset:2048 lds
    s_add_u32 s86, s86, 15360
    buffer_load_dwordx4 v5, s[12:15], s86 offen offset:3072 lds
    s_add_u32 s87, s49, 3
    s_and_b32 s87, s87, 3
    s_add_u32 s86, s87, s3
    s_lshl_b32 s87, s87, 14
    s_add_u32 s87, s87, s96
    s_and_b32 s86, s86, 7
    s_lshl_b32 s86, s86, 18
    s_add_u32 s86, s86, s88
    s_mov_b32 m0, s87
    s_nop 0
    buffer_load_dwordx4 v5, s[12:15], s86 offen offset:0 lds
    s_add_u32 s86, s86, 15360
    buffer_load_dwordx4 v5, s[12:15], s86 offen offset:1024 lds
    s_add_u32 s86, s86, 15360
    buffer_load_dwordx4 v5, s[12:15], s86 offen offset:2048 lds
    s_add_u32 s86, s86, 15360
    buffer_load_dwordx4 v5, s[12:15], s86 offen offset:3072 lds
    s_mov_b32 s57, 0
    s_atomic_add s57, s[4:5], s59 offset:0 glc
    s_lshr_b32 s64, s50, 1
    s_lshl2_add_u32 s64, s49, s64
    s_and_b32 s65, s50, 1
    v_mov_b32 v184, 0x3f803f80
    v_mov_b32 v185, 0x3f803f80
    v_mov_b32 v186, 0x3f803f80
    v_mov_b32 v187, 0x3f803f80
    s_nop 1
    v_mfma_f32_16x16x32_bf16 v[168:171], a[224:227], v[184:187], 0
    v_lshlrev_b32 v16, 16, v48
    v_and_b32 v17, 0xffff0000, v48
    v_mfma_f32_16x16x32_bf16 v[172:175], a[228:231], v[184:187], 0
    v_lshlrev_b32 v18, 16, v49
    v_and_b32 v19, 0xffff0000, v49
    v_mfma_f32_16x16x32_bf16 v[168:171], a[232:235], v[184:187], v[168:171]
    v_lshlrev_b32 v20, 16, v50
    v_and_b32 v21, 0xffff0000, v50
    v_mfma_f32_16x16x32_bf16 v[172:175], a[236:239], v[184:187], v[172:175]
    v_lshlrev_b32 v22, 16, v51
    v_and_b32 v23, 0xffff0000, v51
    v_mfma_f32_16x16x32_bf16 v[168:171], a[240:243], v[184:187], v[168:171]
    v_lshlrev_b32 v24, 16, v52
    v_and_b32 v25, 0xffff0000, v52
    v_mfma_f32_16x16x32_bf16 v[172:175], a[244:247], v[184:187], v[172:175]
    v_lshlrev_b32 v26, 16, v53
    v_and_b32 v27, 0xffff0000, v53
    v_mfma_f32_16x16x32_bf16 v[168:171], a[248:251], v[184:187], v[168:171]
    v_lshlrev_b32 v28, 16, v54
    v_and_b32 v29, 0xffff0000, v54
    v_mfma_f32_16x16x32_bf16 v[172:175], a[252:255], v[184:187], v[172:175]
    v_lshlrev_b32 v30, 16, v55
    v_and_b32 v31, 0xffff0000, v55
    v_mfma_f32_16x16x32_bf16 v[168:171], v[64:67], v[184:187], v[168:171]
    v_lshlrev_b32 v32, 16, v56
    v_and_b32 v33, 0xffff0000, v56
    v_mfma_f32_16x16x32_bf16 v[172:175], v[68:71], v[184:187], v[172:175]
    v_lshlrev_b32 v34, 16, v57
    v_and_b32 v35, 0xffff0000, v57
    v_mfma_f32_16x16x32_bf16 v[168:171], v[72:75], v[184:187], v[168:171]
    v_lshlrev_b32 v36, 16, v58
    v_and_b32 v37, 0xffff0000, v58
    v_mfma_f32_16x16x32_bf16 v[172:175], v[76:79], v[184:187], v[172:175]
    v_lshlrev_b32 v38, 16, v59
    v_and_b32 v39, 0xffff0000, v59
    v_mfma_f32_16x16x32_bf16 v[168:171], v[80:83], v[184:187], v[168:171]
    v_lshlrev_b32 v40, 16, v60
    v_and_b32 v41, 0xffff0000, v60
    v_mfma_f32_16x16x32_bf16 v[172:175], v[84:87], v[184:187], v[172:175]
    v_lshlrev_b32 v42, 16, v61
    v_and_b32 v43, 0xffff0000, v61
    v_mfma_f32_16x16x32_bf16 v[168:171], v[88:91], v[184:187], v[168:171]
    v_lshlrev_b32 v44, 16, v62
    v_and_b32 v45, 0xffff0000, v62
    v_mfma_f32_16x16x32_bf16 v[172:175], v[92:95], v[184:187], v[172:175]
    v_lshlrev_b32 v46, 16, v63
    v_and_b32 v47, 0xffff0000, v63
    s_mul_i32 s85, s54, 65536
    s_add_u32 s85, s85, s56
    v_add_u32 v8, s85, v1
    v_add_u32 v124, 4096, v8
    s_xor_b32 s85, s48, 0
    s_lshl1_add_u32 s85, s85, s3
    s_lshl_b32 s85, s85, 13
    s_and_b32 s68, s85, 0xffff
    s_add_u32 s85, s85, 8192
    s_and_b32 s69, s85, 0xffff
    s_xor_b32 s85, s48, 1
    s_lshl1_add_u32 s85, s85, s3
    s_lshl_b32 s85, s85, 13
    s_and_b32 s70, s85, 0xffff
    s_add_u32 s85, s85, 8192
    s_and_b32 s71, s85, 0xffff
    s_xor_b32 s85, s48, 3
    s_lshl1_add_u32 s85, s85, s3
    s_lshl_b32 s85, s85, 13
    s_and_b32 s72, s85, 0xffff
    s_add_u32 s85, s85, 8192
    s_and_b32 s73, s85, 0xffff
    s_xor_b32 s85, s48, 2
    s_lshl1_add_u32 s85, s85, s3
    s_lshl_b32 s85, s85, 13
    s_and_b32 s74, s85, 0xffff
    s_add_u32 s85, s85, 8192
    s_and_b32 s75, s85, 0xffff
    v_xor_b32 v9, 0, v3
    v_xor_b32 v10, 32, v3
    v_xor_b32 v11, 64, v3
    v_xor_b32 v12, 96, v3
    s_mul_i32 s60, s64, 65536
    s_lshl_b32 s61, s65, 10
    s_add_u32 s60, s60, s61
    s_lshl2_add_u32 s60, s96, s60
    s_add_u32 s60, s60, s56
    s_lshl_b32 s61, s64, 12
    s_add_u32 s61, s61, s56
    s_add_u32 s62, s61, 47185920
    s_cmp_lg_u32 s65, 0
    s_cselect_b64 vcc, -1, 0
    v_and_b32 v160, 15, v0
    v_bfe_u32 v161, v0, 4, 1
    v_lshrrev_b32 v162, 5, v0
    s_mul_i32 s66, s48, 2112
    s_add_u32 s66, s66, 147456
    v_mul_u32_u24 v163, 1056, v162
    s_add_u32 s61, s61, 46137344
    s_cmp_lg_u32 s51, 0
    s_cbranch_scc1 L_vaddra
    v_and_b32 v13, 0x1f0, v1
    v_add_u32 v13, v13, v163
    v_mov_b32 v14, v13
    v_lshlrev_b32 v15, 4, v160
    v_lshl_or_b32 v15, v161, 10, v15
    v_lshl_or_b32 v15, v162, 9, v15
    s_lshl_b32 s65, s65, 8
    s_branch L_kvaddra
L_vaddra:
    v_bfe_u32 v13, v0, 2, 2
    v_mul_u32_u24 v13, 528, v13
    v_and_b32 v14, 0xcc, v2
    v_add_u32 v13, v13, v14
    v_and_b32 v14, 7, v0
    v_lshl_or_b32 v14, v161, 3, v14
    v_bfe_u32 v15, v0, 3, 1
    v_lshl_or_b32 v14, v15, 4, v14
    v_lshl_add_u32 v14, v14, 4, v163
    v_mov_b32 v15, v1
    s_lshl_b32 s65, s65, 10
    s_add_u32 s65, s65, 2048
L_kvaddra:
    s_add_u32 s61, s61, s65
    s_cmp_eq_u32 s48, 0
    s_cselect_b32 s61, s61, 1073741824
    s_add_u32 s76, s91, 131072
    s_add_u32 s77, s91, 163840
    s_add_u32 s78, s59, 384
    s_cmp_eq_u32 s48, 0
    s_cselect_b32 s76, s76, s78
    s_cselect_b32 s77, s77, s78
    s_cselect_b32 s78, 16, 0
    s_cselect_b32 s79, 1, 0
    s_lshl_b32 s80, s54, 12
    s_add_u32 s80, s80, s56
    s_add_u32 s80, s80, 47185920
    s_lshl_b32 s81, s49, 14
    s_lshr_b32 s89, s96, 1
    s_add_u32 s90, s81, s89
    s_add_u32 s90, s90, 2048
    s_add_u32 s89, s89, 131072
    s_add_u32 s82, s56, 46137344
    v_add_u32 v13, s66, v13
    v_add_u32 v14, 147456, v14
L_layer:
    s_mov_b32 s58, 0
L_poll_1:
    s_waitcnt lgkmcnt(0)
    s_cmp_ge_u32 s57, 16
    s_cbranch_scc1 L_polled_2
    s_add_u32 s58, s58, 1
    s_cmp_ge_u32 s58, 0x20000
    s_cbranch_scc1 L_polled_2
    s_mov_b32 s57, 0
    s_atomic_add s57, s[4:5], s59 offset:0 glc
    s_branch L_poll_1
L_polled_2:
    s_barrier
    buffer_load_dwordx4 v[104:107], v1, s[4:7], s62 offen offset:0 sc1
    buffer_load_dwordx4 v[108:111], v1, s[4:7], s62 offen offset:1024 sc1
    buffer_load_dwordx4 v[112:115], v1, s[4:7], s62 offen offset:2048 sc1
    buffer_load_dwordx4 v[116:119], v1, s[4:7], s62 offen offset:3072 sc1
    buffer_load_dwordx4 a[128:131], v1, s[4:7], s60 offen offset:0 sc1
    buffer_load_dwordx4 a[132:135], v1, s[4:7], s60 offen offset:2048 sc1
    s_add_u32 s60, s60, 4096
    buffer_load_dwordx4 a[136:139], v1, s[4:7], s60 offen offset:0 sc1
    buffer_load_dwordx4 a[140:143], v1, s[4:7], s60 offen offset:2048 sc1
    s_add_u32 s60, s60, 4096
    buffer_load_dwordx4 a[144:147], v1, s[4:7], s60 offen offset:0 sc1
    buffer_load_dwordx4 a[148:151], v1, s[4:7], s60 offen offset:2048 sc1
    s_add_u32 s60, s60, 4096
    buffer_load_dwordx4 a[152:155], v1, s[4:7], s60 offen offset:0 sc1
    buffer_load_dwordx4 a[156:159], v1, s[4:7], s60 offen offset:2048 sc1
    s_add_u32 s60, s60, 4096
    s_waitcnt vmcnt(8)
    v_add_f32 v104, v104, v112
    v_add_f32 v105, v105, v113
    v_add_f32 v106, v106, v114
    v_add_f32 v107, v107, v115
    v_add_f32 v108, v108, v116
    v_add_f32 v109, v109, v117
    v_add_f32 v110, v110, v118
    v_add_f32 v111, v111, v119
    s_waitcnt vmcnt(7)
    v_mfma_f32_16x16x32_bf16 v[160:163], a[224:227], a[128:131], 0
    v_add_f32 v104, v104, v108
    v_add_f32 v105, v105, v109
    v_mfma_f32_16x16x32_bf16 v[164:167], a[228:231], a[128:131], 0
    v_add_f32 v106, v106, v110
    v_add_f32 v107, v107, v111
    s_waitcnt vmcnt(6)
    v_mfma_f32_16x16x32_bf16 v[160:163], a[232:235], a[132:135], v[160:163]
    v_permlane32_swap_b32 v104, v106
    v_permlane32_swap_b32 v105, v107
    v_mfma_f32_16x16x32_bf16 v[164:167], a[236:239], a[132:135], v[164:167]
    v_add_f32 v104, v104, v106
    v_add_f32 v105, v105, v107
    s_waitcnt vmcnt(5)
    v_mfma_f32_16x16x32_bf16 v[160:163], a[240:243], a[136:139], v[160:163]
    v_permlane16_swap_b32 v104, v105
    v_add_f32 v104, v104, v105
    v_mfma_f32_16x16x32_bf16 v[164:167], a[244:247], a[136:139], v[164:167]
    v_mul_f32 v104, 0x3a800000, v104
    v_mov_b32 v105, v104
    s_waitcnt vmcnt(4)
    v_mfma_f32_16x16x32_bf16 v[160:163], a[248:251], a[140:143], v[160:163]
    v_permlane32_swap_b32 v104, v105
    v_fma_f32 v105, -v104, v104, v105
    v_mfma_f32_16x16x32_bf16 v[164:167], a[252:255], a[140:143], v[164:167]
    v_max_f32 v105, 0, v105
    v_mov_b32 v106, v104
    s_waitcnt vmcnt(3)
    v_mfma_f32_16x16x32_bf16 v[160:163], v[64:67], a[144:147], v[160:163]
    v_add_f32 v105, 0x3727c5ac, v105
    v_rsq_f32 v105, v105
    v_mfma_f32_16x16x32_bf16 v[164:167], v[68:71], a[144:147], v[164:167]
    v_permlane16_swap_b32 v104, v106
    v_mov_b32 v107, v105
    s_waitcnt vmcnt(2)
    v_mfma_f32_16x16x32_bf16 v[160:163], v[72:75], a[148:151], v[160:163]
    v_cndmask_b32 v104, v104, v106, vcc
    v_permlane16_swap_b32 v105, v107
    v_mfma_f32_16x16x32_bf16 v[164:167], v[76:79], a[148:151], v[164:167]
    v_cndmask_b32 v105, v105, v107, vcc
    v_mul_f32 v104, v104, v105
    s_waitcnt vmcnt(1)
    v_mfma_f32_16x16x32_bf16 v[160:163], v[80:83], a[152:155], v[160:163]
    v_mul_f32 v168, -v104, v168
    v_mul_f32 v169, -v104, v169
    v_mfma_f32_16x16x32_bf16 v[164:167], v[84:87], a[152:155], v[164:167]
    v_mul_f32 v170, -v104, v170
    v_mul_f32 v171, -v104, v171
    s_waitcnt vmcnt(0)
    v_mfma_f32_16x16x32_bf16 v[160:163], v[88:91], a[156:159], v[160:163]
    v_mul_f32 v172, -v104, v172
    v_mul_f32 v173, -v104, v173
    v_mfma_f32_16x16x32_bf16 v[164:167], v[92:95], a[156:159], v[164:167]
    v_mul_f32 v174, -v104, v174
    v_mul_f32 v175, -v104, v175
    buffer_load_dwordx4 a[0:3], v8, s[4:7], s68 offen offset:0 sc1
    buffer_load_dwordx4 a[4:7], v8, s[4:7], s68 offen offset:1024 sc1
    buffer_load_dwordx4 a[8:11], v8, s[4:7], s68 offen offset:2048 sc1
    buffer_load_dwordx4 a[12:15], v8, s[4:7], s68 offen offset:3072 sc1
    buffer_load_dwordx4 a[16:19], v124, s[4:7], s68 offen offset:0 sc1
    buffer_load_dwordx4 a[20:23], v124, s[4:7], s68 offen offset:1024 sc1
    v_fma_f32 v160, v105, v160, v168
    v_fma_f32 v161, v105, v161, v169
    v_fma_f32 v162, v105, v162, v170
    v_fma_f32 v163, v105, v163, v171
    v_fma_f32 v164, v105, v164, v172
    v_fma_f32 v165, v105, v165, v173
    v_fma_f32 v166, v105, v166, v174
    v_fma_f32 v167, v105, v167, v175
    s_cmp_lg_u32 s51, 0
    s_cbranch_scc1 L_vwr
    ds_write_b128 v13, v[160:163] offset:0
    ds_write_b128 v13, v[164:167] offset:528
    s_branch L_kvwr
L_vwr:
    ds_write_b32 v13, v160 offset:0
    ds_write_b32 v13, v161 offset:16
    ds_write_b32 v13, v162 offset:32
    ds_write_b32 v13, v163 offset:48
    ds_write_b32 v13, v164 offset:256
    ds_write_b32 v13, v165 offset:272
    ds_write_b32 v13, v166 offset:288
    ds_write_b32 v13, v167 offset:304
L_kvwr:
    s_waitcnt lgkmcnt(0)
    s_barrier
    ds_read_b128 v[128:131], v14 offset:0
    ds_read_b128 v[132:135], v14 offset:528
    ds_read_b128 v[136:139], v14 offset:2112
    ds_read_b128 v[140:143], v14 offset:2640
    ds_read_b128 v[144:147], v14 offset:4224
    ds_read_b128 v[148:151], v14 offset:4752
    ds_read_b128 v[152:155], v14 offset:6336
    ds_read_b128 v[156:159], v14 offset:6864
    buffer_load_dwordx4 a[24:27], v124, s[4:7], s68 offen offset:2048 sc1
    buffer_load_dwordx4 a[28:31], v124, s[4:7], s68 offen offset:3072 sc1
    buffer_load_dwordx4 a[32:35], v8, s[4:7], s69 offen offset:0 sc1
    buffer_load_dwordx4 a[36:39], v8, s[4:7], s69 offen offset:1024 sc1
    s_waitcnt lgkmcnt(4)
    v_pk_add_f32 v[128:129], v[128:129], v[136:137]
    v_pk_add_f32 v[130:131], v[130:131], v[138:139]
    v_pk_add_f32 v[132:133], v[132:133], v[140:141]
    v_pk_add_f32 v[134:135], v[134:135], v[142:143]
    s_waitcnt lgkmcnt(0)
    v_pk_add_f32 v[144:145], v[144:145], v[152:153]
    v_pk_add_f32 v[146:147], v[146:147], v[154:155]
    v_pk_add_f32 v[148:149], v[148:149], v[156:157]
    v_pk_add_f32 v[150:151], v[150:151], v[158:159]
    v_pk_add_f32 v[128:129], v[128:129], v[144:145]
    v_pk_add_f32 v[130:131], v[130:131], v[146:147]
    v_pk_add_f32 v[132:133], v[132:133], v[148:149]
    v_pk_add_f32 v[134:135], v[134:135], v[150:151]
    v_cvt_pk_bf16_f32 v160, v128, v129
    v_cvt_pk_bf16_f32 v161, v130, v131
    v_cvt_pk_bf16_f32 v162, v132, v133
    v_cvt_pk_bf16_f32 v163, v134, v135
    buffer_store_dwordx4 v[160:163], v15, s[4:7], s61 offen sc1
    buffer_load_dwordx4 a[40:43], v8, s[4:7], s69 offen offset:2048 sc1
    buffer_load_dwordx4 a[44:47], v8, s[4:7], s69 offen offset:3072 sc1
    buffer_load_dwordx4 a[48:51], v124, s[4:7], s69 offen offset:0 sc1
    buffer_load_dwordx4 a[52:55], v124, s[4:7], s69 offen offset:1024 sc1
    s_cmp_lg_u32 s55, 0
    s_cbranch_scc1 L_q_nocs
    ds_read_b64_tr_b16 v[64:65], v9 offset:0
    ds_read_b64_tr_b16 v[66:67], v9 offset:2048
    ds_read_b64_tr_b16 v[68:69], v9 offset:4096
    ds_read_b64_tr_b16 v[70:71], v9 offset:6144
    ds_read_b64_tr_b16 v[72:73], v10 offset:0
    ds_read_b64_tr_b16 v[74:75], v10 offset:2048
    ds_read_b64_tr_b16 v[76:77], v10 offset:4096
    ds_read_b64_tr_b16 v[78:79], v10 offset:6144
    ds_read_b64_tr_b16 v[80:81], v11 offset:0
    ds_read_b64_tr_b16 v[82:83], v11 offset:2048
    s_waitcnt vmcnt(11) lgkmcnt(6)
    v_mfma_f32_16x16x32_bf16 v[224:227], v[64:67], a[0:3], 0
    ds_read_b64_tr_b16 v[84:85], v11 offset:4096
    v_mfma_f32_16x16x32_bf16 v[224:227], v[68:71], a[8:11], v[224:227]
    ds_read_b64_tr_b16 v[86:87], v11 offset:6144
    buffer_load_dwordx4 a[56:59], v124, s[4:7], s69 offen offset:2048 sc1
    v_mfma_f32_16x16x32_bf16 v[232:235], v[68:71], a[12:15], 0
    ds_read_b64_tr_b16 v[88:89], v12 offset:0
    v_mfma_f32_16x16x32_bf16 v[232:235], v[64:67], a[4:7], v[232:235]
    s_waitcnt lgkmcnt(5)
    ds_read_b64_tr_b16 v[90:91], v12 offset:2048
    v_mfma_f32_16x16x32_bf16 v[168:171], v[184:187], v[64:67], 0
    v_mfma_f32_16x16x32_bf16 v[168:171], v[184:187], v[68:71], v[168:171]
    buffer_load_dwordx4 v[104:107], v1, s[4:7], s80 offen offset:0 sc1
    v_mfma_f32_16x16x32_bf16 v[236:239], v[72:75], a[4:7], 0
    ds_read_b64_tr_b16 v[92:93], v12 offset:4096
    v_mfma_f32_16x16x32_bf16 v[236:239], v[76:79], a[12:15], v[236:239]
    ds_read_b64_tr_b16 v[94:95], v12 offset:6144
    buffer_load_dwordx4 a[60:63], v124, s[4:7], s69 offen offset:3072 sc1
    v_mfma_f32_16x16x32_bf16 v[228:231], v[76:79], a[8:11], 0
    ds_read_b64_tr_b16 v[64:65], v9 offset:8192
    v_mfma_f32_16x16x32_bf16 v[228:231], v[72:75], a[0:3], v[228:231]
    s_waitcnt lgkmcnt(5)
    ds_read_b64_tr_b16 v[66:67], v9 offset:10240
    v_mfma_f32_16x16x32_bf16 v[172:175], v[184:187], v[72:75], 0
    v_mfma_f32_16x16x32_bf16 v[172:175], v[184:187], v[76:79], v[172:175]
    buffer_load_dwordx4 v[108:111], v1, s[4:7], s80 offen offset:1024 sc1
    v_mfma_f32_16x16x32_bf16 v[240:243], v[80:83], a[0:3], 0
    ds_read_b64_tr_b16 v[68:69], v9 offset:12288
    v_mfma_f32_16x16x32_bf16 v[240:243], v[84:87], a[8:11], v[240:243]
    ds_read_b64_tr_b16 v[70:71], v9 offset:14336
    buffer_load_dwordx4 a[64:67], v8, s[4:7], s70 offen offset:0 sc1
    v_mfma_f32_16x16x32_bf16 v[248:251], v[84:87], a[12:15], 0
    ds_read_b64_tr_b16 v[72:73], v10 offset:8192
    v_mfma_f32_16x16x32_bf16 v[248:251], v[80:83], a[4:7], v[248:251]
    s_waitcnt lgkmcnt(5)
    ds_read_b64_tr_b16 v[74:75], v10 offset:10240
    v_mfma_f32_16x16x32_bf16 v[176:179], v[184:187], v[80:83], 0
    v_mfma_f32_16x16x32_bf16 v[176:179], v[184:187], v[84:87], v[176:179]
    buffer_load_dwordx4 v[112:115], v1, s[4:7], s80 offen offset:2048 sc1
    v_mfma_f32_16x16x32_bf16 v[252:255], v[88:91], a[4:7], 0
    ds_read_b64_tr_b16 v[76:77], v10 offset:12288
    v_mfma_f32_16x16x32_bf16 v[252:255], v[92:95], a[12:15], v[252:255]
    ds_read_b64_tr_b16 v[78:79], v10 offset:14336
    buffer_load_dwordx4 a[68:71], v8, s[4:7], s70 offen offset:1024 sc1
    v_mfma_f32_16x16x32_bf16 v[244:247], v[92:95], a[8:11], 0
    ds_read_b64_tr_b16 v[80:81], v11 offset:8192
    v_mfma_f32_16x16x32_bf16 v[244:247], v[88:91], a[0:3], v[244:247]
    s_waitcnt vmcnt(14) lgkmcnt(5)
    ds_read_b64_tr_b16 v[82:83], v11 offset:10240
    v_mfma_f32_16x16x32_bf16 v[180:183], v[184:187], v[88:91], 0
L_hop0:
    s_cbranch_execz L_hop4
    v_mfma_f32_16x16x32_bf16 v[180:183], v[184:187], v[92:95], v[180:183]
    buffer_load_dwordx4 v[116:119], v1, s[4:7], s80 offen offset:3072 sc1
    v_mfma_f32_16x16x32_bf16 v[224:227], v[64:67], a[16:19], v[224:227]
    ds_read_b64_tr_b16 v[84:85], v11 offset:12288
    v_mov_b32 v128, 0
    v_mfma_f32_16x16x32_bf16 v[224:227], v[68:71], a[24:27], v[224:227]
    ds_read_b64_tr_b16 v[86:87], v11 offset:14336
    buffer_load_dwordx4 a[72:75], v8, s[4:7], s70 offen offset:2048 sc1
    v_mfma_f32_16x16x32_bf16 v[232:235], v[68:71], a[28:31], v[232:235]
    ds_read_b64_tr_b16 v[88:89], v12 offset:8192
    v_mov_b32 v129, 0
    v_mfma_f32_16x16x32_bf16 v[232:235], v[64:67], a[20:23], v[232:235]
    s_waitcnt lgkmcnt(5)
    ds_read_b64_tr_b16 v[90:91], v12 offset:10240
    v_mfma_f32_16x16x32_bf16 v[168:171], v[184:187], v[64:67], v[168:171]
    v_mfma_f32_16x16x32_bf16 v[168:171], v[184:187], v[68:71], v[168:171]
    v_mov_b32 v130, 0
    v_mfma_f32_16x16x32_bf16 v[236:239], v[72:75], a[20:23], v[236:239]
    ds_read_b64_tr_b16 v[92:93], v12 offset:12288
    v_mov_b32 v131, 0
    v_mfma_f32_16x16x32_bf16 v[236:239], v[76:79], a[28:31], v[236:239]
    ds_read_b64_tr_b16 v[94:95], v12 offset:14336
    buffer_load_dwordx4 a[76:79], v8, s[4:7], s70 offen offset:3072 sc1
    v_mfma_f32_16x16x32_bf16 v[228:231], v[76:79], a[24:27], v[228:231]
    ds_read_b64_tr_b16 v[64:65], v9 offset:16384
    v_mov_b32 v132, 0
    v_mfma_f32_16x16x32_bf16 v[228:231], v[72:75], a[16:19], v[228:231]
    s_waitcnt lgkmcnt(5)
    ds_read_b64_tr_b16 v[66:67], v9 offset:18432
    v_mfma_f32_16x16x32_bf16 v[172:175], v[184:187], v[72:75], v[172:175]
    v_mfma_f32_16x16x32_bf16 v[172:175], v[184:187], v[76:79], v[172:175]
    v_mov_b32 v133, 0
    v_mfma_f32_16x16x32_bf16 v[240:243], v[80:83], a[16:19], v[240:243]
    ds_read_b64_tr_b16 v[68:69], v9 offset:20480
    s_waitcnt vmcnt(14)
    s_atomic_add s79, s[4:5], s76 glc
    v_mfma_f32_16x16x32_bf16 v[240:243], v[84:87], a[24:27], v[240:243]
    ds_read_b64_tr_b16 v[70:71], v9 offset:22528
    buffer_load_dwordx4 a[80:83], v124, s[4:7], s70 offen offset:0 sc1
    v_mfma_f32_16x16x32_bf16 v[248:251], v[84:87], a[28:31], v[248:251]
    ds_read_b64_tr_b16 v[72:73], v10 offset:16384
    v_mov_b32 v134, 0
    v_mfma_f32_16x16x32_bf16 v[248:251], v[80:83], a[20:23], v[248:251]
    s_waitcnt lgkmcnt(5)
    ds_read_b64_tr_b16 v[74:75], v10 offset:18432
    v_mfma_f32_16x16x32_bf16 v[176:179], v[184:187], v[80:83], v[176:179]
    v_mfma_f32_16x16x32_bf16 v[176:179], v[184:187], v[84:87], v[176:179]
    v_mov_b32 v135, 0
    v_mfma_f32_16x16x32_bf16 v[252:255], v[88:91], a[20:23], v[252:255]
    ds_read_b64_tr_b16 v[76:77], v10 offset:20480
    v_mov_b32 v136, 0
    v_mfma_f32_16x16x32_bf16 v[252:255], v[92:95], a[28:31], v[252:255]
    ds_read_b64_tr_b16 v[78:79], v10 offset:22528
    buffer_load_dwordx4 a[84:87], v124, s[4:7], s70 offen offset:1024 sc1
    v_mfma_f32_16x16x32_bf16 v[244:247], v[92:95], a[24:27], v[244:247]
    ds_read_b64_tr_b16 v[80:81], v11 offset:16384
    v_mov_b32 v137, 0
    v_mfma_f32_16x16x32_bf16 v[244:247], v[88:91], a[16:19], v[244:247]
    s_waitcnt vmcnt(14) lgkmcnt(5)
    ds_read_b64_tr_b16 v[82:83], v11 offset:18432
    v_mfma_f32_16x16x32_bf16 v[180:183], v[184:187], v[88:91], v[180:183]
    v_mfma_f32_16x16x32_bf16 v[180:183], v[184:187], v[92:95], v[180:183]
    v_mov_b32 v138, 0
    v_mfma_f32_16x16x32_bf16 v[224:227], v[64:67], a[32:35], v[224:227]
    ds_read_b64_tr_b16 v[84:85], v11 offset:20480
    v_mov_b32 v139, 0
    v_mfma_f32_16x16x32_bf16 v[224:227], v[68:71], a[40:43], v[224:227]
    ds_read_b64_tr_b16 v[86:87], v11 offset:22528
    buffer_load_dwordx4 a[88:91], v124, s[4:7], s70 offen offset:2048 sc1
    v_mfma_f32_16x16x32_bf16 v[232:235], v[68:71], a[44:47], v[232:235]
    ds_read_b64_tr_b16 v[88:89], v12 offset:16384
    v_mov_b32 v140, 0
    v_mfma_f32_16x16x32_bf16 v[232:235], v[64:67], a[36:39], v[232:235]
    s_waitcnt lgkmcnt(5)
    ds_read_b64_tr_b16 v[90:91], v12 offset:18432
    v_mfma_f32_16x16x32_bf16 v[168:171], v[184:187], v[64:67], v[168:171]
    v_mfma_f32_16x16x32_bf16 v[168:171], v[184:187], v[68:71], v[168:171]
    v_mov_b32 v141, 0
    v_mfma_f32_16x16x32_bf16 v[236:239], v[72:75], a[36:39], v[236:239]
    ds_read_b64_tr_b16 v[92:93], v12 offset:20480
    v_mov_b32 v142, 0
    v_mfma_f32_16x16x32_bf16 v[236:239], v[76:79], a[44:47], v[236:239]
    ds_read_b64_tr_b16 v[94:95], v12 offset:22528
    buffer_load_dwordx4 a[92:95], v124, s[4:7], s70 offen offset:3072 sc1
    v_mfma_f32_16x16x32_bf16 v[228:231], v[76:79], a[40:43], v[228:231]
    ds_read_b64_tr_b16 v[64:65], v9 offset:24576
    v_mov_b32 v143, 0
    v_mfma_f32_16x16x32_bf16 v[228:231], v[72:75], a[32:35], v[228:231]
    s_waitcnt lgkmcnt(5)
    ds_read_b64_tr_b16 v[66:67], v9 offset:26624
    v_mfma_f32_16x16x32_bf16 v[172:175], v[184:187], v[72:75], v[172:175]
    v_mfma_f32_16x16x32_bf16 v[172:175], v[184:187], v[76:79], v[172:175]
    v_mov_b32 v144, 0
    v_mfma_f32_16x16x32_bf16 v[240:243], v[80:83], a[32:35], v[240:243]
    ds_read_b64_tr_b16 v[68:69], v9 offset:28672
    v_mov_b32 v145, 0
    v_mfma_f32_16x16x32_bf16 v[240:243], v[84:87], a[40:43], v[240:243]
    ds_read_b64_tr_b16 v[70:71], v9 offset:30720
    buffer_load_dwordx4 a[96:99], v8, s[4:7], s71 offen offset:0 sc1
    v_mfma_f32_16x16x32_bf16 v[248:251], v[84:87], a[44:47], v[248:251]
    ds_read_b64_tr_b16 v[72:73], v10 offset:24576
    v_mov_b32 v146, 0
    v_mfma_f32_16x16x32_bf16 v[248:251], v[80:83], a[36:39], v[248:251]
    s_waitcnt lgkmcnt(5)
    ds_read_b64_tr_b16 v[74:75], v10 offset:26624
    v_mfma_f32_16x16x32_bf16 v[176:179], v[184:187], v[80:83], v[176:179]
    v_mfma_f32_16x16x32_bf16 v[176:179], v[184:187], v[84:87], v[176:179]
    v_mov_b32 v147, 0
    v_mfma_f32_16x16x32_bf16 v[252:255], v[88:91], a[36:39], v[252:255]
    ds_read_b64_tr_b16 v[76:77], v10 offset:28672
    v_mov_b32 v148, 0
    v_mfma_f32_16x16x32_bf16 v[252:255], v[92:95], a[44:47], v[252:255]
    ds_read_b64_tr_b16 v[78:79], v10 offset:30720
    buffer_load_dwordx4 a[100:103], v8, s[4:7], s71 offen offset:1024 sc1
    v_mfma_f32_16x16x32_bf16 v[244:247], v[92:95], a[40:43], v[244:247]
    ds_read_b64_tr_b16 v[80:81], v11 offset:24576
    v_mov_b32 v149, 0
    v_mfma_f32_16x16x32_bf16 v[244:247], v[88:91], a[32:35], v[244:247]
    s_waitcnt vmcnt(13) lgkmcnt(5)
    ds_read_b64_tr_b16 v[82:83], v11 offset:26624
    v_mfma_f32_16x16x32_bf16 v[180:183], v[184:187], v[88:91], v[180:183]
    v_mfma_f32_16x16x32_bf16 v[180:183], v[184:187], v[92:95], v[180:183]
    v_mov_b32 v150, 0
    v_mfma_f32_16x16x32_bf16 v[224:227], v[64:67], a[48:51], v[224:227]
    ds_read_b64_tr_b16 v[84:85], v11 offset:28672
    v_mov_b32 v151, 0
    v_mfma_f32_16x16x32_bf16 v[224:227], v[68:71], a[56:59], v[224:227]
    ds_read_b64_tr_b16 v[86:87], v11 offset:30720
    buffer_load_dwordx4 a[104:107], v8, s[4:7], s71 offen offset:2048 sc1
    v_mfma_f32_16x16x32_bf16 v[232:235], v[68:71], a[60:63], v[232:235]
    ds_read_b64_tr_b16 v[88:89], v12 offset:24576
    v_mov_b32 v152, 0
    v_mfma_f32_16x16x32_bf16 v[232:235], v[64:67], a[52:55], v[232:235]
    s_waitcnt lgkmcnt(5)
    ds_read_b64_tr_b16 v[90:91], v12 offset:26624
    v_mfma_f32_16x16x32_bf16 v[168:171], v[184:187], v[64:67], v[168:171]
    v_mfma_f32_16x16x32_bf16 v[168:171], v[184:187], v[68:71], v[168:171]
    v_mov_b32 v153, 0
    v_mfma_f32_16x16x32_bf16 v[236:239], v[72:75], a[52:55], v[236:239]
    ds_read_b64_tr_b16 v[92:93], v12 offset:28672
    v_xor_b32 v9, 32768, v9
    v_mfma_f32_16x16x32_bf16 v[236:239], v[76:79], a[60:63], v[236:239]
    ds_read_b64_tr_b16 v[94:95], v12 offset:30720
    buffer_load_dwordx4 a[108:111], v8, s[4:7], s71 offen offset:3072 sc1
    v_mfma_f32_16x16x32_bf16 v[228:231], v[76:79], a[56:59], v[228:231]
    ds_read_b64_tr_b16 v[64:65], v9 offset:0
    v_mov_b32 v154, 0
    v_mfma_f32_16x16x32_bf16 v[228:231], v[72:75], a[48:51], v[228:231]
    s_waitcnt lgkmcnt(5)
    ds_read_b64_tr_b16 v[66:67], v9 offset:2048
    v_mfma_f32_16x16x32_bf16 v[172:175], v[184:187], v[72:75], v[172:175]
    v_mfma_f32_16x16x32_bf16 v[172:175], v[184:187], v[76:79], v[172:175]
    v_mov_b32 v155, 0
    v_mfma_f32_16x16x32_bf16 v[240:243], v[80:83], a[48:51], v[240:243]
    ds_read_b64_tr_b16 v[68:69], v9 offset:4096
    v_xor_b32 v10, 32768, v10
    v_mfma_f32_16x16x32_bf16 v[240:243], v[84:87], a[56:59], v[240:243]
    ds_read_b64_tr_b16 v[70:71], v9 offset:6144
    buffer_load_dwordx4 a[112:115], v124, s[4:7], s71 offen offset:0 sc1
    v_mfma_f32_16x16x32_bf16 v[248:251], v[84:87], a[60:63], v[248:251]
    ds_read_b64_tr_b16 v[72:73], v10 offset:0
    v_mov_b32 v156, 0
    v_mfma_f32_16x16x32_bf16 v[248:251], v[80:83], a[52:55], v[248:251]
    s_waitcnt lgkmcnt(5)
    ds_read_b64_tr_b16 v[74:75], v10 offset:2048
    v_mfma_f32_16x16x32_bf16 v[176:179], v[184:187], v[80:83], v[176:179]
    v_mfma_f32_16x16x32_bf16 v[176:179], v[184:187], v[84:87], v[176:179]
    v_mov_b32 v157, 0
    v_mfma_f32_16x16x32_bf16 v[252:255], v[88:91], a[52:55], v[252:255]
    ds_read_b64_tr_b16 v[76:77], v10 offset:4096
    v_xor_b32 v11, 32768, v11
    v_mfma_f32_16x16x32_bf16 v[252:255], v[92:95], a[60:63], v[252:255]
    ds_read_b64_tr_b16 v[78:79], v10 offset:6144
    buffer_load_dwordx4 a[116:119], v124, s[4:7], s71 offen offset:1024 sc1
    v_mfma_f32_16x16x32_bf16 v[244:247], v[92:95], a[56:59], v[244:247]
    ds_read_b64_tr_b16 v[80:81], v11 offset:0
    s_bitcmp1_b32 0x8002, s79
    s_cbranch_scc1 L_slow_3
L_back_4:
    v_mfma_f32_16x16x32_bf16 v[244:247], v[88:91], a[48:51], v[244:247]
    s_waitcnt vmcnt(10) lgkmcnt(5)
    ds_read_b64_tr_b16 v[82:83], v11 offset:2048
    v_mfma_f32_16x16x32_bf16 v[180:183], v[184:187], v[88:91], v[180:183]
    v_mfma_f32_16x16x32_bf16 v[180:183], v[184:187], v[92:95], v[180:183]
    v_mov_b32 v158, 0
    v_permlane16_swap_b32 v168, v172
    s_nop 5
    v_permlane16_swap_b32 v176, v180
    s_nop 1
    v_permlane32_swap_b32 v168, v176
    s_lshr_b32 s61, s96, 4
    s_add_u32 s61, s61, 156672
    v_add_u32 v169, s61, v2
    ds_write_b32 v169, v168
    s_waitcnt lgkmcnt(0)
    s_branch L_q_rest
L_q_nocs:
L_hop1:
    s_cbranch_execz L_hop5
    ds_read_b64_tr_b16 v[64:65], v9 offset:0
    ds_read_b64_tr_b16 v[66:67], v9 offset:2048
    ds_read_b64_tr_b16 v[68:69], v9 offset:4096
    ds_read_b64_tr_b16 v[70:71], v9 offset:6144
    ds_read_b64_tr_b16 v[72:73], v10 offset:0
    ds_read_b64_tr_b16 v[74:75], v10 offset:2048
    ds_read_b64_tr_b16 v[76:77], v10 offset:4096
    ds_read_b64_tr_b16 v[78:79], v10 offset:6144
    ds_read_b64_tr_b16 v[80:81], v11 offset:0
    ds_read_b64_tr_b16 v[82:83], v11 offset:2048
    s_waitcnt vmcnt(11) lgkmcnt(6)
    v_mfma_f32_16x16x32_bf16 v[224:227], v[64:67], a[0:3], 0
    ds_read_b64_tr_b16 v[84:85], v11 offset:4096
    v_mfma_f32_16x16x32_bf16 v[224:227], v[68:71], a[8:11], v[224:227]
    ds_read_b64_tr_b16 v[86:87], v11 offset:6144
    buffer_load_dwordx4 a[56:59], v124, s[4:7], s69 offen offset:2048 sc1
    v_mfma_f32_16x16x32_bf16 v[232:235], v[68:71], a[12:15], 0
    ds_read_b64_tr_b16 v[88:89], v12 offset:0
    v_mfma_f32_16x16x32_bf16 v[232:235], v[64:67], a[4:7], v[232:235]
    s_waitcnt lgkmcnt(5)
    ds_read_b64_tr_b16 v[90:91], v12 offset:2048
    buffer_load_dwordx4 v[104:107], v1, s[4:7], s80 offen offset:0 sc1
    v_mfma_f32_16x16x32_bf16 v[236:239], v[72:75], a[4:7], 0
    ds_read_b64_tr_b16 v[92:93], v12 offset:4096
    v_mfma_f32_16x16x32_bf16 v[236:239], v[76:79], a[12:15], v[236:239]
    ds_read_b64_tr_b16 v[94:95], v12 offset:6144
    buffer_load_dwordx4 a[60:63], v124, s[4:7], s69 offen offset:3072 sc1
    v_mfma_f32_16x16x32_bf16 v[228:231], v[76:79], a[8:11], 0
    ds_read_b64_tr_b16 v[64:65], v9 offset:8192
    v_mfma_f32_16x16x32_bf16 v[228:231], v[72:75], a[0:3], v[228:231]
    s_waitcnt lgkmcnt(5)
    ds_read_b64_tr_b16 v[66:67], v9 offset:10240
    buffer_load_dwordx4 v[108:111], v1, s[4:7], s80 offen offset:1024 sc1
    v_mfma_f32_16x16x32_bf16 v[240:243], v[80:83], a[0:3], 0
    ds_read_b64_tr_b16 v[68:69], v9 offset:12288
    v_mfma_f32_16x16x32_bf16 v[240:243], v[84:87], a[8:11], v[240:243]
    ds_read_b64_tr_b16 v[70:71], v9 offset:14336
    buffer_load_dwordx4 a[64:67], v8, s[4:7], s70 offen offset:0 sc1
    v_mfma_f32_16x16x32_bf16 v[248:251], v[84:87], a[12:15], 0
    ds_read_b64_tr_b16 v[72:73], v10 offset:8192
    v_mfma_f32_16x16x32_bf16 v[248:251], v[80:83], a[4:7], v[248:251]
    s_waitcnt lgkmcnt(5)
    ds_read_b64_tr_b16 v[74:75], v10 offset:10240
    buffer_load_dwordx4 v[112:115], v1, s[4:7], s80 offen offset:2048 sc1
    v_mfma_f32_16x16x32_bf16 v[252:255], v[88:91], a[4:7], 0
    ds_read_b64_tr_b16 v[76:77], v10 offset:12288
    v_mfma_f32_16x16x32_bf16 v[252:255], v[92:95], a[12:15], v[252:255]
    ds_read_b64_tr_b16 v[78:79], v10 offset:14336
    buffer_load_dwordx4 a[68:71], v8, s[4:7], s70 offen offset:1024 sc1
    v_mfma_f32_16x16x32_bf16 v[244:247], v[92:95], a[8:11], 0
    ds_read_b64_tr_b16 v[80:81], v11 offset:8192
    v_mfma_f32_16x16x32_bf16 v[244:247], v[88:91], a[0:3], v[244:247]
    s_waitcnt vmcnt(14) lgkmcnt(5)
    ds_read_b64_tr_b16 v[82:83], v11 offset:10240
    buffer_load_dwordx4 v[116:119], v1, s[4:7], s80 offen offset:3072 sc1
    v_mfma_f32_16x16x32_bf16 v[224:227], v[64:67], a[16:19], v[224:227]
    ds_read_b64_tr_b16 v[84:85], v11 offset:12288
    v_mov_b32 v128, 0
    v_mfma_f32_16x16x32_bf16 v[224:227], v[68:71], a[24:27], v[224:227]
    ds_read_b64_tr_b16 v[86:87], v11 offset:14336
    buffer_load_dwordx4 a[72:75], v8, s[4:7], s70 offen offset:2048 sc1
    v_mfma_f32_16x16x32_bf16 v[232:235], v[68:71], a[28:31], v[232:235]
    ds_read_b64_tr_b16 v[88:89], v12 offset:8192
    v_mov_b32 v129, 0
    v_mfma_f32_16x16x32_bf16 v[232:235], v[64:67], a[20:23], v[232:235]
    s_waitcnt lgkmcnt(5)
    ds_read_b64_tr_b16 v[90:91], v12 offset:10240
    v_mov_b32 v130, 0
    v_mfma_f32_16x16x32_bf16 v[236:239], v[72:75], a[20:23], v[236:239]
    ds_read_b64_tr_b16 v[92:93], v12 offset:12288
    v_mov_b32 v131, 0
    v_mfma_f32_16x16x32_bf16 v[236:239], v[76:79], a[28:31], v[236:239]
    ds_read_b64_tr_b16 v[94:95], v12 offset:14336
    buffer_load_dwordx4 a[76:79], v8, s[4:7], s70 offen offset:3072 sc1
    v_mfma_f32_16x16x32_bf16 v[228:231], v[76:79], a[24:27], v[228:231]
    ds_read_b64_tr_b16 v[64:65], v9 offset:16384
    v_mov_b32 v132, 0
    v_mfma_f32_16x16x32_bf16 v[228:231], v[72:75], a[16:19], v[228:231]
    s_waitcnt lgkmcnt(5)
    ds_read_b64_tr_b16 v[66:67], v9 offset:18432
    v_mov_b32 v133, 0
    v_mfma_f32_16x16x32_bf16 v[240:243], v[80:83], a[16:19], v[240:243]
    ds_read_b64_tr_b16 v[68:69], v9 offset:20480
    s_waitcnt vmcnt(14)
    s_atomic_add s79, s[4:5], s76 glc
    v_mfma_f32_16x16x32_bf16 v[240:243], v[84:87], a[24:27], v[240:243]
    ds_read_b64_tr_b16 v[70:71], v9 offset:22528
    buffer_load_dwordx4 a[80:83], v124, s[4:7], s70 offen offset:0 sc1
    v_mfma_f32_16x16x32_bf16 v[248:251], v[84:87], a[28:31], v[248:251]
    ds_read_b64_tr_b16 v[72:73], v10 offset:16384
    v_mov_b32 v134, 0
    v_mfma_f32_16x16x32_bf16 v[248:251], v[80:83], a[20:23], v[248:251]
    s_waitcnt lgkmcnt(5)
    ds_read_b64_tr_b16 v[74:75], v10 offset:18432
    v_mov_b32 v135, 0
    v_mfma_f32_16x16x32_bf16 v[252:255], v[88:91], a[20:23], v[252:255]
    ds_read_b64_tr_b16 v[76:77], v10 offset:20480
    v_mov_b32 v136, 0
    v_mfma_f32_16x16x32_bf16 v[252:255], v[92:95], a[28:31], v[252:255]
    ds_read_b64_tr_b16 v[78:79], v10 offset:22528
    buffer_load_dwordx4 a[84:87], v124, s[4:7], s70 offen offset:1024 sc1
    v_mfma_f32_16x16x32_bf16 v[244:247], v[92:95], a[24:27], v[244:247]
    ds_read_b64_tr_b16 v[80:81], v11 offset:16384
    v_mov_b32 v137, 0
    v_mfma_f32_16x16x32_bf16 v[244:247], v[88:91], a[16:19], v[244:247]
    s_waitcnt vmcnt(14) lgkmcnt(5)
    ds_read_b64_tr_b16 v[82:83], v11 offset:18432
    v_mov_b32 v138, 0
    v_mfma_f32_16x16x32_bf16 v[224:227], v[64:67], a[32:35], v[224:227]
    ds_read_b64_tr_b16 v[84:85], v11 offset:20480
    v_mov_b32 v139, 0
    v_mfma_f32_16x16x32_bf16 v[224:227], v[68:71], a[40:43], v[224:227]
    ds_read_b64_tr_b16 v[86:87], v11 offset:22528
    buffer_load_dwordx4 a[88:91], v124, s[4:7], s70 offen offset:2048 sc1
    v_mfma_f32_16x16x32_bf16 v[232:235], v[68:71], a[44:47], v[232:235]
    ds_read_b64_tr_b16 v[88:89], v12 offset:16384
    v_mov_b32 v140, 0
    v_mfma_f32_16x16x32_bf16 v[232:235], v[64:67], a[36:39], v[232:235]
    s_waitcnt lgkmcnt(5)
    ds_read_b64_tr_b16 v[90:91], v12 offset:18432
    v_mov_b32 v141, 0
    v_mfma_f32_16x16x32_bf16 v[236:239], v[72:75], a[36:39], v[236:239]
    ds_read_b64_tr_b16 v[92:93], v12 offset:20480
    v_mov_b32 v142, 0
    v_mfma_f32_16x16x32_bf16 v[236:239], v[76:79], a[44:47], v[236:239]
    ds_read_b64_tr_b16 v[94:95], v12 offset:22528
    buffer_load_dwordx4 a[92:95], v124, s[4:7], s70 offen offset:3072 sc1
    v_mfma_f32_16x16x32_bf16 v[228:231], v[76:79], a[40:43], v[228:231]
    ds_read_b64_tr_b16 v[64:65], v9 offset:24576
    v_mov_b32 v143, 0
    v_mfma_f32_16x16x32_bf16 v[228:231], v[72:75], a[32:35], v[228:231]
    s_waitcnt lgkmcnt(5)
    ds_read_b64_tr_b16 v[66:67], v9 offset:26624
    v_mov_b32 v144, 0
    v_mfma_f32_16x16x32_bf16 v[240:243], v[80:83], a[32:35], v[240:243]
    ds_read_b64_tr_b16 v[68:69], v9 offset:28672
    v_mov_b32 v145, 0
    v_mfma_f32_16x16x32_bf16 v[240:243], v[84:87], a[40:43], v[240:243]
    ds_read_b64_tr_b16 v[70:71], v9 offset:30720
    buffer_load_dwordx4 a[96:99], v8, s[4:7], s71 offen offset:0 sc1
    v_mfma_f32_16x16x32_bf16 v[248:251], v[84:87], a[44:47], v[248:251]
    ds_read_b64_tr_b16 v[72:73], v10 offset:24576
    v_mov_b32 v146, 0
    v_mfma_f32_16x16x32_bf16 v[248:251], v[80:83], a[36:39], v[248:251]
    s_waitcnt lgkmcnt(5)
    ds_read_b64_tr_b16 v[74:75], v10 offset:26624
    v_mov_b32 v147, 0
    v_mfma_f32_16x16x32_bf16 v[252:255], v[88:91], a[36:39], v[252:255]
    ds_read_b64_tr_b16 v[76:77], v10 offset:28672
    v_mov_b32 v148, 0
    v_mfma_f32_16x16x32_bf16 v[252:255], v[92:95], a[44:47], v[252:255]
    ds_read_b64_tr_b16 v[78:79], v10 offset:30720
    buffer_load_dwordx4 a[100:103], v8, s[4:7], s71 offen offset:1024 sc1
    v_mfma_f32_16x16x32_bf16 v[244:247], v[92:95], a[40:43], v[244:247]
    ds_read_b64_tr_b16 v[80:81], v11 offset:24576
    v_mov_b32 v149, 0
    v_mfma_f32_16x16x32_bf16 v[244:247], v[88:91], a[32:35], v[244:247]
    s_waitcnt vmcnt(13) lgkmcnt(5)
    ds_read_b64_tr_b16 v[82:83], v11 offset:26624
    v_mov_b32 v150, 0
    v_mfma_f32_16x16x32_bf16 v[224:227], v[64:67], a[48:51], v[224:227]
    ds_read_b64_tr_b16 v[84:85], v11 offset:28672
    v_mov_b32 v151, 0
    v_mfma_f32_16x16x32_bf16 v[224:227], v[68:71], a[56:59], v[224:227]
    ds_read_b64_tr_b16 v[86:87], v11 offset:30720
    buffer_load_dwordx4 a[104:107], v8, s[4:7], s71 offen offset:2048 sc1
    v_mfma_f32_16x16x32_bf16 v[232:235], v[68:71], a[60:63], v[232:235]
    ds_read_b64_tr_b16 v[88:89], v12 offset:24576
    v_mov_b32 v152, 0
    v_mfma_f32_16x16x32_bf16 v[232:235], v[64:67], a[52:55], v[232:235]
    s_waitcnt lgkmcnt(5)
    ds_read_b64_tr_b16 v[90:91], v12 offset:26624
    v_mov_b32 v153, 0
    v_mfma_f32_16x16x32_bf16 v[236:239], v[72:75], a[52:55], v[236:239]
    ds_read_b64_tr_b16 v[92:93], v12 offset:28672
    v_xor_b32 v9, 32768, v9
    v_mfma_f32_16x16x32_bf16 v[236:239], v[76:79], a[60:63], v[236:239]
    ds_read_b64_tr_b16 v[94:95], v12 offset:30720
    buffer_load_dwordx4 a[108:111], v8, s[4:7], s71 offen offset:3072 sc1
    v_mfma_f32_16x16x32_bf16 v[228:231], v[76:79], a[56:59], v[228:231]
    ds_read_b64_tr_b16 v[64:65], v9 offset:0
    v_mov_b32 v154, 0
    v_mfma_f32_16x16x32_bf16 v[228:231], v[72:75], a[48:51], v[228:231]
    s_waitcnt lgkmcnt(5)
    ds_read_b64_tr_b16 v[66:67], v9 offset:2048
    v_mov_b32 v155, 0
    v_mfma_f32_16x16x32_bf16 v[240:243], v[80:83], a[48:51], v[240:243]
    ds_read_b64_tr_b16 v[68:69], v9 offset:4096
    v_xor_b32 v10, 32768, v10
    v_mfma_f32_16x16x32_bf16 v[240:243], v[84:87], a[56:59], v[240:243]
    ds_read_b64_tr_b16 v[70:71], v9 offset:6144
    buffer_load_dwordx4 a[112:115], v124, s[4:7], s71 offen offset:0 sc1
    v_mfma_f32_16x16x32_bf16 v[248:251], v[84:87], a[60:63], v[248:251]
    ds_read_b64_tr_b16 v[72:73], v10 offset:0
    v_mov_b32 v156, 0
    v_mfma_f32_16x16x32_bf16 v[248:251], v[80:83], a[52:55], v[248:251]
    s_waitcnt lgkmcnt(5)
    ds_read_b64_tr_b16 v[74:75], v10 offset:2048
    v_mov_b32 v157, 0
    v_mfma_f32_16x16x32_bf16 v[252:255], v[88:91], a[52:55], v[252:255]
    ds_read_b64_tr_b16 v[76:77], v10 offset:4096
    v_xor_b32 v11, 32768, v11
    v_mfma_f32_16x16x32_bf16 v[252:255], v[92:95], a[60:63], v[252:255]
    ds_read_b64_tr_b16 v[78:79], v10 offset:6144
    buffer_load_dwordx4 a[116:119], v124, s[4:7], s71 offen offset:1024 sc1
    v_mfma_f32_16x16x32_bf16 v[244:247], v[92:95], a[56:59], v[244:247]
    ds_read_b64_tr_b16 v[80:81], v11 offset:0
    s_bitcmp1_b32 0x8002, s79
    s_cbranch_scc1 L_slow_5
L_back_6:
    v_mfma_f32_16x16x32_bf16 v[244:247], v[88:91], a[48:51], v[244:247]
    s_waitcnt vmcnt(10) lgkmcnt(5)
    ds_read_b64_tr_b16 v[82:83], v11 offset:2048
    v_mov_b32 v158, 0
L_q_rest:
L_hop2:
    s_cbranch_execz L_hop6
    v_mfma_f32_16x16x32_bf16 v[224:227], v[64:67], a[64:67], v[224:227]
    ds_read_b64_tr_b16 v[84:85], v11 offset:4096
    v_xor_b32 v12, 32768, v12
    v_mfma_f32_16x16x32_bf16 v[224:227], v[68:71], a[72:75], v[224:227]
    ds_read_b64_tr_b16 v[86:87], v11 offset:6144
    buffer_load_dwordx4 a[120:123], v124, s[4:7], s71 offen offset:2048 sc1
    v_mfma_f32_16x16x32_bf16 v[232:235], v[68:71], a[76:79], v[232:235]
    ds_read_b64_tr_b16 v[88:89], v12 offset:0
    v_mov_b32 v159, 0
    v_mfma_f32_16x16x32_bf16 v[232:235], v[64:67], a[68:71], v[232:235]
    s_waitcnt lgkmcnt(5)
    ds_read_b64_tr_b16 v[90:91], v12 offset:2048
    v_mov_b32 v160, 0
    v_mfma_f32_16x16x32_bf16 v[236:239], v[72:75], a[68:71], v[236:239]
    ds_read_b64_tr_b16 v[92:93], v12 offset:4096
    v_mov_b32 v161, 0
    v_mfma_f32_16x16x32_bf16 v[236:239], v[76:79], a[76:79], v[236:239]
    ds_read_b64_tr_b16 v[94:95], v12 offset:6144
    buffer_load_dwordx4 a[124:127], v124, s[4:7], s71 offen offset:3072 sc1
    v_mfma_f32_16x16x32_bf16 v[228:231], v[76:79], a[72:75], v[228:231]
    ds_read_b64_tr_b16 v[64:65], v9 offset:8192
    v_mov_b32 v162, 0
    v_mfma_f32_16x16x32_bf16 v[228:231], v[72:75], a[64:67], v[228:231]
    s_waitcnt lgkmcnt(5)
    ds_read_b64_tr_b16 v[66:67], v9 offset:10240
    v_mov_b32 v163, 0
    v_mfma_f32_16x16x32_bf16 v[240:243], v[80:83], a[64:67], v[240:243]
    ds_read_b64_tr_b16 v[68:69], v9 offset:12288
    v_mov_b32 v164, 0
    v_mfma_f32_16x16x32_bf16 v[240:243], v[84:87], a[72:75], v[240:243]
    ds_read_b64_tr_b16 v[70:71], v9 offset:14336
    buffer_load_dwordx4 a[0:3], v8, s[4:7], s72 offen offset:0 sc1
    v_mfma_f32_16x16x32_bf16 v[248:251], v[84:87], a[76:79], v[248:251]
    ds_read_b64_tr_b16 v[72:73], v10 offset:8192
    v_mov_b32 v165, 0
    v_mfma_f32_16x16x32_bf16 v[248:251], v[80:83], a[68:71], v[248:251]
    s_waitcnt lgkmcnt(5)
    ds_read_b64_tr_b16 v[74:75], v10 offset:10240
    v_mov_b32 v166, 0
    v_mfma_f32_16x16x32_bf16 v[252:255], v[88:91], a[68:71], v[252:255]
    ds_read_b64_tr_b16 v[76:77], v10 offset:12288
    v_mov_b32 v167, 0
    v_mfma_f32_16x16x32_bf16 v[252:255], v[92:95], a[76:79], v[252:255]
    ds_read_b64_tr_b16 v[78:79], v10 offset:14336
    buffer_load_dwordx4 a[4:7], v8, s[4:7], s72 offen offset:1024 sc1
    v_mfma_f32_16x16x32_bf16 v[244:247], v[92:95], a[72:75], v[244:247]
    ds_read_b64_tr_b16 v[80:81], v11 offset:8192
    v_and_b32 v7, 7, v0
    v_mfma_f32_16x16x32_bf16 v[244:247], v[88:91], a[64:67], v[244:247]
    s_waitcnt vmcnt(10) lgkmcnt(5)
    ds_read_b64_tr_b16 v[82:83], v11 offset:10240
    v_cmp_eq_u32 vcc, 0, v7
    v_mfma_f32_16x16x32_bf16 v[224:227], v[64:67], a[80:83], v[224:227]
    ds_read_b64_tr_b16 v[84:85], v11 offset:12288
    v_mov_b32 v15, 0xdddd
    v_mfma_f32_16x16x32_bf16 v[224:227], v[68:71], a[88:91], v[224:227]
    ds_read_b64_tr_b16 v[86:87], v11 offset:14336
    buffer_load_dwordx4 a[8:11], v8, s[4:7], s72 offen offset:2048 sc1
    v_mfma_f32_16x16x32_bf16 v[232:235], v[68:71], a[92:95], v[232:235]
    ds_read_b64_tr_b16 v[88:89], v12 offset:8192
    v_cndmask_b32 v188, 0, v184, vcc
    v_mfma_f32_16x16x32_bf16 v[232:235], v[64:67], a[84:87], v[232:235]
    s_waitcnt lgkmcnt(5)
    ds_read_b64_tr_b16 v[90:91], v12 offset:10240
    v_cndmask_b32 v189, 0, v184, vcc
    v_mfma_f32_16x16x32_bf16 v[236:239], v[72:75], a[84:87], v[236:239]
    ds_read_b64_tr_b16 v[92:93], v12 offset:12288
    v_cmp_eq_u32 vcc, 4, v7
    v_mfma_f32_16x16x32_bf16 v[236:239], v[76:79], a[92:95], v[236:239]
    ds_read_b64_tr_b16 v[94:95], v12 offset:14336
    buffer_load_dwordx4 a[12:15], v8, s[4:7], s72 offen offset:3072 sc1
    v_mfma_f32_16x16x32_bf16 v[228:231], v[76:79], a[88:91], v[228:231]
    ds_read_b64_tr_b16 v[64:65], v9 offset:16384
    v_add_u32 v14, 131072, v1
    v_mfma_f32_16x16x32_bf16 v[228:231], v[72:75], a[80:83], v[228:231]
    s_waitcnt lgkmcnt(5)
    ds_read_b64_tr_b16 v[66:67], v9 offset:18432
    v_cndmask_b32 v190, 0, v184, vcc
    v_mfma_f32_16x16x32_bf16 v[240:243], v[80:83], a[80:83], v[240:243]
    ds_read_b64_tr_b16 v[68:69], v9 offset:20480
    v_cndmask_b32 v191, 0, v184, vcc
    v_mfma_f32_16x16x32_bf16 v[240:243], v[84:87], a[88:91], v[240:243]
    ds_read_b64_tr_b16 v[70:71], v9 offset:22528
    buffer_load_dwordx4 a[16:19], v124, s[4:7], s72 offen offset:0 sc1
    v_mfma_f32_16x16x32_bf16 v[248:251], v[84:87], a[92:95], v[248:251]
    ds_read_b64_tr_b16 v[72:73], v10 offset:16384
    v_add_u32 v13, s82, v1
    v_mfma_f32_16x16x32_bf16 v[248:251], v[80:83], a[84:87], v[248:251]
    s_waitcnt lgkmcnt(5)
    ds_read_b64_tr_b16 v[74:75], v10 offset:18432
    v_mfma_f32_16x16x32_bf16 v[252:255], v[88:91], a[84:87], v[252:255]
    ds_read_b64_tr_b16 v[76:77], v10 offset:20480
    v_add_f32 v104, v104, v112
    v_mfma_f32_16x16x32_bf16 v[252:255], v[92:95], a[92:95], v[252:255]
    ds_read_b64_tr_b16 v[78:79], v10 offset:22528
    buffer_load_dwordx4 a[20:23], v124, s[4:7], s72 offen offset:1024 sc1
    v_mfma_f32_16x16x32_bf16 v[244:247], v[92:95], a[88:91], v[244:247]
    ds_read_b64_tr_b16 v[80:81], v11 offset:16384
    v_add_f32 v105, v105, v113
    v_mfma_f32_16x16x32_bf16 v[244:247], v[88:91], a[80:83], v[244:247]
    s_waitcnt vmcnt(10) lgkmcnt(5)
    ds_read_b64_tr_b16 v[82:83], v11 offset:18432
    v_add_f32 v106, v106, v114
    v_mfma_f32_16x16x32_bf16 v[224:227], v[64:67], a[96:99], v[224:227]
    ds_read_b64_tr_b16 v[84:85], v11 offset:20480
    v_add_f32 v107, v107, v115
    v_mfma_f32_16x16x32_bf16 v[224:227], v[68:71], a[104:107], v[224:227]
    ds_read_b64_tr_b16 v[86:87], v11 offset:22528
    buffer_load_dwordx4 a[24:27], v124, s[4:7], s72 offen offset:2048 sc1
    v_mfma_f32_16x16x32_bf16 v[232:235], v[68:71], a[108:111], v[232:235]
    ds_read_b64_tr_b16 v[88:89], v12 offset:16384
    v_add_f32 v108, v108, v116
    v_mfma_f32_16x16x32_bf16 v[232:235], v[64:67], a[100:103], v[232:235]
    s_waitcnt lgkmcnt(5)
    ds_read_b64_tr_b16 v[90:91], v12 offset:18432
    v_add_f32 v109, v109, v117
    v_mfma_f32_16x16x32_bf16 v[236:239], v[72:75], a[100:103], v[236:239]
    ds_read_b64_tr_b16 v[92:93], v12 offset:20480
    v_add_f32 v110, v110, v118
    v_mfma_f32_16x16x32_bf16 v[236:239], v[76:79], a[108:111], v[236:239]
    ds_read_b64_tr_b16 v[94:95], v12 offset:22528
    buffer_load_dwordx4 a[28:31], v124, s[4:7], s72 offen offset:3072 sc1
    v_mfma_f32_16x16x32_bf16 v[228:231], v[76:79], a[104:107], v[228:231]
    ds_read_b64_tr_b16 v[64:65], v9 offset:24576
    v_add_f32 v111, v111, v119
    v_mfma_f32_16x16x32_bf16 v[228:231], v[72:75], a[96:99], v[228:231]
    s_waitcnt lgkmcnt(5)
    ds_read_b64_tr_b16 v[66:67], v9 offset:26624
    v_add_f32 v104, v104, v108
    v_mfma_f32_16x16x32_bf16 v[240:243], v[80:83], a[96:99], v[240:243]
    ds_read_b64_tr_b16 v[68:69], v9 offset:28672
    v_add_f32 v105, v105, v109
    v_mfma_f32_16x16x32_bf16 v[240:243], v[84:87], a[104:107], v[240:243]
    ds_read_b64_tr_b16 v[70:71], v9 offset:30720
    buffer_load_dwordx4 a[32:35], v8, s[4:7], s73 offen offset:0 sc1
    v_mfma_f32_16x16x32_bf16 v[248:251], v[84:87], a[108:111], v[248:251]
    ds_read_b64_tr_b16 v[72:73], v10 offset:24576
    v_add_f32 v106, v106, v110
    v_mfma_f32_16x16x32_bf16 v[248:251], v[80:83], a[100:103], v[248:251]
    s_waitcnt lgkmcnt(5)
    ds_read_b64_tr_b16 v[74:75], v10 offset:26624
    v_add_f32 v107, v107, v111
    v_mfma_f32_16x16x32_bf16 v[252:255], v[88:91], a[100:103], v[252:255]
    ds_read_b64_tr_b16 v[76:77], v10 offset:28672
    v_permlane32_swap_b32 v104, v106
    v_mfma_f32_16x16x32_bf16 v[252:255], v[92:95], a[108:111], v[252:255]
    ds_read_b64_tr_b16 v[78:79], v10 offset:30720
    buffer_load_dwordx4 a[36:39], v8, s[4:7], s73 offen offset:1024 sc1
    v_mfma_f32_16x16x32_bf16 v[244:247], v[92:95], a[104:107], v[244:247]
    ds_read_b64_tr_b16 v[80:81], v11 offset:24576
    v_permlane32_swap_b32 v105, v107
    v_mfma_f32_16x16x32_bf16 v[244:247], v[88:91], a[96:99], v[244:247]
    s_waitcnt vmcnt(10) lgkmcnt(5)
    ds_read_b64_tr_b16 v[82:83], v11 offset:26624
    v_add_f32 v104, v104, v106
    v_mfma_f32_16x16x32_bf16 v[224:227], v[64:67], a[112:115], v[224:227]
    ds_read_b64_tr_b16 v[84:85], v11 offset:28672
    v_add_f32 v105, v105, v107
    v_mfma_f32_16x16x32_bf16 v[224:227], v[68:71], a[120:123], v[224:227]
    ds_read_b64_tr_b16 v[86:87], v11 offset:30720
    buffer_load_dwordx4 a[40:43], v8, s[4:7], s73 offen offset:2048 sc1
    v_mfma_f32_16x16x32_bf16 v[232:235], v[68:71], a[124:127], v[232:235]
    ds_read_b64_tr_b16 v[88:89], v12 offset:24576
    v_permlane16_swap_b32 v104, v105
    v_mfma_f32_16x16x32_bf16 v[232:235], v[64:67], a[116:119], v[232:235]
    s_waitcnt lgkmcnt(5)
    ds_read_b64_tr_b16 v[90:91], v12 offset:26624
    v_add_f32 v104, v104, v105
    v_mfma_f32_16x16x32_bf16 v[236:239], v[72:75], a[116:119], v[236:239]
    ds_read_b64_tr_b16 v[92:93], v12 offset:28672
    v_xor_b32 v9, 65536, v9
    v_mfma_f32_16x16x32_bf16 v[236:239], v[76:79], a[124:127], v[236:239]
    ds_read_b64_tr_b16 v[94:95], v12 offset:30720
    buffer_load_dwordx4 a[44:47], v8, s[4:7], s73 offen offset:3072 sc1
    v_mfma_f32_16x16x32_bf16 v[228:231], v[76:79], a[120:123], v[228:231]
    ds_read_b64_tr_b16 v[64:65], v9 offset:0
    v_mul_f32 v104, 0x3a800000, v104
    v_mfma_f32_16x16x32_bf16 v[228:231], v[72:75], a[112:115], v[228:231]
    s_waitcnt lgkmcnt(5)
    ds_read_b64_tr_b16 v[66:67], v9 offset:2048
    v_mov_b32 v105, v104
    v_mfma_f32_16x16x32_bf16 v[240:243], v[80:83], a[112:115], v[240:243]
    ds_read_b64_tr_b16 v[68:69], v9 offset:4096
    v_xor_b32 v10, 65536, v10
L_hop3:
    s_cbranch_execz L_hop7
    v_mfma_f32_16x16x32_bf16 v[240:243], v[84:87], a[120:123], v[240:243]
    ds_read_b64_tr_b16 v[70:71], v9 offset:6144
    buffer_load_dwordx4 a[48:51], v124, s[4:7], s73 offen offset:0 sc1
    v_mfma_f32_16x16x32_bf16 v[248:251], v[84:87], a[124:127], v[248:251]
    ds_read_b64_tr_b16 v[72:73], v10 offset:0
    v_permlane32_swap_b32 v104, v105
    v_mfma_f32_16x16x32_bf16 v[248:251], v[80:83], a[116:119], v[248:251]
    s_waitcnt lgkmcnt(5)
    ds_read_b64_tr_b16 v[74:75], v10 offset:2048
    v_fma_f32 v105, -v104, v104, v105
    v_mfma_f32_16x16x32_bf16 v[252:255], v[88:91], a[116:119], v[252:255]
    ds_read_b64_tr_b16 v[76:77], v10 offset:4096
    v_xor_b32 v11, 65536, v11
    v_mfma_f32_16x16x32_bf16 v[252:255], v[92:95], a[124:127], v[252:255]
    ds_read_b64_tr_b16 v[78:79], v10 offset:6144
    buffer_load_dwordx4 a[52:55], v124, s[4:7], s73 offen offset:1024 sc1
    v_mfma_f32_16x16x32_bf16 v[244:247], v[92:95], a[120:123], v[244:247]
    ds_read_b64_tr_b16 v[80:81], v11 offset:0
    v_max_f32 v105, 0, v105
    v_mfma_f32_16x16x32_bf16 v[244:247], v[88:91], a[112:115], v[244:247]
    s_waitcnt vmcnt(10) lgkmcnt(5)
    ds_read_b64_tr_b16 v[82:83], v11 offset:2048
    v_add_f32 v105, 0x3727c5ac, v105
    v_mfma_f32_16x16x32_bf16 v[224:227], v[64:67], a[0:3], v[224:227]
    ds_read_b64_tr_b16 v[84:85], v11 offset:4096
    v_xor_b32 v12, 65536, v12
    v_mfma_f32_16x16x32_bf16 v[224:227], v[68:71], a[8:11], v[224:227]
    ds_read_b64_tr_b16 v[86:87], v11 offset:6144
    buffer_load_dwordx4 a[56:59], v124, s[4:7], s73 offen offset:2048 sc1
    v_mfma_f32_16x16x32_bf16 v[232:235], v[68:71], a[12:15], v[232:235]
    ds_read_b64_tr_b16 v[88:89], v12 offset:0
    v_rsq_f32 v105, v105
    v_mfma_f32_16x16x32_bf16 v[232:235], v[64:67], a[4:7], v[232:235]
    s_waitcnt lgkmcnt(5)
    ds_read_b64_tr_b16 v[90:91], v12 offset:2048
    v_cvt_pk_bf16_f32 v121, -v104, 0
    v_mfma_f32_16x16x32_bf16 v[236:239], v[72:75], a[4:7], v[236:239]
    ds_read_b64_tr_b16 v[92:93], v12 offset:4096
    v_lshlrev_b32 v106, 16, v121
    v_mfma_f32_16x16x32_bf16 v[236:239], v[76:79], a[12:15], v[236:239]
    ds_read_b64_tr_b16 v[94:95], v12 offset:6144
    buffer_load_dwordx4 a[60:63], v124, s[4:7], s73 offen offset:3072 sc1
    v_mfma_f32_16x16x32_bf16 v[228:231], v[76:79], a[8:11], v[228:231]
    ds_read_b64_tr_b16 v[64:65], v9 offset:8192
    v_add_f32 v106, v106, v104
    v_mfma_f32_16x16x32_bf16 v[228:231], v[72:75], a[0:3], v[228:231]
    s_waitcnt lgkmcnt(5)
    ds_read_b64_tr_b16 v[66:67], v9 offset:10240
    v_cvt_pk_bf16_f32 v120, -v104, -v106
    v_mfma_f32_16x16x32_bf16 v[240:243], v[80:83], a[0:3], v[240:243]
    ds_read_b64_tr_b16 v[68:69], v9 offset:12288
    v_mov_b32 v123, v121
    v_mfma_f32_16x16x32_bf16 v[240:243], v[84:87], a[8:11], v[240:243]
    ds_read_b64_tr_b16 v[70:71], v9 offset:14336
    buffer_load_dwordx4 a[64:67], v8, s[4:7], s74 offen offset:0 sc1
    v_mfma_f32_16x16x32_bf16 v[248:251], v[84:87], a[12:15], v[248:251]
    ds_read_b64_tr_b16 v[72:73], v10 offset:8192
    v_permlane16_swap_b32 v121, v123
    v_mfma_f32_16x16x32_bf16 v[248:251], v[80:83], a[4:7], v[248:251]
    s_waitcnt lgkmcnt(5)
    ds_read_b64_tr_b16 v[74:75], v10 offset:10240
    v_mov_b32 v122, v120
    v_mfma_f32_16x16x32_bf16 v[252:255], v[88:91], a[4:7], v[252:255]
    ds_read_b64_tr_b16 v[76:77], v10 offset:12288
    v_permlane16_swap_b32 v120, v122
    v_mfma_f32_16x16x32_bf16 v[252:255], v[92:95], a[12:15], v[252:255]
    ds_read_b64_tr_b16 v[78:79], v10 offset:14336
    buffer_load_dwordx4 a[68:71], v8, s[4:7], s74 offen offset:1024 sc1
    v_mfma_f32_16x16x32_bf16 v[244:247], v[92:95], a[8:11], v[244:247]
    ds_read_b64_tr_b16 v[80:81], v11 offset:8192
    v_mul_f32 v105, 0x3e8293ee, v105
    v_mfma_f32_16x16x32_bf16 v[244:247], v[88:91], a[0:3], v[244:247]
    s_waitcnt vmcnt(10) lgkmcnt(5)
    ds_read_b64_tr_b16 v[82:83], v11 offset:10240
    v_mov_b32 v106, v105
    v_mfma_f32_16x16x32_bf16 v[224:227], v[64:67], a[16:19], v[224:227]
    ds_read_b64_tr_b16 v[84:85], v11 offset:12288
    v_permlane16_swap_b32 v105, v106
    v_mfma_f32_16x16x32_bf16 v[224:227], v[68:71], a[24:27], v[224:227]
    ds_read_b64_tr_b16 v[86:87], v11 offset:14336
    buffer_load_dwordx4 a[72:75], v8, s[4:7], s74 offen offset:2048 sc1
    v_mfma_f32_16x16x32_bf16 v[232:235], v[68:71], a[28:31], v[232:235]
    ds_read_b64_tr_b16 v[88:89], v12 offset:8192
    v_mfma_f32_16x16x32_bf16 v[232:235], v[64:67], a[20:23], v[232:235]
    s_waitcnt lgkmcnt(5)
    ds_read_b64_tr_b16 v[90:91], v12 offset:10240
    v_mfma_f32_16x16x32_bf16 v[236:239], v[72:75], a[20:23], v[236:239]
    ds_read_b64_tr_b16 v[92:93], v12 offset:12288
    v_mfma_f32_16x16x32_bf16 v[236:239], v[76:79], a[28:31], v[236:239]
    ds_read_b64_tr_b16 v[94:95], v12 offset:14336
    buffer_load_dwordx4 a[76:79], v8, s[4:7], s74 offen offset:3072 sc1
    v_mfma_f32_16x16x32_bf16 v[228:231], v[76:79], a[24:27], v[228:231]
    ds_read_b64_tr_b16 v[64:65], v9 offset:16384
    v_mfma_f32_16x16x32_bf16 v[228:231], v[72:75], a[16:19], v[228:231]
    s_waitcnt lgkmcnt(5)
    ds_read_b64_tr_b16 v[66:67], v9 offset:18432
    v_mfma_f32_16x16x32_bf16 v[240:243], v[80:83], a[16:19], v[240:243]
    ds_read_b64_tr_b16 v[68:69], v9 offset:20480
    v_mfma_f32_16x16x32_bf16 v[240:243], v[84:87], a[24:27], v[240:243]
    ds_read_b64_tr_b16 v[70:71], v9 offset:22528
    buffer_load_dwordx4 a[80:83], v124, s[4:7], s74 offen offset:0 sc1
    v_mfma_f32_16x16x32_bf16 v[248:251], v[84:87], a[28:31], v[248:251]
    ds_read_b64_tr_b16 v[72:73], v10 offset:16384
    v_mfma_f32_16x16x32_bf16 v[248:251], v[80:83], a[20:23], v[248:251]
    s_waitcnt lgkmcnt(5)
    ds_read_b64_tr_b16 v[74:75], v10 offset:18432
    v_mfma_f32_16x16x32_bf16 v[252:255], v[88:91], a[20:23], v[252:255]
    ds_read_b64_tr_b16 v[76:77], v10 offset:20480
    v_mfma_f32_16x16x32_bf16 v[252:255], v[92:95], a[28:31], v[252:255]
    ds_read_b64_tr_b16 v[78:79], v10 offset:22528
    buffer_load_dwordx4 a[84:87], v124, s[4:7], s74 offen offset:1024 sc1
    v_mfma_f32_16x16x32_bf16 v[244:247], v[92:95], a[24:27], v[244:247]
    ds_read_b64_tr_b16 v[80:81], v11 offset:16384
    s_mov_b32 s57, 0
    v_mfma_f32_16x16x32_bf16 v[244:247], v[88:91], a[16:19], v[244:247]
    s_waitcnt vmcnt(10) lgkmcnt(5)
    ds_read_b64_tr_b16 v[82:83], v11 offset:18432
    v_mfma_f32_16x16x32_bf16 v[224:227], v[64:67], a[32:35], v[224:227]
    ds_read_b64_tr_b16 v[84:85], v11 offset:20480
    s_atomic_add s57, s[4:5], s77 glc
    v_mfma_f32_16x16x32_bf16 v[224:227], v[68:71], a[40:43], v[224:227]
    ds_read_b64_tr_b16 v[86:87], v11 offset:22528
    buffer_load_dwordx4 a[88:91], v124, s[4:7], s74 offen offset:2048 sc1
    v_mfma_f32_16x16x32_bf16 v[232:235], v[68:71], a[44:47], v[232:235]
    ds_read_b64_tr_b16 v[88:89], v12 offset:16384
    s_mov_b32 m0, s89
    v_mfma_f32_16x16x32_bf16 v[232:235], v[64:67], a[36:39], v[232:235]
    s_waitcnt lgkmcnt(5)
    ds_read_b64_tr_b16 v[90:91], v12 offset:18432
    v_mfma_f32_16x16x32_bf16 v[236:239], v[72:75], a[36:39], v[236:239]
    ds_read_b64_tr_b16 v[92:93], v12 offset:20480
    v_mfma_f32_16x16x32_bf16 v[236:239], v[76:79], a[44:47], v[236:239]
    ds_read_b64_tr_b16 v[94:95], v12 offset:22528
    buffer_load_dwordx4 a[92:95], v124, s[4:7], s74 offen offset:3072 sc1
    v_mfma_f32_16x16x32_bf16 v[228:231], v[76:79], a[40:43], v[228:231]
    ds_read_b64_tr_b16 v[64:65], v9 offset:24576
    v_mfma_f32_16x16x32_bf16 v[228:231], v[72:75], a[32:35], v[228:231]
    s_waitcnt lgkmcnt(5)
    ds_read_b64_tr_b16 v[66:67], v9 offset:26624
    v_mfma_f32_16x16x32_bf16 v[240:243], v[80:83], a[32:35], v[240:243]
    ds_read_b64_tr_b16 v[68:69], v9 offset:28672
    v_mfma_f32_16x16x32_bf16 v[240:243], v[84:87], a[40:43], v[240:243]
    ds_read_b64_tr_b16 v[70:71], v9 offset:30720
    buffer_load_dwordx4 a[96:99], v8, s[4:7], s75 offen offset:0 sc1
    v_mfma_f32_16x16x32_bf16 v[248:251], v[84:87], a[44:47], v[248:251]
    ds_read_b64_tr_b16 v[72:73], v10 offset:24576
    v_mfma_f32_16x16x32_bf16 v[248:251], v[80:83], a[36:39], v[248:251]
    s_waitcnt lgkmcnt(5)
    ds_read_b64_tr_b16 v[74:75], v10 offset:26624
    v_mfma_f32_16x16x32_bf16 v[252:255], v[88:91], a[36:39], v[252:255]
    ds_read_b64_tr_b16 v[76:77], v10 offset:28672
    v_mfma_f32_16x16x32_bf16 v[252:255], v[92:95], a[44:47], v[252:255]
    ds_read_b64_tr_b16 v[78:79], v10 offset:30720
    buffer_load_dwordx4 a[100:103], v8, s[4:7], s75 offen offset:1024 sc1
    v_mfma_f32_16x16x32_bf16 v[244:247], v[92:95], a[40:43], v[244:247]
    ds_read_b64_tr_b16 v[80:81], v11 offset:24576
    v_mfma_f32_16x16x32_bf16 v[244:247], v[88:91], a[32:35], v[244:247]
    s_waitcnt vmcnt(10) lgkmcnt(5)
    ds_read_b64_tr_b16 v[82:83], v11 offset:26624
    v_mfma_f32_16x16x32_bf16 v[224:227], v[64:67], a[48:51], v[224:227]
    ds_read_b64_tr_b16 v[84:85], v11 offset:28672
    v_mfma_f32_16x16x32_bf16 v[224:227], v[68:71], a[56:59], v[224:227]
    ds_read_b64_tr_b16 v[86:87], v11 offset:30720
    buffer_load_dwordx4 a[104:107], v8, s[4:7], s75 offen offset:2048 sc1
    v_mfma_f32_16x16x32_bf16 v[232:235], v[68:71], a[60:63], v[232:235]
    ds_read_b64_tr_b16 v[88:89], v12 offset:24576
    v_mfma_f32_16x16x32_bf16 v[232:235], v[64:67], a[52:55], v[232:235]
    s_waitcnt lgkmcnt(5)
    ds_read_b64_tr_b16 v[90:91], v12 offset:26624
    v_mfma_f32_16x16x32_bf16 v[236:239], v[72:75], a[52:55], v[236:239]
    ds_read_b64_tr_b16 v[92:93], v12 offset:28672
    v_xor_b32 v9, 32768, v9
    v_mfma_f32_16x16x32_bf16 v[236:239], v[76:79], a[60:63], v[236:239]
    ds_read_b64_tr_b16 v[94:95], v12 offset:30720
    buffer_load_dwordx4 a[108:111], v8, s[4:7], s75 offen offset:3072 sc1
    v_mfma_f32_16x16x32_bf16 v[228:231], v[76:79], a[56:59], v[228:231]
    ds_read_b64_tr_b16 v[64:65], v9 offset:0
    v_mfma_f32_16x16x32_bf16 v[228:231], v[72:75], a[48:51], v[228:231]
    s_waitcnt lgkmcnt(5)
    ds_read_b64_tr_b16 v[66:67], v9 offset:2048
    v_mfma_f32_16x16x32_bf16 v[240:243], v[80:83], a[48:51], v[240:243]
    ds_read_b64_tr_b16 v[68:69], v9 offset:4096
    v_xor_b32 v10, 32768, v10
    v_mfma_f32_16x16x32_bf16 v[240:243], v[84:87], a[56:59], v[240:243]
    ds_read_b64_tr_b16 v[70:71], v9 offset:6144
    buffer_load_dwordx4 a[112:115], v124, s[4:7], s75 offen offset:0 sc1
    v_mfma_f32_16x16x32_bf16 v[248:251], v[84:87], a[60:63], v[248:251]
    ds_read_b64_tr_b16 v[72:73], v10 offset:0
    v_mfma_f32_16x16x32_bf16 v[248:251], v[80:83], a[52:55], v[248:251]
    s_waitcnt lgkmcnt(5)
    ds_read_b64_tr_b16 v[74:75], v10 offset:2048
    v_mfma_f32_16x16x32_bf16 v[252:255], v[88:91], a[52:55], v[252:255]
    ds_read_b64_tr_b16 v[76:77], v10 offset:4096
    v_xor_b32 v11, 32768, v11
    v_mfma_f32_16x16x32_bf16 v[252:255], v[92:95], a[60:63], v[252:255]
    ds_read_b64_tr_b16 v[78:79], v10 offset:6144
    buffer_load_dwordx4 a[116:119], v124, s[4:7], s75 offen offset:1024 sc1
    v_mfma_f32_16x16x32_bf16 v[244:247], v[92:95], a[56:59], v[244:247]
    ds_read_b64_tr_b16 v[80:81], v11 offset:0
    v_mfma_f32_16x16x32_bf16 v[244:247], v[88:91], a[48:51], v[244:247]
    s_waitcnt vmcnt(10) lgkmcnt(5)
    ds_read_b64_tr_b16 v[82:83], v11 offset:2048
    v_mfma_f32_16x16x32_bf16 v[224:227], v[64:67], a[64:67], v[224:227]
    ds_read_b64_tr_b16 v[84:85], v11 offset:4096
    v_xor_b32 v12, 32768, v12
    v_mfma_f32_16x16x32_bf16 v[224:227], v[68:71], a[72:75], v[224:227]
    ds_read_b64_tr_b16 v[86:87], v11 offset:6144
    buffer_load_dwordx4 a[120:123], v124, s[4:7], s75 offen offset:2048 sc1
    v_mfma_f32_16x16x32_bf16 v[232:235], v[68:71], a[76:79], v[232:235]
    ds_read_b64_tr_b16 v[88:89], v12 offset:0
    v_mfma_f32_16x16x32_bf16 v[232:235], v[64:67], a[68:71], v[232:235]
    s_waitcnt lgkmcnt(5)
    ds_read_b64_tr_b16 v[90:91], v12 offset:2048
    v_mfma_f32_16x16x32_bf16 v[236:239], v[72:75], a[68:71], v[236:239]
    ds_read_b64_tr_b16 v[92:93], v12 offset:4096
    v_mfma_f32_16x16x32_bf16 v[236:239], v[76:79], a[76:79], v[236:239]
    ds_read_b64_tr_b16 v[94:95], v12 offset:6144
    buffer_load_dwordx4 a[124:127], v124, s[4:7], s75 offen offset:3072 sc1
    v_mfma_f32_16x16x32_bf16 v[228:231], v[76:79], a[72:75], v[228:231]
    ds_read_b64_tr_b16 v[64:65], v9 offset:8192
    v_mfma_f32_16x16x32_bf16 v[228:231], v[72:75], a[64:67], v[228:231]
    s_waitcnt lgkmcnt(5)
    ds_read_b64_tr_b16 v[66:67], v9 offset:10240
    v_mfma_f32_16x16x32_bf16 v[240:243], v[80:83], a[64:67], v[240:243]
    ds_read_b64_tr_b16 v[68:69], v9 offset:12288
    v_mfma_f32_16x16x32_bf16 v[240:243], v[84:87], a[72:75], v[240:243]
    ds_read_b64_tr_b16 v[70:71], v9 offset:14336
    v_mfma_f32_16x16x32_bf16 v[248:251], v[84:87], a[76:79], v[248:251]
    ds_read_b64_tr_b16 v[72:73], v10 offset:8192
    v_mfma_f32_16x16x32_bf16 v[248:251], v[80:83], a[68:71], v[248:251]
    s_waitcnt lgkmcnt(5)
    ds_read_b64_tr_b16 v[74:75], v10 offset:10240
    v_mfma_f32_16x16x32_bf16 v[252:255], v[88:91], a[68:71], v[252:255]
    ds_read_b64_tr_b16 v[76:77], v10 offset:12288
    v_mfma_f32_16x16x32_bf16 v[252:255], v[92:95], a[76:79], v[252:255]
    ds_read_b64_tr_b16 v[78:79], v10 offset:14336
    s_cmp_lt_u32 s57, s78
    s_cbranch_scc1 L_slow_7
L_back_8:
    s_barrier
    v_mfma_f32_16x16x32_bf16 v[244:247], v[92:95], a[72:75], v[244:247]
    ds_read_b64_tr_b16 v[80:81], v11 offset:8192
    v_mfma_f32_16x16x32_bf16 v[244:247], v[88:91], a[64:67], v[244:247]
    s_waitcnt vmcnt(8) lgkmcnt(5)
    ds_read_b64_tr_b16 v[82:83], v11 offset:10240
    buffer_load_dwordx4 v[168:171], v13, s[4:7], s81 offen offset:0 sc1
    v_mfma_f32_16x16x32_bf16 v[224:227], v[64:67], a[80:83], v[224:227]
    ds_read_b64_tr_b16 v[84:85], v11 offset:12288
    v_mfma_f32_16x16x32_bf16 v[224:227], v[68:71], a[88:91], v[224:227]
    ds_read_b64_tr_b16 v[86:87], v11 offset:14336
    buffer_load_dwordx4 v[172:175], v13, s[4:7], s81 offen offset:1024 sc1
    v_mfma_f32_16x16x32_bf16 v[232:235], v[68:71], a[92:95], v[232:235]
    ds_read_b64_tr_b16 v[88:89], v12 offset:8192
    v_mfma_f32_16x16x32_bf16 v[232:235], v[64:67], a[84:87], v[232:235]
    s_waitcnt lgkmcnt(5)
    ds_read_b64_tr_b16 v[90:91], v12 offset:10240
    buffer_load_dwordx4 v13, s[4:7], s90 offen offset:0 sc1 lds
    v_mfma_f32_16x16x32_bf16 v[236:239], v[72:75], a[84:87], v[236:239]
    ds_read_b64_tr_b16 v[92:93], v12 offset:12288
    v_mfma_f32_16x16x32_bf16 v[236:239], v[76:79], a[92:95], v[236:239]
    ds_read_b64_tr_b16 v[94:95], v12 offset:14336
    buffer_load_dwordx4 v13, s[4:7], s90 offen offset:1024 sc1 lds
    v_mfma_f32_16x16x32_bf16 v[228:231], v[76:79], a[88:91], v[228:231]
    ds_read_b64_tr_b16 v[64:65], v9 offset:16384
    s_add_u32 s90, s90, 8192
    v_mfma_f32_16x16x32_bf16 v[228:231], v[72:75], a[80:83], v[228:231]
    s_waitcnt lgkmcnt(5)
    ds_read_b64_tr_b16 v[66:67], v9 offset:18432
    s_add_u32 m0, s89, 8192
    v_mfma_f32_16x16x32_bf16 v[240:243], v[80:83], a[80:83], v[240:243]
    ds_read_b64_tr_b16 v[68:69], v9 offset:20480
    s_and_b32 s90, s90, 0x3ffff
    v_mfma_f32_16x16x32_bf16 v[240:243], v[84:87], a[88:91], v[240:243]
    ds_read_b64_tr_b16 v[70:71], v9 offset:22528
    buffer_load_dwordx4 v13, s[4:7], s90 offen offset:0 sc1 lds
    v_mfma_f32_16x16x32_bf16 v[248:251], v[84:87], a[92:95], v[248:251]
    ds_read_b64_tr_b16 v[72:73], v10 offset:16384
    v_mfma_f32_16x16x32_bf16 v[248:251], v[80:83], a[84:87], v[248:251]
    s_waitcnt lgkmcnt(5)
    ds_read_b64_tr_b16 v[74:75], v10 offset:18432
    buffer_load_dwordx4 v13, s[4:7], s90 offen offset:1024 sc1 lds
    v_mfma_f32_16x16x32_bf16 v[252:255], v[88:91], a[84:87], v[252:255]
    ds_read_b64_tr_b16 v[76:77], v10 offset:20480
    s_add_u32 s90, s90, 8192
    v_mfma_f32_16x16x32_bf16 v[252:255], v[92:95], a[92:95], v[252:255]
    ds_read_b64_tr_b16 v[78:79], v10 offset:22528
    v_mfma_f32_16x16x32_bf16 v[244:247], v[92:95], a[88:91], v[244:247]
    ds_read_b64_tr_b16 v[80:81], v11 offset:16384
    v_mfma_f32_16x16x32_bf16 v[244:247], v[88:91], a[80:83], v[244:247]
    s_waitcnt vmcnt(10) lgkmcnt(5)
    ds_read_b64_tr_b16 v[82:83], v11 offset:18432
    v_mfma_f32_16x16x32_bf16 v[224:227], v[64:67], a[96:99], v[224:227]
    ds_read_b64_tr_b16 v[84:85], v11 offset:20480
    v_mfma_f32_16x16x32_bf16 v[224:227], v[68:71], a[104:107], v[224:227]
    ds_read_b64_tr_b16 v[86:87], v11 offset:22528
    v_mfma_f32_16x16x32_bf16 v[232:235], v[68:71], a[108:111], v[232:235]
    ds_read_b64_tr_b16 v[88:89], v12 offset:16384
    v_mfma_f32_16x16x32_bf16 v[232:235], v[64:67], a[100:103], v[232:235]
    s_waitcnt lgkmcnt(5)
    ds_read_b64_tr_b16 v[90:91], v12 offset:18432
    v_mfma_f32_16x16x32_bf16 v[236:239], v[72:75], a[100:103], v[236:239]
    ds_read_b64_tr_b16 v[92:93], v12 offset:20480
    v_mfma_f32_16x16x32_bf16 v[236:239], v[76:79], a[108:111], v[236:239]
    ds_read_b64_tr_b16 v[94:95], v12 offset:22528
    v_mfma_f32_16x16x32_bf16 v[228:231], v[76:79], a[104:107], v[228:231]
    ds_read_b64_tr_b16 v[64:65], v9 offset:24576
    v_mfma_f32_16x16x32_bf16 v[228:231], v[72:75], a[96:99], v[228:231]
    s_waitcnt lgkmcnt(5)
    ds_read_b64_tr_b16 v[66:67], v9 offset:26624
    v_mfma_f32_16x16x32_bf16 v[240:243], v[80:83], a[96:99], v[240:243]
    ds_read_b64_tr_b16 v[68:69], v9 offset:28672
    v_mfma_f32_16x16x32_bf16 v[240:243], v[84:87], a[104:107], v[240:243]
    ds_read_b64_tr_b16 v[70:71], v9 offset:30720
    v_mfma_f32_16x16x32_bf16 v[248:251], v[84:87], a[108:111], v[248:251]
    ds_read_b64_tr_b16 v[72:73], v10 offset:24576
    v_mfma_f32_16x16x32_bf16 v[248:251], v[80:83], a[100:103], v[248:251]
    s_waitcnt lgkmcnt(5)
    ds_read_b64_tr_b16 v[74:75], v10 offset:26624
    v_mfma_f32_16x16x32_bf16 v[252:255], v[88:91], a[100:103], v[252:255]
    ds_read_b64_tr_b16 v[76:77], v10 offset:28672
    v_mfma_f32_16x16x32_bf16 v[252:255], v[92:95], a[108:111], v[252:255]
    ds_read_b64_tr_b16 v[78:79], v10 offset:30720
    v_mfma_f32_16x16x32_bf16 v[244:247], v[92:95], a[104:107], v[244:247]
    ds_read_b64_tr_b16 v[80:81], v11 offset:24576
    v_mfma_f32_16x16x32_bf16 v[244:247], v[88:91], a[96:99], v[244:247]
    s_waitcnt vmcnt(6) lgkmcnt(5)
    ds_read_b64_tr_b16 v[82:83], v11 offset:26624
    v_mfma_f32_16x16x32_bf16 v[224:227], v[64:67], a[112:115], v[224:227]
    ds_read_b64_tr_b16 v[84:85], v11 offset:28672
    v_mfma_f32_16x16x32_bf16 v[224:227], v[68:71], a[120:123], v[224:227]
    ds_read_b64_tr_b16 v[86:87], v11 offset:30720
    v_mfma_f32_16x16x32_bf16 v[232:235], v[68:71], a[124:127], v[232:235]
    ds_read_b64_tr_b16 v[88:89], v12 offset:24576
    v_mfma_f32_16x16x32_bf16 v[232:235], v[64:67], a[116:119], v[232:235]
    s_waitcnt lgkmcnt(5)
    ds_read_b64_tr_b16 v[90:91], v12 offset:26624
    v_mfma_f32_16x16x32_bf16 v[236:239], v[72:75], a[116:119], v[236:239]
    ds_read_b64_tr_b16 v[92:93], v12 offset:28672
    v_mfma_f32_16x16x32_bf16 v[236:239], v[76:79], a[124:127], v[236:239]
    ds_read_b64_tr_b16 v[94:95], v12 offset:30720
    v_mfma_f32_16x16x32_bf16 v[228:231], v[76:79], a[120:123], v[228:231]
    v_mfma_f32_16x16x32_bf16 v[228:231], v[72:75], a[112:115], v[228:231]
    s_waitcnt lgkmcnt(4)
    v_mfma_f32_16x16x32_bf16 v[240:243], v[80:83], a[112:115], v[240:243]
    v_mfma_f32_16x16x32_bf16 v[240:243], v[84:87], a[120:123], v[240:243]
    v_mfma_f32_16x16x32_bf16 v[248:251], v[84:87], a[124:127], v[248:251]
    v_mfma_f32_16x16x32_bf16 v[248:251], v[80:83], a[116:119], v[248:251]
    s_waitcnt lgkmcnt(0)
    v_mfma_f32_16x16x32_bf16 v[252:255], v[88:91], a[116:119], v[252:255]
    v_mfma_f32_16x16x32_bf16 v[252:255], v[92:95], a[124:127], v[252:255]
    v_mfma_f32_16x16x32_bf16 v[244:247], v[92:95], a[120:123], v[244:247]
    v_mfma_f32_16x16x32_bf16 v[244:247], v[88:91], a[112:115], v[244:247]
    s_cmp_lg_u32 s55, 0
    s_cbranch_scc1 L_q_wo
    v_and_b32 v7, 15, v0
    v_lshlrev_b32 v7, 2, v7
    v_lshrrev_b32 v9, 4, v0
    v_lshl_or_b32 v7, v9, 8, v7
    v_add_u32 v7, 156672, v7
    ds_read_b32 v108, v7 offset:0
    ds_read_b32 v109, v7 offset:64
    ds_read_b32 v110, v7 offset:128
    ds_read_b32 v111, v7 offset:192
    s_waitcnt lgkmcnt(0)
    v_cvt_pk_bf16_f32 v96, v108, v108
    v_and_b32 v112, 0xffff0000, v96
    v_sub_f32 v112, v108, v112
    v_cvt_pk_bf16_f32 v97, v112, 0
    v_cvt_pk_bf16_f32 v98, v109, v109
    v_and_b32 v113, 0xffff0000, v98
    v_sub_f32 v113, v109, v113
    v_cvt_pk_bf16_f32 v99, v113, 0
    v_cvt_pk_bf16_f32 v100, v110, v110
    v_and_b32 v114, 0xffff0000, v100
    v_sub_f32 v114, v110, v114
    v_cvt_pk_bf16_f32 v101, v114, 0
    v_cvt_pk_bf16_f32 v102, v111, v111
    v_and_b32 v115, 0xffff0000, v102
    v_sub_f32 v115, v111, v115
    v_cvt_pk_bf16_f32 v103, v115, 0
    v_add_u32 v9, 16384, v3
    v_mov_b32 v8, v212
    v_xor_b32 v10, 32, v9
    v_xor_b32 v11, 64, v9
    v_xor_b32 v12, 96, v9
    s_mov_b32 s86, s84
    s_mov_b32 s88, s97
    s_lshl3_add_u32 s87, s96, 16384
    s_mov_b32 s85, 2
    s_mov_b32 s93, 1073741824
    s_mov_b32 s57, -1
    s_branch L_q_fin
L_q_wo:
    s_lshl1_add_u32 s86, s48, s3
    s_lshl_b32 s86, s86, 18
    s_mov_b32 s88, 16384
    s_lshl_b32 s60, s53, 7
    v_add_u32 v8, s60, v5
    s_lshl_b32 s87, s48, 15
    s_mov_b64 s[24:25], s[20:21]
    s_mov_b32 s26, 2097152
    s_mov_b32 s85, 8
    s_and_b32 s93, s54, 15
    s_mul_i32 s60, s52, 896
    s_add_u32 s93, s93, s60
    s_lshl_b32 s93, s93, 10
    s_add_u32 s93, s93, 1081344
    s_mov_b32 s57, 0x1fffff
L_q_fin:
    v_mfma_f32_16x16x16_bf16 v[224:227], v[96:97], v[120:121], v[224:227]
    v_mfma_f32_16x16x16_bf16 v[232:235], v[96:97], v[122:123], v[232:235]
    v_mfma_f32_16x16x16_bf16 v[228:231], v[98:99], v[120:121], v[228:231]
    v_mfma_f32_16x16x16_bf16 v[236:239], v[98:99], v[122:123], v[236:239]
    v_mfma_f32_16x16x16_bf16 v[240:243], v[100:101], v[120:121], v[240:243]
    v_mfma_f32_16x16x16_bf16 v[248:251], v[100:101], v[122:123], v[248:251]
    v_mfma_f32_16x16x16_bf16 v[244:247], v[102:103], v[120:121], v[244:247]
    v_mfma_f32_16x16x16_bf16 v[252:255], v[102:103], v[122:123], v[252:255]
    s_nop 0
    v_pk_mul_f32 v[224:225], v[224:225], v[104:105] op_sel:[0,1] op_sel_hi:[1,1]
    v_pk_mul_f32 v[226:227], v[226:227], v[104:105] op_sel:[0,1] op_sel_hi:[1,1]
    v_pk_mul_f32 v[228:229], v[228:229], v[104:105] op_sel:[0,1] op_sel_hi:[1,1]
    v_pk_mul_f32 v[230:231], v[230:231], v[104:105] op_sel:[0,1] op_sel_hi:[1,1]
    v_pk_mul_f32 v[232:233], v[232:233], v[106:107] op_sel:[0,0] op_sel_hi:[1,0]
    v_pk_mul_f32 v[234:235], v[234:235], v[106:107] op_sel:[0,0] op_sel_hi:[1,0]
    v_pk_mul_f32 v[236:237], v[236:237], v[106:107] op_sel:[0,0] op_sel_hi:[1,0]
    v_pk_mul_f32 v[238:239], v[238:239], v[106:107] op_sel:[0,0] op_sel_hi:[1,0]
    v_pk_mul_f32 v[240:241], v[240:241], v[104:105] op_sel:[0,1] op_sel_hi:[1,1]
    v_pk_mul_f32 v[242:243], v[242:243], v[104:105] op_sel:[0,1] op_sel_hi:[1,1]
    v_pk_mul_f32 v[244:245], v[244:245], v[104:105] op_sel:[0,1] op_sel_hi:[1,1]
    v_pk_mul_f32 v[246:247], v[246:247], v[104:105] op_sel:[0,1] op_sel_hi:[1,1]
    v_pk_mul_f32 v[248:249], v[248:249], v[106:107] op_sel:[0,0] op_sel_hi:[1,0]
    v_pk_mul_f32 v[250:251], v[250:251], v[106:107] op_sel:[0,0] op_sel_hi:[1,0]
    v_pk_mul_f32 v[252:253], v[252:253], v[106:107] op_sel:[0,0] op_sel_hi:[1,0]
    v_pk_mul_f32 v[254:255], v[254:255], v[106:107] op_sel:[0,0] op_sel_hi:[1,0]
    v_cvt_pk_bf16_f32 v48, v224, v225
    v_cvt_pk_bf16_f32 v49, v226, v227
    v_cvt_pk_bf16_f32 v50, v228, v229
    v_cvt_pk_bf16_f32 v51, v230, v231
    v_cvt_pk_bf16_f32 v52, v232, v233
    v_cvt_pk_bf16_f32 v53, v234, v235
    v_cvt_pk_bf16_f32 v54, v236, v237
    v_cvt_pk_bf16_f32 v55, v238, v239
    v_cvt_pk_bf16_f32 v56, v240, v241
    v_cvt_pk_bf16_f32 v57, v242, v243
    v_cvt_pk_bf16_f32 v58, v244, v245
    v_cvt_pk_bf16_f32 v59, v246, v247
    v_cvt_pk_bf16_f32 v60, v248, v249
    v_cvt_pk_bf16_f32 v61, v250, v251
    v_cvt_pk_bf16_f32 v62, v252, v253
    v_cvt_pk_bf16_f32 v63, v254, v255
    v_permlane16_swap_b32 v48, v52
    v_permlane16_swap_b32 v49, v53
    v_permlane16_swap_b32 v50, v54
    v_permlane16_swap_b32 v51, v55
    v_permlane16_swap_b32 v56, v60
    v_permlane16_swap_b32 v57, v61
    v_permlane16_swap_b32 v58, v62
    v_permlane16_swap_b32 v59, v63
    s_mov_b32 s84, 0
    s_waitcnt vmcnt(0) lgkmcnt(0)
    s_add_u32 m0, s89, 16384
    v_mfma_f32_32x32x16_bf16 v[224:239], v[168:171], v[48:51], 0
    s_and_b32 s90, s90, 0x3ffff
    s_barrier
    v_mfma_f32_32x32x16_bf16 v[224:239], v[172:175], v[52:55], v[224:239]
    ds_read_b128 v[176:179], v14 offset:2048
    ds_read_b128 v[180:183], v14 offset:3072
    buffer_load_dwordx4 v13, s[4:7], s90 offen offset:0 sc1 lds
    v_mfma_f32_32x32x16_bf16 v[240:255], v[168:171], v[56:59], 0
    buffer_load_dwordx4 v13, s[4:7], s90 offen offset:1024 sc1 lds
    s_add_u32 s90, s90, 8192
    s_add_u32 m0, s89, 24576
    s_and_b32 s90, s90, 0x3ffff
    v_mfma_f32_32x32x16_bf16 v[240:255], v[172:175], v[60:63], v[240:255]
    ds_read_b128 v[104:107], v14 offset:0
    ds_read_b128 v[108:111], v14 offset:1024
    buffer_load_dwordx4 v13, s[4:7], s90 offen offset:0 sc1 lds
    buffer_load_dwordx4 v13, s[4:7], s90 offen offset:1024 sc1 lds
    s_add_u32 s90, s90, 8192
    v_exp_f32 v224, v224
    v_exp_f32 v225, v225
    v_exp_f32 v226, v226
    v_exp_f32 v227, v227
    v_exp_f32 v228, v228
    v_exp_f32 v229, v229
    v_exp_f32 v230, v230
    v_exp_f32 v231, v231
    v_exp_f32 v232, v232
    v_exp_f32 v233, v233
    v_exp_f32 v234, v234
    v_exp_f32 v235, v235
    v_exp_f32 v236, v236
    v_exp_f32 v237, v237
    v_exp_f32 v238, v238
    v_exp_f32 v239, v239
    s_waitcnt lgkmcnt(2)
    s_branch L_att_in
.p2align 3
L_att_a:
    v_mfma_f32_32x32x16_bf16 v[224:239], v[168:171], v[48:51], 0
    v_exp_f32 v80, v80
    v_exp_f32 v81, v81
    v_exp_f32 v82, v82
    v_mfma_f32_32x32x16_bf16 v[224:239], v[172:175], v[52:55], v[224:239]
    s_waitcnt lgkmcnt(0)
    s_barrier
    v_exp_f32 v83, v83
    v_exp_f32 v84, v84
    v_exp_f32 v85, v85
    v_smfmac_f32_16x16x64_bf16 v[160:163], v[188:191], v[64:71], v15
    ds_read_b128 v[176:179], v14 offset:2048
    v_exp_f32 v86, v86
    v_exp_f32 v87, v87
    v_smfmac_f32_16x16x64_bf16 v[160:163], v[188:191], v[72:79], v15
    ds_read_b128 v[180:183], v14 offset:3072
    v_exp_f32 v88, v88
    v_exp_f32 v89, v89
    v_smfmac_f32_32x32x32_bf16 v[128:143], v[112:115], v[64:71], v15
    s_and_b32 s90, s90, 0x3ffff
    buffer_load_dwordx4 v13, s[4:7], s90 offen offset:0 sc1 lds
    v_exp_f32 v90, v90
    v_exp_f32 v91, v91
    v_exp_f32 v92, v92
    v_smfmac_f32_32x32x32_bf16 v[128:143], v[116:119], v[72:79], v15
    buffer_load_dwordx4 v13, s[4:7], s90 offen offset:1024 sc1 lds
    s_add_u32 s90, s90, 8192
    v_exp_f32 v93, v93
    v_exp_f32 v94, v94
    v_exp_f32 v95, v95
    v_mfma_f32_32x32x16_bf16 v[240:255], v[168:171], v[56:59], 0
    s_add_u32 m0, s89, 24576
    v_exp_f32 v224, v224
    v_exp_f32 v225, v225
    v_exp_f32 v226, v226
    v_mfma_f32_32x32x16_bf16 v[240:255], v[172:175], v[60:63], v[240:255]
    s_waitcnt lgkmcnt(0)
    v_exp_f32 v227, v227
    v_exp_f32 v228, v228
    v_exp_f32 v229, v229
    v_smfmac_f32_16x16x64_bf16 v[164:167], v[188:191], v[80:87], v15
    ds_read_b128 v[104:107], v14 offset:0
    v_exp_f32 v230, v230
    v_exp_f32 v231, v231
    v_smfmac_f32_16x16x64_bf16 v[164:167], v[188:191], v[88:95], v15
    ds_read_b128 v[108:111], v14 offset:1024
    v_exp_f32 v232, v232
    v_exp_f32 v233, v233
    v_smfmac_f32_32x32x32_bf16 v[144:159], v[112:115], v[80:87], v15
    s_and_b32 s90, s90, 0x3ffff
    buffer_load_dwordx4 v13, s[4:7], s90 offen offset:0 sc1 lds
    v_exp_f32 v234, v234
    v_exp_f32 v235, v235
    v_exp_f32 v236, v236
    v_smfmac_f32_32x32x32_bf16 v[144:159], v[116:119], v[88:95], v15
    buffer_load_dwordx4 v13, s[4:7], s90 offen offset:1024 sc1 lds
    s_add_u32 s90, s90, 8192
    v_exp_f32 v237, v237
    v_exp_f32 v238, v238
    v_exp_f32 v239, v239
L_att_in:
    v_mfma_f32_32x32x16_bf16 v[64:79], v[176:179], v[48:51], 0
    s_mov_b32 m0, s87
    v_exp_f32 v240, v240
    v_exp_f32 v241, v241
    v_exp_f32 v242, v242
    v_mfma_f32_32x32x16_bf16 v[64:79], v[180:183], v[52:55], v[64:79]
    s_waitcnt lgkmcnt(0)
    v_exp_f32 v243, v243
    v_exp_f32 v244, v244
    v_exp_f32 v245, v245
    v_smfmac_f32_16x16x64_bf16 v[160:163], v[188:191], v[224:231], v15
    ds_read_b128 v[168:171], v14 offset:6144
    v_exp_f32 v246, v246
    v_exp_f32 v247, v247
    v_smfmac_f32_16x16x64_bf16 v[160:163], v[188:191], v[232:239], v15
    ds_read_b128 v[172:175], v14 offset:7168
    v_exp_f32 v248, v248
    v_exp_f32 v249, v249
    v_smfmac_f32_32x32x32_bf16 v[128:143], v[104:107], v[224:231], v15
    s_and_b32 s86, s86, s57
    buffer_load_dwordx4 v8, s[24:27], s86 offen lds
    v_exp_f32 v250, v250
    v_exp_f32 v251, v251
    v_exp_f32 v252, v252
    v_smfmac_f32_32x32x32_bf16 v[128:143], v[108:111], v[232:239], v15
    s_add_u32 s86, s86, s88
    s_add_u32 s87, s87, 1024
    v_exp_f32 v253, v253
    v_exp_f32 v254, v254
    v_exp_f32 v255, v255
    v_mfma_f32_32x32x16_bf16 v[80:95], v[176:179], v[56:59], 0
    s_mov_b32 m0, s87
    v_exp_f32 v64, v64
    v_exp_f32 v65, v65
    v_exp_f32 v66, v66
    v_mfma_f32_32x32x16_bf16 v[80:95], v[180:183], v[60:63], v[80:95]
    s_waitcnt lgkmcnt(0)
    v_exp_f32 v67, v67
    v_exp_f32 v68, v68
    v_exp_f32 v69, v69
    v_smfmac_f32_16x16x64_bf16 v[164:167], v[188:191], v[240:247], v15
    ds_read_b128 v[112:115], v14 offset:4096
    v_exp_f32 v70, v70
    v_exp_f32 v71, v71
L_hop4:
    s_cbranch_execz L_hop8
    v_smfmac_f32_16x16x64_bf16 v[164:167], v[188:191], v[248:255], v15
    ds_read_b128 v[116:119], v14 offset:5120
    v_exp_f32 v72, v72
    v_exp_f32 v73, v73
    v_smfmac_f32_32x32x32_bf16 v[144:159], v[104:107], v[240:247], v15
    s_and_b32 s86, s86, s57
    buffer_load_dwordx4 v8, s[24:27], s86 offen lds
    v_exp_f32 v74, v74
    v_exp_f32 v75, v75
    v_exp_f32 v76, v76
    v_smfmac_f32_32x32x32_bf16 v[144:159], v[108:111], v[248:255], v15
    s_add_u32 s86, s86, s88
    s_add_u32 s87, s87, 1024
    v_exp_f32 v77, v77
    v_exp_f32 v78, v78
    v_exp_f32 v79, v79
    v_mfma_f32_32x32x16_bf16 v[224:239], v[168:171], v[48:51], 0
    v_exp_f32 v80, v80
    v_exp_f32 v81, v81
    v_exp_f32 v82, v82
    v_mfma_f32_32x32x16_bf16 v[224:239], v[172:175], v[52:55], v[224:239]
    s_waitcnt lgkmcnt(0)
    v_exp_f32 v83, v83
    v_exp_f32 v84, v84
    v_exp_f32 v85, v85
    v_smfmac_f32_16x16x64_bf16 v[160:163], v[188:191], v[64:71], v15
    ds_read_b128 v[176:179], v14 offset:10240
    v_exp_f32 v86, v86
    v_exp_f32 v87, v87
    v_smfmac_f32_16x16x64_bf16 v[160:163], v[188:191], v[72:79], v15
    ds_read_b128 v[180:183], v14 offset:11264
    v_exp_f32 v88, v88
    v_exp_f32 v89, v89
    v_smfmac_f32_32x32x32_bf16 v[128:143], v[112:115], v[64:71], v15
    buffer_load_dwordx4 a[64:67], v1, s[4:7], s93 offen sc1
    v_exp_f32 v90, v90
    v_exp_f32 v91, v91
    v_exp_f32 v92, v92
    v_smfmac_f32_32x32x32_bf16 v[128:143], v[116:119], v[72:79], v15
    s_add_u32 s93, s93, 16384
    v_exp_f32 v93, v93
    v_exp_f32 v94, v94
    v_exp_f32 v95, v95
    v_mfma_f32_32x32x16_bf16 v[240:255], v[168:171], v[56:59], 0
    v_exp_f32 v224, v224
    v_exp_f32 v225, v225
    v_exp_f32 v226, v226
    v_mfma_f32_32x32x16_bf16 v[240:255], v[172:175], v[60:63], v[240:255]
    s_waitcnt lgkmcnt(0)
    v_exp_f32 v227, v227
    v_exp_f32 v228, v228
    v_exp_f32 v229, v229
    v_smfmac_f32_16x16x64_bf16 v[164:167], v[188:191], v[80:87], v15
    ds_read_b128 v[104:107], v14 offset:8192
    v_exp_f32 v230, v230
    v_exp_f32 v231, v231
    v_smfmac_f32_16x16x64_bf16 v[164:167], v[188:191], v[88:95], v15
    ds_read_b128 v[108:111], v14 offset:9216
    v_exp_f32 v232, v232
    v_exp_f32 v233, v233
    v_smfmac_f32_32x32x32_bf16 v[144:159], v[112:115], v[80:87], v15
    v_exp_f32 v234, v234
    v_exp_f32 v235, v235
    v_exp_f32 v236, v236
    v_smfmac_f32_32x32x32_bf16 v[144:159], v[116:119], v[88:95], v15
    v_exp_f32 v237, v237
    v_exp_f32 v238, v238
    v_exp_f32 v239, v239
    v_mfma_f32_32x32x16_bf16 v[64:79], v[176:179], v[48:51], 0
    v_exp_f32 v240, v240
    v_exp_f32 v241, v241
    v_exp_f32 v242, v242
    v_mfma_f32_32x32x16_bf16 v[64:79], v[180:183], v[52:55], v[64:79]
    s_waitcnt lgkmcnt(0)
    v_exp_f32 v243, v243
    v_exp_f32 v244, v244
    v_exp_f32 v245, v245
    v_smfmac_f32_16x16x64_bf16 v[160:163], v[188:191], v[224:231], v15
    ds_read_b128 v[168:171], v14 offset:14336
    v_exp_f32 v246, v246
    v_exp_f32 v247, v247
    v_smfmac_f32_16x16x64_bf16 v[160:163], v[188:191], v[232:239], v15
    ds_read_b128 v[172:175], v14 offset:15360
    v_exp_f32 v248, v248
    v_exp_f32 v249, v249
    v_smfmac_f32_32x32x32_bf16 v[128:143], v[104:107], v[224:231], v15
    v_exp_f32 v250, v250
    v_exp_f32 v251, v251
    v_exp_f32 v252, v252
    v_smfmac_f32_32x32x32_bf16 v[128:143], v[108:111], v[232:239], v15
    v_exp_f32 v253, v253
    v_exp_f32 v254, v254
    v_exp_f32 v255, v255
    v_mfma_f32_32x32x16_bf16 v[80:95], v[176:179], v[56:59], 0
    v_exp_f32 v64, v64
    v_exp_f32 v65, v65
    v_exp_f32 v66, v66
    v_mfma_f32_32x32x16_bf16 v[80:95], v[180:183], v[60:63], v[80:95]
    s_waitcnt lgkmcnt(0)
    v_exp_f32 v67, v67
    v_exp_f32 v68, v68
    v_exp_f32 v69, v69
    v_smfmac_f32_16x16x64_bf16 v[164:167], v[188:191], v[240:247], v15
    ds_read_b128 v[112:115], v14 offset:12288
    v_exp_f32 v70, v70
    v_exp_f32 v71, v71
    v_smfmac_f32_16x16x64_bf16 v[164:167], v[188:191], v[248:255], v15
    ds_read_b128 v[116:119], v14 offset:13312
    v_exp_f32 v72, v72
    v_exp_f32 v73, v73
    v_smfmac_f32_32x32x32_bf16 v[144:159], v[104:107], v[240:247], v15
    s_add_u32 m0, s89, 0
    v_exp_f32 v74, v74
    v_exp_f32 v75, v75
    v_exp_f32 v76, v76
    v_smfmac_f32_32x32x32_bf16 v[144:159], v[108:111], v[248:255], v15
    s_waitcnt vmcnt(3)
    v_exp_f32 v77, v77
    v_exp_f32 v78, v78
    v_exp_f32 v79, v79
    v_mfma_f32_32x32x16_bf16 v[224:239], v[168:171], v[48:51], 0
    v_exp_f32 v80, v80
    v_exp_f32 v81, v81
    v_exp_f32 v82, v82
    v_mfma_f32_32x32x16_bf16 v[224:239], v[172:175], v[52:55], v[224:239]
    s_waitcnt lgkmcnt(0)
    s_barrier
    v_exp_f32 v83, v83
    v_exp_f32 v84, v84
    v_exp_f32 v85, v85
    v_smfmac_f32_16x16x64_bf16 v[160:163], v[188:191], v[64:71], v15
    ds_read_b128 v[176:179], v14 offset:18432
    v_exp_f32 v86, v86
    v_exp_f32 v87, v87
    v_smfmac_f32_16x16x64_bf16 v[160:163], v[188:191], v[72:79], v15
    ds_read_b128 v[180:183], v14 offset:19456
    v_exp_f32 v88, v88
    v_exp_f32 v89, v89
    v_smfmac_f32_32x32x32_bf16 v[128:143], v[112:115], v[64:71], v15
    s_and_b32 s90, s90, 0x3ffff
    buffer_load_dwordx4 v13, s[4:7], s90 offen offset:0 sc1 lds
    v_exp_f32 v90, v90
    v_exp_f32 v91, v91
    v_exp_f32 v92, v92
    v_smfmac_f32_32x32x32_bf16 v[128:143], v[116:119], v[72:79], v15
    buffer_load_dwordx4 v13, s[4:7], s90 offen offset:1024 sc1 lds
    s_add_u32 s90, s90, 8192
    v_exp_f32 v93, v93
    v_exp_f32 v94, v94
    v_exp_f32 v95, v95
    v_mfma_f32_32x32x16_bf16 v[240:255], v[168:171], v[56:59], 0
    s_add_u32 m0, s89, 8192
    v_exp_f32 v224, v224
    v_exp_f32 v225, v225
    v_exp_f32 v226, v226
    v_mfma_f32_32x32x16_bf16 v[240:255], v[172:175], v[60:63], v[240:255]
    s_waitcnt lgkmcnt(0)
    v_exp_f32 v227, v227
    v_exp_f32 v228, v228
    v_exp_f32 v229, v229
    v_smfmac_f32_16x16x64_bf16 v[164:167], v[188:191], v[80:87], v15
    ds_read_b128 v[104:107], v14 offset:16384
    v_exp_f32 v230, v230
    v_exp_f32 v231, v231
    v_smfmac_f32_16x16x64_bf16 v[164:167], v[188:191], v[88:95], v15
    ds_read_b128 v[108:111], v14 offset:17408
    v_exp_f32 v232, v232
    v_exp_f32 v233, v233
    v_smfmac_f32_32x32x32_bf16 v[144:159], v[112:115], v[80:87], v15
    s_and_b32 s90, s90, 0x3ffff
    buffer_load_dwordx4 v13, s[4:7], s90 offen offset:0 sc1 lds
    v_exp_f32 v234, v234
    v_exp_f32 v235, v235
    v_exp_f32 v236, v236
    v_smfmac_f32_32x32x32_bf16 v[144:159], v[116:119], v[88:95], v15
    buffer_load_dwordx4 v13, s[4:7], s90 offen offset:1024 sc1 lds
    s_add_u32 s90, s90, 8192
    v_exp_f32 v237, v237
    v_exp_f32 v238, v238
    v_exp_f32 v239, v239
    v_mfma_f32_32x32x16_bf16 v[64:79], v[176:179], v[48:51], 0
    s_mov_b32 m0, s87
    v_exp_f32 v240, v240
    v_exp_f32 v241, v241
    v_exp_f32 v242, v242
    v_mfma_f32_32x32x16_bf16 v[64:79], v[180:183], v[52:55], v[64:79]
    s_waitcnt lgkmcnt(0)
    v_exp_f32 v243, v243
    v_exp_f32 v244, v244
    v_exp_f32 v245, v245
    v_smfmac_f32_16x16x64_bf16 v[160:163], v[188:191], v[224:231], v15
    ds_read_b128 v[168:171], v14 offset:22528
    v_exp_f32 v246, v246
    v_exp_f32 v247, v247
    v_smfmac_f32_16x16x64_bf16 v[160:163], v[188:191], v[232:239], v15
    ds_read_b128 v[172:175], v14 offset:23552
    v_exp_f32 v248, v248
    v_exp_f32 v249, v249
    v_smfmac_f32_32x32x32_bf16 v[128:143], v[104:107], v[224:231], v15
    s_and_b32 s86, s86, s57
    buffer_load_dwordx4 v8, s[24:27], s86 offen lds
    v_exp_f32 v250, v250
    v_exp_f32 v251, v251
    v_exp_f32 v252, v252
    v_smfmac_f32_32x32x32_bf16 v[128:143], v[108:111], v[232:239], v15
    s_add_u32 s86, s86, s88
    s_add_u32 s87, s87, 1024
    v_exp_f32 v253, v253
    v_exp_f32 v254, v254
    v_exp_f32 v255, v255
    v_mfma_f32_32x32x16_bf16 v[80:95], v[176:179], v[56:59], 0
    s_mov_b32 m0, s87
    v_exp_f32 v64, v64
    v_exp_f32 v65, v65
    v_exp_f32 v66, v66
    v_mfma_f32_32x32x16_bf16 v[80:95], v[180:183], v[60:63], v[80:95]
    s_waitcnt lgkmcnt(0)
    v_exp_f32 v67, v67
    v_exp_f32 v68, v68
    v_exp_f32 v69, v69
    v_smfmac_f32_16x16x64_bf16 v[164:167], v[188:191], v[240:247], v15
    ds_read_b128 v[112:115], v14 offset:20480
    v_exp_f32 v70, v70
    v_exp_f32 v71, v71
    v_smfmac_f32_16x16x64_bf16 v[164:167], v[188:191], v[248:255], v15
    ds_read_b128 v[116:119], v14 offset:21504
    v_exp_f32 v72, v72
    v_exp_f32 v73, v73
    v_smfmac_f32_32x32x32_bf16 v[144:159], v[104:107], v[240:247], v15
    s_and_b32 s86, s86, s57
    buffer_load_dwordx4 v8, s[24:27], s86 offen lds
    v_exp_f32 v74, v74
    v_exp_f32 v75, v75
    v_exp_f32 v76, v76
    v_smfmac_f32_32x32x32_bf16 v[144:159], v[108:111], v[248:255], v15
    s_add_u32 s86, s86, s88
    s_add_u32 s87, s87, 1024
    v_exp_f32 v77, v77
    v_exp_f32 v78, v78
    v_exp_f32 v79, v79
    v_mfma_f32_32x32x16_bf16 v[224:239], v[168:171], v[48:51], 0
    v_exp_f32 v80, v80
    v_exp_f32 v81, v81
    v_exp_f32 v82, v82
    v_mfma_f32_32x32x16_bf16 v[224:239], v[172:175], v[52:55], v[224:239]
    s_waitcnt lgkmcnt(0)
    v_exp_f32 v83, v83
    v_exp_f32 v84, v84
    v_exp_f32 v85, v85
    v_smfmac_f32_16x16x64_bf16 v[160:163], v[188:191], v[64:71], v15
    ds_read_b128 v[176:179], v14 offset:26624
    v_exp_f32 v86, v86
    v_exp_f32 v87, v87
    v_smfmac_f32_16x16x64_bf16 v[160:163], v[188:191], v[72:79], v15
    ds_read_b128 v[180:183], v14 offset:27648
    v_exp_f32 v88, v88
    v_exp_f32 v89, v89
    v_smfmac_f32_32x32x32_bf16 v[128:143], v[112:115], v[64:71], v15
    v_exp_f32 v90, v90
    v_exp_f32 v91, v91
    v_exp_f32 v92, v92
    v_smfmac_f32_32x32x32_bf16 v[128:143], v[116:119], v[72:79], v15
    v_exp_f32 v93, v93
    v_exp_f32 v94, v94
    v_exp_f32 v95, v95
    v_mfma_f32_32x32x16_bf16 v[240:255], v[168:171], v[56:59], 0
    v_exp_f32 v224, v224
    v_exp_f32 v225, v225
    v_exp_f32 v226, v226
    v_mfma_f32_32x32x16_bf16 v[240:255], v[172:175], v[60:63], v[240:255]
    s_waitcnt lgkmcnt(0)
    v_exp_f32 v227, v227
    v_exp_f32 v228, v228
    v_exp_f32 v229, v229
    v_smfmac_f32_16x16x64_bf16 v[164:167], v[188:191], v[80:87], v15
    ds_read_b128 v[104:107], v14 offset:24576
    v_exp_f32 v230, v230
    v_exp_f32 v231, v231
    v_smfmac_f32_16x16x64_bf16 v[164:167], v[188:191], v[88:95], v15
    ds_read_b128 v[108:111], v14 offset:25600
    v_exp_f32 v232, v232
    v_exp_f32 v233, v233
    v_smfmac_f32_32x32x32_bf16 v[144:159], v[112:115], v[80:87], v15
    v_exp_f32 v234, v234
    v_exp_f32 v235, v235
    v_exp_f32 v236, v236
    v_smfmac_f32_32x32x32_bf16 v[144:159], v[116:119], v[88:95], v15
    v_exp_f32 v237, v237
    v_exp_f32 v238, v238
    v_exp_f32 v239, v239
    v_mfma_f32_32x32x16_bf16 v[64:79], v[176:179], v[48:51], 0
    v_exp_f32 v240, v240
    v_exp_f32 v241, v241
    v_exp_f32 v242, v242
    v_mfma_f32_32x32x16_bf16 v[64:79], v[180:183], v[52:55], v[64:79]
    s_waitcnt lgkmcnt(0)
    v_exp_f32 v243, v243
    v_exp_f32 v244, v244
    v_exp_f32 v245, v245
    v_smfmac_f32_16x16x64_bf16 v[160:163], v[188:191], v[224:231], v15
    ds_read_b128 v[168:171], v14 offset:30720
    v_exp_f32 v246, v246
    v_exp_f32 v247, v247
    v_smfmac_f32_16x16x64_bf16 v[160:163], v[188:191], v[232:239], v15
    ds_read_b128 v[172:175], v14 offset:31744
    v_exp_f32 v248, v248
    v_exp_f32 v249, v249
    v_smfmac_f32_32x32x32_bf16 v[128:143], v[104:107], v[224:231], v15
    s_add_u32 s84, s84, 1
    v_exp_f32 v250, v250
    v_exp_f32 v251, v251
    v_exp_f32 v252, v252
    v_smfmac_f32_32x32x32_bf16 v[128:143], v[108:111], v[232:239], v15
    v_exp_f32 v253, v253
    v_exp_f32 v254, v254
    v_exp_f32 v255, v255
    v_mfma_f32_32x32x16_bf16 v[80:95], v[176:179], v[56:59], 0
    v_exp_f32 v64, v64
    v_exp_f32 v65, v65
    v_exp_f32 v66, v66
    v_mfma_f32_32x32x16_bf16 v[80:95], v[180:183], v[60:63], v[80:95]
    s_waitcnt lgkmcnt(0)
    v_exp_f32 v67, v67
    v_exp_f32 v68, v68
    v_exp_f32 v69, v69
    v_smfmac_f32_16x16x64_bf16 v[164:167], v[188:191], v[240:247], v15
    ds_read_b128 v[112:115], v14 offset:28672
    v_exp_f32 v70, v70
    v_exp_f32 v71, v71
    v_smfmac_f32_16x16x64_bf16 v[164:167], v[188:191], v[248:255], v15
    ds_read_b128 v[116:119], v14 offset:29696
    v_exp_f32 v72, v72
    v_exp_f32 v73, v73
    v_smfmac_f32_32x32x32_bf16 v[144:159], v[104:107], v[240:247], v15
    s_add_u32 m0, s89, 16384
    v_exp_f32 v74, v74
    v_exp_f32 v75, v75
    v_exp_f32 v76, v76
    v_smfmac_f32_32x32x32_bf16 v[144:159], v[108:111], v[248:255], v15
    s_waitcnt vmcnt(2)
    s_cmp_lt_u32 s84, s85
    v_exp_f32 v77, v77
    v_exp_f32 v78, v78
    v_exp_f32 v79, v79
    s_cbranch_scc1 L_att_a
    s_cmp_lt_u32 s84, 8
    s_cbranch_scc1 L_pack_a
L_att_tail:
    v_smfmac_f32_16x16x64_bf16 v[160:163], v[188:191], v[64:71], v15
    s_waitcnt lgkmcnt(0)
    v_exp_f32 v80, v80
    v_exp_f32 v81, v81
    v_exp_f32 v82, v82
    v_smfmac_f32_32x32x32_bf16 v[128:143], v[112:115], v[64:71], v15
    v_exp_f32 v83, v83
    v_exp_f32 v84, v84
    v_exp_f32 v85, v85
    v_smfmac_f32_32x32x32_bf16 v[128:143], v[116:119], v[72:79], v15
    v_exp_f32 v86, v86
    v_exp_f32 v87, v87
    v_exp_f32 v88, v88
    v_smfmac_f32_16x16x64_bf16 v[160:163], v[188:191], v[72:79], v15
    v_exp_f32 v89, v89
    v_exp_f32 v90, v90
    v_smfmac_f32_32x32x32_bf16 v[144:159], v[112:115], v[80:87], v15
    v_exp_f32 v91, v91
    v_exp_f32 v92, v92
    v_exp_f32 v93, v93
    v_smfmac_f32_16x16x64_bf16 v[164:167], v[188:191], v[80:87], v15
    v_exp_f32 v94, v94
    v_exp_f32 v95, v95
    s_nop 1
    v_smfmac_f32_16x16x64_bf16 v[164:167], v[188:191], v[88:95], v15
    v_smfmac_f32_32x32x32_bf16 v[144:159], v[116:119], v[88:95], v15
    s_lshl_b32 s93, s54, 16
    s_lshl_b32 s60, s53, 12
    s_add_u32 s93, s93, s60
    s_lshr_b32 s94, s93, 4
    s_add_u32 s93, s93, s56
    s_add_u32 s94, s94, s56
    s_add_u32 s93, s93, 5242880
    v_and_b32 v14, 15, v0
    v_lshlrev_b32 v14, 4, v14
    v_bfe_u32 v7, v0, 4, 1
    v_lshl_or_b32 v14, v7, 10, v14
    v_lshrrev_b32 v7, 5, v0
    v_lshl_or_b32 v14, v7, 8, v14
    v_min_f32 v122, v160, v164
    v_add_f32 v123, v160, v164
    v_cmp_nle_f32 vcc, 0x21800000, v122
    s_nop 0
    s_mov_b64 s[62:63], vcc
    v_cmp_nge_f32 vcc, 0x5d800000, v123
    s_nop 0
    s_or_b64 s[62:63], s[62:63], vcc
    s_cbranch_scc1 L_fallback
L_att_fin:
    v_rcp_f32 v122, v160
    v_rcp_f32 v123, v164
    s_nop 0
    v_pk_mul_f32 v[128:129], v[128:129], v[122:123] op_sel:[0,0] op_sel_hi:[1,0]
    v_pk_mul_f32 v[130:131], v[130:131], v[122:123] op_sel:[0,0] op_sel_hi:[1,0]
    v_pk_mul_f32 v[132:133], v[132:133], v[122:123] op_sel:[0,0] op_sel_hi:[1,0]
    v_pk_mul_f32 v[134:135], v[134:135], v[122:123] op_sel:[0,0] op_sel_hi:[1,0]
    v_pk_mul_f32 v[136:137], v[136:137], v[122:123] op_sel:[0,0] op_sel_hi:[1,0]
    v_pk_mul_f32 v[138:139], v[138:139], v[122:123] op_sel:[0,0] op_sel_hi:[1,0]
    v_pk_mul_f32 v[140:141], v[140:141], v[122:123] op_sel:[0,0] op_sel_hi:[1,0]
    v_pk_mul_f32 v[142:143], v[142:143], v[122:123] op_sel:[0,0] op_sel_hi:[1,0]
    v_cvt_pk_bf16_f32 v48, v128, v129
    v_cvt_pk_bf16_f32 v49, v130, v131
    v_cvt_pk_bf16_f32 v50, v132, v133
    v_cvt_pk_bf16_f32 v51, v134, v135
    v_cvt_pk_bf16_f32 v52, v136, v137
    v_cvt_pk_bf16_f32 v53, v138, v139
    v_cvt_pk_bf16_f32 v54, v140, v141
    v_cvt_pk_bf16_f32 v55, v142, v143
    buffer_store_dwordx4 v[48:51], v14, s[4:7], s93 offen offset:0 sc1
    buffer_store_dwordx4 v[52:55], v14, s[4:7], s93 offen offset:512 sc1
    v_pk_mul_f32 v[144:145], v[144:145], v[122:123] op_sel:[0,1] op_sel_hi:[1,1]
    v_pk_mul_f32 v[146:147], v[146:147], v[122:123] op_sel:[0,1] op_sel_hi:[1,1]
    v_pk_mul_f32 v[148:149], v[148:149], v[122:123] op_sel:[0,1] op_sel_hi:[1,1]
    v_pk_mul_f32 v[150:151], v[150:151], v[122:123] op_sel:[0,1] op_sel_hi:[1,1]
    v_pk_mul_f32 v[152:153], v[152:153], v[122:123] op_sel:[0,1] op_sel_hi:[1,1]
    v_pk_mul_f32 v[154:155], v[154:155], v[122:123] op_sel:[0,1] op_sel_hi:[1,1]
    v_pk_mul_f32 v[156:157], v[156:157], v[122:123] op_sel:[0,1] op_sel_hi:[1,1]
    v_pk_mul_f32 v[158:159], v[158:159], v[122:123] op_sel:[0,1] op_sel_hi:[1,1]
    v_cvt_pk_bf16_f32 v56, v144, v145
    v_cvt_pk_bf16_f32 v57, v146, v147
    v_cvt_pk_bf16_f32 v58, v148, v149
    v_cvt_pk_bf16_f32 v59, v150, v151
    v_cvt_pk_bf16_f32 v60, v152, v153
    v_cvt_pk_bf16_f32 v61, v154, v155
    v_cvt_pk_bf16_f32 v62, v156, v157
    v_cvt_pk_bf16_f32 v63, v158, v159
    buffer_store_dwordx4 v[56:59], v14, s[4:7], s93 offen offset:2048 sc1
    buffer_store_dwordx4 v[60:63], v14, s[4:7], s93 offen offset:2560 sc1
    s_mov_b32 s97, 1
    s_or_b32 s64, s48, s55
    s_cbranch_scc1 L_nopk
    s_atomic_add s97, s[4:5], s91 offset:131080 glc
L_nopk:
    s_mul_i32 s85, s54, 65536
    s_add_u32 s85, s85, s56
    s_add_u32 s85, s85, 5242880
    v_add_u32 v8, s85, v1
    v_add_u32 v124, 4096, v8
    s_xor_b32 s85, s48, 0
    s_lshl1_add_u32 s85, s85, s3
    s_lshl_b32 s85, s85, 13
    s_and_b32 s68, s85, 0xffff
    s_add_u32 s85, s85, 8192
    s_and_b32 s69, s85, 0xffff
    s_xor_b32 s85, s48, 1
    s_lshl1_add_u32 s85, s85, s3
    s_lshl_b32 s85, s85, 13
    s_and_b32 s70, s85, 0xffff
    s_add_u32 s85, s85, 8192
    s_and_b32 s71, s85, 0xffff
    s_xor_b32 s85, s48, 3
    s_lshl1_add_u32 s85, s85, s3
    s_lshl_b32 s85, s85, 13
    s_and_b32 s72, s85, 0xffff
    s_add_u32 s85, s85, 8192
    s_and_b32 s73, s85, 0xffff
    s_xor_b32 s85, s48, 2
    s_lshl1_add_u32 s85, s85, s3
    s_lshl_b32 s85, s85, 13
    s_and_b32 s74, s85, 0xffff
    s_add_u32 s85, s85, 8192
    s_and_b32 s75, s85, 0xffff
    v_xor_b32 v9, 0, v3
    v_xor_b32 v10, 32, v3
    v_xor_b32 v11, 64, v3
    v_xor_b32 v12, 96, v3
    v_and_b32 v13, 48, v4
    s_lshl_b32 s60, s53, 7
    s_mul_i32 s62, s49, 2048
    s_mul_i32 s95, s52, 917504
    s_add_u32 s95, s95, s96
    s_add_u32 s95, s95, 1048576
    s_waitcnt vmcnt(0) lgkmcnt(0)
    s_mov_b32 s57, 1
    s_atomic_add s57, s[4:5], s59 offset:8 glc
    s_waitcnt lgkmcnt(0)
    s_add_u32 s57, s57, 1
    s_mov_b32 s58, 0
L_poll_9:
    s_waitcnt lgkmcnt(0)
    s_cmp_ge_u32 s57, 16
    s_cbranch_scc1 L_polled_10
    s_add_u32 s58, s58, 1
    s_cmp_ge_u32 s58, 0x20000
    s_cbranch_scc1 L_polled_10
    s_mov_b32 s57, 0
    s_atomic_add s57, s[4:5], s59 offset:8 glc
    s_branch L_poll_9
L_polled_10:
    s_cmp_eq_u32 s97, 15
    s_cbranch_scc1 L_slow_11
L_back_12:
    buffer_load_dwordx4 a[0:3], v8, s[4:7], s68 offen offset:0 sc1
    buffer_load_dwordx4 a[4:7], v8, s[4:7], s68 offen offset:1024 sc1
    buffer_load_dwordx4 a[8:11], v8, s[4:7], s68 offen offset:2048 sc1
    buffer_load_dwordx4 a[12:15], v8, s[4:7], s68 offen offset:3072 sc1
    buffer_load_dwordx4 a[16:19], v124, s[4:7], s68 offen offset:0 sc1
    buffer_load_dwordx4 a[20:23], v124, s[4:7], s68 offen offset:1024 sc1
    buffer_load_dwordx4 a[24:27], v124, s[4:7], s68 offen offset:2048 sc1
    buffer_load_dwordx4 a[28:31], v124, s[4:7], s68 offen offset:3072 sc1
    buffer_load_dwordx4 a[32:35], v8, s[4:7], s69 offen offset:0 sc1
    buffer_load_dwordx4 a[36:39], v8, s[4:7], s69 offen offset:1024 sc1
    buffer_load_dwordx4 a[40:43], v8, s[4:7], s69 offen offset:2048 sc1
    buffer_load_dwordx4 a[44:47], v8, s[4:7], s69 offen offset:3072 sc1
    s_barrier
    ds_read_b64_tr_b16 v[64:65], v9 offset:0
    ds_read_b64_tr_b16 v[66:67], v9 offset:2048
    ds_read_b64_tr_b16 v[68:69], v9 offset:4096
    ds_read_b64_tr_b16 v[70:71], v9 offset:6144
    ds_read_b64_tr_b16 v[72:73], v10 offset:0
    ds_read_b64_tr_b16 v[74:75], v10 offset:2048
    ds_read_b64_tr_b16 v[76:77], v10 offset:4096
    ds_read_b64_tr_b16 v[78:79], v10 offset:6144
    ds_read_b64_tr_b16 v[80:81], v11 offset:0
    ds_read_b64_tr_b16 v[82:83], v11 offset:2048
    s_waitcnt vmcnt(8) lgkmcnt(6)
    v_mfma_f32_16x16x32_bf16 v[16:19], v[64:67], a[0:3], v[16:19]
    ds_read_b64_tr_b16 v[84:85], v11 offset:4096
    v_mfma_f32_16x16x32_bf16 v[16:19], v[68:71], a[8:11], v[16:19]
    ds_read_b64_tr_b16 v[86:87], v11 offset:6144
    buffer_load_dwordx4 a[48:51], v124, s[4:7], s69 offen offset:0 sc1
    v_mfma_f32_16x16x32_bf16 v[24:27], v[68:71], a[12:15], v[24:27]
    ds_read_b64_tr_b16 v[88:89], v12 offset:0
    v_mfma_f32_16x16x32_bf16 v[24:27], v[64:67], a[4:7], v[24:27]
    s_waitcnt lgkmcnt(5)
    ds_read_b64_tr_b16 v[90:91], v12 offset:2048
    v_mfma_f32_16x16x32_bf16 v[28:31], v[72:75], a[4:7], v[28:31]
    ds_read_b64_tr_b16 v[92:93], v12 offset:4096
    v_mfma_f32_16x16x32_bf16 v[28:31], v[76:79], a[12:15], v[28:31]
    ds_read_b64_tr_b16 v[94:95], v12 offset:6144
    buffer_load_dwordx4 a[52:55], v124, s[4:7], s69 offen offset:1024 sc1
    v_mfma_f32_16x16x32_bf16 v[20:23], v[76:79], a[8:11], v[20:23]
    ds_read_b64_tr_b16 v[64:65], v9 offset:8192
    v_mfma_f32_16x16x32_bf16 v[20:23], v[72:75], a[0:3], v[20:23]
    s_waitcnt lgkmcnt(5)
    ds_read_b64_tr_b16 v[66:67], v9 offset:10240
    v_mfma_f32_16x16x32_bf16 v[32:35], v[80:83], a[0:3], v[32:35]
    ds_read_b64_tr_b16 v[68:69], v9 offset:12288
    v_mfma_f32_16x16x32_bf16 v[32:35], v[84:87], a[8:11], v[32:35]
    ds_read_b64_tr_b16 v[70:71], v9 offset:14336
    buffer_load_dwordx4 a[56:59], v124, s[4:7], s69 offen offset:2048 sc1
    v_mfma_f32_16x16x32_bf16 v[40:43], v[84:87], a[12:15], v[40:43]
    ds_read_b64_tr_b16 v[72:73], v10 offset:8192
    v_mfma_f32_16x16x32_bf16 v[40:43], v[80:83], a[4:7], v[40:43]
    s_waitcnt lgkmcnt(5)
    ds_read_b64_tr_b16 v[74:75], v10 offset:10240
    v_mfma_f32_16x16x32_bf16 v[44:47], v[88:91], a[4:7], v[44:47]
    ds_read_b64_tr_b16 v[76:77], v10 offset:12288
    v_mfma_f32_16x16x32_bf16 v[44:47], v[92:95], a[12:15], v[44:47]
    ds_read_b64_tr_b16 v[78:79], v10 offset:14336
    buffer_load_dwordx4 a[60:63], v124, s[4:7], s69 offen offset:3072 sc1
    v_mfma_f32_16x16x32_bf16 v[36:39], v[92:95], a[8:11], v[36:39]
    ds_read_b64_tr_b16 v[80:81], v11 offset:8192
    v_mfma_f32_16x16x32_bf16 v[36:39], v[88:91], a[0:3], v[36:39]
    s_waitcnt vmcnt(8) lgkmcnt(5)
    ds_read_b64_tr_b16 v[82:83], v11 offset:10240
    v_mfma_f32_16x16x32_bf16 v[16:19], v[64:67], a[16:19], v[16:19]
    ds_read_b64_tr_b16 v[84:85], v11 offset:12288
    v_mfma_f32_16x16x32_bf16 v[16:19], v[68:71], a[24:27], v[16:19]
    ds_read_b64_tr_b16 v[86:87], v11 offset:14336
    buffer_load_dwordx4 a[64:67], v8, s[4:7], s70 offen offset:0 sc1
    v_mfma_f32_16x16x32_bf16 v[24:27], v[68:71], a[28:31], v[24:27]
    ds_read_b64_tr_b16 v[88:89], v12 offset:8192
    v_mfma_f32_16x16x32_bf16 v[24:27], v[64:67], a[20:23], v[24:27]
    s_waitcnt lgkmcnt(5)
    ds_read_b64_tr_b16 v[90:91], v12 offset:10240
    v_mfma_f32_16x16x32_bf16 v[28:31], v[72:75], a[20:23], v[28:31]
    ds_read_b64_tr_b16 v[92:93], v12 offset:12288
    v_mfma_f32_16x16x32_bf16 v[28:31], v[76:79], a[28:31], v[28:31]
    ds_read_b64_tr_b16 v[94:95], v12 offset:14336
    buffer_load_dwordx4 a[68:71], v8, s[4:7], s70 offen offset:1024 sc1
    v_mfma_f32_16x16x32_bf16 v[20:23], v[76:79], a[24:27], v[20:23]
    ds_read_b64_tr_b16 v[64:65], v9 offset:16384
    v_mfma_f32_16x16x32_bf16 v[20:23], v[72:75], a[16:19], v[20:23]
    s_waitcnt lgkmcnt(5)
    ds_read_b64_tr_b16 v[66:67], v9 offset:18432
    v_mfma_f32_16x16x32_bf16 v[32:35], v[80:83], a[16:19], v[32:35]
    ds_read_b64_tr_b16 v[68:69], v9 offset:20480
    v_mfma_f32_16x16x32_bf16 v[32:35], v[84:87], a[24:27], v[32:35]
    ds_read_b64_tr_b16 v[70:71], v9 offset:22528
    buffer_load_dwordx4 a[72:75], v8, s[4:7], s70 offen offset:2048 sc1
    v_mfma_f32_16x16x32_bf16 v[40:43], v[84:87], a[28:31], v[40:43]
    ds_read_b64_tr_b16 v[72:73], v10 offset:16384
    v_mfma_f32_16x16x32_bf16 v[40:43], v[80:83], a[20:23], v[40:43]
    s_waitcnt lgkmcnt(5)
    ds_read_b64_tr_b16 v[74:75], v10 offset:18432
    v_mfma_f32_16x16x32_bf16 v[44:47], v[88:91], a[20:23], v[44:47]
    ds_read_b64_tr_b16 v[76:77], v10 offset:20480
    v_mfma_f32_16x16x32_bf16 v[44:47], v[92:95], a[28:31], v[44:47]
    ds_read_b64_tr_b16 v[78:79], v10 offset:22528
    buffer_load_dwordx4 a[76:79], v8, s[4:7], s70 offen offset:3072 sc1
    v_mfma_f32_16x16x32_bf16 v[36:39], v[92:95], a[24:27], v[36:39]
    ds_read_b64_tr_b16 v[80:81], v11 offset:16384
    v_mfma_f32_16x16x32_bf16 v[36:39], v[88:91], a[16:19], v[36:39]
    s_waitcnt vmcnt(8) lgkmcnt(5)
    ds_read_b64_tr_b16 v[82:83], v11 offset:18432
    v_mfma_f32_16x16x32_bf16 v[16:19], v[64:67], a[32:35], v[16:19]
    ds_read_b64_tr_b16 v[84:85], v11 offset:20480
    v_mfma_f32_16x16x32_bf16 v[16:19], v[68:71], a[40:43], v[16:19]
    ds_read_b64_tr_b16 v[86:87], v11 offset:22528
    buffer_load_dwordx4 a[80:83], v124, s[4:7], s70 offen offset:0 sc1
    v_mfma_f32_16x16x32_bf16 v[24:27], v[68:71], a[44:47], v[24:27]
    ds_read_b64_tr_b16 v[88:89], v12 offset:16384
    v_mfma_f32_16x16x32_bf16 v[24:27], v[64:67], a[36:39], v[24:27]
    s_waitcnt lgkmcnt(5)
    ds_read_b64_tr_b16 v[90:91], v12 offset:18432
    v_mfma_f32_16x16x32_bf16 v[28:31], v[72:75], a[36:39], v[28:31]
    ds_read_b64_tr_b16 v[92:93], v12 offset:20480
    v_mfma_f32_16x16x32_bf16 v[28:31], v[76:79], a[44:47], v[28:31]
    ds_read_b64_tr_b16 v[94:95], v12 offset:22528
    buffer_load_dwordx4 a[84:87], v124, s[4:7], s70 offen offset:1024 sc1
    v_mfma_f32_16x16x32_bf16 v[20:23], v[76:79], a[40:43], v[20:23]
    ds_read_b64_tr_b16 v[64:65], v9 offset:24576
    v_mfma_f32_16x16x32_bf16 v[20:23], v[72:75], a[32:35], v[20:23]
    s_waitcnt lgkmcnt(5)
    ds_read_b64_tr_b16 v[66:67], v9 offset:26624
    v_mfma_f32_16x16x32_bf16 v[32:35], v[80:83], a[32:35], v[32:35]
    ds_read_b64_tr_b16 v[68:69], v9 offset:28672
    v_mfma_f32_16x16x32_bf16 v[32:35], v[84:87], a[40:43], v[32:35]
    ds_read_b64_tr_b16 v[70:71], v9 offset:30720
    buffer_load_dwordx4 a[88:91], v124, s[4:7], s70 offen offset:2048 sc1
    v_mfma_f32_16x16x32_bf16 v[40:43], v[84:87], a[44:47], v[40:43]
    ds_read_b64_tr_b16 v[72:73], v10 offset:24576
    v_mfma_f32_16x16x32_bf16 v[40:43], v[80:83], a[36:39], v[40:43]
    s_waitcnt lgkmcnt(5)
    ds_read_b64_tr_b16 v[74:75], v10 offset:26624
    v_mfma_f32_16x16x32_bf16 v[44:47], v[88:91], a[36:39], v[44:47]
    ds_read_b64_tr_b16 v[76:77], v10 offset:28672
    v_mfma_f32_16x16x32_bf16 v[44:47], v[92:95], a[44:47], v[44:47]
    ds_read_b64_tr_b16 v[78:79], v10 offset:30720
    buffer_load_dwordx4 a[92:95], v124, s[4:7], s70 offen offset:3072 sc1
    v_mfma_f32_16x16x32_bf16 v[36:39], v[92:95], a[40:43], v[36:39]
    ds_read_b64_tr_b16 v[80:81], v11 offset:24576
    v_mfma_f32_16x16x32_bf16 v[36:39], v[88:91], a[32:35], v[36:39]
    s_waitcnt vmcnt(8) lgkmcnt(5)
    ds_read_b64_tr_b16 v[82:83], v11 offset:26624
    v_mfma_f32_16x16x32_bf16 v[16:19], v[64:67], a[48:51], v[16:19]
    ds_read_b64_tr_b16 v[84:85], v11 offset:28672
    v_mfma_f32_16x16x32_bf16 v[16:19], v[68:71], a[56:59], v[16:19]
    ds_read_b64_tr_b16 v[86:87], v11 offset:30720
    buffer_load_dwordx4 a[96:99], v8, s[4:7], s71 offen offset:0 sc1
    v_mfma_f32_16x16x32_bf16 v[24:27], v[68:71], a[60:63], v[24:27]
    ds_read_b64_tr_b16 v[88:89], v12 offset:24576
    v_mfma_f32_16x16x32_bf16 v[24:27], v[64:67], a[52:55], v[24:27]
    s_waitcnt lgkmcnt(5)
    ds_read_b64_tr_b16 v[90:91], v12 offset:26624
    v_mfma_f32_16x16x32_bf16 v[28:31], v[72:75], a[52:55], v[28:31]
    ds_read_b64_tr_b16 v[92:93], v12 offset:28672
    v_xor_b32 v9, 32768, v9
    v_mfma_f32_16x16x32_bf16 v[28:31], v[76:79], a[60:63], v[28:31]
    ds_read_b64_tr_b16 v[94:95], v12 offset:30720
    buffer_load_dwordx4 a[100:103], v8, s[4:7], s71 offen offset:1024 sc1
    v_mfma_f32_16x16x32_bf16 v[20:23], v[76:79], a[56:59], v[20:23]
    ds_read_b64_tr_b16 v[64:65], v9 offset:0
    v_mfma_f32_16x16x32_bf16 v[20:23], v[72:75], a[48:51], v[20:23]
    s_waitcnt lgkmcnt(5)
    ds_read_b64_tr_b16 v[66:67], v9 offset:2048
    v_mfma_f32_16x16x32_bf16 v[32:35], v[80:83], a[48:51], v[32:35]
    ds_read_b64_tr_b16 v[68:69], v9 offset:4096
    v_xor_b32 v10, 32768, v10
    v_mfma_f32_16x16x32_bf16 v[32:35], v[84:87], a[56:59], v[32:35]
    ds_read_b64_tr_b16 v[70:71], v9 offset:6144
    buffer_load_dwordx4 a[104:107], v8, s[4:7], s71 offen offset:2048 sc1
    v_mfma_f32_16x16x32_bf16 v[40:43], v[84:87], a[60:63], v[40:43]
    ds_read_b64_tr_b16 v[72:73], v10 offset:0
    v_mfma_f32_16x16x32_bf16 v[40:43], v[80:83], a[52:55], v[40:43]
    s_waitcnt lgkmcnt(5)
    ds_read_b64_tr_b16 v[74:75], v10 offset:2048
    v_mfma_f32_16x16x32_bf16 v[44:47], v[88:91], a[52:55], v[44:47]
    ds_read_b64_tr_b16 v[76:77], v10 offset:4096
L_hop5:
    s_cbranch_execz L_hop9
    v_xor_b32 v11, 32768, v11
    v_mfma_f32_16x16x32_bf16 v[44:47], v[92:95], a[60:63], v[44:47]
    ds_read_b64_tr_b16 v[78:79], v10 offset:6144
    buffer_load_dwordx4 a[108:111], v8, s[4:7], s71 offen offset:3072 sc1
    v_mfma_f32_16x16x32_bf16 v[36:39], v[92:95], a[56:59], v[36:39]
    ds_read_b64_tr_b16 v[80:81], v11 offset:0
    v_mfma_f32_16x16x32_bf16 v[36:39], v[88:91], a[48:51], v[36:39]
    s_waitcnt vmcnt(8) lgkmcnt(5)
    ds_read_b64_tr_b16 v[82:83], v11 offset:2048
    v_mfma_f32_16x16x32_bf16 v[16:19], v[64:67], a[64:67], v[16:19]
    ds_read_b64_tr_b16 v[84:85], v11 offset:4096
    v_xor_b32 v12, 32768, v12
    v_mfma_f32_16x16x32_bf16 v[16:19], v[68:71], a[72:75], v[16:19]
    ds_read_b64_tr_b16 v[86:87], v11 offset:6144
    buffer_load_dwordx4 a[112:115], v124, s[4:7], s71 offen offset:0 sc1
    v_mfma_f32_16x16x32_bf16 v[24:27], v[68:71], a[76:79], v[24:27]
    ds_read_b64_tr_b16 v[88:89], v12 offset:0
    v_mfma_f32_16x16x32_bf16 v[24:27], v[64:67], a[68:71], v[24:27]
    s_waitcnt lgkmcnt(5)
    ds_read_b64_tr_b16 v[90:91], v12 offset:2048
    v_mfma_f32_16x16x32_bf16 v[28:31], v[72:75], a[68:71], v[28:31]
    ds_read_b64_tr_b16 v[92:93], v12 offset:4096
    v_mfma_f32_16x16x32_bf16 v[28:31], v[76:79], a[76:79], v[28:31]
    ds_read_b64_tr_b16 v[94:95], v12 offset:6144
    buffer_load_dwordx4 a[116:119], v124, s[4:7], s71 offen offset:1024 sc1
    v_mfma_f32_16x16x32_bf16 v[20:23], v[76:79], a[72:75], v[20:23]
    ds_read_b64_tr_b16 v[64:65], v9 offset:8192
    v_mfma_f32_16x16x32_bf16 v[20:23], v[72:75], a[64:67], v[20:23]
    s_waitcnt lgkmcnt(5)
    ds_read_b64_tr_b16 v[66:67], v9 offset:10240
    v_mfma_f32_16x16x32_bf16 v[32:35], v[80:83], a[64:67], v[32:35]
    ds_read_b64_tr_b16 v[68:69], v9 offset:12288
    v_mfma_f32_16x16x32_bf16 v[32:35], v[84:87], a[72:75], v[32:35]
    ds_read_b64_tr_b16 v[70:71], v9 offset:14336
    buffer_load_dwordx4 a[120:123], v124, s[4:7], s71 offen offset:2048 sc1
    v_mfma_f32_16x16x32_bf16 v[40:43], v[84:87], a[76:79], v[40:43]
    ds_read_b64_tr_b16 v[72:73], v10 offset:8192
    v_mfma_f32_16x16x32_bf16 v[40:43], v[80:83], a[68:71], v[40:43]
    s_waitcnt lgkmcnt(5)
    ds_read_b64_tr_b16 v[74:75], v10 offset:10240
    v_mfma_f32_16x16x32_bf16 v[44:47], v[88:91], a[68:71], v[44:47]
    ds_read_b64_tr_b16 v[76:77], v10 offset:12288
    v_mfma_f32_16x16x32_bf16 v[44:47], v[92:95], a[76:79], v[44:47]
    ds_read_b64_tr_b16 v[78:79], v10 offset:14336
    buffer_load_dwordx4 a[124:127], v124, s[4:7], s71 offen offset:3072 sc1
    v_mfma_f32_16x16x32_bf16 v[36:39], v[92:95], a[72:75], v[36:39]
    ds_read_b64_tr_b16 v[80:81], v11 offset:8192
    v_mfma_f32_16x16x32_bf16 v[36:39], v[88:91], a[64:67], v[36:39]
    s_waitcnt vmcnt(8) lgkmcnt(5)
    ds_read_b64_tr_b16 v[82:83], v11 offset:10240
    v_mfma_f32_16x16x32_bf16 v[16:19], v[64:67], a[80:83], v[16:19]
    ds_read_b64_tr_b16 v[84:85], v11 offset:12288
    v_mfma_f32_16x16x32_bf16 v[16:19], v[68:71], a[88:91], v[16:19]
    ds_read_b64_tr_b16 v[86:87], v11 offset:14336
    buffer_load_dwordx4 a[0:3], v8, s[4:7], s72 offen offset:0 sc1
    v_mfma_f32_16x16x32_bf16 v[24:27], v[68:71], a[92:95], v[24:27]
    ds_read_b64_tr_b16 v[88:89], v12 offset:8192
    v_mfma_f32_16x16x32_bf16 v[24:27], v[64:67], a[84:87], v[24:27]
    s_waitcnt lgkmcnt(5)
    ds_read_b64_tr_b16 v[90:91], v12 offset:10240
    buffer_load_dwordx4 v[176:179], v13, s[32:35], s60 offen offset:0
    v_mfma_f32_16x16x32_bf16 v[28:31], v[72:75], a[84:87], v[28:31]
    ds_read_b64_tr_b16 v[92:93], v12 offset:12288
    v_mfma_f32_16x16x32_bf16 v[28:31], v[76:79], a[92:95], v[28:31]
    ds_read_b64_tr_b16 v[94:95], v12 offset:14336
    buffer_load_dwordx4 a[4:7], v8, s[4:7], s72 offen offset:1024 sc1
    v_mfma_f32_16x16x32_bf16 v[20:23], v[76:79], a[88:91], v[20:23]
    ds_read_b64_tr_b16 v[64:65], v9 offset:16384
    v_mfma_f32_16x16x32_bf16 v[20:23], v[72:75], a[80:83], v[20:23]
    s_waitcnt lgkmcnt(5)
    ds_read_b64_tr_b16 v[66:67], v9 offset:18432
    buffer_load_dwordx4 v[180:183], v13, s[32:35], s60 offen offset:64
    v_mfma_f32_16x16x32_bf16 v[32:35], v[80:83], a[80:83], v[32:35]
    ds_read_b64_tr_b16 v[68:69], v9 offset:20480
    v_mfma_f32_16x16x32_bf16 v[32:35], v[84:87], a[88:91], v[32:35]
    ds_read_b64_tr_b16 v[70:71], v9 offset:22528
    buffer_load_dwordx4 a[8:11], v8, s[4:7], s72 offen offset:2048 sc1
    v_mfma_f32_16x16x32_bf16 v[40:43], v[84:87], a[92:95], v[40:43]
    ds_read_b64_tr_b16 v[72:73], v10 offset:16384
    v_mfma_f32_16x16x32_bf16 v[40:43], v[80:83], a[84:87], v[40:43]
    s_waitcnt lgkmcnt(5)
    ds_read_b64_tr_b16 v[74:75], v10 offset:18432
    v_mfma_f32_16x16x32_bf16 v[44:47], v[88:91], a[84:87], v[44:47]
    ds_read_b64_tr_b16 v[76:77], v10 offset:20480
    v_mfma_f32_16x16x32_bf16 v[44:47], v[92:95], a[92:95], v[44:47]
    ds_read_b64_tr_b16 v[78:79], v10 offset:22528
    buffer_load_dwordx4 a[12:15], v8, s[4:7], s72 offen offset:3072 sc1
    v_mfma_f32_16x16x32_bf16 v[36:39], v[92:95], a[88:91], v[36:39]
    ds_read_b64_tr_b16 v[80:81], v11 offset:16384
    v_mfma_f32_16x16x32_bf16 v[36:39], v[88:91], a[80:83], v[36:39]
    s_waitcnt vmcnt(10) lgkmcnt(5)
    ds_read_b64_tr_b16 v[82:83], v11 offset:18432
    v_mfma_f32_16x16x32_bf16 v[16:19], v[64:67], a[96:99], v[16:19]
    ds_read_b64_tr_b16 v[84:85], v11 offset:20480
    v_mfma_f32_16x16x32_bf16 v[16:19], v[68:71], a[104:107], v[16:19]
    ds_read_b64_tr_b16 v[86:87], v11 offset:22528
    buffer_load_dwordx4 a[16:19], v124, s[4:7], s72 offen offset:0 sc1
    v_mfma_f32_16x16x32_bf16 v[24:27], v[68:71], a[108:111], v[24:27]
    ds_read_b64_tr_b16 v[88:89], v12 offset:16384
    v_mfma_f32_16x16x32_bf16 v[24:27], v[64:67], a[100:103], v[24:27]
    s_waitcnt lgkmcnt(5)
    ds_read_b64_tr_b16 v[90:91], v12 offset:18432
    v_mfma_f32_16x16x32_bf16 v[28:31], v[72:75], a[100:103], v[28:31]
    ds_read_b64_tr_b16 v[92:93], v12 offset:20480
    v_mfma_f32_16x16x32_bf16 v[28:31], v[76:79], a[108:111], v[28:31]
    ds_read_b64_tr_b16 v[94:95], v12 offset:22528
    buffer_load_dwordx4 a[20:23], v124, s[4:7], s72 offen offset:1024 sc1
    v_mfma_f32_16x16x32_bf16 v[20:23], v[76:79], a[104:107], v[20:23]
    ds_read_b64_tr_b16 v[64:65], v9 offset:24576
    v_mfma_f32_16x16x32_bf16 v[20:23], v[72:75], a[96:99], v[20:23]
    s_waitcnt lgkmcnt(5)
    ds_read_b64_tr_b16 v[66:67], v9 offset:26624
    v_mfma_f32_16x16x32_bf16 v[32:35], v[80:83], a[96:99], v[32:35]
    ds_read_b64_tr_b16 v[68:69], v9 offset:28672
    v_mfma_f32_16x16x32_bf16 v[32:35], v[84:87], a[104:107], v[32:35]
    ds_read_b64_tr_b16 v[70:71], v9 offset:30720
    buffer_load_dwordx4 a[24:27], v124, s[4:7], s72 offen offset:2048 sc1
    v_mfma_f32_16x16x32_bf16 v[40:43], v[84:87], a[108:111], v[40:43]
    ds_read_b64_tr_b16 v[72:73], v10 offset:24576
    v_mfma_f32_16x16x32_bf16 v[40:43], v[80:83], a[100:103], v[40:43]
    s_waitcnt lgkmcnt(5)
    ds_read_b64_tr_b16 v[74:75], v10 offset:26624
    v_mfma_f32_16x16x32_bf16 v[44:47], v[88:91], a[100:103], v[44:47]
    ds_read_b64_tr_b16 v[76:77], v10 offset:28672
    v_mfma_f32_16x16x32_bf16 v[44:47], v[92:95], a[108:111], v[44:47]
    ds_read_b64_tr_b16 v[78:79], v10 offset:30720
    buffer_load_dwordx4 a[28:31], v124, s[4:7], s72 offen offset:3072 sc1
    v_mfma_f32_16x16x32_bf16 v[36:39], v[92:95], a[104:107], v[36:39]
    ds_read_b64_tr_b16 v[80:81], v11 offset:24576
    v_mfma_f32_16x16x32_bf16 v[36:39], v[88:91], a[96:99], v[36:39]
    s_waitcnt vmcnt(10) lgkmcnt(5)
    ds_read_b64_tr_b16 v[82:83], v11 offset:26624
    v_mfma_f32_16x16x32_bf16 v[16:19], v[64:67], a[112:115], v[16:19]
    ds_read_b64_tr_b16 v[84:85], v11 offset:28672
    v_mfma_f32_16x16x32_bf16 v[16:19], v[68:71], a[120:123], v[16:19]
    ds_read_b64_tr_b16 v[86:87], v11 offset:30720
    buffer_load_dwordx4 a[32:35], v8, s[4:7], s73 offen offset:0 sc1
    v_mfma_f32_16x16x32_bf16 v[24:27], v[68:71], a[124:127], v[24:27]
    ds_read_b64_tr_b16 v[88:89], v12 offset:24576
    v_mfma_f32_16x16x32_bf16 v[24:27], v[64:67], a[116:119], v[24:27]
    s_waitcnt lgkmcnt(5)
    ds_read_b64_tr_b16 v[90:91], v12 offset:26624
    v_mfma_f32_16x16x32_bf16 v[28:31], v[72:75], a[116:119], v[28:31]
    ds_read_b64_tr_b16 v[92:93], v12 offset:28672
    v_xor_b32 v9, 65536, v9
    v_mfma_f32_16x16x32_bf16 v[28:31], v[76:79], a[124:127], v[28:31]
    ds_read_b64_tr_b16 v[94:95], v12 offset:30720
    buffer_load_dwordx4 a[36:39], v8, s[4:7], s73 offen offset:1024 sc1
    v_mfma_f32_16x16x32_bf16 v[20:23], v[76:79], a[120:123], v[20:23]
    ds_read_b64_tr_b16 v[64:65], v9 offset:0
    v_mfma_f32_16x16x32_bf16 v[20:23], v[72:75], a[112:115], v[20:23]
    s_waitcnt lgkmcnt(5)
    ds_read_b64_tr_b16 v[66:67], v9 offset:2048
    v_mfma_f32_16x16x32_bf16 v[32:35], v[80:83], a[112:115], v[32:35]
    ds_read_b64_tr_b16 v[68:69], v9 offset:4096
    v_xor_b32 v10, 65536, v10
    v_mfma_f32_16x16x32_bf16 v[32:35], v[84:87], a[120:123], v[32:35]
    ds_read_b64_tr_b16 v[70:71], v9 offset:6144
    buffer_load_dwordx4 a[40:43], v8, s[4:7], s73 offen offset:2048 sc1
    v_mfma_f32_16x16x32_bf16 v[40:43], v[84:87], a[124:127], v[40:43]
    ds_read_b64_tr_b16 v[72:73], v10 offset:0
    v_mfma_f32_16x16x32_bf16 v[40:43], v[80:83], a[116:119], v[40:43]
    s_waitcnt lgkmcnt(5)
    ds_read_b64_tr_b16 v[74:75], v10 offset:2048
    v_mfma_f32_16x16x32_bf16 v[44:47], v[88:91], a[116:119], v[44:47]
    ds_read_b64_tr_b16 v[76:77], v10 offset:4096
    v_xor_b32 v11, 65536, v11
    v_mfma_f32_16x16x32_bf16 v[44:47], v[92:95], a[124:127], v[44:47]
    ds_read_b64_tr_b16 v[78:79], v10 offset:6144
    buffer_load_dwordx4 a[44:47], v8, s[4:7], s73 offen offset:3072 sc1
    v_mfma_f32_16x16x32_bf16 v[36:39], v[92:95], a[120:123], v[36:39]
    ds_read_b64_tr_b16 v[80:81], v11 offset:0
    s_waitcnt vmcnt(10)
    v_mfma_f32_16x16x32_bf16 v[36:39], v[88:91], a[112:115], v[36:39]
    s_waitcnt vmcnt(8) lgkmcnt(5)
    ds_read_b64_tr_b16 v[82:83], v11 offset:2048
    v_permlane16_swap_b32 v176, v178
    v_mfma_f32_16x16x32_bf16 v[16:19], v[64:67], a[0:3], v[16:19]
    ds_read_b64_tr_b16 v[84:85], v11 offset:4096
    v_xor_b32 v12, 65536, v12
    v_mfma_f32_16x16x32_bf16 v[16:19], v[68:71], a[8:11], v[16:19]
    ds_read_b64_tr_b16 v[86:87], v11 offset:6144
    buffer_load_dwordx4 a[48:51], v124, s[4:7], s73 offen offset:0 sc1
    v_mfma_f32_16x16x32_bf16 v[24:27], v[68:71], a[12:15], v[24:27]
    ds_read_b64_tr_b16 v[88:89], v12 offset:0
    v_permlane16_swap_b32 v177, v179
    v_mfma_f32_16x16x32_bf16 v[24:27], v[64:67], a[4:7], v[24:27]
    s_waitcnt lgkmcnt(5)
    ds_read_b64_tr_b16 v[90:91], v12 offset:2048
    v_permlane16_swap_b32 v180, v182
    v_mfma_f32_16x16x32_bf16 v[28:31], v[72:75], a[4:7], v[28:31]
    ds_read_b64_tr_b16 v[92:93], v12 offset:4096
    v_permlane16_swap_b32 v181, v183
    v_mfma_f32_16x16x32_bf16 v[28:31], v[76:79], a[12:15], v[28:31]
    ds_read_b64_tr_b16 v[94:95], v12 offset:6144
    buffer_load_dwordx4 a[52:55], v124, s[4:7], s73 offen offset:1024 sc1
    v_mfma_f32_16x16x32_bf16 v[20:23], v[76:79], a[8:11], v[20:23]
    ds_read_b64_tr_b16 v[64:65], v9 offset:8192
    v_lshlrev_b32 v224, 16, v176
    v_mfma_f32_16x16x32_bf16 v[20:23], v[72:75], a[0:3], v[20:23]
    s_waitcnt lgkmcnt(5)
    ds_read_b64_tr_b16 v[66:67], v9 offset:10240
    v_and_b32 v225, 0xffff0000, v176
    v_mfma_f32_16x16x32_bf16 v[32:35], v[80:83], a[0:3], v[32:35]
    ds_read_b64_tr_b16 v[68:69], v9 offset:12288
    v_lshlrev_b32 v226, 16, v177
    v_mfma_f32_16x16x32_bf16 v[32:35], v[84:87], a[8:11], v[32:35]
    ds_read_b64_tr_b16 v[70:71], v9 offset:14336
    buffer_load_dwordx4 a[56:59], v124, s[4:7], s73 offen offset:2048 sc1
    v_mfma_f32_16x16x32_bf16 v[40:43], v[84:87], a[12:15], v[40:43]
    ds_read_b64_tr_b16 v[72:73], v10 offset:8192
    v_and_b32 v227, 0xffff0000, v177
    v_mfma_f32_16x16x32_bf16 v[40:43], v[80:83], a[4:7], v[40:43]
    s_waitcnt lgkmcnt(5)
    ds_read_b64_tr_b16 v[74:75], v10 offset:10240
    v_lshlrev_b32 v228, 16, v178
    v_mfma_f32_16x16x32_bf16 v[44:47], v[88:91], a[4:7], v[44:47]
    ds_read_b64_tr_b16 v[76:77], v10 offset:12288
    v_and_b32 v229, 0xffff0000, v178
    v_mfma_f32_16x16x32_bf16 v[44:47], v[92:95], a[12:15], v[44:47]
    ds_read_b64_tr_b16 v[78:79], v10 offset:14336
    buffer_load_dwordx4 a[60:63], v124, s[4:7], s73 offen offset:3072 sc1
    v_mfma_f32_16x16x32_bf16 v[36:39], v[92:95], a[8:11], v[36:39]
    ds_read_b64_tr_b16 v[80:81], v11 offset:8192
    v_lshlrev_b32 v230, 16, v179
    v_mfma_f32_16x16x32_bf16 v[36:39], v[88:91], a[0:3], v[36:39]
    s_waitcnt vmcnt(8) lgkmcnt(5)
    ds_read_b64_tr_b16 v[82:83], v11 offset:10240
    v_and_b32 v231, 0xffff0000, v179
    v_mfma_f32_16x16x32_bf16 v[16:19], v[64:67], a[16:19], v[16:19]
    ds_read_b64_tr_b16 v[84:85], v11 offset:12288
    v_lshlrev_b32 v232, 16, v180
    v_mfma_f32_16x16x32_bf16 v[16:19], v[68:71], a[24:27], v[16:19]
    ds_read_b64_tr_b16 v[86:87], v11 offset:14336
    buffer_load_dwordx4 a[64:67], v8, s[4:7], s74 offen offset:0 sc1
    v_mfma_f32_16x16x32_bf16 v[24:27], v[68:71], a[28:31], v[24:27]
    ds_read_b64_tr_b16 v[88:89], v12 offset:8192
    v_and_b32 v233, 0xffff0000, v180
    v_mfma_f32_16x16x32_bf16 v[24:27], v[64:67], a[20:23], v[24:27]
    s_waitcnt lgkmcnt(5)
    ds_read_b64_tr_b16 v[90:91], v12 offset:10240
    v_lshlrev_b32 v234, 16, v181
    v_mfma_f32_16x16x32_bf16 v[28:31], v[72:75], a[20:23], v[28:31]
    ds_read_b64_tr_b16 v[92:93], v12 offset:12288
    v_and_b32 v235, 0xffff0000, v181
    v_mfma_f32_16x16x32_bf16 v[28:31], v[76:79], a[28:31], v[28:31]
    ds_read_b64_tr_b16 v[94:95], v12 offset:14336
    buffer_load_dwordx4 a[68:71], v8, s[4:7], s74 offen offset:1024 sc1
    v_mfma_f32_16x16x32_bf16 v[20:23], v[76:79], a[24:27], v[20:23]
    ds_read_b64_tr_b16 v[64:65], v9 offset:16384
    v_lshlrev_b32 v236, 16, v182
    v_mfma_f32_16x16x32_bf16 v[20:23], v[72:75], a[16:19], v[20:23]
    s_waitcnt lgkmcnt(5)
    ds_read_b64_tr_b16 v[66:67], v9 offset:18432
    v_and_b32 v237, 0xffff0000, v182
    v_mfma_f32_16x16x32_bf16 v[32:35], v[80:83], a[16:19], v[32:35]
    ds_read_b64_tr_b16 v[68:69], v9 offset:20480
    v_lshlrev_b32 v238, 16, v183
    v_mfma_f32_16x16x32_bf16 v[32:35], v[84:87], a[24:27], v[32:35]
    ds_read_b64_tr_b16 v[70:71], v9 offset:22528
    buffer_load_dwordx4 a[72:75], v8, s[4:7], s74 offen offset:2048 sc1
    v_mfma_f32_16x16x32_bf16 v[40:43], v[84:87], a[28:31], v[40:43]
    ds_read_b64_tr_b16 v[72:73], v10 offset:16384
    v_and_b32 v239, 0xffff0000, v183
    v_mfma_f32_16x16x32_bf16 v[40:43], v[80:83], a[20:23], v[40:43]
    s_waitcnt lgkmcnt(5)
    ds_read_b64_tr_b16 v[74:75], v10 offset:18432
    v_mfma_f32_16x16x32_bf16 v[44:47], v[88:91], a[20:23], v[44:47]
    ds_read_b64_tr_b16 v[76:77], v10 offset:20480
    s_mov_b32 s97, 0
    v_mfma_f32_16x16x32_bf16 v[44:47], v[92:95], a[28:31], v[44:47]
    ds_read_b64_tr_b16 v[78:79], v10 offset:22528
    buffer_load_dwordx4 a[76:79], v8, s[4:7], s74 offen offset:3072 sc1
    v_mfma_f32_16x16x32_bf16 v[36:39], v[92:95], a[24:27], v[36:39]
    ds_read_b64_tr_b16 v[80:81], v11 offset:16384
    s_atomic_add s97, s[4:5], s62 offset:163848 glc
    v_mfma_f32_16x16x32_bf16 v[36:39], v[88:91], a[16:19], v[36:39]
    s_waitcnt vmcnt(8) lgkmcnt(5)
    ds_read_b64_tr_b16 v[82:83], v11 offset:18432
    v_mfma_f32_16x16x32_bf16 v[16:19], v[64:67], a[32:35], v[16:19]
    ds_read_b64_tr_b16 v[84:85], v11 offset:20480
    v_mfma_f32_16x16x32_bf16 v[16:19], v[68:71], a[40:43], v[16:19]
    ds_read_b64_tr_b16 v[86:87], v11 offset:22528
    buffer_load_dwordx4 a[80:83], v124, s[4:7], s74 offen offset:0 sc1
    v_mfma_f32_16x16x32_bf16 v[24:27], v[68:71], a[44:47], v[24:27]
    ds_read_b64_tr_b16 v[88:89], v12 offset:16384
    v_mfma_f32_16x16x32_bf16 v[24:27], v[64:67], a[36:39], v[24:27]
    s_waitcnt lgkmcnt(5)
    ds_read_b64_tr_b16 v[90:91], v12 offset:18432
    v_mfma_f32_16x16x32_bf16 v[28:31], v[72:75], a[36:39], v[28:31]
    ds_read_b64_tr_b16 v[92:93], v12 offset:20480
    v_mfma_f32_16x16x32_bf16 v[28:31], v[76:79], a[44:47], v[28:31]
    ds_read_b64_tr_b16 v[94:95], v12 offset:22528
    buffer_load_dwordx4 a[84:87], v124, s[4:7], s74 offen offset:1024 sc1
    v_mfma_f32_16x16x32_bf16 v[20:23], v[76:79], a[40:43], v[20:23]
    ds_read_b64_tr_b16 v[64:65], v9 offset:24576
    v_mfma_f32_16x16x32_bf16 v[20:23], v[72:75], a[32:35], v[20:23]
    s_waitcnt lgkmcnt(5)
    ds_read_b64_tr_b16 v[66:67], v9 offset:26624
    v_mfma_f32_16x16x32_bf16 v[32:35], v[80:83], a[32:35], v[32:35]
    ds_read_b64_tr_b16 v[68:69], v9 offset:28672
    v_mfma_f32_16x16x32_bf16 v[32:35], v[84:87], a[40:43], v[32:35]
    ds_read_b64_tr_b16 v[70:71], v9 offset:30720
    buffer_load_dwordx4 a[88:91], v124, s[4:7], s74 offen offset:2048 sc1
    v_mfma_f32_16x16x32_bf16 v[40:43], v[84:87], a[44:47], v[40:43]
    ds_read_b64_tr_b16 v[72:73], v10 offset:24576
    v_mfma_f32_16x16x32_bf16 v[40:43], v[80:83], a[36:39], v[40:43]
    s_waitcnt lgkmcnt(5)
    ds_read_b64_tr_b16 v[74:75], v10 offset:26624
    v_mfma_f32_16x16x32_bf16 v[44:47], v[88:91], a[36:39], v[44:47]
    ds_read_b64_tr_b16 v[76:77], v10 offset:28672
    v_mfma_f32_16x16x32_bf16 v[44:47], v[92:95], a[44:47], v[44:47]
    ds_read_b64_tr_b16 v[78:79], v10 offset:30720
    buffer_load_dwordx4 a[92:95], v124, s[4:7], s74 offen offset:3072 sc1
    v_mfma_f32_16x16x32_bf16 v[36:39], v[92:95], a[40:43], v[36:39]
    ds_read_b64_tr_b16 v[80:81], v11 offset:24576
    v_mfma_f32_16x16x32_bf16 v[36:39], v[88:91], a[32:35], v[36:39]
    s_waitcnt vmcnt(8) lgkmcnt(5)
    ds_read_b64_tr_b16 v[82:83], v11 offset:26624
    v_mfma_f32_16x16x32_bf16 v[16:19], v[64:67], a[48:51], v[16:19]
    ds_read_b64_tr_b16 v[84:85], v11 offset:28672
    v_mfma_f32_16x16x32_bf16 v[16:19], v[68:71], a[56:59], v[16:19]
    ds_read_b64_tr_b16 v[86:87], v11 offset:30720
    buffer_load_dwordx4 a[96:99], v8, s[4:7], s75 offen offset:0 sc1
    v_mfma_f32_16x16x32_bf16 v[24:27], v[68:71], a[60:63], v[24:27]
    ds_read_b64_tr_b16 v[88:89], v12 offset:24576
    v_mfma_f32_16x16x32_bf16 v[24:27], v[64:67], a[52:55], v[24:27]
    s_waitcnt lgkmcnt(5)
    ds_read_b64_tr_b16 v[90:91], v12 offset:26624
    v_mfma_f32_16x16x32_bf16 v[28:31], v[72:75], a[52:55], v[28:31]
    ds_read_b64_tr_b16 v[92:93], v12 offset:28672
    v_xor_b32 v9, 32768, v9
    v_mfma_f32_16x16x32_bf16 v[28:31], v[76:79], a[60:63], v[28:31]
    ds_read_b64_tr_b16 v[94:95], v12 offset:30720
    buffer_load_dwordx4 a[100:103], v8, s[4:7], s75 offen offset:1024 sc1
    v_mfma_f32_16x16x32_bf16 v[20:23], v[76:79], a[56:59], v[20:23]
    ds_read_b64_tr_b16 v[64:65], v9 offset:0
    v_mfma_f32_16x16x32_bf16 v[20:23], v[72:75], a[48:51], v[20:23]
    s_waitcnt lgkmcnt(5)
    ds_read_b64_tr_b16 v[66:67], v9 offset:2048
    v_mfma_f32_16x16x32_bf16 v[32:35], v[80:83], a[48:51], v[32:35]
    ds_read_b64_tr_b16 v[68:69], v9 offset:4096
    v_xor_b32 v10, 32768, v10
    v_mfma_f32_16x16x32_bf16 v[32:35], v[84:87], a[56:59], v[32:35]
    ds_read_b64_tr_b16 v[70:71], v9 offset:6144
    buffer_load_dwordx4 a[104:107], v8, s[4:7], s75 offen offset:2048 sc1
    v_mfma_f32_16x16x32_bf16 v[40:43], v[84:87], a[60:63], v[40:43]
    ds_read_b64_tr_b16 v[72:73], v10 offset:0
    v_mfma_f32_16x16x32_bf16 v[40:43], v[80:83], a[52:55], v[40:43]
    s_waitcnt lgkmcnt(5)
    ds_read_b64_tr_b16 v[74:75], v10 offset:2048
    v_mfma_f32_16x16x32_bf16 v[44:47], v[88:91], a[52:55], v[44:47]
    ds_read_b64_tr_b16 v[76:77], v10 offset:4096
    v_xor_b32 v11, 32768, v11
    v_mfma_f32_16x16x32_bf16 v[44:47], v[92:95], a[60:63], v[44:47]
    ds_read_b64_tr_b16 v[78:79], v10 offset:6144
    buffer_load_dwordx4 a[108:111], v8, s[4:7], s75 offen offset:3072 sc1
    v_mfma_f32_16x16x32_bf16 v[36:39], v[92:95], a[56:59], v[36:39]
    ds_read_b64_tr_b16 v[80:81], v11 offset:0
    v_mfma_f32_16x16x32_bf16 v[36:39], v[88:91], a[48:51], v[36:39]
    s_waitcnt vmcnt(8) lgkmcnt(5)
    ds_read_b64_tr_b16 v[82:83], v11 offset:2048
    v_mfma_f32_16x16x32_bf16 v[16:19], v[64:67], a[64:67], v[16:19]
    ds_read_b64_tr_b16 v[84:85], v11 offset:4096
    v_xor_b32 v12, 32768, v12
    v_mfma_f32_16x16x32_bf16 v[16:19], v[68:71], a[72:75], v[16:19]
    ds_read_b64_tr_b16 v[86:87], v11 offset:6144
    buffer_load_dwordx4 a[112:115], v124, s[4:7], s75 offen offset:0 sc1
    v_mfma_f32_16x16x32_bf16 v[24:27], v[68:71], a[76:79], v[24:27]
    ds_read_b64_tr_b16 v[88:89], v12 offset:0
    v_mfma_f32_16x16x32_bf16 v[24:27], v[64:67], a[68:71], v[24:27]
    s_waitcnt lgkmcnt(5)
    ds_read_b64_tr_b16 v[90:91], v12 offset:2048
    v_mfma_f32_16x16x32_bf16 v[28:31], v[72:75], a[68:71], v[28:31]
    ds_read_b64_tr_b16 v[92:93], v12 offset:4096
    v_mfma_f32_16x16x32_bf16 v[28:31], v[76:79], a[76:79], v[28:31]
    ds_read_b64_tr_b16 v[94:95], v12 offset:6144
    buffer_load_dwordx4 a[116:119], v124, s[4:7], s75 offen offset:1024 sc1
    v_mfma_f32_16x16x32_bf16 v[20:23], v[76:79], a[72:75], v[20:23]
    ds_read_b64_tr_b16 v[64:65], v9 offset:8192
    v_mfma_f32_16x16x32_bf16 v[20:23], v[72:75], a[64:67], v[20:23]
    s_waitcnt lgkmcnt(5)
    ds_read_b64_tr_b16 v[66:67], v9 offset:10240
    v_mfma_f32_16x16x32_bf16 v[32:35], v[80:83], a[64:67], v[32:35]
    ds_read_b64_tr_b16 v[68:69], v9 offset:12288
    v_mfma_f32_16x16x32_bf16 v[32:35], v[84:87], a[72:75], v[32:35]
    ds_read_b64_tr_b16 v[70:71], v9 offset:14336
    buffer_load_dwordx4 a[120:123], v124, s[4:7], s75 offen offset:2048 sc1
    v_mfma_f32_16x16x32_bf16 v[40:43], v[84:87], a[76:79], v[40:43]
    ds_read_b64_tr_b16 v[72:73], v10 offset:8192
    v_mfma_f32_16x16x32_bf16 v[40:43], v[80:83], a[68:71], v[40:43]
    s_waitcnt lgkmcnt(5)
    ds_read_b64_tr_b16 v[74:75], v10 offset:10240
    v_mfma_f32_16x16x32_bf16 v[44:47], v[88:91], a[68:71], v[44:47]
    ds_read_b64_tr_b16 v[76:77], v10 offset:12288
    s_cmp_lt_u32 s97, 16
    s_cbranch_scc1 L_slow_13
L_back_14:
    v_mfma_f32_16x16x32_bf16 v[44:47], v[92:95], a[76:79], v[44:47]
    ds_read_b64_tr_b16 v[78:79], v10 offset:14336
    buffer_load_dwordx4 a[124:127], v124, s[4:7], s75 offen offset:3072 sc1
    v_mfma_f32_16x16x32_bf16 v[36:39], v[92:95], a[72:75], v[36:39]
    ds_read_b64_tr_b16 v[80:81], v11 offset:8192
    s_add_u32 m0, s96, 131072
    v_mfma_f32_16x16x32_bf16 v[36:39], v[88:91], a[64:67], v[36:39]
    s_waitcnt vmcnt(8) lgkmcnt(5)
    ds_read_b64_tr_b16 v[82:83], v11 offset:10240
    s_add_u32 s90, s95, 0
    v_mfma_f32_16x16x32_bf16 v[16:19], v[64:67], a[80:83], v[16:19]
    ds_read_b64_tr_b16 v[84:85], v11 offset:12288
    v_mfma_f32_16x16x32_bf16 v[16:19], v[68:71], a[88:91], v[16:19]
    ds_read_b64_tr_b16 v[86:87], v11 offset:14336
    buffer_load_dwordx4 v1, s[4:7], s90 offen offset:0 sc1 lds
    v_mfma_f32_16x16x32_bf16 v[24:27], v[68:71], a[92:95], v[24:27]
    ds_read_b64_tr_b16 v[88:89], v12 offset:8192
    v_mfma_f32_16x16x32_bf16 v[24:27], v[64:67], a[84:87], v[24:27]
    s_waitcnt lgkmcnt(5)
    ds_read_b64_tr_b16 v[90:91], v12 offset:10240
    v_mfma_f32_16x16x32_bf16 v[28:31], v[72:75], a[84:87], v[28:31]
    ds_read_b64_tr_b16 v[92:93], v12 offset:12288
    v_mfma_f32_16x16x32_bf16 v[28:31], v[76:79], a[92:95], v[28:31]
    ds_read_b64_tr_b16 v[94:95], v12 offset:14336
    buffer_load_dwordx4 v1, s[4:7], s90 offen offset:1024 sc1 lds
    v_mfma_f32_16x16x32_bf16 v[20:23], v[76:79], a[88:91], v[20:23]
    ds_read_b64_tr_b16 v[64:65], v9 offset:16384
    v_mfma_f32_16x16x32_bf16 v[20:23], v[72:75], a[80:83], v[20:23]
    s_waitcnt lgkmcnt(5)
    ds_read_b64_tr_b16 v[66:67], v9 offset:18432
    v_mfma_f32_16x16x32_bf16 v[32:35], v[80:83], a[80:83], v[32:35]
    ds_read_b64_tr_b16 v[68:69], v9 offset:20480
    v_mfma_f32_16x16x32_bf16 v[32:35], v[84:87], a[88:91], v[32:35]
    ds_read_b64_tr_b16 v[70:71], v9 offset:22528
    buffer_load_dwordx4 v1, s[4:7], s90 offen offset:2048 sc1 lds
    v_mfma_f32_16x16x32_bf16 v[40:43], v[84:87], a[92:95], v[40:43]
    ds_read_b64_tr_b16 v[72:73], v10 offset:16384
    v_mfma_f32_16x16x32_bf16 v[40:43], v[80:83], a[84:87], v[40:43]
    s_waitcnt lgkmcnt(5)
    ds_read_b64_tr_b16 v[74:75], v10 offset:18432
    v_mfma_f32_16x16x32_bf16 v[44:47], v[88:91], a[84:87], v[44:47]
    ds_read_b64_tr_b16 v[76:77], v10 offset:20480
    v_mfma_f32_16x16x32_bf16 v[44:47], v[92:95], a[92:95], v[44:47]
    ds_read_b64_tr_b16 v[78:79], v10 offset:22528
    buffer_load_dwordx4 v1, s[4:7], s90 offen offset:3072 sc1 lds
    v_mfma_f32_16x16x32_bf16 v[36:39], v[92:95], a[88:91], v[36:39]
    ds_read_b64_tr_b16 v[80:81], v11 offset:16384
    s_add_u32 m0, s96, 147456
    v_mfma_f32_16x16x32_bf16 v[36:39], v[88:91], a[80:83], v[36:39]
    s_waitcnt vmcnt(8) lgkmcnt(5)
    ds_read_b64_tr_b16 v[82:83], v11 offset:18432
    s_add_u32 s90, s95, 16384
    v_mfma_f32_16x16x32_bf16 v[16:19], v[64:67], a[96:99], v[16:19]
    ds_read_b64_tr_b16 v[84:85], v11 offset:20480
    v_mfma_f32_16x16x32_bf16 v[16:19], v[68:71], a[104:107], v[16:19]
    ds_read_b64_tr_b16 v[86:87], v11 offset:22528
    buffer_load_dwordx4 v1, s[4:7], s90 offen offset:0 sc1 lds
    v_mfma_f32_16x16x32_bf16 v[24:27], v[68:71], a[108:111], v[24:27]
    ds_read_b64_tr_b16 v[88:89], v12 offset:16384
    v_mfma_f32_16x16x32_bf16 v[24:27], v[64:67], a[100:103], v[24:27]
    s_waitcnt lgkmcnt(5)
    ds_read_b64_tr_b16 v[90:91], v12 offset:18432
    v_mfma_f32_16x16x32_bf16 v[28:31], v[72:75], a[100:103], v[28:31]
    ds_read_b64_tr_b16 v[92:93], v12 offset:20480
    v_mfma_f32_16x16x32_bf16 v[28:31], v[76:79], a[108:111], v[28:31]
    ds_read_b64_tr_b16 v[94:95], v12 offset:22528
    buffer_load_dwordx4 v1, s[4:7], s90 offen offset:1024 sc1 lds
    v_mfma_f32_16x16x32_bf16 v[20:23], v[76:79], a[104:107], v[20:23]
    ds_read_b64_tr_b16 v[64:65], v9 offset:24576
    v_mfma_f32_16x16x32_bf16 v[20:23], v[72:75], a[96:99], v[20:23]
    s_waitcnt lgkmcnt(5)
    ds_read_b64_tr_b16 v[66:67], v9 offset:26624
    v_mfma_f32_16x16x32_bf16 v[32:35], v[80:83], a[96:99], v[32:35]
    ds_read_b64_tr_b16 v[68:69], v9 offset:28672
    v_mfma_f32_16x16x32_bf16 v[32:35], v[84:87], a[104:107], v[32:35]
    ds_read_b64_tr_b16 v[70:71], v9 offset:30720
    buffer_load_dwordx4 v1, s[4:7], s90 offen offset:2048 sc1 lds
    v_mfma_f32_16x16x32_bf16 v[40:43], v[84:87], a[108:111], v[40:43]
    ds_read_b64_tr_b16 v[72:73], v10 offset:24576
    v_mfma_f32_16x16x32_bf16 v[40:43], v[80:83], a[100:103], v[40:43]
    s_waitcnt lgkmcnt(5)
    ds_read_b64_tr_b16 v[74:75], v10 offset:26624
    v_mfma_f32_16x16x32_bf16 v[44:47], v[88:91], a[100:103], v[44:47]
    ds_read_b64_tr_b16 v[76:77], v10 offset:28672
    v_mfma_f32_16x16x32_bf16 v[44:47], v[92:95], a[108:111], v[44:47]
    ds_read_b64_tr_b16 v[78:79], v10 offset:30720
    buffer_load_dwordx4 v1, s[4:7], s90 offen offset:3072 sc1 lds
    v_mfma_f32_16x16x32_bf16 v[36:39], v[92:95], a[104:107], v[36:39]
    ds_read_b64_tr_b16 v[80:81], v11 offset:24576
    v_mfma_f32_16x16x32_bf16 v[36:39], v[88:91], a[96:99], v[36:39]
    s_waitcnt vmcnt(8) lgkmcnt(5)
    ds_read_b64_tr_b16 v[82:83], v11 offset:26624
    v_mfma_f32_16x16x32_bf16 v[16:19], v[64:67], a[112:115], v[16:19]
    ds_read_b64_tr_b16 v[84:85], v11 offset:28672
    v_mfma_f32_16x16x32_bf16 v[16:19], v[68:71], a[120:123], v[16:19]
    ds_read_b64_tr_b16 v[86:87], v11 offset:30720
    v_mfma_f32_16x16x32_bf16 v[24:27], v[68:71], a[124:127], v[24:27]
    ds_read_b64_tr_b16 v[88:89], v12 offset:24576
    v_mfma_f32_16x16x32_bf16 v[24:27], v[64:67], a[116:119], v[24:27]
    s_waitcnt lgkmcnt(5)
    ds_read_b64_tr_b16 v[90:91], v12 offset:26624
    v_mfma_f32_16x16x32_bf16 v[28:31], v[72:75], a[116:119], v[28:31]
    ds_read_b64_tr_b16 v[92:93], v12 offset:28672
    v_mfma_f32_16x16x32_bf16 v[28:31], v[76:79], a[124:127], v[28:31]
    ds_read_b64_tr_b16 v[94:95], v12 offset:30720
    v_mfma_f32_16x16x32_bf16 v[20:23], v[76:79], a[120:123], v[20:23]
    v_mfma_f32_16x16x32_bf16 v[20:23], v[72:75], a[112:115], v[20:23]
    s_waitcnt lgkmcnt(4)
    v_mfma_f32_16x16x32_bf16 v[32:35], v[80:83], a[112:115], v[32:35]
    v_mfma_f32_16x16x32_bf16 v[32:35], v[84:87], a[120:123], v[32:35]
    v_mfma_f32_16x16x32_bf16 v[40:43], v[84:87], a[124:127], v[40:43]
    v_mfma_f32_16x16x32_bf16 v[40:43], v[80:83], a[116:119], v[40:43]
    s_waitcnt lgkmcnt(0)
    v_mfma_f32_16x16x32_bf16 v[44:47], v[88:91], a[116:119], v[44:47]
    v_mfma_f32_16x16x32_bf16 v[44:47], v[92:95], a[124:127], v[44:47]
    v_mfma_f32_16x16x32_bf16 v[36:39], v[92:95], a[120:123], v[36:39]
    v_mfma_f32_16x16x32_bf16 v[36:39], v[88:91], a[112:115], v[36:39]
    s_lshl_b32 s93, s54, 16
    s_lshl_b32 s60, s53, 12
    s_add_u32 s93, s93, s60
    s_lshr_b32 s94, s93, 4
    s_add_u32 s93, s93, s56
    s_add_u32 s94, s94, s56
    s_add_u32 s93, s93, 10485760
    s_add_u32 s94, s94, 48234496
    v_cvt_pk_bf16_f32 v48, v16, v17
    v_cvt_pk_bf16_f32 v49, v18, v19
    v_cvt_pk_bf16_f32 v50, v20, v21
    v_cvt_pk_bf16_f32 v51, v22, v23
    v_cvt_pk_bf16_f32 v52, v24, v25
    v_cvt_pk_bf16_f32 v53, v26, v27
    v_cvt_pk_bf16_f32 v54, v28, v29
    v_cvt_pk_bf16_f32 v55, v30, v31
    v_cvt_pk_bf16_f32 v56, v32, v33
    v_cvt_pk_bf16_f32 v57, v34, v35
    v_cvt_pk_bf16_f32 v58, v36, v37
    v_cvt_pk_bf16_f32 v59, v38, v39
    v_cvt_pk_bf16_f32 v60, v40, v41
    v_cvt_pk_bf16_f32 v61, v42, v43
    v_cvt_pk_bf16_f32 v62, v44, v45
    v_cvt_pk_bf16_f32 v63, v46, v47
    buffer_store_dwordx4 v[48:51], v1, s[4:7], s93 offen offset:0 sc1
    buffer_store_dwordx4 v[52:55], v1, s[4:7], s93 offen offset:1024 sc1
    buffer_store_dwordx4 v[56:59], v1, s[4:7], s93 offen offset:2048 sc1
    buffer_store_dwordx4 v[60:63], v1, s[4:7], s93 offen offset:3072 sc1
    s_mov_b32 s66, 0x3f803f80
    v_and_b32 v107, 0xf0, v1
    v_lshrrev_b32 v106, 4, v0
    v_lshl_or_b32 v107, v106, 2, v107
    v_dot2_f32_bf16 v108, v48, s66, 0
L_hop6:
    s_cbranch_execz L_hop10
    v_dot2_f32_bf16 v110, v48, v48, 0
    v_dot2_f32_bf16 v109, v52, s66, 0
    v_dot2_f32_bf16 v111, v52, v52, 0
    v_dot2_f32_bf16 v108, v49, s66, v108
    v_dot2_f32_bf16 v110, v49, v49, v110
    v_dot2_f32_bf16 v109, v53, s66, v109
    v_dot2_f32_bf16 v111, v53, v53, v111
    v_dot2_f32_bf16 v108, v50, s66, v108
    v_dot2_f32_bf16 v110, v50, v50, v110
    v_dot2_f32_bf16 v109, v54, s66, v109
    v_dot2_f32_bf16 v111, v54, v54, v111
    v_dot2_f32_bf16 v108, v51, s66, v108
    v_dot2_f32_bf16 v110, v51, v51, v110
    v_dot2_f32_bf16 v109, v55, s66, v109
    v_dot2_f32_bf16 v111, v55, v55, v111
    v_dot2_f32_bf16 v108, v56, s66, v108
    v_dot2_f32_bf16 v110, v56, v56, v110
    v_dot2_f32_bf16 v109, v60, s66, v109
    v_dot2_f32_bf16 v111, v60, v60, v111
    v_dot2_f32_bf16 v108, v57, s66, v108
    v_dot2_f32_bf16 v110, v57, v57, v110
    v_dot2_f32_bf16 v109, v61, s66, v109
    v_dot2_f32_bf16 v111, v61, v61, v111
    v_dot2_f32_bf16 v108, v58, s66, v108
    v_dot2_f32_bf16 v110, v58, v58, v110
    v_dot2_f32_bf16 v109, v62, s66, v109
    v_dot2_f32_bf16 v111, v62, v62, v111
    v_dot2_f32_bf16 v108, v59, s66, v108
    v_dot2_f32_bf16 v110, v59, v59, v110
    v_dot2_f32_bf16 v109, v63, s66, v109
    v_dot2_f32_bf16 v111, v63, v63, v111
    s_nop 0
    v_permlane32_swap_b32 v108, v110
    s_nop 0
    v_permlane32_swap_b32 v109, v111
    v_add_f32 v108, v108, v110
    v_add_f32 v109, v109, v111
    s_nop 1
    v_permlane16_swap_b32 v108, v109
    v_add_f32 v108, v108, v109
    buffer_store_dword v108, v107, s[4:7], s94 offen sc1
    s_lshl_b32 s94, s54, 12
    s_add_u32 s94, s94, s56
    s_add_u32 s94, s94, 48234496
    v_add_u32 v10, 0x10000, v1
    v_add_u32 v11, 0x20000, v1
    s_mul_i32 s60, s54, 229376
    s_add_u32 s60, s60, s56
    s_add_u32 s60, s60, 31457280
    s_mul_i32 s61, s52, 14336
    s_add_u32 s93, s60, s61
    s_and_b32 s62, s52, 12
    s_mul_i32 s61, s62, 14336
    s_add_u32 s60, s60, s61
    v_add_u32 v12, s60, v1
    s_add_u32 s60, s52, 0
    s_and_b32 s60, s60, 3
    s_mul_i32 s68, s60, 14336
    s_add_u32 s60, s52, 1
    s_and_b32 s60, s60, 3
    s_mul_i32 s69, s60, 14336
    s_add_u32 s60, s52, 2
    s_and_b32 s60, s60, 3
    s_mul_i32 s70, s60, 14336
    s_add_u32 s60, s52, 3
    s_and_b32 s60, s60, 3
    s_mul_i32 s71, s60, 14336
    s_lshl2_add_u32 s72, s62, s59
    s_mul_i32 s60, s54, 2048
    s_lshl_b32 s61, s55, 6
    s_add_u32 s60, s60, s61
    s_lshl2_add_u32 s73, s52, s60
    s_mul_i32 s61, s54, 65536
    s_add_u32 s61, s61, s56
    s_add_u32 s61, s61, 15728640
    s_lshl_b32 s62, s52, 12
    s_add_u32 s74, s61, s62
    s_add_u32 s62, s52, 4
    s_and_b32 s62, s62, 15
    s_lshl2_add_u32 s77, s62, s60
    s_add_u32 s62, s62, 0
    s_lshl_b32 s62, s62, 12
    s_add_u32 s80, s61, s62
    s_add_u32 s62, s52, 8
    s_and_b32 s62, s62, 15
    s_lshl2_add_u32 s78, s62, s60
    s_add_u32 s62, s62, 1280
    s_lshl_b32 s62, s62, 12
    s_add_u32 s81, s61, s62
    s_add_u32 s62, s52, 12
    s_and_b32 s62, s62, 15
    s_lshl2_add_u32 s79, s62, s60
    s_add_u32 s62, s62, 2560
    s_lshl_b32 s62, s62, 12
    s_add_u32 s82, s61, s62
    s_mov_b32 s75, 2
    s_mov_b32 s76, 4
    s_mul_i32 s89, s52, 7168
    s_add_u32 s89, s89, 15728640
    s_add_u32 s84, s89, 4096
    s_lshl_b32 s88, s48, 16
    s_lshl_b32 s60, s53, 7
    s_add_u32 s88, s88, s60
    v_lshrrev_b32 v13, 2, v0
    v_lshlrev_b32 v13, 6, v13
    v_and_b32 v7, 3, v0
    v_lshl_or_b32 v13, v7, 3, v13
    v_add_u32 v13, s96, v13
    s_cmp_eq_u32 s55, 0
    s_cselect_b32 s14, 2097152, 0
    s_cselect_b32 s18, 65536, 0
    s_mul_i32 s85, s54, 65536
    s_add_u32 s85, s85, s56
    s_add_u32 s85, s85, 10485760
    v_add_u32 v8, s85, v1
    s_lshl_b32 s85, s3, 13
    s_lshl_b32 s86, s53, 12
    s_xor_b32 s87, s85, 61440
    s_waitcnt vmcnt(0)
    s_mov_b32 s57, 1
    s_atomic_add s57, s[4:5], s59 offset:16 glc
    s_barrier
    s_add_u32 m0, s96, 65536
    s_add_u32 s90, s95, 32768
    buffer_load_dwordx4 v1, s[4:7], s90 offen offset:0 sc1 lds
    s_xor_b32 s60, s85, 0
    s_cmp_eq_u32 s60, s86
    s_cselect_b32 s60, s87, s60
    buffer_load_dwordx4 v1, s[4:7], s90 offen offset:1024 sc1 lds
    s_xor_b32 s61, s85, 4096
    s_cmp_eq_u32 s61, s86
    s_cselect_b32 s61, s87, s61
    buffer_load_dwordx4 v1, s[4:7], s90 offen offset:2048 sc1 lds
    s_xor_b32 s62, s85, 8192
    s_cmp_eq_u32 s62, s86
    s_cselect_b32 s62, s87, s62
    buffer_load_dwordx4 v1, s[4:7], s90 offen offset:3072 sc1 lds
    s_xor_b32 s63, s85, 12288
    s_cmp_eq_u32 s63, s86
    s_cselect_b32 s63, s87, s63
    s_add_u32 m0, s96, 81920
    s_add_u32 s90, s95, 49152
    buffer_load_dwordx4 v1, s[4:7], s90 offen offset:0 sc1 lds
    s_xor_b32 s64, s85, 16384
    s_cmp_eq_u32 s64, s86
    s_cselect_b32 s64, s87, s64
    buffer_load_dwordx4 v1, s[4:7], s90 offen offset:1024 sc1 lds
    s_xor_b32 s65, s85, 20480
    s_cmp_eq_u32 s65, s86
    s_cselect_b32 s65, s87, s65
    buffer_load_dwordx4 v1, s[4:7], s90 offen offset:2048 sc1 lds
    s_xor_b32 s66, s85, 24576
    s_cmp_eq_u32 s66, s86
    s_cselect_b32 s66, s87, s66
    buffer_load_dwordx4 v1, s[4:7], s90 offen offset:3072 sc1 lds
    s_xor_b32 s67, s85, 28672
    s_cmp_eq_u32 s67, s86
    s_cselect_b32 s67, s87, s67
    s_add_u32 m0, s96, 98304
    s_add_u32 s90, s95, 65536
    buffer_load_dwordx4 v1, s[4:7], s90 offen offset:0 sc1 lds
    s_xor_b32 s44, s85, 32768
    s_cmp_eq_u32 s44, s86
    s_cselect_b32 s44, s87, s44
    buffer_load_dwordx4 v1, s[4:7], s90 offen offset:1024 sc1 lds
    s_xor_b32 s45, s85, 36864
    s_cmp_eq_u32 s45, s86
    s_cselect_b32 s45, s87, s45
    buffer_load_dwordx4 v1, s[4:7], s90 offen offset:2048 sc1 lds
    s_xor_b32 s46, s85, 40960
    s_cmp_eq_u32 s46, s86
    s_cselect_b32 s46, s87, s46
    buffer_load_dwordx4 v1, s[4:7], s90 offen offset:3072 sc1 lds
    s_xor_b32 s47, s85, 45056
    s_cmp_eq_u32 s47, s86
    s_cselect_b32 s47, s87, s47
    s_add_u32 m0, s96, 114688
    s_add_u32 s90, s95, 81920
    buffer_load_dwordx4 v1, s[4:7], s90 offen offset:0 sc1 lds
    s_xor_b32 s8, s85, 49152
    s_cmp_eq_u32 s8, s86
    s_cselect_b32 s8, s87, s8
    buffer_load_dwordx4 v1, s[4:7], s90 offen offset:1024 sc1 lds
    s_xor_b32 s9, s85, 53248
    s_cmp_eq_u32 s9, s86
    s_cselect_b32 s9, s87, s9
    buffer_load_dwordx4 v1, s[4:7], s90 offen offset:2048 sc1 lds
    s_xor_b32 s10, s85, 57344
    s_cmp_eq_u32 s10, s86
    s_cselect_b32 s10, s87, s10
    buffer_load_dwordx4 v1, s[4:7], s90 offen offset:3072 sc1 lds
    s_add_u32 m0, s96, 0
    s_add_u32 s90, s95, 98304
    buffer_load_dwordx4 v1, s[4:7], s90 offen offset:0 sc1 lds
    buffer_load_dwordx4 v1, s[4:7], s90 offen offset:1024 sc1 lds
    buffer_load_dwordx4 v1, s[4:7], s90 offen offset:2048 sc1 lds
    buffer_load_dwordx4 v1, s[4:7], s90 offen offset:3072 sc1 lds
    s_mov_b32 s97, 0
    s_atomic_add s97, s[4:5], s59 offset:16 glc
    s_add_u32 m0, s96, 16384
    s_add_u32 s90, s95, 114688
    buffer_load_dwordx4 v1, s[4:7], s90 offen offset:0 sc1 lds
    buffer_load_dwordx4 v1, s[4:7], s90 offen offset:1024 sc1 lds
    buffer_load_dwordx4 v1, s[4:7], s90 offen offset:2048 sc1 lds
    buffer_load_dwordx4 v1, s[4:7], s90 offen offset:3072 sc1 lds
    s_add_u32 m0, s96, 32768
    s_add_u32 s90, s95, 131072
    buffer_load_dwordx4 v1, s[4:7], s90 offen offset:0 sc1 lds
    buffer_load_dwordx4 v1, s[4:7], s90 offen offset:1024 sc1 lds
    buffer_load_dwordx4 v1, s[4:7], s90 offen offset:2048 sc1 lds
    buffer_load_dwordx4 v1, s[4:7], s90 offen offset:3072 sc1 lds
    s_waitcnt lgkmcnt(0)
    s_add_u32 s57, s57, 1
    s_max_u32 s57, s57, s97
    s_mov_b32 s58, 0
L_poll_15:
    s_waitcnt lgkmcnt(0)
    s_cmp_ge_u32 s57, 16
    s_cbranch_scc1 L_polled_16
    s_add_u32 s58, s58, 1
    s_cmp_ge_u32 s58, 0x20000
    s_cbranch_scc1 L_polled_16
    s_mov_b32 s57, 0
    s_atomic_add s57, s[4:5], s59 offset:16 glc
    s_branch L_poll_15
L_polled_16:
    ds_read_b128 v[128:131], v11 offset:0
    ds_read_b128 v[132:135], v11 offset:1024
    ds_read_b128 v[136:139], v11 offset:2048
    ds_read_b128 v[140:143], v11 offset:3072
    ds_read_b128 v[144:147], v11 offset:4096
    buffer_load_dwordx4 a[0:3], v8, s[4:7], s60 offen offset:0 sc1
    buffer_load_dwordx4 a[4:7], v8, s[4:7], s60 offen offset:1024 sc1
    buffer_load_dwordx4 a[8:11], v8, s[4:7], s60 offen offset:2048 sc1
    buffer_load_dwordx4 a[12:15], v8, s[4:7], s60 offen offset:3072 sc1
    buffer_load_dwordx4 a[16:19], v8, s[4:7], s61 offen offset:0 sc1
    buffer_load_dwordx4 a[20:23], v8, s[4:7], s61 offen offset:1024 sc1
    buffer_load_dwordx4 a[24:27], v8, s[4:7], s61 offen offset:2048 sc1
    buffer_load_dwordx4 a[28:31], v8, s[4:7], s61 offen offset:3072 sc1
    buffer_load_dwordx4 a[32:35], v8, s[4:7], s62 offen offset:0 sc1
    buffer_load_dwordx4 a[36:39], v8, s[4:7], s62 offen offset:1024 sc1
    s_waitcnt lgkmcnt(3)
    v_mfma_f32_16x16x32_bf16 v[160:163], v[128:131], v[48:51], 0
    ds_read_b128 v[148:151], v11 offset:5120
    v_lshlrev_b32 v16, 16, v48
    v_mfma_f32_16x16x32_bf16 v[160:163], v[132:135], v[56:59], v[160:163]
    v_and_b32 v17, 0xffff0000, v48
    v_lshlrev_b32 v18, 16, v49
    v_mfma_f32_16x16x32_bf16 v[168:171], v[132:135], v[60:63], 0
    ds_read_b128 v[152:155], v11 offset:6144
    v_and_b32 v19, 0xffff0000, v49
    v_mfma_f32_16x16x32_bf16 v[168:171], v[128:131], v[52:55], v[168:171]
    s_waitcnt lgkmcnt(3)
    v_lshlrev_b32 v20, 16, v50
    v_and_b32 v21, 0xffff0000, v50
    v_mfma_f32_16x16x32_bf16 v[172:175], v[136:139], v[52:55], 0
    ds_read_b128 v[156:159], v11 offset:7168
    v_lshlrev_b32 v22, 16, v51
    v_mfma_f32_16x16x32_bf16 v[172:175], v[140:143], v[60:63], v[172:175]
    v_and_b32 v23, 0xffff0000, v51
    v_lshlrev_b32 v24, 16, v52
    v_mfma_f32_16x16x32_bf16 v[164:167], v[140:143], v[56:59], 0
    ds_read_b128 v[128:131], v11 offset:8192
    v_and_b32 v25, 0xffff0000, v52
    v_mfma_f32_16x16x32_bf16 v[164:167], v[136:139], v[48:51], v[164:167]
    s_waitcnt lgkmcnt(3)
    v_lshlrev_b32 v26, 16, v53
    v_and_b32 v27, 0xffff0000, v53
    v_mfma_f32_16x16x32_bf16 v[112:115], v[144:147], v[48:51], 0
    ds_read_b128 v[132:135], v11 offset:9216
    v_lshlrev_b32 v28, 16, v54
    v_mfma_f32_16x16x32_bf16 v[112:115], v[148:151], v[56:59], v[112:115]
    v_and_b32 v29, 0xffff0000, v54
    v_lshlrev_b32 v30, 16, v55
    v_mfma_f32_16x16x32_bf16 v[120:123], v[148:151], v[60:63], 0
    ds_read_b128 v[136:139], v11 offset:10240
    v_and_b32 v31, 0xffff0000, v55
    v_mfma_f32_16x16x32_bf16 v[120:123], v[144:147], v[52:55], v[120:123]
    s_waitcnt lgkmcnt(3)
    v_lshlrev_b32 v32, 16, v56
    v_and_b32 v33, 0xffff0000, v56
    v_mfma_f32_16x16x32_bf16 v[124:127], v[152:155], v[52:55], 0
    ds_read_b128 v[140:143], v11 offset:11264
    v_lshlrev_b32 v34, 16, v57
    v_mfma_f32_16x16x32_bf16 v[124:127], v[156:159], v[60:63], v[124:127]
    v_and_b32 v35, 0xffff0000, v57
    v_lshlrev_b32 v36, 16, v58
    v_mfma_f32_16x16x32_bf16 v[116:119], v[156:159], v[56:59], 0
    ds_read_b128 v[144:147], v11 offset:12288
    v_and_b32 v37, 0xffff0000, v58
    v_mfma_f32_16x16x32_bf16 v[116:119], v[152:155], v[48:51], v[116:119]
    s_waitcnt lgkmcnt(3)
    v_lshlrev_b32 v38, 16, v59
    v_and_b32 v39, 0xffff0000, v59
    v_mfma_f32_16x16x32_bf16 v[240:243], v[128:131], v[48:51], 0
    ds_read_b128 v[148:151], v11 offset:13312
    v_lshlrev_b32 v40, 16, v60
    v_mfma_f32_16x16x32_bf16 v[240:243], v[132:135], v[56:59], v[240:243]
    v_and_b32 v41, 0xffff0000, v60
    v_lshlrev_b32 v42, 16, v61
    v_mfma_f32_16x16x32_bf16 v[248:251], v[132:135], v[60:63], 0
    ds_read_b128 v[152:155], v11 offset:14336
    v_and_b32 v43, 0xffff0000, v61
    v_mfma_f32_16x16x32_bf16 v[248:251], v[128:131], v[52:55], v[248:251]
    s_waitcnt lgkmcnt(3)
    v_lshlrev_b32 v44, 16, v62
    v_and_b32 v45, 0xffff0000, v62
    v_mfma_f32_16x16x32_bf16 v[252:255], v[136:139], v[52:55], 0
    ds_read_b128 v[156:159], v11 offset:15360
    v_lshlrev_b32 v46, 16, v63
    v_mfma_f32_16x16x32_bf16 v[252:255], v[140:143], v[60:63], v[252:255]
    v_and_b32 v47, 0xffff0000, v63
    v_add_f32 v16, v16, v224
    v_mfma_f32_16x16x32_bf16 v[244:247], v[140:143], v[56:59], 0
    ds_read_b128 v[128:131], v11 offset:16384
    v_add_f32 v17, v17, v225
    v_mfma_f32_16x16x32_bf16 v[244:247], v[136:139], v[48:51], v[244:247]
    s_waitcnt lgkmcnt(3)
    v_add_f32 v18, v18, v226
    v_add_f32 v19, v19, v227
    v_mfma_f32_16x16x32_bf16 v[176:179], v[144:147], v[48:51], 0
    ds_read_b128 v[132:135], v11 offset:17408
    v_add_f32 v20, v20, v228
    v_mfma_f32_16x16x32_bf16 v[176:179], v[148:151], v[56:59], v[176:179]
    v_add_f32 v21, v21, v229
    v_add_f32 v22, v22, v230
    v_mfma_f32_16x16x32_bf16 v[184:187], v[148:151], v[60:63], 0
    ds_read_b128 v[136:139], v11 offset:18432
    v_add_f32 v23, v23, v231
    v_mfma_f32_16x16x32_bf16 v[184:187], v[144:147], v[52:55], v[184:187]
    s_waitcnt lgkmcnt(3)
    v_add_f32 v24, v24, v224
    v_add_f32 v25, v25, v225
    v_mfma_f32_16x16x32_bf16 v[188:191], v[152:155], v[52:55], 0
    ds_read_b128 v[140:143], v11 offset:19456
    v_add_f32 v26, v26, v226
    v_mfma_f32_16x16x32_bf16 v[188:191], v[156:159], v[60:63], v[188:191]
    v_add_f32 v27, v27, v227
    v_add_f32 v28, v28, v228
    v_mfma_f32_16x16x32_bf16 v[180:183], v[156:159], v[56:59], 0
    ds_read_b128 v[144:147], v11 offset:20480
    v_add_f32 v29, v29, v229
    v_mfma_f32_16x16x32_bf16 v[180:183], v[152:155], v[48:51], v[180:183]
    s_waitcnt lgkmcnt(3)
    v_add_f32 v30, v30, v230
    v_add_f32 v31, v31, v231
    v_mfma_f32_16x16x32_bf16 v[64:67], v[128:131], v[48:51], 0
    ds_read_b128 v[148:151], v11 offset:21504
    v_add_f32 v32, v32, v232
    v_mfma_f32_16x16x32_bf16 v[64:67], v[132:135], v[56:59], v[64:67]
    buffer_load_dwordx4 a[40:43], v8, s[4:7], s62 offen offset:2048 sc1
    v_mfma_f32_16x16x32_bf16 v[72:75], v[132:135], v[60:63], 0
    ds_read_b128 v[152:155], v11 offset:22528
    v_add_f32 v33, v33, v233
    v_mfma_f32_16x16x32_bf16 v[72:75], v[128:131], v[52:55], v[72:75]
    s_waitcnt lgkmcnt(3)
    v_add_f32 v34, v34, v234
    v_add_f32 v35, v35, v235
    v_mfma_f32_16x16x32_bf16 v[76:79], v[136:139], v[52:55], 0
    ds_read_b128 v[156:159], v11 offset:23552
    v_add_f32 v36, v36, v236
    v_mfma_f32_16x16x32_bf16 v[76:79], v[140:143], v[60:63], v[76:79]
    buffer_load_dwordx4 a[44:47], v8, s[4:7], s62 offen offset:3072 sc1
    v_mfma_f32_16x16x32_bf16 v[68:71], v[140:143], v[56:59], 0
    ds_read_b128 v[128:131], v11 offset:24576
    v_add_f32 v37, v37, v237
    v_mfma_f32_16x16x32_bf16 v[68:71], v[136:139], v[48:51], v[68:71]
    s_waitcnt lgkmcnt(3)
    v_add_f32 v38, v38, v238
    v_add_f32 v39, v39, v239
    v_mfma_f32_16x16x32_bf16 v[80:83], v[144:147], v[48:51], 0
    ds_read_b128 v[132:135], v11 offset:25600
    v_add_f32 v40, v40, v232
    v_mfma_f32_16x16x32_bf16 v[80:83], v[148:151], v[56:59], v[80:83]
    buffer_load_dwordx4 a[48:51], v8, s[4:7], s63 offen offset:0 sc1
    v_mfma_f32_16x16x32_bf16 v[88:91], v[148:151], v[60:63], 0
    ds_read_b128 v[136:139], v11 offset:26624
    v_add_f32 v41, v41, v233
    v_mfma_f32_16x16x32_bf16 v[88:91], v[144:147], v[52:55], v[88:91]
    s_waitcnt lgkmcnt(3)
    v_add_f32 v42, v42, v234
    v_add_f32 v43, v43, v235
    v_mfma_f32_16x16x32_bf16 v[92:95], v[152:155], v[52:55], 0
    ds_read_b128 v[140:143], v11 offset:27648
    v_add_f32 v44, v44, v236
    v_mfma_f32_16x16x32_bf16 v[92:95], v[156:159], v[60:63], v[92:95]
    buffer_load_dwordx4 a[52:55], v8, s[4:7], s63 offen offset:1024 sc1
    v_mfma_f32_16x16x32_bf16 v[84:87], v[156:159], v[56:59], 0
    ds_read_b128 v[144:147], v11 offset:28672
    v_add_f32 v45, v45, v237
    v_mfma_f32_16x16x32_bf16 v[84:87], v[152:155], v[48:51], v[84:87]
    s_waitcnt lgkmcnt(3)
    v_add_f32 v46, v46, v238
    v_add_f32 v47, v47, v239
    v_mfma_f32_16x16x32_bf16 a[240:243], v[128:131], v[48:51], 0
    ds_read_b128 v[148:151], v11 offset:29696
    v_mfma_f32_16x16x32_bf16 a[240:243], v[132:135], v[56:59], a[240:243]
    buffer_load_dwordx4 a[56:59], v8, s[4:7], s63 offen offset:2048 sc1
    v_mfma_f32_16x16x32_bf16 a[248:251], v[132:135], v[60:63], 0
    ds_read_b128 v[152:155], v11 offset:30720
    v_mfma_f32_16x16x32_bf16 a[248:251], v[128:131], v[52:55], a[248:251]
    s_waitcnt lgkmcnt(3)
    v_mfma_f32_16x16x32_bf16 a[252:255], v[136:139], v[52:55], 0
    ds_read_b128 v[156:159], v11 offset:31744
    v_mfma_f32_16x16x32_bf16 a[252:255], v[140:143], v[60:63], a[252:255]
    s_waitcnt vmcnt(35)
    s_barrier
    v_mfma_f32_16x16x32_bf16 a[244:247], v[140:143], v[56:59], 0
    ds_read_b128 v[128:131], v10 offset:0
    v_mfma_f32_16x16x32_bf16 a[244:247], v[136:139], v[48:51], a[244:247]
    s_waitcnt lgkmcnt(3)
    s_waitcnt vmcnt(11)
    v_mfma_f32_16x16x32_bf16 v[160:163], v[144:147], a[0:3], v[160:163]
    ds_read_b128 v[132:135], v10 offset:1024
    s_add_u32 m0, s96, 49152
    v_mfma_f32_16x16x32_bf16 v[160:163], v[148:151], a[8:11], v[160:163]
    s_add_u32 s90, s95, 147456
    v_mfma_f32_16x16x32_bf16 v[168:171], v[148:151], a[12:15], v[168:171]
    ds_read_b128 v[136:139], v10 offset:2048
    v_mfma_f32_16x16x32_bf16 v[168:171], v[144:147], a[4:7], v[168:171]
    s_waitcnt lgkmcnt(3)
    buffer_load_dwordx4 a[60:63], v8, s[4:7], s63 offen offset:3072 sc1
    v_mfma_f32_16x16x32_bf16 v[172:175], v[152:155], a[4:7], v[172:175]
    ds_read_b128 v[140:143], v10 offset:3072
    v_mfma_f32_16x16x32_bf16 v[172:175], v[156:159], a[12:15], v[172:175]
    v_mfma_f32_16x16x32_bf16 v[164:167], v[156:159], a[8:11], v[164:167]
    ds_read_b128 v[144:147], v10 offset:4096
    v_mfma_f32_16x16x32_bf16 v[164:167], v[152:155], a[0:3], v[164:167]
    s_waitcnt lgkmcnt(3)
    buffer_load_dwordx4 a[64:67], v8, s[4:7], s64 offen offset:0 sc1
    v_mfma_f32_16x16x32_bf16 v[112:115], v[128:131], a[0:3], v[112:115]
    ds_read_b128 v[148:151], v10 offset:5120
    v_mfma_f32_16x16x32_bf16 v[112:115], v[132:135], a[8:11], v[112:115]
    v_mfma_f32_16x16x32_bf16 v[120:123], v[132:135], a[12:15], v[120:123]
    ds_read_b128 v[152:155], v10 offset:6144
    v_mfma_f32_16x16x32_bf16 v[120:123], v[128:131], a[4:7], v[120:123]
    s_waitcnt lgkmcnt(3)
    buffer_load_dwordx4 a[68:71], v8, s[4:7], s64 offen offset:1024 sc1
    v_mfma_f32_16x16x32_bf16 v[124:127], v[136:139], a[4:7], v[124:127]
    ds_read_b128 v[156:159], v10 offset:7168
    v_mfma_f32_16x16x32_bf16 v[124:127], v[140:143], a[12:15], v[124:127]
    v_mfma_f32_16x16x32_bf16 v[116:119], v[140:143], a[8:11], v[116:119]
    ds_read_b128 v[128:131], v10 offset:8192
    v_mfma_f32_16x16x32_bf16 v[116:119], v[136:139], a[0:3], v[116:119]
    s_waitcnt vmcnt(10) lgkmcnt(3)
    buffer_load_dwordx4 a[72:75], v8, s[4:7], s64 offen offset:2048 sc1
    v_mfma_f32_16x16x32_bf16 v[160:163], v[144:147], a[16:19], v[160:163]
    ds_read_b128 v[132:135], v10 offset:9216
    v_mfma_f32_16x16x32_bf16 v[160:163], v[148:151], a[24:27], v[160:163]
    v_mfma_f32_16x16x32_bf16 v[168:171], v[148:151], a[28:31], v[168:171]
    ds_read_b128 v[136:139], v10 offset:10240
    v_mfma_f32_16x16x32_bf16 v[168:171], v[144:147], a[20:23], v[168:171]
    s_waitcnt lgkmcnt(3)
    buffer_load_dwordx4 a[76:79], v8, s[4:7], s64 offen offset:3072 sc1
    v_mfma_f32_16x16x32_bf16 v[172:175], v[152:155], a[20:23], v[172:175]
    ds_read_b128 v[140:143], v10 offset:11264
    v_mfma_f32_16x16x32_bf16 v[172:175], v[156:159], a[28:31], v[172:175]
    v_mfma_f32_16x16x32_bf16 v[164:167], v[156:159], a[24:27], v[164:167]
    ds_read_b128 v[144:147], v10 offset:12288
    v_mfma_f32_16x16x32_bf16 v[164:167], v[152:155], a[16:19], v[164:167]
    s_waitcnt lgkmcnt(3)
    buffer_load_dwordx4 a[80:83], v8, s[4:7], s65 offen offset:0 sc1
    v_mfma_f32_16x16x32_bf16 v[112:115], v[128:131], a[16:19], v[112:115]
    ds_read_b128 v[148:151], v10 offset:13312
    v_mfma_f32_16x16x32_bf16 v[112:115], v[132:135], a[24:27], v[112:115]
    v_mfma_f32_16x16x32_bf16 v[120:123], v[132:135], a[28:31], v[120:123]
    ds_read_b128 v[152:155], v10 offset:14336
    v_mfma_f32_16x16x32_bf16 v[120:123], v[128:131], a[20:23], v[120:123]
    s_waitcnt lgkmcnt(3)
    buffer_load_dwordx4 a[84:87], v8, s[4:7], s65 offen offset:1024 sc1
    v_mfma_f32_16x16x32_bf16 v[124:127], v[136:139], a[20:23], v[124:127]
    ds_read_b128 v[156:159], v10 offset:15360
    v_mfma_f32_16x16x32_bf16 v[124:127], v[140:143], a[28:31], v[124:127]
    buffer_load_dwordx4 v[224:227], v1, s[4:7], s94 offen offset:0 sc1
    v_mfma_f32_16x16x32_bf16 v[116:119], v[140:143], a[24:27], v[116:119]
    ds_read_b128 v[128:131], v10 offset:16384
    v_mfma_f32_16x16x32_bf16 v[116:119], v[136:139], a[16:19], v[116:119]
    s_waitcnt vmcnt(11) lgkmcnt(3)
    buffer_load_dwordx4 a[88:91], v8, s[4:7], s65 offen offset:2048 sc1
    v_mfma_f32_16x16x32_bf16 v[160:163], v[144:147], a[32:35], v[160:163]
    ds_read_b128 v[132:135], v10 offset:17408
    v_mfma_f32_16x16x32_bf16 v[160:163], v[148:151], a[40:43], v[160:163]
    v_mfma_f32_16x16x32_bf16 v[168:171], v[148:151], a[44:47], v[168:171]
    ds_read_b128 v[136:139], v10 offset:18432
    v_mfma_f32_16x16x32_bf16 v[168:171], v[144:147], a[36:39], v[168:171]
    s_waitcnt lgkmcnt(3)
    buffer_load_dwordx4 a[92:95], v8, s[4:7], s65 offen offset:3072 sc1
    v_mfma_f32_16x16x32_bf16 v[172:175], v[152:155], a[36:39], v[172:175]
    ds_read_b128 v[140:143], v10 offset:19456
    v_mfma_f32_16x16x32_bf16 v[172:175], v[156:159], a[44:47], v[172:175]
    v_mfma_f32_16x16x32_bf16 v[164:167], v[156:159], a[40:43], v[164:167]
    ds_read_b128 v[144:147], v10 offset:20480
    v_mfma_f32_16x16x32_bf16 v[164:167], v[152:155], a[32:35], v[164:167]
    s_waitcnt lgkmcnt(3)
    buffer_load_dwordx4 a[96:99], v8, s[4:7], s66 offen offset:0 sc1
    v_mfma_f32_16x16x32_bf16 v[112:115], v[128:131], a[32:35], v[112:115]
    ds_read_b128 v[148:151], v10 offset:21504
    v_mfma_f32_16x16x32_bf16 v[112:115], v[132:135], a[40:43], v[112:115]
    v_mfma_f32_16x16x32_bf16 v[120:123], v[132:135], a[44:47], v[120:123]
    ds_read_b128 v[152:155], v10 offset:22528
    v_mfma_f32_16x16x32_bf16 v[120:123], v[128:131], a[36:39], v[120:123]
    s_waitcnt lgkmcnt(3)
    buffer_load_dwordx4 a[100:103], v8, s[4:7], s66 offen offset:1024 sc1
    v_mfma_f32_16x16x32_bf16 v[124:127], v[136:139], a[36:39], v[124:127]
    ds_read_b128 v[156:159], v10 offset:23552
    v_mfma_f32_16x16x32_bf16 v[124:127], v[140:143], a[44:47], v[124:127]
    buffer_load_dwordx4 v[228:231], v1, s[4:7], s94 offen offset:1024 sc1
    v_mfma_f32_16x16x32_bf16 v[116:119], v[140:143], a[40:43], v[116:119]
    ds_read_b128 v[128:131], v10 offset:24576
    v_mfma_f32_16x16x32_bf16 v[116:119], v[136:139], a[32:35], v[116:119]
    s_waitcnt vmcnt(12) lgkmcnt(3)
    buffer_load_dwordx4 a[104:107], v8, s[4:7], s66 offen offset:2048 sc1
    v_mfma_f32_16x16x32_bf16 v[160:163], v[144:147], a[48:51], v[160:163]
    ds_read_b128 v[132:135], v10 offset:25600
    v_mfma_f32_16x16x32_bf16 v[160:163], v[148:151], a[56:59], v[160:163]
    v_mfma_f32_16x16x32_bf16 v[168:171], v[148:151], a[60:63], v[168:171]
    ds_read_b128 v[136:139], v10 offset:26624
    v_mfma_f32_16x16x32_bf16 v[168:171], v[144:147], a[52:55], v[168:171]
    s_waitcnt lgkmcnt(3)
    buffer_load_dwordx4 a[108:111], v8, s[4:7], s66 offen offset:3072 sc1
    v_mfma_f32_16x16x32_bf16 v[172:175], v[152:155], a[52:55], v[172:175]
    ds_read_b128 v[140:143], v10 offset:27648
    v_mfma_f32_16x16x32_bf16 v[172:175], v[156:159], a[60:63], v[172:175]
    v_mfma_f32_16x16x32_bf16 v[164:167], v[156:159], a[56:59], v[164:167]
    ds_read_b128 v[144:147], v10 offset:28672
    v_mfma_f32_16x16x32_bf16 v[164:167], v[152:155], a[48:51], v[164:167]
    s_waitcnt lgkmcnt(3)
    buffer_load_dwordx4 a[112:115], v8, s[4:7], s67 offen offset:0 sc1
    v_mfma_f32_16x16x32_bf16 v[112:115], v[128:131], a[48:51], v[112:115]
    ds_read_b128 v[148:151], v10 offset:29696
    v_mfma_f32_16x16x32_bf16 v[112:115], v[132:135], a[56:59], v[112:115]
    v_mfma_f32_16x16x32_bf16 v[120:123], v[132:135], a[60:63], v[120:123]
    ds_read_b128 v[152:155], v10 offset:30720
    v_mfma_f32_16x16x32_bf16 v[120:123], v[128:131], a[52:55], v[120:123]
    s_waitcnt lgkmcnt(3)
    buffer_load_dwordx4 a[116:119], v8, s[4:7], s67 offen offset:1024 sc1
    v_mfma_f32_16x16x32_bf16 v[124:127], v[136:139], a[52:55], v[124:127]
    ds_read_b128 v[156:159], v10 offset:31744
    v_mfma_f32_16x16x32_bf16 v[124:127], v[140:143], a[60:63], v[124:127]
    s_barrier
    v_mfma_f32_16x16x32_bf16 v[116:119], v[140:143], a[56:59], v[116:119]
    ds_read_b128 v[128:131], v10 offset:32768
    v_mfma_f32_16x16x32_bf16 v[116:119], v[136:139], a[48:51], v[116:119]
    s_waitcnt vmcnt(12) lgkmcnt(3)
    buffer_load_dwordx4 v[232:235], v1, s[4:7], s94 offen offset:2048 sc1
    v_mfma_f32_16x16x32_bf16 v[160:163], v[144:147], a[64:67], v[160:163]
    ds_read_b128 v[132:135], v10 offset:33792
    v_mfma_f32_16x16x32_bf16 v[160:163], v[148:151], a[72:75], v[160:163]
    buffer_load_dwordx4 a[120:123], v8, s[4:7], s67 offen offset:2048 sc1
    v_mfma_f32_16x16x32_bf16 v[168:171], v[148:151], a[76:79], v[168:171]
    ds_read_b128 v[136:139], v10 offset:34816
    v_mfma_f32_16x16x32_bf16 v[168:171], v[144:147], a[68:71], v[168:171]
    s_waitcnt lgkmcnt(3)
    buffer_load_dwordx4 a[124:127], v8, s[4:7], s67 offen offset:3072 sc1
    v_mfma_f32_16x16x32_bf16 v[172:175], v[152:155], a[68:71], v[172:175]
    ds_read_b128 v[140:143], v10 offset:35840
    v_mfma_f32_16x16x32_bf16 v[172:175], v[156:159], a[76:79], v[172:175]
    v_mfma_f32_16x16x32_bf16 v[164:167], v[156:159], a[72:75], v[164:167]
    ds_read_b128 v[144:147], v10 offset:36864
    v_mfma_f32_16x16x32_bf16 v[164:167], v[152:155], a[64:67], v[164:167]
    s_waitcnt lgkmcnt(3)
    buffer_load_dwordx4 a[128:131], v8, s[4:7], s44 offen offset:0 sc1
    v_mfma_f32_16x16x32_bf16 v[112:115], v[128:131], a[64:67], v[112:115]
    ds_read_b128 v[148:151], v10 offset:37888
    v_mfma_f32_16x16x32_bf16 v[112:115], v[132:135], a[72:75], v[112:115]
    v_mfma_f32_16x16x32_bf16 v[120:123], v[132:135], a[76:79], v[120:123]
    ds_read_b128 v[152:155], v10 offset:38912
    v_mfma_f32_16x16x32_bf16 v[120:123], v[128:131], a[68:71], v[120:123]
    s_waitcnt lgkmcnt(3)
    buffer_load_dwordx4 a[132:135], v8, s[4:7], s44 offen offset:1024 sc1
    v_mfma_f32_16x16x32_bf16 v[124:127], v[136:139], a[68:71], v[124:127]
    ds_read_b128 v[156:159], v10 offset:39936
    v_mfma_f32_16x16x32_bf16 v[124:127], v[140:143], a[76:79], v[124:127]
    buffer_load_dwordx4 v[236:239], v1, s[4:7], s94 offen offset:3072 sc1
    v_mfma_f32_16x16x32_bf16 v[116:119], v[140:143], a[72:75], v[116:119]
    ds_read_b128 v[128:131], v10 offset:40960
    v_mfma_f32_16x16x32_bf16 v[116:119], v[136:139], a[64:67], v[116:119]
    s_waitcnt vmcnt(13) lgkmcnt(3)
    buffer_load_dwordx4 a[136:139], v8, s[4:7], s44 offen offset:2048 sc1
    v_mfma_f32_16x16x32_bf16 v[160:163], v[144:147], a[80:83], v[160:163]
    ds_read_b128 v[132:135], v10 offset:41984
    v_mfma_f32_16x16x32_bf16 v[160:163], v[148:151], a[88:91], v[160:163]
    v_mfma_f32_16x16x32_bf16 v[168:171], v[148:151], a[92:95], v[168:171]
    ds_read_b128 v[136:139], v10 offset:43008
    v_mfma_f32_16x16x32_bf16 v[168:171], v[144:147], a[84:87], v[168:171]
    s_waitcnt lgkmcnt(3)
    buffer_load_dwordx4 a[140:143], v8, s[4:7], s44 offen offset:3072 sc1
    v_mfma_f32_16x16x32_bf16 v[172:175], v[152:155], a[84:87], v[172:175]
    ds_read_b128 v[140:143], v10 offset:44032
    v_mfma_f32_16x16x32_bf16 v[172:175], v[156:159], a[92:95], v[172:175]
    v_mfma_f32_16x16x32_bf16 v[164:167], v[156:159], a[88:91], v[164:167]
    ds_read_b128 v[144:147], v10 offset:45056
    v_mfma_f32_16x16x32_bf16 v[164:167], v[152:155], a[80:83], v[164:167]
    s_waitcnt lgkmcnt(3)
    buffer_load_dwordx4 a[144:147], v8, s[4:7], s45 offen offset:0 sc1
    v_mfma_f32_16x16x32_bf16 v[112:115], v[128:131], a[80:83], v[112:115]
    ds_read_b128 v[148:151], v10 offset:46080
    v_mfma_f32_16x16x32_bf16 v[112:115], v[132:135], a[88:91], v[112:115]
    v_mfma_f32_16x16x32_bf16 v[120:123], v[132:135], a[92:95], v[120:123]
    ds_read_b128 v[152:155], v10 offset:47104
    v_mfma_f32_16x16x32_bf16 v[120:123], v[128:131], a[84:87], v[120:123]
    s_waitcnt lgkmcnt(3)
    buffer_load_dwordx4 a[148:151], v8, s[4:7], s45 offen offset:1024 sc1
    v_mfma_f32_16x16x32_bf16 v[124:127], v[136:139], a[84:87], v[124:127]
    ds_read_b128 v[156:159], v10 offset:48128
    v_mfma_f32_16x16x32_bf16 v[124:127], v[140:143], a[92:95], v[124:127]
L_hop7:
    s_cbranch_execz L_hop11
    v_mfma_f32_16x16x32_bf16 v[116:119], v[140:143], a[88:91], v[116:119]
    ds_read_b128 v[128:131], v10 offset:49152
    v_mfma_f32_16x16x32_bf16 v[116:119], v[136:139], a[80:83], v[116:119]
    s_waitcnt vmcnt(12) lgkmcnt(3)
    buffer_load_dwordx4 a[152:155], v8, s[4:7], s45 offen offset:2048 sc1
    v_mfma_f32_16x16x32_bf16 v[160:163], v[144:147], a[96:99], v[160:163]
    ds_read_b128 v[132:135], v10 offset:50176
    v_mfma_f32_16x16x32_bf16 v[160:163], v[148:151], a[104:107], v[160:163]
    v_mfma_f32_16x16x32_bf16 v[168:171], v[148:151], a[108:111], v[168:171]
    ds_read_b128 v[136:139], v10 offset:51200
    v_mfma_f32_16x16x32_bf16 v[168:171], v[144:147], a[100:103], v[168:171]
    s_waitcnt lgkmcnt(3)
    buffer_load_dwordx4 a[156:159], v8, s[4:7], s45 offen offset:3072 sc1
    v_mfma_f32_16x16x32_bf16 v[172:175], v[152:155], a[100:103], v[172:175]
    ds_read_b128 v[140:143], v10 offset:52224
    v_mfma_f32_16x16x32_bf16 v[172:175], v[156:159], a[108:111], v[172:175]
    v_mfma_f32_16x16x32_bf16 v[164:167], v[156:159], a[104:107], v[164:167]
    ds_read_b128 v[144:147], v10 offset:53248
    v_mfma_f32_16x16x32_bf16 v[164:167], v[152:155], a[96:99], v[164:167]
    s_waitcnt lgkmcnt(3)
    buffer_load_dwordx4 a[160:163], v8, s[4:7], s46 offen offset:0 sc1
    v_mfma_f32_16x16x32_bf16 v[112:115], v[128:131], a[96:99], v[112:115]
    ds_read_b128 v[148:151], v10 offset:54272
    v_mfma_f32_16x16x32_bf16 v[112:115], v[132:135], a[104:107], v[112:115]
    v_mfma_f32_16x16x32_bf16 v[120:123], v[132:135], a[108:111], v[120:123]
    ds_read_b128 v[152:155], v10 offset:55296
    v_mfma_f32_16x16x32_bf16 v[120:123], v[128:131], a[100:103], v[120:123]
    s_waitcnt lgkmcnt(3)
    buffer_load_dwordx4 a[164:167], v8, s[4:7], s46 offen offset:1024 sc1
    v_mfma_f32_16x16x32_bf16 v[124:127], v[136:139], a[100:103], v[124:127]
    ds_read_b128 v[156:159], v10 offset:56320
    v_mfma_f32_16x16x32_bf16 v[124:127], v[140:143], a[108:111], v[124:127]
    v_mfma_f32_16x16x32_bf16 v[116:119], v[140:143], a[104:107], v[116:119]
    ds_read_b128 v[128:131], v10 offset:57344
    v_mfma_f32_16x16x32_bf16 v[116:119], v[136:139], a[96:99], v[116:119]
    s_waitcnt vmcnt(11) lgkmcnt(3)
    buffer_load_dwordx4 a[168:171], v8, s[4:7], s46 offen offset:2048 sc1
    v_mfma_f32_16x16x32_bf16 v[160:163], v[144:147], a[112:115], v[160:163]
    ds_read_b128 v[132:135], v10 offset:58368
    v_mfma_f32_16x16x32_bf16 v[160:163], v[148:151], a[120:123], v[160:163]
    v_mfma_f32_16x16x32_bf16 v[168:171], v[148:151], a[124:127], v[168:171]
    ds_read_b128 v[136:139], v10 offset:59392
    v_mfma_f32_16x16x32_bf16 v[168:171], v[144:147], a[116:119], v[168:171]
    s_waitcnt lgkmcnt(3)
    buffer_load_dwordx4 a[172:175], v8, s[4:7], s46 offen offset:3072 sc1
    v_mfma_f32_16x16x32_bf16 v[172:175], v[152:155], a[116:119], v[172:175]
    ds_read_b128 v[140:143], v10 offset:60416
    v_mfma_f32_16x16x32_bf16 v[172:175], v[156:159], a[124:127], v[172:175]
    v_mfma_f32_16x16x32_bf16 v[164:167], v[156:159], a[120:123], v[164:167]
    ds_read_b128 v[144:147], v10 offset:61440
    v_mfma_f32_16x16x32_bf16 v[164:167], v[152:155], a[112:115], v[164:167]
    s_waitcnt lgkmcnt(3)
    buffer_load_dwordx4 a[176:179], v8, s[4:7], s47 offen offset:0 sc1
    v_mfma_f32_16x16x32_bf16 v[112:115], v[128:131], a[112:115], v[112:115]
    ds_read_b128 v[148:151], v10 offset:62464
    v_mfma_f32_16x16x32_bf16 v[112:115], v[132:135], a[120:123], v[112:115]
    s_waitcnt vmcnt(11)
    v_mfma_f32_16x16x32_bf16 v[120:123], v[132:135], a[124:127], v[120:123]
    ds_read_b128 v[152:155], v10 offset:63488
    v_add_f32 v224, v224, v232
    v_mfma_f32_16x16x32_bf16 v[120:123], v[128:131], a[116:119], v[120:123]
    s_waitcnt lgkmcnt(3)
    buffer_load_dwordx4 a[180:183], v8, s[4:7], s47 offen offset:1024 sc1
    v_add_f32 v225, v225, v233
    v_mfma_f32_16x16x32_bf16 v[124:127], v[136:139], a[116:119], v[124:127]
    ds_read_b128 v[156:159], v10 offset:64512
    v_add_f32 v226, v226, v234
    v_mfma_f32_16x16x32_bf16 v[124:127], v[140:143], a[124:127], v[124:127]
    s_barrier
    v_mfma_f32_16x16x32_bf16 v[116:119], v[140:143], a[120:123], v[116:119]
    ds_read_b128 v[128:131], v1 offset:0
    v_add_f32 v227, v227, v235
    v_mfma_f32_16x16x32_bf16 v[116:119], v[136:139], a[112:115], v[116:119]
    s_waitcnt vmcnt(10) lgkmcnt(3)
    buffer_load_dwordx4 a[184:187], v8, s[4:7], s47 offen offset:2048 sc1
    v_add_f32 v228, v228, v236
    v_mfma_f32_16x16x32_bf16 v[160:163], v[144:147], a[128:131], v[160:163]
    ds_read_b128 v[132:135], v1 offset:1024
    v_add_f32 v229, v229, v237
    v_mfma_f32_16x16x32_bf16 v[160:163], v[148:151], a[136:139], v[160:163]
    v_add_f32 v230, v230, v238
    v_mfma_f32_16x16x32_bf16 v[168:171], v[148:151], a[140:143], v[168:171]
    ds_read_b128 v[136:139], v1 offset:2048
    v_add_f32 v231, v231, v239
    v_mfma_f32_16x16x32_bf16 v[168:171], v[144:147], a[132:135], v[168:171]
    s_waitcnt lgkmcnt(3)
    buffer_load_dwordx4 a[188:191], v8, s[4:7], s47 offen offset:3072 sc1
    v_add_f32 v224, v224, v228
    v_mfma_f32_16x16x32_bf16 v[172:175], v[152:155], a[132:135], v[172:175]
    ds_read_b128 v[140:143], v1 offset:3072
    v_add_f32 v225, v225, v229
    v_mfma_f32_16x16x32_bf16 v[172:175], v[156:159], a[140:143], v[172:175]
    v_add_f32 v226, v226, v230
    v_mfma_f32_16x16x32_bf16 v[164:167], v[156:159], a[136:139], v[164:167]
    ds_read_b128 v[144:147], v1 offset:4096
    v_add_f32 v227, v227, v231
    v_mfma_f32_16x16x32_bf16 v[164:167], v[152:155], a[128:131], v[164:167]
    s_waitcnt lgkmcnt(3)
    buffer_load_dwordx4 a[192:195], v8, s[4:7], s8 offen offset:0 sc1
    v_permlane32_swap_b32 v224, v226
    v_mfma_f32_16x16x32_bf16 v[112:115], v[128:131], a[128:131], v[112:115]
    ds_read_b128 v[148:151], v1 offset:5120
    v_permlane32_swap_b32 v225, v227
    v_mfma_f32_16x16x32_bf16 v[112:115], v[132:135], a[136:139], v[112:115]
    v_add_f32 v224, v224, v226
    v_mfma_f32_16x16x32_bf16 v[120:123], v[132:135], a[140:143], v[120:123]
    ds_read_b128 v[152:155], v1 offset:6144
    v_add_f32 v225, v225, v227
    v_mfma_f32_16x16x32_bf16 v[120:123], v[128:131], a[132:135], v[120:123]
    s_waitcnt lgkmcnt(3)
    buffer_load_dwordx4 a[196:199], v8, s[4:7], s8 offen offset:1024 sc1
    v_permlane16_swap_b32 v224, v225
    v_mfma_f32_16x16x32_bf16 v[124:127], v[136:139], a[132:135], v[124:127]
    ds_read_b128 v[156:159], v1 offset:7168
    v_add_f32 v224, v224, v225
    v_mfma_f32_16x16x32_bf16 v[124:127], v[140:143], a[140:143], v[124:127]
    v_mul_f32 v224, 0x3a800000, v224
    v_mfma_f32_16x16x32_bf16 v[116:119], v[140:143], a[136:139], v[116:119]
    ds_read_b128 v[128:131], v1 offset:8192
    v_mov_b32 v225, v224
    v_mfma_f32_16x16x32_bf16 v[116:119], v[136:139], a[128:131], v[116:119]
    s_waitcnt vmcnt(10) lgkmcnt(3)
    buffer_load_dwordx4 a[200:203], v8, s[4:7], s8 offen offset:2048 sc1
    v_permlane32_swap_b32 v224, v225
    v_mfma_f32_16x16x32_bf16 v[160:163], v[144:147], a[144:147], v[160:163]
    ds_read_b128 v[132:135], v1 offset:9216
    v_fma_f32 v225, -v224, v224, v225
    v_mfma_f32_16x16x32_bf16 v[160:163], v[148:151], a[152:155], v[160:163]
    v_max_f32 v225, 0, v225
    v_mfma_f32_16x16x32_bf16 v[168:171], v[148:151], a[156:159], v[168:171]
    ds_read_b128 v[136:139], v1 offset:10240
    v_add_f32 v226, 0x3727c5ac, v225
    v_mfma_f32_16x16x32_bf16 v[168:171], v[144:147], a[148:151], v[168:171]
    s_waitcnt lgkmcnt(3)
    buffer_load_dwordx4 a[204:207], v8, s[4:7], s8 offen offset:3072 sc1
    v_mfma_f32_16x16x32_bf16 v[172:175], v[152:155], a[148:151], v[172:175]
    ds_read_b128 v[140:143], v1 offset:11264
    v_mfma_f32_16x16x32_bf16 v[172:175], v[156:159], a[156:159], v[172:175]
    v_rsq_f32 v226, v226
    v_mfma_f32_16x16x32_bf16 v[164:167], v[156:159], a[152:155], v[164:167]
    ds_read_b128 v[144:147], v1 offset:12288
    v_mul_f32 v227, v225, v226
    v_mfma_f32_16x16x32_bf16 v[164:167], v[152:155], a[144:147], v[164:167]
    s_waitcnt lgkmcnt(3)
    buffer_load_dwordx4 a[208:211], v8, s[4:7], s9 offen offset:0 sc1
    v_fmaak_f32 v227, v227, v226, 0x3727c5ac
    v_mfma_f32_16x16x32_bf16 v[112:115], v[128:131], a[144:147], v[112:115]
    ds_read_b128 v[148:151], v1 offset:13312
    v_mfma_f32_16x16x32_bf16 v[112:115], v[132:135], a[152:155], v[112:115]
    v_rsq_f32 v227, v227
    v_mfma_f32_16x16x32_bf16 v[120:123], v[132:135], a[156:159], v[120:123]
    ds_read_b128 v[152:155], v1 offset:14336
    v_mul_f32 v226, v226, v227
    v_mfma_f32_16x16x32_bf16 v[120:123], v[128:131], a[148:151], v[120:123]
    s_waitcnt lgkmcnt(3)
    buffer_load_dwordx4 a[212:215], v8, s[4:7], s9 offen offset:1024 sc1
    v_mfma_f32_16x16x32_bf16 v[124:127], v[136:139], a[148:151], v[124:127]
    ds_read_b128 v[156:159], v1 offset:15360
    v_mfma_f32_16x16x32_bf16 v[124:127], v[140:143], a[156:159], v[124:127]
    v_rcp_f32 v220, v226
    v_mfma_f32_16x16x32_bf16 v[116:119], v[140:143], a[152:155], v[116:119]
    ds_read_b128 v[128:131], v1 offset:16384
    v_mul_f32 v108, 0xc0135761, v226
    v_mfma_f32_16x16x32_bf16 v[116:119], v[136:139], a[144:147], v[116:119]
    s_waitcnt vmcnt(10) lgkmcnt(3)
    buffer_load_dwordx4 a[216:219], v8, s[4:7], s9 offen offset:2048 sc1
    v_mul_f32 v110, v226, v226
    v_mfma_f32_16x16x32_bf16 v[160:163], v[144:147], a[160:163], v[160:163]
    ds_read_b128 v[132:135], v1 offset:17408
    v_mul_f32 v110, v110, v108
    v_mfma_f32_16x16x32_bf16 v[160:163], v[148:151], a[168:171], v[160:163]
    v_mul_f32 v110, 0x3d372713, v110
    v_mfma_f32_16x16x32_bf16 v[168:171], v[148:151], a[172:175], v[168:171]
    ds_read_b128 v[136:139], v1 offset:18432
    v_cvt_pk_bf16_f32 v228, 0, v220
    v_mfma_f32_16x16x32_bf16 v[168:171], v[144:147], a[164:167], v[168:171]
    s_waitcnt lgkmcnt(3)
    buffer_load_dwordx4 a[220:223], v8, s[4:7], s9 offen offset:3072 sc1
    v_sub_f32 v229, v220, v228
    v_mfma_f32_16x16x32_bf16 v[172:175], v[152:155], a[164:167], v[172:175]
    ds_read_b128 v[140:143], v1 offset:19456
    v_permlane32_swap_b32 v228, v229
    v_mfma_f32_16x16x32_bf16 v[172:175], v[156:159], a[172:175], v[172:175]
    v_cvt_pk_bf16_f32 v105, -v224, v228
    v_mfma_f32_16x16x32_bf16 v[164:167], v[156:159], a[168:171], v[164:167]
    ds_read_b128 v[144:147], v1 offset:20480
    v_lshlrev_b32 v228, 16, v105
    v_mfma_f32_16x16x32_bf16 v[164:167], v[152:155], a[160:163], v[164:167]
    s_waitcnt lgkmcnt(3)
    buffer_load_dwordx4 a[224:227], v8, s[4:7], s10 offen offset:0 sc1
    v_add_f32 v228, v228, v224
    v_mfma_f32_16x16x32_bf16 v[112:115], v[128:131], a[160:163], v[112:115]
    ds_read_b128 v[148:151], v1 offset:21504
    v_cvt_pk_bf16_f32 v104, -v224, -v228
    v_mfma_f32_16x16x32_bf16 v[112:115], v[132:135], a[168:171], v[112:115]
    v_mov_b32 v107, v105
    v_mfma_f32_16x16x32_bf16 v[120:123], v[132:135], a[172:175], v[120:123]
    ds_read_b128 v[152:155], v1 offset:22528
    v_permlane16_swap_b32 v105, v107
    v_mfma_f32_16x16x32_bf16 v[120:123], v[128:131], a[164:167], v[120:123]
    s_waitcnt lgkmcnt(3)
    buffer_load_dwordx4 a[228:231], v8, s[4:7], s10 offen offset:1024 sc1
    v_mov_b32 v106, v104
    v_mfma_f32_16x16x32_bf16 v[124:127], v[136:139], a[164:167], v[124:127]
    ds_read_b128 v[156:159], v1 offset:23552
    v_permlane16_swap_b32 v104, v106
    v_mfma_f32_16x16x32_bf16 v[124:127], v[140:143], a[172:175], v[124:127]
    v_mov_b32 v109, v108
    v_mfma_f32_16x16x32_bf16 v[116:119], v[140:143], a[168:171], v[116:119]
    ds_read_b128 v[128:131], v1 offset:24576
    v_permlane16_swap_b32 v108, v109
    v_mfma_f32_16x16x32_bf16 v[116:119], v[136:139], a[160:163], v[116:119]
    s_waitcnt vmcnt(10) lgkmcnt(3)
    buffer_load_dwordx4 a[232:235], v8, s[4:7], s10 offen offset:2048 sc1
    v_mov_b32 v111, v110
    v_mfma_f32_16x16x32_bf16 v[160:163], v[144:147], a[176:179], v[160:163]
    ds_read_b128 v[132:135], v1 offset:25600
    v_permlane16_swap_b32 v110, v111
    v_mfma_f32_16x16x32_bf16 v[160:163], v[148:151], a[184:187], v[160:163]
    buffer_load_dwordx4 v1, s[4:7], s90 offen offset:0 sc1 lds
    v_mov_b32 v221, v220
    v_mfma_f32_16x16x32_bf16 v[168:171], v[148:151], a[188:191], v[168:171]
    ds_read_b128 v[136:139], v1 offset:26624
    v_permlane16_swap_b32 v220, v221
    v_mfma_f32_16x16x32_bf16 v[168:171], v[144:147], a[180:183], v[168:171]
    s_waitcnt lgkmcnt(3)
    buffer_load_dwordx4 v1, s[4:7], s90 offen offset:1024 sc1 lds
    v_mfma_f32_16x16x32_bf16 v[172:175], v[152:155], a[180:183], v[172:175]
    ds_read_b128 v[140:143], v1 offset:27648
    v_mfma_f32_16x16x32_bf16 v[172:175], v[156:159], a[188:191], v[172:175]
    buffer_load_dwordx4 v1, s[4:7], s90 offen offset:2048 sc1 lds
    v_mfma_f32_16x16x32_bf16 v[164:167], v[156:159], a[184:187], v[164:167]
    ds_read_b128 v[144:147], v1 offset:28672
    v_mfma_f32_16x16x32_bf16 v[164:167], v[152:155], a[176:179], v[164:167]
    s_waitcnt lgkmcnt(3)
    buffer_load_dwordx4 v1, s[4:7], s90 offen offset:3072 sc1 lds
    s_add_u32 m0, s96, 65536
    v_mfma_f32_16x16x32_bf16 v[112:115], v[128:131], a[176:179], v[112:115]
    ds_read_b128 v[148:151], v1 offset:29696
    s_add_u32 s90, s95, 163840
    v_mfma_f32_16x16x32_bf16 v[112:115], v[132:135], a[184:187], v[112:115]
    buffer_load_dwordx4 a[236:239], v8, s[4:7], s10 offen offset:3072 sc1
    v_mfma_f32_16x16x32_bf16 v[120:123], v[132:135], a[188:191], v[120:123]
    ds_read_b128 v[152:155], v1 offset:30720
    v_mfma_f32_16x16x32_bf16 v[120:123], v[128:131], a[180:183], v[120:123]
    s_waitcnt lgkmcnt(3)
    v_mfma_f32_16x16x32_bf16 v[124:127], v[136:139], a[180:183], v[124:127]
    ds_read_b128 v[156:159], v1 offset:31744
    v_mfma_f32_16x16x32_bf16 v[124:127], v[140:143], a[188:191], v[124:127]
    s_barrier
    v_mfma_f32_16x16x32_bf16 v[116:119], v[140:143], a[184:187], v[116:119]
    ds_read_b128 v[128:131], v1 offset:32768
    v_mfma_f32_16x16x32_bf16 v[116:119], v[136:139], a[176:179], v[116:119]
    s_waitcnt vmcnt(12) lgkmcnt(3)
    v_mfma_f32_16x16x32_bf16 v[160:163], v[144:147], a[192:195], v[160:163]
    ds_read_b128 v[132:135], v1 offset:33792
    v_mfma_f32_16x16x32_bf16 v[160:163], v[148:151], a[200:203], v[160:163]
    buffer_load_dwordx4 v[200:203], v1, s[4:7], s89 offen offset:2048 sc1
    v_mfma_f32_16x16x32_bf16 v[168:171], v[148:151], a[204:207], v[168:171]
    ds_read_b128 v[136:139], v1 offset:34816
    v_mfma_f32_16x16x32_bf16 v[168:171], v[144:147], a[196:199], v[168:171]
    s_waitcnt lgkmcnt(3)
    buffer_load_dwordx4 v[192:195], v1, s[4:7], s89 offen offset:0 sc1
    v_mfma_f32_16x16x32_bf16 v[172:175], v[152:155], a[196:199], v[172:175]
    ds_read_b128 v[140:143], v1 offset:35840
    v_mfma_f32_16x16x32_bf16 v[172:175], v[156:159], a[204:207], v[172:175]
    v_mfma_f32_16x16x32_bf16 v[164:167], v[156:159], a[200:203], v[164:167]
    ds_read_b128 v[144:147], v1 offset:36864
    v_mfma_f32_16x16x32_bf16 v[164:167], v[152:155], a[192:195], v[164:167]
    s_waitcnt lgkmcnt(3)
    buffer_load_dwordx4 v[196:199], v1, s[4:7], s89 offen offset:1024 sc1
    v_mfma_f32_16x16x32_bf16 v[112:115], v[128:131], a[192:195], v[112:115]
    ds_read_b128 v[148:151], v1 offset:37888
    v_mfma_f32_16x16x32_bf16 v[112:115], v[132:135], a[200:203], v[112:115]
    v_mfma_f32_16x16x32_bf16 v[120:123], v[132:135], a[204:207], v[120:123]
    ds_read_b128 v[152:155], v1 offset:38912
    v_mfma_f32_16x16x32_bf16 v[120:123], v[128:131], a[196:199], v[120:123]
    s_waitcnt lgkmcnt(3)
    v_mfma_f32_16x16x32_bf16 v[124:127], v[136:139], a[196:199], v[124:127]
    ds_read_b128 v[156:159], v1 offset:39936
    v_mfma_f32_16x16x32_bf16 v[124:127], v[140:143], a[204:207], v[124:127]
    v_mfma_f32_16x16x32_bf16 v[116:119], v[140:143], a[200:203], v[116:119]
    ds_read_b128 v[128:131], v1 offset:40960
    v_mfma_f32_16x16x32_bf16 v[116:119], v[136:139], a[192:195], v[116:119]
    s_waitcnt vmcnt(11) lgkmcnt(3)
    buffer_load_dwordx4 v1, s[4:7], s90 offen offset:0 sc1 lds
    v_mfma_f32_16x16x32_bf16 v[160:163], v[144:147], a[208:211], v[160:163]
    ds_read_b128 v[132:135], v1 offset:41984
    v_mfma_f32_16x16x32_bf16 v[160:163], v[148:151], a[216:219], v[160:163]
    v_mfma_f32_16x16x32_bf16 v[168:171], v[148:151], a[220:223], v[168:171]
    ds_read_b128 v[136:139], v1 offset:43008
    v_mfma_f32_16x16x32_bf16 v[168:171], v[144:147], a[212:215], v[168:171]
    s_waitcnt lgkmcnt(3)
    buffer_load_dwordx4 v1, s[4:7], s90 offen offset:1024 sc1 lds
    v_mfma_f32_16x16x32_bf16 v[172:175], v[152:155], a[212:215], v[172:175]
    ds_read_b128 v[140:143], v1 offset:44032
    v_mfma_f32_16x16x32_bf16 v[172:175], v[156:159], a[220:223], v[172:175]
    v_mfma_f32_16x16x32_bf16 v[164:167], v[156:159], a[216:219], v[164:167]
    ds_read_b128 v[144:147], v1 offset:45056
    v_mfma_f32_16x16x32_bf16 v[164:167], v[152:155], a[208:211], v[164:167]
    s_waitcnt lgkmcnt(3)
    buffer_load_dwordx4 v1, s[4:7], s90 offen offset:2048 sc1 lds
    v_mfma_f32_16x16x32_bf16 v[112:115], v[128:131], a[208:211], v[112:115]
    ds_read_b128 v[148:151], v1 offset:46080
    v_mfma_f32_16x16x32_bf16 v[112:115], v[132:135], a[216:219], v[112:115]
    v_mfma_f32_16x16x32_bf16 v[120:123], v[132:135], a[220:223], v[120:123]
    ds_read_b128 v[152:155], v1 offset:47104
    v_mfma_f32_16x16x32_bf16 v[120:123], v[128:131], a[212:215], v[120:123]
    s_waitcnt lgkmcnt(3)
    buffer_load_dwordx4 v1, s[4:7], s90 offen offset:3072 sc1 lds
    s_add_u32 m0, s96, 81920
    v_mfma_f32_16x16x32_bf16 v[124:127], v[136:139], a[212:215], v[124:127]
    ds_read_b128 v[156:159], v1 offset:48128
    s_add_u32 s90, s95, 180224
    v_mfma_f32_16x16x32_bf16 v[124:127], v[140:143], a[220:223], v[124:127]
    s_waitcnt vmcnt(8)
    s_barrier
    v_mfma_f32_16x16x32_bf16 v[116:119], v[140:143], a[216:219], v[116:119]
    ds_read_b128 v[128:131], v1 offset:49152
    v_mfma_f32_16x16x32_bf16 v[116:119], v[136:139], a[208:211], v[116:119]
    s_waitcnt vmcnt(7) lgkmcnt(3)
    v_mfma_f32_16x16x32_bf16 v[160:163], v[144:147], a[224:227], v[160:163]
    ds_read_b128 v[132:135], v1 offset:50176
    v_mfma_f32_16x16x32_bf16 v[160:163], v[148:151], a[232:235], v[160:163]
    buffer_load_dwordx4 v1, s[4:7], s90 offen offset:0 sc1 lds
    v_mfma_f32_16x16x32_bf16 v[168:171], v[148:151], a[236:239], v[168:171]
    ds_read_b128 v[136:139], v1 offset:51200
    v_mfma_f32_16x16x32_bf16 v[168:171], v[144:147], a[228:231], v[168:171]
    s_waitcnt lgkmcnt(3)
    v_mfma_f32_16x16x32_bf16 v[172:175], v[152:155], a[228:231], v[172:175]
    ds_read_b128 v[140:143], v1 offset:52224
    v_mfma_f32_16x16x32_bf16 v[172:175], v[156:159], a[236:239], v[172:175]
    buffer_load_dwordx4 v1, s[4:7], s90 offen offset:1024 sc1 lds
    v_mfma_f32_16x16x32_bf16 v[164:167], v[156:159], a[232:235], v[164:167]
    ds_read_b128 v[144:147], v1 offset:53248
    v_mfma_f32_16x16x32_bf16 v[164:167], v[152:155], a[224:227], v[164:167]
    s_waitcnt lgkmcnt(3)
    v_mfma_f32_16x16x32_bf16 v[112:115], v[128:131], a[224:227], v[112:115]
    ds_read_b128 v[148:151], v1 offset:54272
    v_mfma_f32_16x16x32_bf16 v[112:115], v[132:135], a[232:235], v[112:115]
    buffer_load_dwordx4 v1, s[4:7], s90 offen offset:2048 sc1 lds
    v_mfma_f32_16x16x32_bf16 v[120:123], v[132:135], a[236:239], v[120:123]
    ds_read_b128 v[152:155], v1 offset:55296
    v_mfma_f32_16x16x32_bf16 v[120:123], v[128:131], a[228:231], v[120:123]
    s_waitcnt lgkmcnt(3)
    v_mfma_f32_16x16x32_bf16 v[124:127], v[136:139], a[228:231], v[124:127]
    ds_read_b128 v[156:159], v1 offset:56320
    v_mfma_f32_16x16x32_bf16 v[124:127], v[140:143], a[236:239], v[124:127]
    buffer_load_dwordx4 v1, s[4:7], s90 offen offset:3072 sc1 lds
    s_add_u32 m0, s96, 98304
    v_mfma_f32_16x16x32_bf16 v[116:119], v[140:143], a[232:235], v[116:119]
    ds_read_b128 v[128:131], v1 offset:57344
    s_add_u32 s90, s95, 196608
    v_mfma_f32_16x16x32_bf16 v[116:119], v[136:139], a[224:227], v[116:119]
    s_waitcnt vmcnt(10)
    v_mfma_f32_16x16x16_bf16 v[240:243], v[200:201], v[104:105], v[240:243]
    v_mfma_f32_16x16x16_bf16 v[248:251], v[200:201], v[106:107], v[248:251]
    s_waitcnt vmcnt(9)
    buffer_load_dwordx4 v1, s[4:7], s90 offen offset:0 sc1 lds
    v_mfma_f32_16x16x16_bf16 v[160:163], v[192:193], v[104:105], v[160:163]
    v_mfma_f32_16x16x16_bf16 v[168:171], v[192:193], v[106:107], v[168:171]
    v_mfma_f32_16x16x16_bf16 v[164:167], v[194:195], v[104:105], v[164:167]
    v_mfma_f32_16x16x16_bf16 v[172:175], v[194:195], v[106:107], v[172:175]
    s_waitcnt vmcnt(9)
    buffer_load_dwordx4 v1, s[4:7], s90 offen offset:1024 sc1 lds
    v_mfma_f32_16x16x16_bf16 v[112:115], v[196:197], v[104:105], v[112:115]
    v_mfma_f32_16x16x16_bf16 v[120:123], v[196:197], v[106:107], v[120:123]
    v_mfma_f32_16x16x16_bf16 v[116:119], v[198:199], v[104:105], v[116:119]
    v_mul_f32 v224, v160, v160
    v_mul_f32 v225, v161, v161
    v_mfma_f32_16x16x16_bf16 v[124:127], v[198:199], v[106:107], v[124:127]
    s_waitcnt lgkmcnt(3)
    buffer_load_dwordx4 v1, s[4:7], s90 offen offset:2048 sc1 lds
    v_fma_f32 v224, v224, v110, v108
    v_mfma_f32_16x16x32_bf16 v[240:243], v[144:147], a[0:3], v[240:243]
    ds_read_b128 v[132:135], v1 offset:58368
    v_mul_f32 v224, v224, v160
    v_mfma_f32_16x16x32_bf16 v[240:243], v[148:151], a[8:11], v[240:243]
    v_exp_f32 v224, v224
    v_mfma_f32_16x16x32_bf16 v[248:251], v[148:151], a[12:15], v[248:251]
    ds_read_b128 v[136:139], v1 offset:59392
    v_fma_f32 v224, v224, v220, v220
    v_mfma_f32_16x16x32_bf16 v[248:251], v[144:147], a[4:7], v[248:251]
    s_waitcnt lgkmcnt(3)
    v_rcp_f32 v224, v224
    v_mfma_f32_16x16x32_bf16 v[248:251], v[152:155], a[20:23], v[248:251]
    ds_read_b128 v[140:143], v1 offset:60416
    v_mul_f32 v224, v224, v160
    v_mfma_f32_16x16x32_bf16 v[248:251], v[156:159], a[28:31], v[248:251]
    buffer_load_dwordx4 v1, s[4:7], s90 offen offset:3072 sc1 lds
    v_fma_f32 v225, v225, v110, v108
    v_mfma_f32_16x16x32_bf16 v[240:243], v[156:159], a[24:27], v[240:243]
    ds_read_b128 v[144:147], v1 offset:61440
    v_mul_f32 v225, v225, v161
    v_mfma_f32_16x16x32_bf16 v[240:243], v[152:155], a[16:19], v[240:243]
    s_waitcnt lgkmcnt(3)
    v_exp_f32 v225, v225
    v_mfma_f32_16x16x32_bf16 v[240:243], v[128:131], a[32:35], v[240:243]
    ds_read_b128 v[148:151], v1 offset:62464
    v_fma_f32 v225, v225, v220, v220
    v_mfma_f32_16x16x32_bf16 v[240:243], v[132:135], a[40:43], v[240:243]
    buffer_load_dwordx4 v[204:207], v1, s[4:7], s89 offen offset:3072 sc1
    v_mul_f32 v226, v162, v162
    v_mfma_f32_16x16x32_bf16 v[248:251], v[132:135], a[44:47], v[248:251]
    ds_read_b128 v[152:155], v1 offset:63488
    v_fma_f32 v226, v226, v110, v108
    v_mfma_f32_16x16x32_bf16 v[248:251], v[128:131], a[36:39], v[248:251]
    s_waitcnt lgkmcnt(3)
    v_rcp_f32 v225, v225
    v_mfma_f32_16x16x32_bf16 v[248:251], v[136:139], a[52:55], v[248:251]
    ds_read_b128 v[156:159], v1 offset:64512
    v_mul_f32 v225, v225, v161
    v_mfma_f32_16x16x32_bf16 v[248:251], v[140:143], a[60:63], v[248:251]
    s_waitcnt vmcnt(9)
    s_barrier
    v_mfma_f32_16x16x32_bf16 v[240:243], v[140:143], a[56:59], v[240:243]
    ds_read_b128 v[128:131], v10 offset:0
    v_cvt_pk_bf16_f32 v48, v224, v225
    v_mfma_f32_16x16x32_bf16 v[240:243], v[136:139], a[48:51], v[240:243]
    s_waitcnt lgkmcnt(3)
    v_mul_f32 v226, v226, v162
    v_mul_f32 v227, v163, v163
    v_mfma_f32_16x16x32_bf16 v[240:243], v[144:147], a[64:67], v[240:243]
    ds_read_b128 v[132:135], v10 offset:1024
    v_fma_f32 v227, v227, v110, v108
    v_mfma_f32_16x16x32_bf16 v[240:243], v[148:151], a[72:75], v[240:243]
    s_add_u32 m0, s96, 114688
    v_exp_f32 v226, v226
    v_mfma_f32_16x16x32_bf16 v[248:251], v[148:151], a[76:79], v[248:251]
    ds_read_b128 v[136:139], v10 offset:2048
    v_fma_f32 v226, v226, v220, v220
    v_mfma_f32_16x16x32_bf16 v[248:251], v[144:147], a[68:71], v[248:251]
    s_waitcnt lgkmcnt(3)
    v_rcp_f32 v226, v226
    v_mfma_f32_16x16x32_bf16 v[248:251], v[152:155], a[84:87], v[248:251]
    ds_read_b128 v[140:143], v10 offset:3072
    v_mul_f32 v226, v226, v162
    v_mfma_f32_16x16x32_bf16 v[248:251], v[156:159], a[92:95], v[248:251]
    s_add_u32 s90, s95, 212992
    v_mul_f32 v227, v227, v163
    v_mul_f32 v232, v168, v168
    v_mfma_f32_16x16x32_bf16 v[240:243], v[156:159], a[88:91], v[240:243]
    ds_read_b128 v[144:147], v10 offset:4096
    v_fma_f32 v232, v232, v111, v109
    v_mfma_f32_16x16x32_bf16 v[240:243], v[152:155], a[80:83], v[240:243]
    s_waitcnt lgkmcnt(3)
    buffer_load_dwordx4 v1, s[4:7], s90 offen offset:0 sc1 lds
    v_mul_f32 v232, v232, v168
    v_mfma_f32_16x16x32_bf16 v[240:243], v[128:131], a[96:99], v[240:243]
    ds_read_b128 v[148:151], v10 offset:5120
    v_mul_f32 v233, v169, v169
    v_mfma_f32_16x16x32_bf16 v[240:243], v[132:135], a[104:107], v[240:243]
    buffer_load_dwordx4 v1, s[4:7], s90 offen offset:1024 sc1 lds
    v_fma_f32 v233, v233, v111, v109
    v_mfma_f32_16x16x32_bf16 v[248:251], v[132:135], a[108:111], v[248:251]
    ds_read_b128 v[152:155], v10 offset:6144
    v_mul_f32 v233, v233, v169
    v_mfma_f32_16x16x32_bf16 v[248:251], v[128:131], a[100:103], v[248:251]
    s_waitcnt lgkmcnt(3)
    v_exp_f32 v227, v227
    v_mfma_f32_16x16x32_bf16 v[248:251], v[136:139], a[116:119], v[248:251]
    ds_read_b128 v[156:159], v10 offset:7168
    v_fma_f32 v227, v227, v220, v220
    v_mfma_f32_16x16x32_bf16 v[248:251], v[140:143], a[124:127], v[248:251]
    buffer_load_dwordx4 v1, s[4:7], s90 offen offset:2048 sc1 lds
    v_mul_f32 v234, v170, v170
    v_mfma_f32_16x16x32_bf16 v[240:243], v[140:143], a[120:123], v[240:243]
    ds_read_b128 v[128:131], v10 offset:8192
    v_fma_f32 v234, v234, v111, v109
    v_mfma_f32_16x16x32_bf16 v[240:243], v[136:139], a[112:115], v[240:243]
    s_waitcnt lgkmcnt(3)
    v_rcp_f32 v227, v227
    v_mfma_f32_16x16x32_bf16 v[240:243], v[144:147], a[128:131], v[240:243]
    ds_read_b128 v[132:135], v10 offset:9216
    v_mul_f32 v227, v227, v163
    v_mfma_f32_16x16x32_bf16 v[240:243], v[148:151], a[136:139], v[240:243]
    buffer_load_dwordx4 v1, s[4:7], s90 offen offset:3072 sc1 lds
    v_cvt_pk_bf16_f32 v49, v226, v227
    v_mfma_f32_16x16x32_bf16 v[248:251], v[148:151], a[140:143], v[248:251]
    ds_read_b128 v[136:139], v10 offset:10240
    v_mul_f32 v234, v234, v170
    v_mfma_f32_16x16x32_bf16 v[248:251], v[144:147], a[132:135], v[248:251]
    s_waitcnt lgkmcnt(3)
    v_exp_f32 v232, v232
    v_mfma_f32_16x16x32_bf16 v[248:251], v[152:155], a[148:151], v[248:251]
    ds_read_b128 v[140:143], v10 offset:11264
    v_fma_f32 v232, v232, v221, v221
    v_mfma_f32_16x16x32_bf16 v[248:251], v[156:159], a[156:159], v[248:251]
    s_add_u32 m0, s96, 131072
    v_rcp_f32 v232, v232
    v_mfma_f32_16x16x32_bf16 v[240:243], v[156:159], a[152:155], v[240:243]
    ds_read_b128 v[144:147], v10 offset:12288
    v_mul_f32 v232, v232, v168
    v_mfma_f32_16x16x32_bf16 v[240:243], v[152:155], a[144:147], v[240:243]
    s_add_u32 s90, s95, 229376
    v_exp_f32 v233, v233
    v_mfma_f32_16x16x16_bf16 v[244:247], v[202:203], v[104:105], v[244:247]
    v_exp_f32 v234, v234
    v_mfma_f32_16x16x16_bf16 v[252:255], v[202:203], v[106:107], v[252:255]
    s_waitcnt lgkmcnt(3)
    buffer_load_dwordx4 v1, s[4:7], s90 offen offset:0 sc1 lds
    v_fma_f32 v233, v233, v221, v221
    v_mfma_f32_16x16x32_bf16 v[240:243], v[128:131], a[160:163], v[240:243]
    ds_read_b128 v[148:151], v10 offset:13312
    v_fma_f32 v234, v234, v221, v221
    v_mfma_f32_16x16x32_bf16 v[240:243], v[132:135], a[168:171], v[240:243]
    buffer_load_dwordx4 v1, s[4:7], s90 offen offset:1024 sc1 lds
    v_mul_f32 v235, v171, v171
    v_mfma_f32_16x16x32_bf16 v[248:251], v[132:135], a[172:175], v[248:251]
    ds_read_b128 v[152:155], v10 offset:14336
    v_fma_f32 v235, v235, v111, v109
    v_mfma_f32_16x16x32_bf16 v[248:251], v[128:131], a[164:167], v[248:251]
    s_waitcnt lgkmcnt(3)
    v_rcp_f32 v233, v233
    v_mfma_f32_16x16x32_bf16 v[248:251], v[136:139], a[180:183], v[248:251]
    ds_read_b128 v[156:159], v10 offset:15360
    v_mul_f32 v233, v233, v169
    v_mfma_f32_16x16x32_bf16 v[248:251], v[140:143], a[188:191], v[248:251]
    s_waitcnt vmcnt(11)
    s_barrier
    v_mfma_f32_16x16x32_bf16 v[240:243], v[140:143], a[184:187], v[240:243]
    ds_read_b128 v[128:131], v10 offset:16384
    v_cvt_pk_bf16_f32 v52, v232, v233
    v_mfma_f32_16x16x32_bf16 v[240:243], v[136:139], a[176:179], v[240:243]
    s_waitcnt lgkmcnt(3)
    buffer_load_dwordx4 v1, s[4:7], s90 offen offset:2048 sc1 lds
    v_mul_f32 v235, v235, v171
    v_mfma_f32_16x16x32_bf16 v[240:243], v[144:147], a[192:195], v[240:243]
    ds_read_b128 v[132:135], v10 offset:17408
    v_mul_f32 v228, v164, v164
    v_mfma_f32_16x16x32_bf16 v[240:243], v[148:151], a[200:203], v[240:243]
    v_rcp_f32 v234, v234
    v_mfma_f32_16x16x32_bf16 v[248:251], v[148:151], a[204:207], v[248:251]
    ds_read_b128 v[136:139], v10 offset:18432
    v_mul_f32 v234, v234, v170
    v_mfma_f32_16x16x32_bf16 v[248:251], v[144:147], a[196:199], v[248:251]
    s_waitcnt lgkmcnt(3)
    v_exp_f32 v235, v235
    v_mfma_f32_16x16x32_bf16 v[248:251], v[152:155], a[212:215], v[248:251]
    ds_read_b128 v[140:143], v10 offset:19456
    v_fma_f32 v235, v235, v221, v221
    v_mfma_f32_16x16x32_bf16 v[248:251], v[156:159], a[220:223], v[248:251]
    buffer_load_dwordx4 v1, s[4:7], s90 offen offset:3072 sc1 lds
    v_fma_f32 v228, v228, v110, v108
    v_mfma_f32_16x16x32_bf16 v[240:243], v[156:159], a[216:219], v[240:243]
    ds_read_b128 v[144:147], v10 offset:20480
    v_mul_f32 v228, v228, v164
    v_mfma_f32_16x16x32_bf16 v[240:243], v[152:155], a[208:211], v[240:243]
    s_waitcnt lgkmcnt(3)
    v_rcp_f32 v235, v235
    v_mfma_f32_16x16x32_bf16 v[240:243], v[128:131], a[224:227], v[240:243]
    ds_read_b128 v[148:151], v10 offset:21504
    v_mul_f32 v235, v235, v171
    v_mfma_f32_16x16x32_bf16 v[240:243], v[132:135], a[232:235], v[240:243]
    s_add_u32 m0, s96, 147456
    v_exp_f32 v228, v228
    v_mfma_f32_16x16x32_bf16 v[248:251], v[132:135], a[236:239], v[248:251]
    ds_read_b128 v[152:155], v10 offset:22528
    v_cvt_pk_bf16_f32 v53, v234, v235
    v_mfma_f32_16x16x32_bf16 v[248:251], v[128:131], a[228:231], v[248:251]
    s_waitcnt lgkmcnt(3)
    v_fma_f32 v228, v228, v220, v220
    v_mul_f32 v229, v165, v165
    v_mfma_f32_16x16x32_bf16 v[252:255], v[136:139], a[4:7], v[252:255]
    ds_read_b128 v[156:159], v10 offset:23552
    v_fma_f32 v229, v229, v110, v108
    v_mfma_f32_16x16x32_bf16 v[252:255], v[140:143], a[12:15], v[252:255]
    s_add_u32 s90, s95, 245760
    v_rcp_f32 v228, v228
    v_mfma_f32_16x16x32_bf16 v[244:247], v[140:143], a[8:11], v[244:247]
    ds_read_b128 v[128:131], v10 offset:24576
    v_mul_f32 v228, v228, v164
    v_mfma_f32_16x16x32_bf16 v[244:247], v[136:139], a[0:3], v[244:247]
    s_waitcnt lgkmcnt(3)
    buffer_load_dwordx4 v1, s[4:7], s90 offen offset:0 sc1 lds
    v_mul_f32 v229, v229, v165
    v_mfma_f32_16x16x32_bf16 v[244:247], v[144:147], a[16:19], v[244:247]
    ds_read_b128 v[132:135], v10 offset:25600
    v_mul_f32 v230, v166, v166
    v_mfma_f32_16x16x32_bf16 v[244:247], v[148:151], a[24:27], v[244:247]
    buffer_load_dwordx4 v1, s[4:7], s90 offen offset:1024 sc1 lds
    v_fma_f32 v230, v230, v110, v108
    v_mfma_f32_16x16x32_bf16 v[252:255], v[148:151], a[28:31], v[252:255]
    ds_read_b128 v[136:139], v10 offset:26624
    v_mul_f32 v230, v230, v166
    v_mfma_f32_16x16x32_bf16 v[252:255], v[144:147], a[20:23], v[252:255]
    s_waitcnt lgkmcnt(3)
    v_exp_f32 v229, v229
    v_mfma_f32_16x16x32_bf16 v[252:255], v[152:155], a[36:39], v[252:255]
    ds_read_b128 v[140:143], v10 offset:27648
    v_fma_f32 v229, v229, v220, v220
    v_mfma_f32_16x16x32_bf16 v[252:255], v[156:159], a[44:47], v[252:255]
    buffer_load_dwordx4 v1, s[4:7], s90 offen offset:2048 sc1 lds
    v_mul_f32 v231, v167, v167
    v_mfma_f32_16x16x32_bf16 v[244:247], v[156:159], a[40:43], v[244:247]
    ds_read_b128 v[144:147], v10 offset:28672
    v_fma_f32 v231, v231, v110, v108
    v_mfma_f32_16x16x32_bf16 v[244:247], v[152:155], a[32:35], v[244:247]
L_hop8:
    s_cbranch_execz L_hop12
    s_waitcnt lgkmcnt(3)
    v_rcp_f32 v229, v229
    v_mfma_f32_16x16x32_bf16 v[244:247], v[128:131], a[48:51], v[244:247]
    ds_read_b128 v[148:151], v10 offset:29696
    v_mul_f32 v229, v229, v165
    v_mfma_f32_16x16x32_bf16 v[244:247], v[132:135], a[56:59], v[244:247]
    buffer_load_dwordx4 v1, s[4:7], s90 offen offset:3072 sc1 lds
    v_cvt_pk_bf16_f32 v50, v228, v229
    v_mfma_f32_16x16x32_bf16 v[252:255], v[132:135], a[60:63], v[252:255]
    ds_read_b128 v[152:155], v10 offset:30720
    v_mul_f32 v231, v231, v167
    v_mfma_f32_16x16x32_bf16 v[252:255], v[128:131], a[52:55], v[252:255]
    s_waitcnt lgkmcnt(3)
    v_exp_f32 v230, v230
    v_mfma_f32_16x16x32_bf16 v[252:255], v[136:139], a[68:71], v[252:255]
    ds_read_b128 v[156:159], v10 offset:31744
    v_fma_f32 v230, v230, v220, v220
    v_mfma_f32_16x16x32_bf16 v[252:255], v[140:143], a[76:79], v[252:255]
    s_waitcnt vmcnt(8)
    s_barrier
    v_mfma_f32_16x16x32_bf16 v[244:247], v[140:143], a[72:75], v[244:247]
    ds_read_b128 v[128:131], v10 offset:32768
    v_mul_f32 v236, v172, v172
    v_mfma_f32_16x16x32_bf16 v[244:247], v[136:139], a[64:67], v[244:247]
    s_waitcnt lgkmcnt(3)
    v_rcp_f32 v230, v230
    v_mfma_f32_16x16x32_bf16 v[244:247], v[144:147], a[80:83], v[244:247]
    ds_read_b128 v[132:135], v10 offset:33792
    v_mul_f32 v230, v230, v166
    v_mfma_f32_16x16x32_bf16 v[244:247], v[148:151], a[88:91], v[244:247]
    s_add_u32 m0, s96, 0
    v_exp_f32 v231, v231
    v_mfma_f32_16x16x32_bf16 v[252:255], v[148:151], a[92:95], v[252:255]
    ds_read_b128 v[136:139], v10 offset:34816
    v_fma_f32 v231, v231, v220, v220
    v_mfma_f32_16x16x32_bf16 v[252:255], v[144:147], a[84:87], v[252:255]
    s_waitcnt lgkmcnt(3)
    v_rcp_f32 v231, v231
    v_mfma_f32_16x16x32_bf16 v[252:255], v[152:155], a[100:103], v[252:255]
    ds_read_b128 v[140:143], v10 offset:35840
    v_mul_f32 v231, v231, v167
    v_mfma_f32_16x16x32_bf16 v[252:255], v[156:159], a[108:111], v[252:255]
    s_add_u32 s90, s95, 262144
    v_cvt_pk_bf16_f32 v51, v230, v231
    v_fma_f32 v236, v236, v111, v109
    v_mfma_f32_16x16x32_bf16 v[244:247], v[156:159], a[104:107], v[244:247]
    ds_read_b128 v[144:147], v10 offset:36864
    v_mul_f32 v236, v236, v172
    v_mfma_f32_16x16x32_bf16 v[244:247], v[152:155], a[96:99], v[244:247]
    s_waitcnt lgkmcnt(3)
    buffer_store_dwordx4 v[48:51], v1, s[4:7], s93 offen offset:0 sc1
    v_mul_f32 v237, v173, v173
    v_mfma_f32_16x16x32_bf16 v[244:247], v[128:131], a[112:115], v[244:247]
    ds_read_b128 v[148:151], v10 offset:37888
    v_fma_f32 v237, v237, v111, v109
    v_mfma_f32_16x16x32_bf16 v[244:247], v[132:135], a[120:123], v[244:247]
    buffer_load_dwordx4 v1, s[4:7], s90 offen offset:0 sc1 lds
    v_mul_f32 v237, v237, v173
    v_mfma_f32_16x16x32_bf16 v[252:255], v[132:135], a[124:127], v[252:255]
    ds_read_b128 v[152:155], v10 offset:38912
    v_mul_f32 v238, v174, v174
    v_mfma_f32_16x16x32_bf16 v[252:255], v[128:131], a[116:119], v[252:255]
    s_waitcnt lgkmcnt(3)
    v_exp_f32 v236, v236
    v_mfma_f32_16x16x32_bf16 v[252:255], v[136:139], a[132:135], v[252:255]
    ds_read_b128 v[156:159], v10 offset:39936
    v_fma_f32 v236, v236, v221, v221
    v_mfma_f32_16x16x32_bf16 v[252:255], v[140:143], a[140:143], v[252:255]
    buffer_load_dwordx4 v1, s[4:7], s90 offen offset:1024 sc1 lds
    v_fma_f32 v238, v238, v111, v109
    v_mfma_f32_16x16x32_bf16 v[244:247], v[140:143], a[136:139], v[244:247]
    ds_read_b128 v[128:131], v10 offset:40960
    v_mul_f32 v238, v238, v174
    v_mfma_f32_16x16x32_bf16 v[244:247], v[136:139], a[128:131], v[244:247]
    s_waitcnt lgkmcnt(3)
    v_rcp_f32 v236, v236
    v_mfma_f32_16x16x32_bf16 v[244:247], v[144:147], a[144:147], v[244:247]
    ds_read_b128 v[132:135], v10 offset:41984
    v_mul_f32 v236, v236, v172
    v_mfma_f32_16x16x32_bf16 v[244:247], v[148:151], a[152:155], v[244:247]
    buffer_load_dwordx4 v1, s[4:7], s90 offen offset:2048 sc1 lds
    v_mul_f32 v239, v175, v175
    v_mfma_f32_16x16x32_bf16 v[252:255], v[148:151], a[156:159], v[252:255]
    ds_read_b128 v[136:139], v10 offset:43008
    v_fma_f32 v239, v239, v111, v109
    v_mfma_f32_16x16x32_bf16 v[252:255], v[144:147], a[148:151], v[252:255]
    v_exp_f32 v237, v237
    v_mfma_f32_16x16x16_bf16 v[176:179], v[204:205], v[104:105], v[176:179]
    v_exp_f32 v238, v238
    v_mfma_f32_16x16x16_bf16 v[184:187], v[204:205], v[106:107], v[184:187]
    s_waitcnt lgkmcnt(3)
    v_fma_f32 v237, v237, v221, v221
    v_fma_f32 v238, v238, v221, v221
    v_mfma_f32_16x16x32_bf16 v[252:255], v[152:155], a[164:167], v[252:255]
    ds_read_b128 v[140:143], v10 offset:44032
    v_mul_f32 v239, v239, v175
    v_mfma_f32_16x16x32_bf16 v[252:255], v[156:159], a[172:175], v[252:255]
    buffer_load_dwordx4 v1, s[4:7], s90 offen offset:3072 sc1 lds
    v_mul_f32 v224, v112, v112
    v_mfma_f32_16x16x32_bf16 v[244:247], v[156:159], a[168:171], v[244:247]
    ds_read_b128 v[144:147], v10 offset:45056
    v_fma_f32 v224, v224, v110, v108
    v_mfma_f32_16x16x32_bf16 v[244:247], v[152:155], a[160:163], v[244:247]
    s_waitcnt lgkmcnt(3)
    v_rcp_f32 v237, v237
    v_mfma_f32_16x16x32_bf16 v[244:247], v[128:131], a[176:179], v[244:247]
    ds_read_b128 v[148:151], v10 offset:46080
    v_mul_f32 v237, v237, v173
    v_mfma_f32_16x16x32_bf16 v[244:247], v[132:135], a[184:187], v[244:247]
    buffer_load_dwordx4 v[208:211], v1, s[4:7], s84 offen offset:0 sc1
    v_cvt_pk_bf16_f32 v54, v236, v237
    v_mfma_f32_16x16x32_bf16 v[252:255], v[132:135], a[188:191], v[252:255]
    ds_read_b128 v[152:155], v10 offset:47104
    v_mul_f32 v224, v224, v112
    v_mfma_f32_16x16x32_bf16 v[252:255], v[128:131], a[180:183], v[252:255]
    s_waitcnt lgkmcnt(3)
    v_rcp_f32 v238, v238
    v_mfma_f32_16x16x32_bf16 v[252:255], v[136:139], a[196:199], v[252:255]
    ds_read_b128 v[156:159], v10 offset:48128
    v_mul_f32 v238, v238, v174
    v_mfma_f32_16x16x32_bf16 v[252:255], v[140:143], a[204:207], v[252:255]
    s_add_u32 m0, s96, 16384
    v_exp_f32 v239, v239
    v_mfma_f32_16x16x32_bf16 v[244:247], v[140:143], a[200:203], v[244:247]
    ds_read_b128 v[128:131], v10 offset:49152
    v_fma_f32 v239, v239, v221, v221
    v_mfma_f32_16x16x32_bf16 v[244:247], v[136:139], a[192:195], v[244:247]
    s_waitcnt lgkmcnt(3)
    v_rcp_f32 v239, v239
    v_mfma_f32_16x16x32_bf16 v[244:247], v[144:147], a[208:211], v[244:247]
    ds_read_b128 v[132:135], v10 offset:50176
    v_mul_f32 v239, v239, v175
    v_mfma_f32_16x16x32_bf16 v[244:247], v[148:151], a[216:219], v[244:247]
    s_add_u32 s90, s95, 278528
    v_exp_f32 v224, v224
    v_mfma_f32_16x16x32_bf16 v[252:255], v[148:151], a[220:223], v[252:255]
    ds_read_b128 v[136:139], v10 offset:51200
    v_cvt_pk_bf16_f32 v55, v238, v239
    v_mfma_f32_16x16x32_bf16 v[252:255], v[144:147], a[212:215], v[252:255]
    s_waitcnt lgkmcnt(3)
    buffer_store_dwordx4 v[52:55], v1, s[4:7], s93 offen offset:1024 sc1
    v_fma_f32 v224, v224, v220, v220
    v_mfma_f32_16x16x32_bf16 v[252:255], v[152:155], a[228:231], v[252:255]
    ds_read_b128 v[140:143], v10 offset:52224
    v_mul_f32 v225, v113, v113
    v_mfma_f32_16x16x32_bf16 v[252:255], v[156:159], a[236:239], v[252:255]
    buffer_load_dwordx4 v1, s[4:7], s90 offen offset:0 sc1 lds
    v_fma_f32 v225, v225, v110, v108
    v_mfma_f32_16x16x32_bf16 v[244:247], v[156:159], a[232:235], v[244:247]
    ds_read_b128 v[144:147], v10 offset:53248
    v_mul_f32 v225, v225, v113
    v_mfma_f32_16x16x32_bf16 v[244:247], v[152:155], a[224:227], v[244:247]
    s_waitcnt lgkmcnt(3)
    v_rcp_f32 v224, v224
    v_mfma_f32_16x16x32_bf16 v[176:179], v[128:131], a[0:3], v[176:179]
    ds_read_b128 v[148:151], v10 offset:54272
    v_mul_f32 v224, v224, v112
    v_mfma_f32_16x16x32_bf16 v[176:179], v[132:135], a[8:11], v[176:179]
    buffer_load_dwordx4 v1, s[4:7], s90 offen offset:1024 sc1 lds
    v_mul_f32 v226, v114, v114
    v_mfma_f32_16x16x32_bf16 v[184:187], v[132:135], a[12:15], v[184:187]
    ds_read_b128 v[152:155], v10 offset:55296
    v_fma_f32 v226, v226, v110, v108
    v_mfma_f32_16x16x32_bf16 v[184:187], v[128:131], a[4:7], v[184:187]
    s_waitcnt lgkmcnt(3)
    v_exp_f32 v225, v225
    v_mfma_f32_16x16x32_bf16 v[184:187], v[136:139], a[20:23], v[184:187]
    ds_read_b128 v[156:159], v10 offset:56320
    v_fma_f32 v225, v225, v220, v220
    v_mfma_f32_16x16x32_bf16 v[184:187], v[140:143], a[28:31], v[184:187]
    buffer_load_dwordx4 v1, s[4:7], s90 offen offset:2048 sc1 lds
    v_mul_f32 v226, v226, v114
    v_mfma_f32_16x16x32_bf16 v[176:179], v[140:143], a[24:27], v[176:179]
    ds_read_b128 v[128:131], v10 offset:57344
    v_mul_f32 v227, v115, v115
    v_mfma_f32_16x16x32_bf16 v[176:179], v[136:139], a[16:19], v[176:179]
    s_waitcnt lgkmcnt(3)
    v_rcp_f32 v225, v225
    v_mfma_f32_16x16x32_bf16 v[176:179], v[144:147], a[32:35], v[176:179]
    ds_read_b128 v[132:135], v10 offset:58368
    v_mul_f32 v225, v225, v113
    v_mfma_f32_16x16x32_bf16 v[176:179], v[148:151], a[40:43], v[176:179]
    v_exp_f32 v226, v226
    v_mfma_f32_16x16x32_bf16 v[184:187], v[148:151], a[44:47], v[184:187]
    ds_read_b128 v[136:139], v10 offset:59392
    v_cvt_pk_bf16_f32 v56, v224, v225
    v_mfma_f32_16x16x32_bf16 v[184:187], v[144:147], a[36:39], v[184:187]
    s_waitcnt lgkmcnt(3)
    buffer_load_dwordx4 v1, s[4:7], s90 offen offset:3072 sc1 lds
    v_fma_f32 v226, v226, v220, v220
    v_mfma_f32_16x16x32_bf16 v[184:187], v[152:155], a[52:55], v[184:187]
    ds_read_b128 v[140:143], v10 offset:60416
    v_fma_f32 v227, v227, v110, v108
    v_mfma_f32_16x16x32_bf16 v[184:187], v[156:159], a[60:63], v[184:187]
    s_add_u32 m0, s96, 32768
    v_rcp_f32 v226, v226
    v_mfma_f32_16x16x32_bf16 v[176:179], v[156:159], a[56:59], v[176:179]
    ds_read_b128 v[144:147], v10 offset:61440
    v_mul_f32 v226, v226, v114
    v_mfma_f32_16x16x32_bf16 v[176:179], v[152:155], a[48:51], v[176:179]
    s_waitcnt lgkmcnt(3)
    v_mul_f32 v227, v227, v115
    v_mul_f32 v232, v120, v120
    v_mfma_f32_16x16x32_bf16 v[176:179], v[128:131], a[64:67], v[176:179]
    ds_read_b128 v[148:151], v10 offset:62464
    v_fma_f32 v232, v232, v111, v109
    v_mfma_f32_16x16x32_bf16 v[176:179], v[132:135], a[72:75], v[176:179]
    s_add_u32 s90, s95, 294912
    v_exp_f32 v227, v227
    v_mfma_f32_16x16x32_bf16 v[184:187], v[132:135], a[76:79], v[184:187]
    ds_read_b128 v[152:155], v10 offset:63488
    v_fma_f32 v227, v227, v220, v220
    v_mfma_f32_16x16x32_bf16 v[184:187], v[128:131], a[68:71], v[184:187]
    s_waitcnt lgkmcnt(3)
    buffer_load_dwordx4 v1, s[4:7], s90 offen offset:0 sc1 lds
    v_mul_f32 v232, v232, v120
    v_mfma_f32_16x16x32_bf16 v[184:187], v[136:139], a[84:87], v[184:187]
    ds_read_b128 v[156:159], v10 offset:64512
    v_mul_f32 v233, v121, v121
    v_mfma_f32_16x16x32_bf16 v[184:187], v[140:143], a[92:95], v[184:187]
    s_waitcnt vmcnt(12)
    s_barrier
    v_mfma_f32_16x16x32_bf16 v[176:179], v[140:143], a[88:91], v[176:179]
    ds_read_b128 v[128:131], v11 offset:0
    v_fma_f32 v233, v233, v111, v109
    v_mfma_f32_16x16x32_bf16 v[176:179], v[136:139], a[80:83], v[176:179]
    s_waitcnt lgkmcnt(3)
    buffer_load_dwordx4 v1, s[4:7], s90 offen offset:1024 sc1 lds
    v_mul_f32 v233, v233, v121
    v_mfma_f32_16x16x32_bf16 v[176:179], v[144:147], a[96:99], v[176:179]
    ds_read_b128 v[132:135], v11 offset:1024
    v_mul_f32 v234, v122, v122
    v_mfma_f32_16x16x32_bf16 v[176:179], v[148:151], a[104:107], v[176:179]
    v_rcp_f32 v227, v227
    v_mfma_f32_16x16x32_bf16 v[184:187], v[148:151], a[108:111], v[184:187]
    ds_read_b128 v[136:139], v11 offset:2048
    v_mul_f32 v227, v227, v115
    v_mfma_f32_16x16x32_bf16 v[184:187], v[144:147], a[100:103], v[184:187]
    s_waitcnt lgkmcnt(3)
    buffer_load_dwordx4 v1, s[4:7], s90 offen offset:2048 sc1 lds
    v_cvt_pk_bf16_f32 v57, v226, v227
    v_mfma_f32_16x16x32_bf16 v[184:187], v[152:155], a[116:119], v[184:187]
    ds_read_b128 v[140:143], v11 offset:3072
    v_fma_f32 v234, v234, v111, v109
    v_mfma_f32_16x16x32_bf16 v[184:187], v[156:159], a[124:127], v[184:187]
    v_exp_f32 v232, v232
    v_mfma_f32_16x16x32_bf16 v[176:179], v[156:159], a[120:123], v[176:179]
    ds_read_b128 v[144:147], v11 offset:4096
    v_fma_f32 v232, v232, v221, v221
    v_mfma_f32_16x16x32_bf16 v[176:179], v[152:155], a[112:115], v[176:179]
    s_waitcnt lgkmcnt(3)
    buffer_load_dwordx4 v1, s[4:7], s90 offen offset:3072 sc1 lds
    v_mul_f32 v234, v234, v122
    v_mfma_f32_16x16x32_bf16 v[176:179], v[128:131], a[128:131], v[176:179]
    ds_read_b128 v[148:151], v11 offset:5120
    v_mul_f32 v235, v123, v123
    v_mfma_f32_16x16x32_bf16 v[176:179], v[132:135], a[136:139], v[176:179]
    s_add_u32 m0, s96, 49152
    v_rcp_f32 v232, v232
    v_mfma_f32_16x16x32_bf16 v[184:187], v[132:135], a[140:143], v[184:187]
    ds_read_b128 v[152:155], v11 offset:6144
    v_mul_f32 v232, v232, v120
    v_mfma_f32_16x16x32_bf16 v[184:187], v[128:131], a[132:135], v[184:187]
    s_waitcnt lgkmcnt(3)
    v_exp_f32 v233, v233
    v_mfma_f32_16x16x32_bf16 v[184:187], v[136:139], a[148:151], v[184:187]
    ds_read_b128 v[156:159], v11 offset:7168
    v_fma_f32 v233, v233, v221, v221
    v_mfma_f32_16x16x32_bf16 v[184:187], v[140:143], a[156:159], v[184:187]
    s_add_u32 s90, s95, 311296
    v_rcp_f32 v233, v233
    v_mfma_f32_16x16x32_bf16 v[176:179], v[140:143], a[152:155], v[176:179]
    ds_read_b128 v[128:131], v11 offset:8192
    v_mul_f32 v233, v233, v121
    v_mfma_f32_16x16x32_bf16 v[176:179], v[136:139], a[144:147], v[176:179]
    buffer_load_dwordx4 v1, s[4:7], s90 offen offset:0 sc1 lds
    v_cvt_pk_bf16_f32 v60, v232, v233
    v_mfma_f32_16x16x16_bf16 v[180:183], v[206:207], v[104:105], v[180:183]
    v_exp_f32 v234, v234
    v_mfma_f32_16x16x16_bf16 v[188:191], v[206:207], v[106:107], v[188:191]
    s_waitcnt lgkmcnt(3)
    buffer_load_dwordx4 v1, s[4:7], s90 offen offset:1024 sc1 lds
    v_fma_f32 v234, v234, v221, v221
    v_mfma_f32_16x16x32_bf16 v[176:179], v[144:147], a[160:163], v[176:179]
    ds_read_b128 v[132:135], v11 offset:9216
    v_fma_f32 v235, v235, v111, v109
    v_mfma_f32_16x16x32_bf16 v[176:179], v[148:151], a[168:171], v[176:179]
    v_rcp_f32 v234, v234
    v_mfma_f32_16x16x32_bf16 v[184:187], v[148:151], a[172:175], v[184:187]
    ds_read_b128 v[136:139], v11 offset:10240
    v_mul_f32 v234, v234, v122
    v_mfma_f32_16x16x32_bf16 v[184:187], v[144:147], a[164:167], v[184:187]
    s_waitcnt lgkmcnt(3)
    buffer_load_dwordx4 v1, s[4:7], s90 offen offset:2048 sc1 lds
    v_mul_f32 v235, v235, v123
    v_mfma_f32_16x16x32_bf16 v[184:187], v[152:155], a[180:183], v[184:187]
    ds_read_b128 v[140:143], v11 offset:11264
    v_mul_f32 v228, v116, v116
    v_mfma_f32_16x16x32_bf16 v[184:187], v[156:159], a[188:191], v[184:187]
    v_exp_f32 v235, v235
    v_mfma_f32_16x16x32_bf16 v[176:179], v[156:159], a[184:187], v[176:179]
    ds_read_b128 v[144:147], v11 offset:12288
    v_fma_f32 v235, v235, v221, v221
    v_mfma_f32_16x16x32_bf16 v[176:179], v[152:155], a[176:179], v[176:179]
    s_waitcnt lgkmcnt(3)
    v_rcp_f32 v235, v235
    v_mfma_f32_16x16x32_bf16 v[176:179], v[128:131], a[192:195], v[176:179]
    ds_read_b128 v[148:151], v11 offset:13312
    v_mul_f32 v235, v235, v123
    v_mfma_f32_16x16x32_bf16 v[176:179], v[132:135], a[200:203], v[176:179]
    buffer_load_dwordx4 v1, s[4:7], s90 offen offset:3072 sc1 lds
    v_cvt_pk_bf16_f32 v61, v234, v235
    v_mfma_f32_16x16x32_bf16 v[184:187], v[132:135], a[204:207], v[184:187]
    ds_read_b128 v[152:155], v11 offset:14336
    v_fma_f32 v228, v228, v110, v108
    v_mfma_f32_16x16x32_bf16 v[184:187], v[128:131], a[196:199], v[184:187]
    s_waitcnt lgkmcnt(3)
    v_mul_f32 v228, v228, v116
    v_mul_f32 v229, v117, v117
    v_mfma_f32_16x16x32_bf16 v[184:187], v[136:139], a[212:215], v[184:187]
    ds_read_b128 v[156:159], v11 offset:15360
    v_fma_f32 v229, v229, v110, v108
    v_mfma_f32_16x16x32_bf16 v[184:187], v[140:143], a[220:223], v[184:187]
    s_add_u32 m0, s96, 65536
    v_exp_f32 v228, v228
    v_mfma_f32_16x16x32_bf16 v[176:179], v[140:143], a[216:219], v[176:179]
    ds_read_b128 v[128:131], v11 offset:16384
    v_fma_f32 v228, v228, v220, v220
    v_mfma_f32_16x16x32_bf16 v[176:179], v[136:139], a[208:211], v[176:179]
    s_waitcnt lgkmcnt(3)
    v_rcp_f32 v228, v228
    v_mfma_f32_16x16x32_bf16 v[176:179], v[144:147], a[224:227], v[176:179]
    ds_read_b128 v[132:135], v11 offset:17408
    v_mul_f32 v228, v228, v116
    v_mfma_f32_16x16x32_bf16 v[176:179], v[148:151], a[232:235], v[176:179]
    s_add_u32 s90, s95, 327680
    v_mul_f32 v229, v229, v117
    v_mul_f32 v230, v118, v118
    v_mfma_f32_16x16x32_bf16 v[184:187], v[148:151], a[236:239], v[184:187]
    ds_read_b128 v[136:139], v11 offset:18432
    v_fma_f32 v230, v230, v110, v108
    v_mfma_f32_16x16x32_bf16 v[184:187], v[144:147], a[228:231], v[184:187]
    s_waitcnt lgkmcnt(3)
    buffer_load_dwordx4 v1, s[4:7], s90 offen offset:0 sc1 lds
    v_mul_f32 v230, v230, v118
    v_mfma_f32_16x16x32_bf16 v[188:191], v[152:155], a[4:7], v[188:191]
    ds_read_b128 v[140:143], v11 offset:19456
    v_mul_f32 v231, v119, v119
    v_mfma_f32_16x16x32_bf16 v[188:191], v[156:159], a[12:15], v[188:191]
    buffer_load_dwordx4 v1, s[4:7], s90 offen offset:1024 sc1 lds
    v_fma_f32 v231, v231, v110, v108
    v_mfma_f32_16x16x32_bf16 v[180:183], v[156:159], a[8:11], v[180:183]
    ds_read_b128 v[144:147], v11 offset:20480
    v_mul_f32 v231, v231, v119
    v_mfma_f32_16x16x32_bf16 v[180:183], v[152:155], a[0:3], v[180:183]
    s_waitcnt lgkmcnt(3)
    v_exp_f32 v229, v229
    v_mfma_f32_16x16x32_bf16 v[180:183], v[128:131], a[16:19], v[180:183]
    ds_read_b128 v[148:151], v11 offset:21504
    v_fma_f32 v229, v229, v220, v220
    v_mfma_f32_16x16x32_bf16 v[180:183], v[132:135], a[24:27], v[180:183]
    buffer_load_dwordx4 v1, s[4:7], s90 offen offset:2048 sc1 lds
    v_mul_f32 v236, v124, v124
    v_mfma_f32_16x16x32_bf16 v[188:191], v[132:135], a[28:31], v[188:191]
    ds_read_b128 v[152:155], v11 offset:22528
    v_fma_f32 v236, v236, v111, v109
    v_mfma_f32_16x16x32_bf16 v[188:191], v[128:131], a[20:23], v[188:191]
    s_waitcnt lgkmcnt(3)
    v_rcp_f32 v229, v229
    v_mfma_f32_16x16x32_bf16 v[188:191], v[136:139], a[36:39], v[188:191]
    ds_read_b128 v[156:159], v11 offset:23552
    v_mul_f32 v229, v229, v117
    v_mfma_f32_16x16x32_bf16 v[188:191], v[140:143], a[44:47], v[188:191]
    buffer_load_dwordx4 v1, s[4:7], s90 offen offset:3072 sc1 lds
    v_cvt_pk_bf16_f32 v58, v228, v229
    v_mfma_f32_16x16x32_bf16 v[180:183], v[140:143], a[40:43], v[180:183]
    ds_read_b128 v[128:131], v11 offset:24576
    v_mul_f32 v236, v236, v124
    v_mfma_f32_16x16x32_bf16 v[180:183], v[136:139], a[32:35], v[180:183]
    s_waitcnt lgkmcnt(3)
    v_exp_f32 v230, v230
    v_mfma_f32_16x16x32_bf16 v[180:183], v[144:147], a[48:51], v[180:183]
    ds_read_b128 v[132:135], v11 offset:25600
    v_fma_f32 v230, v230, v220, v220
    v_mfma_f32_16x16x32_bf16 v[180:183], v[148:151], a[56:59], v[180:183]
    s_add_u32 m0, s96, 81920
    v_rcp_f32 v230, v230
    v_mfma_f32_16x16x32_bf16 v[188:191], v[148:151], a[60:63], v[188:191]
    ds_read_b128 v[136:139], v11 offset:26624
    v_mul_f32 v230, v230, v118
    v_mfma_f32_16x16x32_bf16 v[188:191], v[144:147], a[52:55], v[188:191]
    s_waitcnt lgkmcnt(3)
    v_exp_f32 v231, v231
    v_mfma_f32_16x16x32_bf16 v[188:191], v[152:155], a[68:71], v[188:191]
    ds_read_b128 v[140:143], v11 offset:27648
    v_fma_f32 v231, v231, v220, v220
    v_mfma_f32_16x16x32_bf16 v[188:191], v[156:159], a[76:79], v[188:191]
    s_add_u32 s90, s95, 344064
    v_rcp_f32 v231, v231
    v_mfma_f32_16x16x32_bf16 v[180:183], v[156:159], a[72:75], v[180:183]
    ds_read_b128 v[144:147], v11 offset:28672
    v_mul_f32 v231, v231, v119
    v_mfma_f32_16x16x32_bf16 v[180:183], v[152:155], a[64:67], v[180:183]
    s_waitcnt lgkmcnt(3)
    buffer_load_dwordx4 v1, s[4:7], s90 offen offset:0 sc1 lds
    v_cvt_pk_bf16_f32 v59, v230, v231
    v_mfma_f32_16x16x32_bf16 v[180:183], v[128:131], a[80:83], v[180:183]
    ds_read_b128 v[148:151], v11 offset:29696
    v_mul_f32 v237, v125, v125
    v_mfma_f32_16x16x32_bf16 v[180:183], v[132:135], a[88:91], v[180:183]
    buffer_store_dwordx4 v[56:59], v1, s[4:7], s93 offen offset:2048 sc1
    v_fma_f32 v237, v237, v111, v109
    v_mfma_f32_16x16x32_bf16 v[188:191], v[132:135], a[92:95], v[188:191]
    ds_read_b128 v[152:155], v11 offset:30720
    v_mul_f32 v237, v237, v125
    v_mfma_f32_16x16x32_bf16 v[188:191], v[128:131], a[84:87], v[188:191]
    s_waitcnt lgkmcnt(3)
    v_exp_f32 v236, v236
    v_mfma_f32_16x16x32_bf16 v[188:191], v[136:139], a[100:103], v[188:191]
    ds_read_b128 v[156:159], v11 offset:31744
    v_fma_f32 v236, v236, v221, v221
    v_mfma_f32_16x16x32_bf16 v[188:191], v[140:143], a[108:111], v[188:191]
    s_waitcnt vmcnt(14)
    s_barrier
    v_mfma_f32_16x16x32_bf16 v[180:183], v[140:143], a[104:107], v[180:183]
    ds_read_b128 v[128:131], v1 offset:0
    v_mul_f32 v238, v126, v126
    v_mfma_f32_16x16x32_bf16 v[180:183], v[136:139], a[96:99], v[180:183]
    s_waitcnt lgkmcnt(3)
    buffer_load_dwordx4 v1, s[4:7], s90 offen offset:1024 sc1 lds
    v_fma_f32 v238, v238, v111, v109
    v_mfma_f32_16x16x32_bf16 v[180:183], v[144:147], a[112:115], v[180:183]
    ds_read_b128 v[132:135], v1 offset:1024
    v_mul_f32 v238, v238, v126
    v_mfma_f32_16x16x32_bf16 v[180:183], v[148:151], a[120:123], v[180:183]
    v_rcp_f32 v236, v236
    v_mfma_f32_16x16x32_bf16 v[188:191], v[148:151], a[124:127], v[188:191]
    ds_read_b128 v[136:139], v1 offset:2048
    v_mul_f32 v236, v236, v124
    v_mfma_f32_16x16x32_bf16 v[188:191], v[144:147], a[116:119], v[188:191]
    s_waitcnt lgkmcnt(3)
    buffer_load_dwordx4 v1, s[4:7], s90 offen offset:2048 sc1 lds
    v_mul_f32 v239, v127, v127
    v_mfma_f32_16x16x32_bf16 v[188:191], v[152:155], a[132:135], v[188:191]
    ds_read_b128 v[140:143], v1 offset:3072
    v_fma_f32 v239, v239, v111, v109
    v_mfma_f32_16x16x32_bf16 v[188:191], v[156:159], a[140:143], v[188:191]
    v_exp_f32 v237, v237
    v_mfma_f32_16x16x32_bf16 v[180:183], v[156:159], a[136:139], v[180:183]
    ds_read_b128 v[144:147], v1 offset:4096
    v_fma_f32 v237, v237, v221, v221
    v_mfma_f32_16x16x32_bf16 v[180:183], v[152:155], a[128:131], v[180:183]
    s_waitcnt lgkmcnt(3)
    v_rcp_f32 v237, v237
    v_mfma_f32_16x16x32_bf16 v[180:183], v[128:131], a[144:147], v[180:183]
    ds_read_b128 v[148:151], v1 offset:5120
    v_mul_f32 v237, v237, v125
    v_mfma_f32_16x16x32_bf16 v[180:183], v[132:135], a[152:155], v[180:183]
    buffer_load_dwordx4 v1, s[4:7], s90 offen offset:3072 sc1 lds
    v_cvt_pk_bf16_f32 v62, v236, v237
    v_mfma_f32_16x16x32_bf16 v[188:191], v[132:135], a[156:159], v[188:191]
    ds_read_b128 v[152:155], v1 offset:6144
    v_mul_f32 v239, v239, v127
    v_mfma_f32_16x16x32_bf16 v[188:191], v[128:131], a[148:151], v[188:191]
    s_add_u32 m0, s96, 98304
    v_exp_f32 v238, v238
    v_mfma_f32_16x16x16_bf16 v[64:67], v[208:209], v[104:105], v[64:67]
    v_exp_f32 v239, v239
    v_mfma_f32_16x16x16_bf16 v[72:75], v[208:209], v[106:107], v[72:75]
    s_waitcnt lgkmcnt(3)
    v_fma_f32 v238, v238, v221, v221
    v_fma_f32 v239, v239, v221, v221
    v_mfma_f32_16x16x32_bf16 v[188:191], v[136:139], a[164:167], v[188:191]
    ds_read_b128 v[156:159], v1 offset:7168
    v_accvgpr_read_b32 v160, a240
    v_mfma_f32_16x16x32_bf16 v[188:191], v[140:143], a[172:175], v[188:191]
    s_add_u32 s90, s95, 360448
    v_rcp_f32 v238, v238
    v_mfma_f32_16x16x32_bf16 v[180:183], v[140:143], a[168:171], v[180:183]
    ds_read_b128 v[128:131], v1 offset:8192
    v_mul_f32 v238, v238, v126
    v_mfma_f32_16x16x32_bf16 v[180:183], v[136:139], a[160:163], v[180:183]
    s_waitcnt lgkmcnt(3)
    buffer_load_dwordx4 v[212:215], v1, s[4:7], s84 offen offset:1024 sc1
    v_accvgpr_read_b32 v161, a241
    v_mfma_f32_16x16x32_bf16 v[180:183], v[144:147], a[176:179], v[180:183]
    ds_read_b128 v[132:135], v1 offset:9216
    v_accvgpr_read_b32 v162, a242
    v_mfma_f32_16x16x32_bf16 v[180:183], v[148:151], a[184:187], v[180:183]
    buffer_load_dwordx4 v1, s[4:7], s90 offen offset:0 sc1 lds
    v_accvgpr_read_b32 v163, a243
    v_mfma_f32_16x16x32_bf16 v[188:191], v[148:151], a[188:191], v[188:191]
    ds_read_b128 v[136:139], v1 offset:10240
    v_accvgpr_read_b32 v164, a244
    v_mfma_f32_16x16x32_bf16 v[188:191], v[144:147], a[180:183], v[188:191]
    s_waitcnt lgkmcnt(3)
    v_rcp_f32 v239, v239
    v_mfma_f32_16x16x32_bf16 v[188:191], v[152:155], a[196:199], v[188:191]
    ds_read_b128 v[140:143], v1 offset:11264
    v_mul_f32 v239, v239, v127
    v_mfma_f32_16x16x32_bf16 v[188:191], v[156:159], a[204:207], v[188:191]
    buffer_load_dwordx4 v1, s[4:7], s90 offen offset:1024 sc1 lds
    v_cvt_pk_bf16_f32 v63, v238, v239
    v_mfma_f32_16x16x32_bf16 v[180:183], v[156:159], a[200:203], v[180:183]
    ds_read_b128 v[144:147], v1 offset:12288
    v_accvgpr_read_b32 v165, a245
    v_mfma_f32_16x16x32_bf16 v[180:183], v[152:155], a[192:195], v[180:183]
    s_waitcnt lgkmcnt(3)
    buffer_store_dwordx4 v[60:63], v1, s[4:7], s93 offen offset:3072 sc1
    v_accvgpr_read_b32 v166, a246
    v_mfma_f32_16x16x32_bf16 v[180:183], v[128:131], a[208:211], v[180:183]
    ds_read_b128 v[148:151], v1 offset:13312
    v_accvgpr_read_b32 v167, a247
    v_mfma_f32_16x16x32_bf16 v[180:183], v[132:135], a[216:219], v[180:183]
    v_accvgpr_read_b32 v168, a248
    v_accvgpr_read_b32 v169, a249
    v_mfma_f32_16x16x32_bf16 v[188:191], v[132:135], a[220:223], v[188:191]
    ds_read_b128 v[152:155], v1 offset:14336
    v_accvgpr_read_b32 v170, a250
    v_mfma_f32_16x16x32_bf16 v[188:191], v[128:131], a[212:215], v[188:191]
    s_waitcnt lgkmcnt(3)
    v_accvgpr_read_b32 v171, a251
    v_accvgpr_read_b32 v172, a252
    v_mfma_f32_16x16x32_bf16 v[188:191], v[136:139], a[228:231], v[188:191]
    ds_read_b128 v[156:159], v1 offset:15360
    v_accvgpr_read_b32 v173, a253
    v_mfma_f32_16x16x32_bf16 v[188:191], v[140:143], a[236:239], v[188:191]
    v_accvgpr_read_b32 v174, a254
    v_accvgpr_read_b32 v175, a255
    v_mfma_f32_16x16x32_bf16 v[180:183], v[140:143], a[232:235], v[180:183]
    ds_read_b128 v[128:131], v1 offset:16384
    v_mul_f32 v224, v240, v240
    v_mfma_f32_16x16x32_bf16 v[180:183], v[136:139], a[224:227], v[180:183]
    s_waitcnt lgkmcnt(3)
    buffer_load_dwordx4 v1, s[4:7], s90 offen offset:2048 sc1 lds
    v_fma_f32 v224, v224, v110, v108
    v_mfma_f32_16x16x32_bf16 v[64:67], v[144:147], a[0:3], v[64:67]
    ds_read_b128 v[132:135], v1 offset:17408
    v_mul_f32 v224, v224, v240
    v_mfma_f32_16x16x32_bf16 v[64:67], v[148:151], a[8:11], v[64:67]
    v_exp_f32 v224, v224
    v_mfma_f32_16x16x32_bf16 v[72:75], v[148:151], a[12:15], v[72:75]
    ds_read_b128 v[136:139], v1 offset:18432
    v_fma_f32 v224, v224, v220, v220
    v_mfma_f32_16x16x32_bf16 v[72:75], v[144:147], a[4:7], v[72:75]
    s_waitcnt lgkmcnt(3)
    buffer_load_dwordx4 v1, s[4:7], s90 offen offset:3072 sc1 lds
    v_mul_f32 v225, v241, v241
    v_mfma_f32_16x16x32_bf16 v[72:75], v[152:155], a[20:23], v[72:75]
    ds_read_b128 v[140:143], v1 offset:19456
    v_fma_f32 v225, v225, v110, v108
    v_mfma_f32_16x16x32_bf16 v[72:75], v[156:159], a[28:31], v[72:75]
    s_add_u32 m0, s96, 114688
    v_rcp_f32 v224, v224
    v_mfma_f32_16x16x32_bf16 v[64:67], v[156:159], a[24:27], v[64:67]
    ds_read_b128 v[144:147], v1 offset:20480
    v_mul_f32 v224, v224, v240
    v_mfma_f32_16x16x32_bf16 v[64:67], v[152:155], a[16:19], v[64:67]
    s_waitcnt lgkmcnt(3)
    v_mul_f32 v225, v225, v241
    v_mul_f32 v226, v242, v242
    v_mfma_f32_16x16x32_bf16 v[64:67], v[128:131], a[32:35], v[64:67]
    ds_read_b128 v[148:151], v1 offset:21504
    v_fma_f32 v226, v226, v110, v108
    v_mfma_f32_16x16x32_bf16 v[64:67], v[132:135], a[40:43], v[64:67]
    s_add_u32 s90, s95, 376832
    v_exp_f32 v225, v225
    v_mfma_f32_16x16x32_bf16 v[72:75], v[132:135], a[44:47], v[72:75]
    ds_read_b128 v[152:155], v1 offset:22528
    v_fma_f32 v225, v225, v220, v220
    v_mfma_f32_16x16x32_bf16 v[72:75], v[128:131], a[36:39], v[72:75]
    s_waitcnt lgkmcnt(3)
    buffer_load_dwordx4 v1, s[4:7], s90 offen offset:0 sc1 lds
    v_mul_f32 v226, v226, v242
    v_mfma_f32_16x16x32_bf16 v[72:75], v[136:139], a[52:55], v[72:75]
    ds_read_b128 v[156:159], v1 offset:23552
    v_mul_f32 v227, v243, v243
    v_mfma_f32_16x16x32_bf16 v[72:75], v[140:143], a[60:63], v[72:75]
    buffer_load_dwordx4 v1, s[4:7], s90 offen offset:1024 sc1 lds
    v_fma_f32 v227, v227, v110, v108
    v_mfma_f32_16x16x32_bf16 v[64:67], v[140:143], a[56:59], v[64:67]
    ds_read_b128 v[128:131], v1 offset:24576
    v_mul_f32 v227, v227, v243
    v_mfma_f32_16x16x32_bf16 v[64:67], v[136:139], a[48:51], v[64:67]
    s_waitcnt lgkmcnt(3)
    v_rcp_f32 v225, v225
    v_mfma_f32_16x16x32_bf16 v[64:67], v[144:147], a[64:67], v[64:67]
    ds_read_b128 v[132:135], v1 offset:25600
    v_mul_f32 v225, v225, v241
    v_mfma_f32_16x16x32_bf16 v[64:67], v[148:151], a[72:75], v[64:67]
    buffer_load_dwordx4 v1, s[4:7], s90 offen offset:2048 sc1 lds
    v_cvt_pk_bf16_f32 v48, v224, v225
    v_mfma_f32_16x16x32_bf16 v[72:75], v[148:151], a[76:79], v[72:75]
    ds_read_b128 v[136:139], v1 offset:26624
    v_mul_f32 v232, v248, v248
    v_mfma_f32_16x16x32_bf16 v[72:75], v[144:147], a[68:71], v[72:75]
    s_waitcnt lgkmcnt(3)
    v_exp_f32 v226, v226
    v_mfma_f32_16x16x32_bf16 v[72:75], v[152:155], a[84:87], v[72:75]
    ds_read_b128 v[140:143], v1 offset:27648
    v_fma_f32 v226, v226, v220, v220
L_hop9:
    s_cbranch_execz L_hop13
    v_mfma_f32_16x16x32_bf16 v[72:75], v[156:159], a[92:95], v[72:75]
    v_rcp_f32 v226, v226
    v_mfma_f32_16x16x32_bf16 v[64:67], v[156:159], a[88:91], v[64:67]
    ds_read_b128 v[144:147], v1 offset:28672
    v_mul_f32 v226, v226, v242
    v_mfma_f32_16x16x32_bf16 v[64:67], v[152:155], a[80:83], v[64:67]
    s_waitcnt lgkmcnt(3)
    buffer_load_dwordx4 v1, s[4:7], s90 offen offset:3072 sc1 lds
    v_fma_f32 v232, v232, v111, v109
    v_mfma_f32_16x16x32_bf16 v[64:67], v[128:131], a[96:99], v[64:67]
    ds_read_b128 v[148:151], v1 offset:29696
    v_mul_f32 v232, v232, v248
    v_mfma_f32_16x16x32_bf16 v[64:67], v[132:135], a[104:107], v[64:67]
    s_add_u32 m0, s96, 131072
    v_exp_f32 v227, v227
    v_mfma_f32_16x16x32_bf16 v[72:75], v[132:135], a[108:111], v[72:75]
    ds_read_b128 v[152:155], v1 offset:30720
    v_fma_f32 v227, v227, v220, v220
    v_mfma_f32_16x16x32_bf16 v[72:75], v[128:131], a[100:103], v[72:75]
    s_waitcnt lgkmcnt(3)
    v_rcp_f32 v227, v227
    v_mfma_f32_16x16x32_bf16 v[72:75], v[136:139], a[116:119], v[72:75]
    ds_read_b128 v[156:159], v1 offset:31744
    v_mul_f32 v227, v227, v243
    v_mfma_f32_16x16x32_bf16 v[72:75], v[140:143], a[124:127], v[72:75]
    s_waitcnt vmcnt(19)
    s_barrier
    v_mfma_f32_16x16x32_bf16 v[64:67], v[140:143], a[120:123], v[64:67]
    ds_read_b128 v[128:131], v1 offset:32768
    v_cvt_pk_bf16_f32 v49, v226, v227
    v_mfma_f32_16x16x32_bf16 v[64:67], v[136:139], a[112:115], v[64:67]
    s_waitcnt lgkmcnt(3)
    v_exp_f32 v232, v232
    v_mfma_f32_16x16x32_bf16 v[64:67], v[144:147], a[128:131], v[64:67]
    ds_read_b128 v[132:135], v1 offset:33792
    v_fma_f32 v232, v232, v221, v221
    v_mfma_f32_16x16x32_bf16 v[64:67], v[148:151], a[136:139], v[64:67]
    s_add_u32 s90, s95, 393216
    v_rcp_f32 v232, v232
    v_mfma_f32_16x16x32_bf16 v[72:75], v[148:151], a[140:143], v[72:75]
    ds_read_b128 v[136:139], v1 offset:34816
    v_mul_f32 v232, v232, v248
    v_mfma_f32_16x16x32_bf16 v[72:75], v[144:147], a[132:135], v[72:75]
    s_waitcnt lgkmcnt(3)
    buffer_load_dwordx4 v1, s[4:7], s90 offen offset:0 sc1 lds
    v_mul_f32 v233, v249, v249
    v_mfma_f32_16x16x32_bf16 v[72:75], v[152:155], a[148:151], v[72:75]
    ds_read_b128 v[140:143], v1 offset:35840
    v_fma_f32 v233, v233, v111, v109
    v_mfma_f32_16x16x32_bf16 v[72:75], v[156:159], a[156:159], v[72:75]
    buffer_load_dwordx4 v1, s[4:7], s90 offen offset:1024 sc1 lds
    v_mul_f32 v233, v233, v249
    v_mfma_f32_16x16x32_bf16 v[64:67], v[156:159], a[152:155], v[64:67]
    ds_read_b128 v[144:147], v1 offset:36864
    v_mul_f32 v234, v250, v250
    v_mfma_f32_16x16x32_bf16 v[64:67], v[152:155], a[144:147], v[64:67]
    v_exp_f32 v233, v233
    v_mfma_f32_16x16x16_bf16 v[68:71], v[210:211], v[104:105], v[68:71]
    v_fma_f32 v233, v233, v221, v221
    v_fma_f32 v234, v234, v111, v109
    v_mfma_f32_16x16x16_bf16 v[76:79], v[210:211], v[106:107], v[76:79]
    s_waitcnt lgkmcnt(3)
    buffer_load_dwordx4 v1, s[4:7], s90 offen offset:2048 sc1 lds
    v_mul_f32 v234, v234, v250
    v_mfma_f32_16x16x32_bf16 v[64:67], v[128:131], a[160:163], v[64:67]
    ds_read_b128 v[148:151], v1 offset:37888
    v_mul_f32 v235, v251, v251
    v_mfma_f32_16x16x32_bf16 v[64:67], v[132:135], a[168:171], v[64:67]
    v_rcp_f32 v233, v233
    v_mfma_f32_16x16x32_bf16 v[72:75], v[132:135], a[172:175], v[72:75]
    ds_read_b128 v[152:155], v1 offset:38912
    v_mul_f32 v233, v233, v249
    v_mfma_f32_16x16x32_bf16 v[72:75], v[128:131], a[164:167], v[72:75]
    s_waitcnt lgkmcnt(3)
    buffer_load_dwordx4 v1, s[4:7], s90 offen offset:3072 sc1 lds
    v_cvt_pk_bf16_f32 v52, v232, v233
    v_mfma_f32_16x16x32_bf16 v[72:75], v[136:139], a[180:183], v[72:75]
    ds_read_b128 v[156:159], v1 offset:39936
    v_fma_f32 v235, v235, v111, v109
    v_mfma_f32_16x16x32_bf16 v[72:75], v[140:143], a[188:191], v[72:75]
    s_add_u32 m0, s96, 147456
    v_exp_f32 v234, v234
    v_mfma_f32_16x16x32_bf16 v[64:67], v[140:143], a[184:187], v[64:67]
    ds_read_b128 v[128:131], v1 offset:40960
    v_fma_f32 v234, v234, v221, v221
    v_mfma_f32_16x16x32_bf16 v[64:67], v[136:139], a[176:179], v[64:67]
    s_waitcnt lgkmcnt(3)
    v_rcp_f32 v234, v234
    v_mfma_f32_16x16x32_bf16 v[64:67], v[144:147], a[192:195], v[64:67]
    ds_read_b128 v[132:135], v1 offset:41984
    v_mul_f32 v234, v234, v250
    v_mfma_f32_16x16x32_bf16 v[64:67], v[148:151], a[200:203], v[64:67]
    s_add_u32 s90, s95, 409600
    v_mul_f32 v235, v235, v251
    v_mul_f32 v228, v244, v244
    v_mfma_f32_16x16x32_bf16 v[72:75], v[148:151], a[204:207], v[72:75]
    ds_read_b128 v[136:139], v1 offset:43008
    v_fma_f32 v228, v228, v110, v108
    v_mfma_f32_16x16x32_bf16 v[72:75], v[144:147], a[196:199], v[72:75]
    s_waitcnt lgkmcnt(3)
    buffer_load_dwordx4 v1, s[4:7], s90 offen offset:0 sc1 lds
    v_mul_f32 v228, v228, v244
    v_mfma_f32_16x16x32_bf16 v[72:75], v[152:155], a[212:215], v[72:75]
    ds_read_b128 v[140:143], v1 offset:44032
    v_mul_f32 v229, v245, v245
    v_mfma_f32_16x16x32_bf16 v[72:75], v[156:159], a[220:223], v[72:75]
    buffer_load_dwordx4 v1, s[4:7], s90 offen offset:1024 sc1 lds
    v_fma_f32 v229, v229, v110, v108
    v_mfma_f32_16x16x32_bf16 v[64:67], v[156:159], a[216:219], v[64:67]
    ds_read_b128 v[144:147], v1 offset:45056
    v_mul_f32 v229, v229, v245
    v_mfma_f32_16x16x32_bf16 v[64:67], v[152:155], a[208:211], v[64:67]
    s_waitcnt lgkmcnt(3)
    v_exp_f32 v235, v235
    v_mfma_f32_16x16x32_bf16 v[64:67], v[128:131], a[224:227], v[64:67]
    ds_read_b128 v[148:151], v1 offset:46080
    v_fma_f32 v235, v235, v221, v221
    v_mfma_f32_16x16x32_bf16 v[64:67], v[132:135], a[232:235], v[64:67]
    buffer_load_dwordx4 v1, s[4:7], s90 offen offset:2048 sc1 lds
    v_mul_f32 v230, v246, v246
    v_mfma_f32_16x16x32_bf16 v[72:75], v[132:135], a[236:239], v[72:75]
    ds_read_b128 v[152:155], v1 offset:47104
    v_fma_f32 v230, v230, v110, v108
    v_mfma_f32_16x16x32_bf16 v[72:75], v[128:131], a[228:231], v[72:75]
    s_waitcnt lgkmcnt(3)
    v_rcp_f32 v235, v235
    v_mfma_f32_16x16x32_bf16 v[76:79], v[136:139], a[4:7], v[76:79]
    ds_read_b128 v[156:159], v1 offset:48128
    v_mul_f32 v235, v235, v251
    v_mfma_f32_16x16x32_bf16 v[76:79], v[140:143], a[12:15], v[76:79]
    v_exp_f32 v228, v228
    v_mfma_f32_16x16x32_bf16 v[68:71], v[140:143], a[8:11], v[68:71]
    ds_read_b128 v[128:131], v1 offset:49152
    v_cvt_pk_bf16_f32 v53, v234, v235
    v_mfma_f32_16x16x32_bf16 v[68:71], v[136:139], a[0:3], v[68:71]
    s_waitcnt lgkmcnt(3)
    buffer_load_dwordx4 v1, s[4:7], s90 offen offset:3072 sc1 lds
    v_fma_f32 v228, v228, v220, v220
    v_mfma_f32_16x16x32_bf16 v[68:71], v[144:147], a[16:19], v[68:71]
    ds_read_b128 v[132:135], v1 offset:50176
    v_mul_f32 v230, v230, v246
    v_mfma_f32_16x16x32_bf16 v[68:71], v[148:151], a[24:27], v[68:71]
    s_add_u32 m0, s96, 0
    v_rcp_f32 v228, v228
    v_mfma_f32_16x16x32_bf16 v[76:79], v[148:151], a[28:31], v[76:79]
    ds_read_b128 v[136:139], v1 offset:51200
    v_mul_f32 v228, v228, v244
    v_mfma_f32_16x16x32_bf16 v[76:79], v[144:147], a[20:23], v[76:79]
    s_waitcnt lgkmcnt(3)
    v_exp_f32 v229, v229
    v_mfma_f32_16x16x32_bf16 v[76:79], v[152:155], a[36:39], v[76:79]
    ds_read_b128 v[140:143], v1 offset:52224
    v_fma_f32 v229, v229, v220, v220
    v_mfma_f32_16x16x32_bf16 v[76:79], v[156:159], a[44:47], v[76:79]
    s_add_u32 s90, s95, 425984
    v_rcp_f32 v229, v229
    v_mfma_f32_16x16x32_bf16 v[68:71], v[156:159], a[40:43], v[68:71]
    ds_read_b128 v[144:147], v1 offset:53248
    v_mul_f32 v229, v229, v245
    v_mfma_f32_16x16x32_bf16 v[68:71], v[152:155], a[32:35], v[68:71]
    s_waitcnt lgkmcnt(3)
    buffer_load_dwordx4 v1, s[4:7], s90 offen offset:0 sc1 lds
    v_cvt_pk_bf16_f32 v50, v228, v229
    v_mfma_f32_16x16x32_bf16 v[68:71], v[128:131], a[48:51], v[68:71]
    ds_read_b128 v[148:151], v1 offset:54272
    v_mul_f32 v231, v247, v247
    v_mfma_f32_16x16x32_bf16 v[68:71], v[132:135], a[56:59], v[68:71]
    buffer_load_dwordx4 v1, s[4:7], s90 offen offset:1024 sc1 lds
    v_fma_f32 v231, v231, v110, v108
    v_mfma_f32_16x16x32_bf16 v[76:79], v[132:135], a[60:63], v[76:79]
    ds_read_b128 v[152:155], v1 offset:55296
    v_mul_f32 v231, v231, v247
    v_mfma_f32_16x16x32_bf16 v[76:79], v[128:131], a[52:55], v[76:79]
    s_waitcnt lgkmcnt(3)
    v_exp_f32 v230, v230
    v_mfma_f32_16x16x32_bf16 v[76:79], v[136:139], a[68:71], v[76:79]
    ds_read_b128 v[156:159], v1 offset:56320
    v_fma_f32 v230, v230, v220, v220
    v_mfma_f32_16x16x32_bf16 v[76:79], v[140:143], a[76:79], v[76:79]
    buffer_load_dwordx4 v1, s[4:7], s90 offen offset:2048 sc1 lds
    v_mul_f32 v236, v252, v252
    v_mfma_f32_16x16x32_bf16 v[68:71], v[140:143], a[72:75], v[68:71]
    ds_read_b128 v[128:131], v1 offset:57344
    v_fma_f32 v236, v236, v111, v109
    v_mfma_f32_16x16x32_bf16 v[68:71], v[136:139], a[64:67], v[68:71]
    s_waitcnt lgkmcnt(3)
    v_rcp_f32 v230, v230
    v_mfma_f32_16x16x32_bf16 v[68:71], v[144:147], a[80:83], v[68:71]
    ds_read_b128 v[132:135], v1 offset:58368
    v_mul_f32 v230, v230, v246
    v_mfma_f32_16x16x32_bf16 v[68:71], v[148:151], a[88:91], v[68:71]
    buffer_load_dwordx4 v1, s[4:7], s90 offen offset:3072 sc1 lds
    v_mul_f32 v236, v236, v252
    v_mfma_f32_16x16x32_bf16 v[76:79], v[148:151], a[92:95], v[76:79]
    ds_read_b128 v[136:139], v1 offset:59392
    v_mul_f32 v237, v253, v253
    v_mfma_f32_16x16x32_bf16 v[76:79], v[144:147], a[84:87], v[76:79]
    s_waitcnt lgkmcnt(3)
    v_exp_f32 v231, v231
    v_mfma_f32_16x16x32_bf16 v[76:79], v[152:155], a[100:103], v[76:79]
    ds_read_b128 v[140:143], v1 offset:60416
    v_fma_f32 v231, v231, v220, v220
    v_mfma_f32_16x16x32_bf16 v[76:79], v[156:159], a[108:111], v[76:79]
    v_rcp_f32 v231, v231
    v_mfma_f32_16x16x32_bf16 v[68:71], v[156:159], a[104:107], v[68:71]
    ds_read_b128 v[144:147], v1 offset:61440
    v_mul_f32 v231, v231, v247
    v_mfma_f32_16x16x32_bf16 v[68:71], v[152:155], a[96:99], v[68:71]
    s_waitcnt lgkmcnt(3)
    v_exp_f32 v236, v236
    v_mfma_f32_16x16x32_bf16 v[68:71], v[128:131], a[112:115], v[68:71]
    ds_read_b128 v[148:151], v1 offset:62464
    v_cvt_pk_bf16_f32 v51, v230, v231
    v_mfma_f32_16x16x32_bf16 v[68:71], v[132:135], a[120:123], v[68:71]
    s_add_u32 s93, s93, 4096
    buffer_store_dwordx4 v[48:51], v1, s[4:7], s93 offen offset:0 sc1
    v_fma_f32 v236, v236, v221, v221
    v_mfma_f32_16x16x32_bf16 v[76:79], v[132:135], a[124:127], v[76:79]
    ds_read_b128 v[152:155], v1 offset:63488
    v_fma_f32 v237, v237, v111, v109
    v_mfma_f32_16x16x32_bf16 v[76:79], v[128:131], a[116:119], v[76:79]
    s_waitcnt lgkmcnt(3)
    v_rcp_f32 v236, v236
    v_mfma_f32_16x16x32_bf16 v[76:79], v[136:139], a[132:135], v[76:79]
    ds_read_b128 v[156:159], v1 offset:64512
    v_mul_f32 v236, v236, v252
    v_mfma_f32_16x16x32_bf16 v[76:79], v[140:143], a[140:143], v[76:79]
    s_waitcnt vmcnt(23)
    s_barrier
    v_mfma_f32_16x16x32_bf16 v[68:71], v[140:143], a[136:139], v[68:71]
    ds_read_b128 v[128:131], v10 offset:0
    v_mul_f32 v237, v237, v253
    v_mfma_f32_16x16x32_bf16 v[68:71], v[136:139], a[128:131], v[68:71]
    s_waitcnt lgkmcnt(3)
    v_exp_f32 v237, v237
    v_mfma_f32_16x16x32_bf16 v[68:71], v[144:147], a[144:147], v[68:71]
    ds_read_b128 v[132:135], v10 offset:1024
    v_fma_f32 v237, v237, v221, v221
    v_mfma_f32_16x16x32_bf16 v[68:71], v[148:151], a[152:155], v[68:71]
    s_add_u32 m0, s96, 16384
    v_rcp_f32 v237, v237
    v_mfma_f32_16x16x32_bf16 v[76:79], v[148:151], a[156:159], v[76:79]
    ds_read_b128 v[136:139], v10 offset:2048
    v_mul_f32 v237, v237, v253
    v_mfma_f32_16x16x32_bf16 v[76:79], v[144:147], a[148:151], v[76:79]
    s_waitcnt vmcnt(22)
    v_cvt_pk_bf16_f32 v54, v236, v237
    v_mul_f32 v238, v254, v254
    v_mfma_f32_16x16x16_bf16 v[80:83], v[212:213], v[104:105], v[80:83]
    v_fma_f32 v238, v238, v111, v109
    v_mul_f32 v239, v255, v255
    v_mfma_f32_16x16x16_bf16 v[88:91], v[212:213], v[106:107], v[88:91]
    s_waitcnt lgkmcnt(3)
    v_mul_f32 v238, v238, v254
    v_fma_f32 v239, v239, v111, v109
    v_mfma_f32_16x16x32_bf16 v[76:79], v[152:155], a[164:167], v[76:79]
    ds_read_b128 v[140:143], v10 offset:3072
    v_mul_f32 v239, v239, v255
    v_mfma_f32_16x16x32_bf16 v[76:79], v[156:159], a[172:175], v[76:79]
    s_add_u32 s90, s95, 442368
    v_exp_f32 v238, v238
    v_mfma_f32_16x16x32_bf16 v[68:71], v[156:159], a[168:171], v[68:71]
    ds_read_b128 v[144:147], v10 offset:4096
    v_fma_f32 v238, v238, v221, v221
    v_mfma_f32_16x16x32_bf16 v[68:71], v[152:155], a[160:163], v[68:71]
    s_waitcnt lgkmcnt(3)
    buffer_load_dwordx4 v[216:219], v1, s[4:7], s84 offen offset:2048 sc1
    v_mul_f32 v224, v176, v176
    v_mfma_f32_16x16x32_bf16 v[68:71], v[128:131], a[176:179], v[68:71]
    ds_read_b128 v[148:151], v10 offset:5120
    v_fma_f32 v224, v224, v110, v108
    v_mfma_f32_16x16x32_bf16 v[68:71], v[132:135], a[184:187], v[68:71]
    buffer_load_dwordx4 v1, s[4:7], s90 offen offset:0 sc1 lds
    v_mul_f32 v224, v224, v176
    v_mfma_f32_16x16x32_bf16 v[76:79], v[132:135], a[188:191], v[76:79]
    ds_read_b128 v[152:155], v10 offset:6144
    v_mul_f32 v225, v177, v177
    v_mfma_f32_16x16x32_bf16 v[76:79], v[128:131], a[180:183], v[76:79]
    s_waitcnt lgkmcnt(3)
    v_rcp_f32 v238, v238
    v_mfma_f32_16x16x32_bf16 v[76:79], v[136:139], a[196:199], v[76:79]
    ds_read_b128 v[156:159], v10 offset:7168
    v_mul_f32 v238, v238, v254
    v_mfma_f32_16x16x32_bf16 v[76:79], v[140:143], a[204:207], v[76:79]
    buffer_load_dwordx4 v1, s[4:7], s90 offen offset:1024 sc1 lds
    v_fma_f32 v225, v225, v110, v108
    v_mfma_f32_16x16x32_bf16 v[68:71], v[140:143], a[200:203], v[68:71]
    ds_read_b128 v[128:131], v10 offset:8192
    v_mul_f32 v225, v225, v177
    v_mfma_f32_16x16x32_bf16 v[68:71], v[136:139], a[192:195], v[68:71]
    s_waitcnt lgkmcnt(3)
    v_exp_f32 v239, v239
    v_mfma_f32_16x16x32_bf16 v[68:71], v[144:147], a[208:211], v[68:71]
    ds_read_b128 v[132:135], v10 offset:9216
    v_fma_f32 v239, v239, v221, v221
    v_mfma_f32_16x16x32_bf16 v[68:71], v[148:151], a[216:219], v[68:71]
    buffer_load_dwordx4 v1, s[4:7], s90 offen offset:2048 sc1 lds
    v_mul_f32 v226, v178, v178
    v_mfma_f32_16x16x32_bf16 v[76:79], v[148:151], a[220:223], v[76:79]
    ds_read_b128 v[136:139], v10 offset:10240
    v_fma_f32 v226, v226, v110, v108
    v_mfma_f32_16x16x32_bf16 v[76:79], v[144:147], a[212:215], v[76:79]
    s_waitcnt lgkmcnt(3)
    v_rcp_f32 v239, v239
    v_mfma_f32_16x16x32_bf16 v[76:79], v[152:155], a[228:231], v[76:79]
    ds_read_b128 v[140:143], v10 offset:11264
    v_mul_f32 v239, v239, v255
    v_mfma_f32_16x16x32_bf16 v[76:79], v[156:159], a[236:239], v[76:79]
    v_exp_f32 v224, v224
    v_mfma_f32_16x16x32_bf16 v[68:71], v[156:159], a[232:235], v[68:71]
    ds_read_b128 v[144:147], v10 offset:12288
    v_cvt_pk_bf16_f32 v55, v238, v239
    v_mfma_f32_16x16x32_bf16 v[68:71], v[152:155], a[224:227], v[68:71]
    s_waitcnt lgkmcnt(3)
    buffer_store_dwordx4 v[52:55], v1, s[4:7], s93 offen offset:1024 sc1
    v_fma_f32 v224, v224, v220, v220
    v_mfma_f32_16x16x32_bf16 v[80:83], v[128:131], a[0:3], v[80:83]
    ds_read_b128 v[148:151], v10 offset:13312
    v_mul_f32 v226, v226, v178
    v_mfma_f32_16x16x32_bf16 v[80:83], v[132:135], a[8:11], v[80:83]
    v_rcp_f32 v224, v224
    v_mfma_f32_16x16x32_bf16 v[88:91], v[132:135], a[12:15], v[88:91]
    ds_read_b128 v[152:155], v10 offset:14336
    v_mul_f32 v224, v224, v176
    v_mfma_f32_16x16x32_bf16 v[88:91], v[128:131], a[4:7], v[88:91]
    s_waitcnt lgkmcnt(3)
    buffer_load_dwordx4 v1, s[4:7], s90 offen offset:3072 sc1 lds
    v_mul_f32 v227, v179, v179
    v_mfma_f32_16x16x32_bf16 v[88:91], v[136:139], a[20:23], v[88:91]
    ds_read_b128 v[156:159], v10 offset:15360
    v_fma_f32 v227, v227, v110, v108
    v_mfma_f32_16x16x32_bf16 v[88:91], v[140:143], a[28:31], v[88:91]
    s_add_u32 m0, s96, 32768
    v_exp_f32 v225, v225
    v_mfma_f32_16x16x32_bf16 v[80:83], v[140:143], a[24:27], v[80:83]
    ds_read_b128 v[128:131], v10 offset:16384
    v_fma_f32 v225, v225, v220, v220
    v_mfma_f32_16x16x32_bf16 v[80:83], v[136:139], a[16:19], v[80:83]
    s_waitcnt lgkmcnt(3)
    v_rcp_f32 v225, v225
    v_mfma_f32_16x16x32_bf16 v[80:83], v[144:147], a[32:35], v[80:83]
    ds_read_b128 v[132:135], v10 offset:17408
    v_mul_f32 v225, v225, v177
    v_mfma_f32_16x16x32_bf16 v[80:83], v[148:151], a[40:43], v[80:83]
    s_add_u32 s90, s95, 458752
    v_exp_f32 v226, v226
    v_mfma_f32_16x16x32_bf16 v[88:91], v[148:151], a[44:47], v[88:91]
    ds_read_b128 v[136:139], v10 offset:18432
    v_cvt_pk_bf16_f32 v56, v224, v225
    v_mfma_f32_16x16x32_bf16 v[88:91], v[144:147], a[36:39], v[88:91]
    s_waitcnt lgkmcnt(3)
    buffer_load_dwordx4 v1, s[4:7], s90 offen offset:0 sc1 lds
    v_fma_f32 v226, v226, v220, v220
    v_mfma_f32_16x16x32_bf16 v[88:91], v[152:155], a[52:55], v[88:91]
    ds_read_b128 v[140:143], v10 offset:19456
    v_mul_f32 v227, v227, v179
    v_mfma_f32_16x16x32_bf16 v[88:91], v[156:159], a[60:63], v[88:91]
    buffer_load_dwordx4 v1, s[4:7], s90 offen offset:1024 sc1 lds
    v_mul_f32 v232, v184, v184
    v_mfma_f32_16x16x32_bf16 v[80:83], v[156:159], a[56:59], v[80:83]
    ds_read_b128 v[144:147], v10 offset:20480
    v_fma_f32 v232, v232, v111, v109
    v_mfma_f32_16x16x32_bf16 v[80:83], v[152:155], a[48:51], v[80:83]
    s_waitcnt lgkmcnt(3)
    v_rcp_f32 v226, v226
    v_mfma_f32_16x16x32_bf16 v[80:83], v[128:131], a[64:67], v[80:83]
    ds_read_b128 v[148:151], v10 offset:21504
    v_mul_f32 v226, v226, v178
    v_mfma_f32_16x16x32_bf16 v[80:83], v[132:135], a[72:75], v[80:83]
    buffer_load_dwordx4 v1, s[4:7], s90 offen offset:2048 sc1 lds
    v_mul_f32 v232, v232, v184
    v_mfma_f32_16x16x32_bf16 v[88:91], v[132:135], a[76:79], v[88:91]
    ds_read_b128 v[152:155], v10 offset:22528
    v_mul_f32 v233, v185, v185
    v_mfma_f32_16x16x32_bf16 v[88:91], v[128:131], a[68:71], v[88:91]
    s_waitcnt lgkmcnt(3)
    v_exp_f32 v227, v227
    v_mfma_f32_16x16x32_bf16 v[88:91], v[136:139], a[84:87], v[88:91]
    ds_read_b128 v[156:159], v10 offset:23552
    v_fma_f32 v227, v227, v220, v220
    v_mfma_f32_16x16x32_bf16 v[88:91], v[140:143], a[92:95], v[88:91]
    v_rcp_f32 v227, v227
    v_mfma_f32_16x16x32_bf16 v[80:83], v[140:143], a[88:91], v[80:83]
    ds_read_b128 v[128:131], v10 offset:24576
    v_mul_f32 v227, v227, v179
    v_mfma_f32_16x16x32_bf16 v[80:83], v[136:139], a[80:83], v[80:83]
    s_waitcnt lgkmcnt(3)
    buffer_load_dwordx4 v1, s[4:7], s90 offen offset:3072 sc1 lds
    v_cvt_pk_bf16_f32 v57, v226, v227
    v_mfma_f32_16x16x32_bf16 v[80:83], v[144:147], a[96:99], v[80:83]
    ds_read_b128 v[132:135], v10 offset:25600
    v_fma_f32 v233, v233, v111, v109
    v_mfma_f32_16x16x32_bf16 v[80:83], v[148:151], a[104:107], v[80:83]
    v_exp_f32 v232, v232
    v_mfma_f32_16x16x32_bf16 v[88:91], v[148:151], a[108:111], v[88:91]
    ds_read_b128 v[136:139], v10 offset:26624
    v_fma_f32 v232, v232, v221, v221
    v_mfma_f32_16x16x32_bf16 v[88:91], v[144:147], a[100:103], v[88:91]
    s_waitcnt lgkmcnt(3)
    v_rcp_f32 v232, v232
    v_mfma_f32_16x16x32_bf16 v[88:91], v[152:155], a[116:119], v[88:91]
    ds_read_b128 v[140:143], v10 offset:27648
    v_mul_f32 v232, v232, v184
    v_mfma_f32_16x16x32_bf16 v[88:91], v[156:159], a[124:127], v[88:91]
    v_mul_f32 v233, v233, v185
    v_mul_f32 v234, v186, v186
    v_mfma_f32_16x16x32_bf16 v[80:83], v[156:159], a[120:123], v[80:83]
    ds_read_b128 v[144:147], v10 offset:28672
    v_fma_f32 v234, v234, v111, v109
    v_mfma_f32_16x16x32_bf16 v[80:83], v[152:155], a[112:115], v[80:83]
    s_waitcnt lgkmcnt(3)
    v_exp_f32 v233, v233
    v_mfma_f32_16x16x32_bf16 v[80:83], v[128:131], a[128:131], v[80:83]
    ds_read_b128 v[148:151], v10 offset:29696
    v_fma_f32 v233, v233, v221, v221
    v_mfma_f32_16x16x32_bf16 v[80:83], v[132:135], a[136:139], v[80:83]
    v_rcp_f32 v233, v233
    v_mfma_f32_16x16x32_bf16 v[88:91], v[132:135], a[140:143], v[88:91]
    ds_read_b128 v[152:155], v10 offset:30720
    v_mul_f32 v233, v233, v185
    v_mfma_f32_16x16x32_bf16 v[88:91], v[128:131], a[132:135], v[88:91]
    s_waitcnt lgkmcnt(3)
    v_cvt_pk_bf16_f32 v60, v232, v233
    v_mul_f32 v234, v234, v186
    v_mfma_f32_16x16x32_bf16 v[88:91], v[136:139], a[148:151], v[88:91]
    ds_read_b128 v[156:159], v10 offset:31744
    v_mul_f32 v235, v187, v187
    v_mfma_f32_16x16x32_bf16 v[88:91], v[140:143], a[156:159], v[88:91]
    s_waitcnt vmcnt(23)
    s_barrier
    v_mfma_f32_16x16x32_bf16 v[80:83], v[140:143], a[152:155], v[80:83]
    ds_read_b128 v[128:131], v10 offset:32768
    v_fma_f32 v235, v235, v111, v109
    v_mfma_f32_16x16x32_bf16 v[80:83], v[136:139], a[144:147], v[80:83]
    s_add_u32 m0, s96, 49152
    v_exp_f32 v234, v234
    v_mfma_f32_16x16x16_bf16 v[84:87], v[214:215], v[104:105], v[84:87]
    v_fma_f32 v234, v234, v221, v221
    v_mul_f32 v235, v235, v187
    v_mfma_f32_16x16x16_bf16 v[92:95], v[214:215], v[106:107], v[92:95]
    s_waitcnt lgkmcnt(3)
    v_rcp_f32 v234, v234
    v_mfma_f32_16x16x32_bf16 v[80:83], v[144:147], a[160:163], v[80:83]
    ds_read_b128 v[132:135], v10 offset:33792
    v_mul_f32 v234, v234, v186
    v_mfma_f32_16x16x32_bf16 v[80:83], v[148:151], a[168:171], v[80:83]
    s_add_u32 s90, s95, 475136
    v_exp_f32 v235, v235
    v_mfma_f32_16x16x32_bf16 v[88:91], v[148:151], a[172:175], v[88:91]
    ds_read_b128 v[136:139], v10 offset:34816
    v_fma_f32 v235, v235, v221, v221
    v_mfma_f32_16x16x32_bf16 v[88:91], v[144:147], a[164:167], v[88:91]
    s_waitcnt lgkmcnt(3)
    buffer_load_dwordx4 v1, s[4:7], s90 offen offset:0 sc1 lds
    v_mul_f32 v228, v180, v180
    v_mfma_f32_16x16x32_bf16 v[88:91], v[152:155], a[180:183], v[88:91]
    ds_read_b128 v[140:143], v10 offset:35840
    v_fma_f32 v228, v228, v110, v108
    v_mfma_f32_16x16x32_bf16 v[88:91], v[156:159], a[188:191], v[88:91]
    buffer_load_dwordx4 v1, s[4:7], s90 offen offset:1024 sc1 lds
    v_mul_f32 v228, v228, v180
    v_mfma_f32_16x16x32_bf16 v[80:83], v[156:159], a[184:187], v[80:83]
    ds_read_b128 v[144:147], v10 offset:36864
    v_mul_f32 v229, v181, v181
    v_mfma_f32_16x16x32_bf16 v[80:83], v[152:155], a[176:179], v[80:83]
    s_waitcnt lgkmcnt(3)
    v_rcp_f32 v235, v235
    v_mfma_f32_16x16x32_bf16 v[80:83], v[128:131], a[192:195], v[80:83]
    ds_read_b128 v[148:151], v10 offset:37888
    v_mul_f32 v235, v235, v187
    v_mfma_f32_16x16x32_bf16 v[80:83], v[132:135], a[200:203], v[80:83]
    buffer_load_dwordx4 v1, s[4:7], s90 offen offset:2048 sc1 lds
    s_waitcnt vmcnt(8)
    s_atomic_add s92, s[4:5], s72 offset:128
    v_cvt_pk_bf16_f32 v61, v234, v235
    v_mfma_f32_16x16x32_bf16 v[88:91], v[132:135], a[204:207], v[88:91]
    ds_read_b128 v[152:155], v10 offset:38912
    v_fma_f32 v229, v229, v110, v108
    v_mfma_f32_16x16x32_bf16 v[88:91], v[128:131], a[196:199], v[88:91]
    s_waitcnt lgkmcnt(3)
    v_exp_f32 v228, v228
    v_mfma_f32_16x16x32_bf16 v[88:91], v[136:139], a[212:215], v[88:91]
    ds_read_b128 v[156:159], v10 offset:39936
    v_fma_f32 v228, v228, v220, v220
    v_mfma_f32_16x16x32_bf16 v[88:91], v[140:143], a[220:223], v[88:91]
    buffer_load_dwordx4 v1, s[4:7], s90 offen offset:3072 sc1 lds
    v_mul_f32 v229, v229, v181
    v_mfma_f32_16x16x32_bf16 v[80:83], v[140:143], a[216:219], v[80:83]
    ds_read_b128 v[128:131], v10 offset:40960
    v_mul_f32 v230, v182, v182
    v_mfma_f32_16x16x32_bf16 v[80:83], v[136:139], a[208:211], v[80:83]
    s_waitcnt lgkmcnt(3)
    v_rcp_f32 v228, v228
    v_mfma_f32_16x16x32_bf16 v[80:83], v[144:147], a[224:227], v[80:83]
    ds_read_b128 v[132:135], v10 offset:41984
    v_mul_f32 v228, v228, v180
    v_mfma_f32_16x16x32_bf16 v[80:83], v[148:151], a[232:235], v[80:83]
    s_add_u32 m0, s96, 65536
    v_exp_f32 v229, v229
    v_mfma_f32_16x16x32_bf16 v[88:91], v[148:151], a[236:239], v[88:91]
    ds_read_b128 v[136:139], v10 offset:43008
    v_fma_f32 v229, v229, v220, v220
    v_mfma_f32_16x16x32_bf16 v[88:91], v[144:147], a[228:231], v[88:91]
    s_waitcnt lgkmcnt(3)
    v_rcp_f32 v229, v229
    v_mfma_f32_16x16x32_bf16 v[92:95], v[152:155], a[4:7], v[92:95]
    ds_read_b128 v[140:143], v10 offset:44032
    v_mul_f32 v229, v229, v181
    v_mfma_f32_16x16x32_bf16 v[92:95], v[156:159], a[12:15], v[92:95]
    s_add_u32 s90, s95, 491520
    v_cvt_pk_bf16_f32 v58, v228, v229
    v_fma_f32 v230, v230, v110, v108
    v_mfma_f32_16x16x32_bf16 v[84:87], v[156:159], a[8:11], v[84:87]
    ds_read_b128 v[144:147], v10 offset:45056
    v_mul_f32 v230, v230, v182
    v_mfma_f32_16x16x32_bf16 v[84:87], v[152:155], a[0:3], v[84:87]
    s_waitcnt lgkmcnt(3)
    buffer_load_dwordx4 v1, s[4:7], s90 offen offset:0 sc1 lds
    v_mul_f32 v231, v183, v183
    v_mfma_f32_16x16x32_bf16 v[84:87], v[128:131], a[16:19], v[84:87]
    ds_read_b128 v[148:151], v10 offset:46080
    v_fma_f32 v231, v231, v110, v108
    v_mfma_f32_16x16x32_bf16 v[84:87], v[132:135], a[24:27], v[84:87]
    buffer_load_dwordx4 v1, s[4:7], s90 offen offset:1024 sc1 lds
    v_mul_f32 v231, v231, v183
    v_mfma_f32_16x16x32_bf16 v[92:95], v[132:135], a[28:31], v[92:95]
    ds_read_b128 v[152:155], v10 offset:47104
    v_mul_f32 v236, v188, v188
    v_mfma_f32_16x16x32_bf16 v[92:95], v[128:131], a[20:23], v[92:95]
    s_waitcnt lgkmcnt(3)
    v_exp_f32 v230, v230
    v_mfma_f32_16x16x32_bf16 v[92:95], v[136:139], a[36:39], v[92:95]
    ds_read_b128 v[156:159], v10 offset:48128
    v_fma_f32 v230, v230, v220, v220
    v_mfma_f32_16x16x32_bf16 v[92:95], v[140:143], a[44:47], v[92:95]
    buffer_load_dwordx4 v1, s[4:7], s90 offen offset:2048 sc1 lds
    v_fma_f32 v236, v236, v111, v109
    v_mfma_f32_16x16x32_bf16 v[84:87], v[140:143], a[40:43], v[84:87]
    ds_read_b128 v[128:131], v10 offset:49152
    v_mul_f32 v236, v236, v188
    v_mfma_f32_16x16x32_bf16 v[84:87], v[136:139], a[32:35], v[84:87]
    s_waitcnt lgkmcnt(3)
    v_rcp_f32 v230, v230
    v_mfma_f32_16x16x32_bf16 v[84:87], v[144:147], a[48:51], v[84:87]
    ds_read_b128 v[132:135], v10 offset:50176
    v_mul_f32 v230, v230, v182
    v_mfma_f32_16x16x32_bf16 v[84:87], v[148:151], a[56:59], v[84:87]
    buffer_load_dwordx4 v1, s[4:7], s90 offen offset:3072 sc1 lds
    v_mul_f32 v237, v189, v189
    v_mfma_f32_16x16x32_bf16 v[92:95], v[148:151], a[60:63], v[92:95]
    ds_read_b128 v[136:139], v10 offset:51200
    v_fma_f32 v237, v237, v111, v109
    v_mfma_f32_16x16x32_bf16 v[92:95], v[144:147], a[52:55], v[92:95]
    s_waitcnt lgkmcnt(3)
    v_exp_f32 v231, v231
    v_mfma_f32_16x16x32_bf16 v[92:95], v[152:155], a[68:71], v[92:95]
    ds_read_b128 v[140:143], v10 offset:52224
    v_fma_f32 v231, v231, v220, v220
    v_mfma_f32_16x16x32_bf16 v[92:95], v[156:159], a[76:79], v[92:95]
    v_rcp_f32 v231, v231
    v_mfma_f32_16x16x32_bf16 v[84:87], v[156:159], a[72:75], v[84:87]
    ds_read_b128 v[144:147], v10 offset:53248
    v_mul_f32 v231, v231, v183
    v_mfma_f32_16x16x32_bf16 v[84:87], v[152:155], a[64:67], v[84:87]
    s_waitcnt lgkmcnt(3)
    v_exp_f32 v236, v236
    v_mfma_f32_16x16x32_bf16 v[84:87], v[128:131], a[80:83], v[84:87]
    ds_read_b128 v[148:151], v10 offset:54272
    v_cvt_pk_bf16_f32 v59, v230, v231
    v_mfma_f32_16x16x32_bf16 v[84:87], v[132:135], a[88:91], v[84:87]
    buffer_store_dwordx4 v[56:59], v1, s[4:7], s93 offen offset:2048 sc1
    v_fma_f32 v236, v236, v221, v221
    v_mfma_f32_16x16x32_bf16 v[92:95], v[132:135], a[92:95], v[92:95]
    ds_read_b128 v[152:155], v10 offset:55296
    v_mul_f32 v237, v237, v189
    v_mfma_f32_16x16x32_bf16 v[92:95], v[128:131], a[84:87], v[92:95]
    s_waitcnt lgkmcnt(3)
    v_rcp_f32 v236, v236
    v_mfma_f32_16x16x32_bf16 v[92:95], v[136:139], a[100:103], v[92:95]
    ds_read_b128 v[156:159], v10 offset:56320
    v_mul_f32 v236, v236, v188
    v_mfma_f32_16x16x32_bf16 v[92:95], v[140:143], a[108:111], v[92:95]
    v_exp_f32 v237, v237
    v_mfma_f32_16x16x32_bf16 v[84:87], v[140:143], a[104:107], v[84:87]
    ds_read_b128 v[128:131], v10 offset:57344
    v_fma_f32 v237, v237, v221, v221
    v_mfma_f32_16x16x32_bf16 v[84:87], v[136:139], a[96:99], v[84:87]
    s_waitcnt lgkmcnt(3)
    v_rcp_f32 v237, v237
    v_mfma_f32_16x16x32_bf16 v[84:87], v[144:147], a[112:115], v[84:87]
    ds_read_b128 v[132:135], v10 offset:58368
    v_mul_f32 v237, v237, v189
    v_mfma_f32_16x16x32_bf16 v[84:87], v[148:151], a[120:123], v[84:87]
    s_mov_b32 s57, 0
    s_atomic_add s57, s[4:5], s72 offset:128 glc
    v_cvt_pk_bf16_f32 v62, v236, v237
    v_mul_f32 v238, v190, v190
    v_mfma_f32_16x16x32_bf16 v[92:95], v[148:151], a[124:127], v[92:95]
    ds_read_b128 v[136:139], v10 offset:59392
    v_fma_f32 v238, v238, v111, v109
    v_mfma_f32_16x16x32_bf16 v[92:95], v[144:147], a[116:119], v[92:95]
    s_waitcnt lgkmcnt(3)
    v_mul_f32 v238, v238, v190
    v_mul_f32 v239, v191, v191
    v_mfma_f32_16x16x32_bf16 v[92:95], v[152:155], a[132:135], v[92:95]
    ds_read_b128 v[140:143], v10 offset:60416
    v_fma_f32 v239, v239, v111, v109
    v_mfma_f32_16x16x32_bf16 v[92:95], v[156:159], a[140:143], v[92:95]
L_hop10:
    s_cbranch_execz L_hop14
    v_exp_f32 v238, v238
    v_mfma_f32_16x16x32_bf16 v[84:87], v[156:159], a[136:139], v[84:87]
    ds_read_b128 v[144:147], v10 offset:61440
    v_fma_f32 v238, v238, v221, v221
    v_mfma_f32_16x16x32_bf16 v[84:87], v[152:155], a[128:131], v[84:87]
    s_waitcnt lgkmcnt(3)
    v_rcp_f32 v238, v238
    v_mfma_f32_16x16x32_bf16 v[84:87], v[128:131], a[144:147], v[84:87]
    ds_read_b128 v[148:151], v10 offset:62464
    v_mul_f32 v238, v238, v190
    v_mfma_f32_16x16x32_bf16 v[84:87], v[132:135], a[152:155], v[84:87]
    v_mul_f32 v239, v239, v191
    v_mul_f32 v224, v64, v64
    v_mfma_f32_16x16x32_bf16 v[92:95], v[132:135], a[156:159], v[92:95]
    ds_read_b128 v[152:155], v10 offset:63488
    v_fma_f32 v224, v224, v110, v108
    v_mfma_f32_16x16x32_bf16 v[92:95], v[128:131], a[148:151], v[92:95]
    v_exp_f32 v239, v239
    v_mfma_f32_16x16x16_bf16 v[160:163], v[216:217], v[104:105], v[160:163]
    v_fma_f32 v239, v239, v221, v221
    v_mul_f32 v224, v224, v64
    v_mfma_f32_16x16x16_bf16 v[168:171], v[216:217], v[106:107], v[168:171]
    v_rcp_f32 v239, v239
    v_mfma_f32_16x16x16_bf16 v[164:167], v[218:219], v[104:105], v[164:167]
    v_exp_f32 v224, v224
    v_mfma_f32_16x16x16_bf16 v[172:175], v[218:219], v[106:107], v[172:175]
    s_waitcnt lgkmcnt(3)
    v_mul_f32 v239, v239, v191
    v_fma_f32 v224, v224, v220, v220
    v_mfma_f32_16x16x32_bf16 v[92:95], v[136:139], a[164:167], v[92:95]
    ds_read_b128 v[156:159], v10 offset:64512
    v_cvt_pk_bf16_f32 v63, v238, v239
    v_mfma_f32_16x16x32_bf16 v[92:95], v[140:143], a[172:175], v[92:95]
    s_barrier
    v_mfma_f32_16x16x32_bf16 v[84:87], v[140:143], a[168:171], v[84:87]
    ds_read_b128 v[128:131], v11 offset:0
    v_mul_f32 v225, v65, v65
    v_mfma_f32_16x16x32_bf16 v[84:87], v[136:139], a[160:163], v[84:87]
    s_waitcnt lgkmcnt(3)
    buffer_store_dwordx4 v[60:63], v1, s[4:7], s93 offen offset:3072 sc1
    v_fma_f32 v225, v225, v110, v108
    v_mfma_f32_16x16x32_bf16 v[84:87], v[144:147], a[176:179], v[84:87]
    ds_read_b128 v[132:135], v11 offset:1024
    v_mul_f32 v225, v225, v65
    v_mfma_f32_16x16x32_bf16 v[84:87], v[148:151], a[184:187], v[84:87]
    s_add_u32 m0, s96, 81920
    v_rcp_f32 v224, v224
    v_mfma_f32_16x16x32_bf16 v[92:95], v[148:151], a[188:191], v[92:95]
    ds_read_b128 v[136:139], v11 offset:2048
    v_mul_f32 v224, v224, v64
    v_mfma_f32_16x16x32_bf16 v[92:95], v[144:147], a[180:183], v[92:95]
    s_waitcnt lgkmcnt(3)
    v_exp_f32 v225, v225
    v_mfma_f32_16x16x32_bf16 v[92:95], v[152:155], a[196:199], v[92:95]
    ds_read_b128 v[140:143], v11 offset:3072
    v_fma_f32 v225, v225, v220, v220
    v_mfma_f32_16x16x32_bf16 v[92:95], v[156:159], a[204:207], v[92:95]
    s_add_u32 s90, s95, 507904
    v_rcp_f32 v225, v225
    v_mfma_f32_16x16x32_bf16 v[84:87], v[156:159], a[200:203], v[84:87]
    ds_read_b128 v[144:147], v11 offset:4096
    v_mul_f32 v225, v225, v65
    v_mfma_f32_16x16x32_bf16 v[84:87], v[152:155], a[192:195], v[84:87]
    s_waitcnt lgkmcnt(3)
    buffer_load_dwordx4 v1, s[4:7], s90 offen offset:0 sc1 lds
    v_cvt_pk_bf16_f32 v48, v224, v225
    v_mfma_f32_16x16x32_bf16 v[84:87], v[128:131], a[208:211], v[84:87]
    ds_read_b128 v[148:151], v11 offset:5120
    v_mul_f32 v226, v66, v66
    v_mfma_f32_16x16x32_bf16 v[84:87], v[132:135], a[216:219], v[84:87]
    buffer_load_dwordx4 v1, s[4:7], s90 offen offset:1024 sc1 lds
    v_fma_f32 v226, v226, v110, v108
    v_mfma_f32_16x16x32_bf16 v[92:95], v[132:135], a[220:223], v[92:95]
    ds_read_b128 v[152:155], v11 offset:6144
    v_mul_f32 v226, v226, v66
    v_mfma_f32_16x16x32_bf16 v[92:95], v[128:131], a[212:215], v[92:95]
    s_waitcnt lgkmcnt(3)
    v_exp_f32 v226, v226
    v_mfma_f32_16x16x32_bf16 v[92:95], v[136:139], a[228:231], v[92:95]
    ds_read_b128 v[156:159], v11 offset:7168
    v_fma_f32 v226, v226, v220, v220
    v_mfma_f32_16x16x32_bf16 v[92:95], v[140:143], a[236:239], v[92:95]
    buffer_load_dwordx4 v1, s[4:7], s90 offen offset:2048 sc1 lds
    v_mul_f32 v227, v67, v67
    v_mfma_f32_16x16x32_bf16 v[84:87], v[140:143], a[232:235], v[84:87]
    ds_read_b128 v[128:131], v11 offset:8192
    v_fma_f32 v227, v227, v110, v108
    v_mfma_f32_16x16x32_bf16 v[84:87], v[136:139], a[224:227], v[84:87]
    s_waitcnt lgkmcnt(3)
    v_rcp_f32 v226, v226
    v_mfma_f32_16x16x32_bf16 v[160:163], v[144:147], a[0:3], v[160:163]
    ds_read_b128 v[132:135], v11 offset:9216
    v_mul_f32 v226, v226, v66
    v_mfma_f32_16x16x32_bf16 v[160:163], v[148:151], a[8:11], v[160:163]
    buffer_load_dwordx4 v1, s[4:7], s90 offen offset:3072 sc1 lds
    v_mul_f32 v227, v227, v67
    v_mfma_f32_16x16x32_bf16 v[168:171], v[148:151], a[12:15], v[168:171]
    ds_read_b128 v[136:139], v11 offset:10240
    v_mul_f32 v232, v72, v72
    v_mfma_f32_16x16x32_bf16 v[168:171], v[144:147], a[4:7], v[168:171]
    s_waitcnt lgkmcnt(3)
    v_exp_f32 v227, v227
    v_mfma_f32_16x16x32_bf16 v[172:175], v[152:155], a[4:7], v[172:175]
    ds_read_b128 v[140:143], v11 offset:11264
    v_fma_f32 v227, v227, v220, v220
    v_mfma_f32_16x16x32_bf16 v[172:175], v[156:159], a[12:15], v[172:175]
    s_add_u32 m0, s96, 98304
    v_rcp_f32 v227, v227
    v_mfma_f32_16x16x32_bf16 v[164:167], v[156:159], a[8:11], v[164:167]
    ds_read_b128 v[144:147], v11 offset:12288
    v_mul_f32 v227, v227, v67
    v_mfma_f32_16x16x32_bf16 v[164:167], v[152:155], a[0:3], v[164:167]
    s_waitcnt lgkmcnt(3)
    v_cvt_pk_bf16_f32 v49, v226, v227
    v_fma_f32 v232, v232, v111, v109
    v_mfma_f32_16x16x32_bf16 v[160:163], v[128:131], a[16:19], v[160:163]
    ds_read_b128 v[148:151], v11 offset:13312
    v_mul_f32 v232, v232, v72
    v_mfma_f32_16x16x32_bf16 v[160:163], v[132:135], a[24:27], v[160:163]
    s_cmp_lt_u32 s57, 4
    s_cbranch_scc1 L_slow_17
L_back_18:
    v_exp_f32 v232, v232
    v_mfma_f32_16x16x32_bf16 v[168:171], v[132:135], a[28:31], v[168:171]
    ds_read_b128 v[152:155], v11 offset:14336
    v_fma_f32 v232, v232, v221, v221
    v_mfma_f32_16x16x32_bf16 v[168:171], v[128:131], a[20:23], v[168:171]
    s_waitcnt lgkmcnt(3)
    buffer_load_dwordx4 a[0:3], v12, s[4:7], s68 offen offset:0 sc1
    v_mul_f32 v233, v73, v73
    v_mfma_f32_16x16x32_bf16 v[172:175], v[136:139], a[20:23], v[172:175]
    ds_read_b128 v[156:159], v11 offset:15360
    v_fma_f32 v233, v233, v111, v109
    v_mfma_f32_16x16x32_bf16 v[172:175], v[140:143], a[28:31], v[172:175]
    buffer_load_dwordx4 a[4:7], v12, s[4:7], s68 offen offset:1024 sc1
    v_mul_f32 v233, v233, v73
    v_mfma_f32_16x16x32_bf16 v[164:167], v[140:143], a[24:27], v[164:167]
    ds_read_b128 v[128:131], v11 offset:16384
    v_mul_f32 v234, v74, v74
    v_mfma_f32_16x16x32_bf16 v[164:167], v[136:139], a[16:19], v[164:167]
    s_waitcnt lgkmcnt(3)
    v_rcp_f32 v232, v232
    v_mfma_f32_16x16x32_bf16 v[160:163], v[144:147], a[32:35], v[160:163]
    ds_read_b128 v[132:135], v11 offset:17408
    v_mul_f32 v232, v232, v72
    v_mfma_f32_16x16x32_bf16 v[160:163], v[148:151], a[40:43], v[160:163]
    buffer_load_dwordx4 a[8:11], v12, s[4:7], s69 offen offset:0 sc1
    v_fma_f32 v234, v234, v111, v109
    v_mfma_f32_16x16x32_bf16 v[168:171], v[148:151], a[44:47], v[168:171]
    ds_read_b128 v[136:139], v11 offset:18432
    v_mul_f32 v234, v234, v74
    v_mfma_f32_16x16x32_bf16 v[168:171], v[144:147], a[36:39], v[168:171]
    s_waitcnt lgkmcnt(3)
    v_exp_f32 v233, v233
    v_mfma_f32_16x16x32_bf16 v[172:175], v[152:155], a[36:39], v[172:175]
    ds_read_b128 v[140:143], v11 offset:19456
    v_fma_f32 v233, v233, v221, v221
    v_mfma_f32_16x16x32_bf16 v[172:175], v[156:159], a[44:47], v[172:175]
    buffer_load_dwordx4 a[12:15], v12, s[4:7], s69 offen offset:1024 sc1
    v_mul_f32 v235, v75, v75
    v_mfma_f32_16x16x32_bf16 v[164:167], v[156:159], a[40:43], v[164:167]
    ds_read_b128 v[144:147], v11 offset:20480
    v_fma_f32 v235, v235, v111, v109
    v_mfma_f32_16x16x32_bf16 v[164:167], v[152:155], a[32:35], v[164:167]
    s_waitcnt lgkmcnt(3)
    v_rcp_f32 v233, v233
    v_mfma_f32_16x16x32_bf16 v[160:163], v[128:131], a[48:51], v[160:163]
    ds_read_b128 v[148:151], v11 offset:21504
    v_mul_f32 v233, v233, v73
    v_mfma_f32_16x16x32_bf16 v[160:163], v[132:135], a[56:59], v[160:163]
    s_add_u32 s90, s95, 524288
    v_exp_f32 v234, v234
    v_mfma_f32_16x16x32_bf16 v[168:171], v[132:135], a[60:63], v[168:171]
    ds_read_b128 v[152:155], v11 offset:22528
    v_cvt_pk_bf16_f32 v52, v232, v233
    v_mfma_f32_16x16x32_bf16 v[168:171], v[128:131], a[52:55], v[168:171]
    s_waitcnt lgkmcnt(3)
    buffer_load_dwordx4 a[16:19], v12, s[4:7], s70 offen offset:0 sc1
    v_fma_f32 v234, v234, v221, v221
    v_mfma_f32_16x16x32_bf16 v[172:175], v[136:139], a[52:55], v[172:175]
    ds_read_b128 v[156:159], v11 offset:23552
    v_mul_f32 v235, v235, v75
    v_mfma_f32_16x16x32_bf16 v[172:175], v[140:143], a[60:63], v[172:175]
    v_rcp_f32 v234, v234
    v_mfma_f32_16x16x32_bf16 v[164:167], v[140:143], a[56:59], v[164:167]
    ds_read_b128 v[128:131], v11 offset:24576
    v_mul_f32 v234, v234, v74
    v_mfma_f32_16x16x32_bf16 v[164:167], v[136:139], a[48:51], v[164:167]
    s_waitcnt lgkmcnt(3)
    buffer_load_dwordx4 a[20:23], v12, s[4:7], s70 offen offset:1024 sc1
    v_mul_f32 v228, v68, v68
    v_mfma_f32_16x16x32_bf16 v[160:163], v[144:147], a[64:67], v[160:163]
    ds_read_b128 v[132:135], v11 offset:25600
    v_fma_f32 v228, v228, v110, v108
    v_mfma_f32_16x16x32_bf16 v[160:163], v[148:151], a[72:75], v[160:163]
    v_exp_f32 v235, v235
    v_mfma_f32_16x16x32_bf16 v[168:171], v[148:151], a[76:79], v[168:171]
    ds_read_b128 v[136:139], v11 offset:26624
    v_fma_f32 v235, v235, v221, v221
    v_mfma_f32_16x16x32_bf16 v[168:171], v[144:147], a[68:71], v[168:171]
    s_waitcnt lgkmcnt(3)
    buffer_load_dwordx4 a[24:27], v12, s[4:7], s71 offen offset:0 sc1
    v_mul_f32 v228, v228, v68
    v_mfma_f32_16x16x32_bf16 v[172:175], v[152:155], a[68:71], v[172:175]
    ds_read_b128 v[140:143], v11 offset:27648
    v_mul_f32 v229, v69, v69
    v_mfma_f32_16x16x32_bf16 v[172:175], v[156:159], a[76:79], v[172:175]
    v_rcp_f32 v235, v235
    v_mfma_f32_16x16x32_bf16 v[164:167], v[156:159], a[72:75], v[164:167]
    ds_read_b128 v[144:147], v11 offset:28672
    v_mul_f32 v235, v235, v75
    v_mfma_f32_16x16x32_bf16 v[164:167], v[152:155], a[64:67], v[164:167]
    s_waitcnt lgkmcnt(3)
    v_exp_f32 v228, v228
    v_mfma_f32_16x16x32_bf16 v[160:163], v[128:131], a[80:83], v[160:163]
    ds_read_b128 v[148:151], v11 offset:29696
    v_cvt_pk_bf16_f32 v53, v234, v235
    v_mfma_f32_16x16x32_bf16 v[160:163], v[132:135], a[88:91], v[160:163]
    buffer_load_dwordx4 a[28:31], v12, s[4:7], s71 offen offset:1024 sc1
    v_fma_f32 v228, v228, v220, v220
    v_mfma_f32_16x16x32_bf16 v[168:171], v[132:135], a[92:95], v[168:171]
    ds_read_b128 v[152:155], v11 offset:30720
    v_fma_f32 v229, v229, v110, v108
    v_mfma_f32_16x16x32_bf16 v[168:171], v[128:131], a[84:87], v[168:171]
    s_waitcnt lgkmcnt(3)
    v_rcp_f32 v228, v228
    v_mfma_f32_16x16x32_bf16 v[172:175], v[136:139], a[84:87], v[172:175]
    ds_read_b128 v[156:159], v11 offset:31744
    v_mul_f32 v228, v228, v68
    v_mfma_f32_16x16x32_bf16 v[172:175], v[140:143], a[92:95], v[172:175]
    s_waitcnt vmcnt(26)
    s_barrier
    v_mfma_f32_16x16x32_bf16 v[164:167], v[140:143], a[88:91], v[164:167]
    ds_read_b128 v[128:131], v1 offset:0
    v_mul_f32 v229, v229, v69
    v_mfma_f32_16x16x32_bf16 v[164:167], v[136:139], a[80:83], v[164:167]
    s_waitcnt lgkmcnt(3)
    buffer_load_dwordx4 a[32:35], v12, s[4:7], s68 offen offset:2048 sc1
    v_mul_f32 v230, v70, v70
    v_mfma_f32_16x16x32_bf16 v[160:163], v[144:147], a[96:99], v[160:163]
    ds_read_b128 v[132:135], v1 offset:1024
    v_fma_f32 v230, v230, v110, v108
    v_mfma_f32_16x16x32_bf16 v[160:163], v[148:151], a[104:107], v[160:163]
    v_exp_f32 v229, v229
    v_mfma_f32_16x16x32_bf16 v[168:171], v[148:151], a[108:111], v[168:171]
    ds_read_b128 v[136:139], v1 offset:2048
    v_fma_f32 v229, v229, v220, v220
    v_mfma_f32_16x16x32_bf16 v[168:171], v[144:147], a[100:103], v[168:171]
    s_waitcnt lgkmcnt(3)
    v_rcp_f32 v229, v229
    v_mfma_f32_16x16x32_bf16 v[172:175], v[152:155], a[100:103], v[172:175]
    ds_read_b128 v[140:143], v1 offset:3072
    v_mul_f32 v229, v229, v69
    v_mfma_f32_16x16x32_bf16 v[172:175], v[156:159], a[108:111], v[172:175]
    buffer_load_dwordx4 a[36:39], v12, s[4:7], s68 offen offset:3072 sc1
    v_cvt_pk_bf16_f32 v50, v228, v229
    v_mfma_f32_16x16x32_bf16 v[164:167], v[156:159], a[104:107], v[164:167]
    ds_read_b128 v[144:147], v1 offset:4096
    v_mul_f32 v230, v230, v70
    v_mfma_f32_16x16x32_bf16 v[164:167], v[152:155], a[96:99], v[164:167]
    s_waitcnt lgkmcnt(3)
    v_exp_f32 v230, v230
    v_mfma_f32_16x16x32_bf16 v[160:163], v[128:131], a[112:115], v[160:163]
    ds_read_b128 v[148:151], v1 offset:5120
    v_fma_f32 v230, v230, v220, v220
    v_mfma_f32_16x16x32_bf16 v[160:163], v[132:135], a[120:123], v[160:163]
    buffer_load_dwordx4 a[40:43], v12, s[4:7], s69 offen offset:2048 sc1
    v_mul_f32 v231, v71, v71
    v_mfma_f32_16x16x32_bf16 v[168:171], v[132:135], a[124:127], v[168:171]
    ds_read_b128 v[152:155], v1 offset:6144
    v_fma_f32 v231, v231, v110, v108
    v_mfma_f32_16x16x32_bf16 v[168:171], v[128:131], a[116:119], v[168:171]
    s_waitcnt lgkmcnt(3)
    v_rcp_f32 v230, v230
    v_mfma_f32_16x16x32_bf16 v[172:175], v[136:139], a[116:119], v[172:175]
    ds_read_b128 v[156:159], v1 offset:7168
    v_mul_f32 v230, v230, v70
    v_mfma_f32_16x16x32_bf16 v[172:175], v[140:143], a[124:127], v[172:175]
    buffer_load_dwordx4 a[44:47], v12, s[4:7], s69 offen offset:3072 sc1
    v_mul_f32 v231, v231, v71
    v_mfma_f32_16x16x32_bf16 v[164:167], v[140:143], a[120:123], v[164:167]
    ds_read_b128 v[128:131], v1 offset:8192
    v_mul_f32 v236, v76, v76
    v_mfma_f32_16x16x32_bf16 v[164:167], v[136:139], a[112:115], v[164:167]
    s_waitcnt lgkmcnt(3)
    v_exp_f32 v231, v231
    v_mfma_f32_16x16x32_bf16 v[160:163], v[144:147], a[128:131], v[160:163]
    ds_read_b128 v[132:135], v1 offset:9216
    v_fma_f32 v231, v231, v220, v220
    v_mfma_f32_16x16x32_bf16 v[160:163], v[148:151], a[136:139], v[160:163]
    v_rcp_f32 v231, v231
    v_mfma_f32_16x16x32_bf16 v[168:171], v[148:151], a[140:143], v[168:171]
    ds_read_b128 v[136:139], v1 offset:10240
    v_mul_f32 v231, v231, v71
    v_mfma_f32_16x16x32_bf16 v[168:171], v[144:147], a[132:135], v[168:171]
    s_waitcnt lgkmcnt(3)
    buffer_load_dwordx4 a[48:51], v12, s[4:7], s70 offen offset:2048 sc1
    v_cvt_pk_bf16_f32 v51, v230, v231
    v_mfma_f32_16x16x32_bf16 v[172:175], v[152:155], a[132:135], v[172:175]
    ds_read_b128 v[140:143], v1 offset:11264
    v_fma_f32 v236, v236, v111, v109
    v_mfma_f32_16x16x32_bf16 v[172:175], v[156:159], a[140:143], v[172:175]
    s_add_u32 s93, s93, 4096
    buffer_store_dwordx4 v[48:51], v1, s[4:7], s93 offen offset:0 sc1
    v_mul_f32 v236, v236, v76
    v_mfma_f32_16x16x32_bf16 v[164:167], v[156:159], a[136:139], v[164:167]
    ds_read_b128 v[144:147], v1 offset:12288
    v_mul_f32 v237, v77, v77
    v_mfma_f32_16x16x32_bf16 v[164:167], v[152:155], a[128:131], v[164:167]
    s_waitcnt lgkmcnt(3)
    v_exp_f32 v236, v236
    v_mfma_f32_16x16x32_bf16 v[160:163], v[128:131], a[144:147], v[160:163]
    ds_read_b128 v[148:151], v1 offset:13312
    v_fma_f32 v236, v236, v221, v221
    v_mfma_f32_16x16x32_bf16 v[160:163], v[132:135], a[152:155], v[160:163]
    v_rcp_f32 v236, v236
    v_mfma_f32_16x16x32_bf16 v[168:171], v[132:135], a[156:159], v[168:171]
    ds_read_b128 v[152:155], v1 offset:14336
    v_mul_f32 v236, v236, v76
    v_mfma_f32_16x16x32_bf16 v[168:171], v[128:131], a[148:151], v[168:171]
    s_waitcnt lgkmcnt(3)
    buffer_load_dwordx4 a[52:55], v12, s[4:7], s70 offen offset:3072 sc1
    v_fma_f32 v237, v237, v111, v109
    v_mfma_f32_16x16x32_bf16 v[172:175], v[136:139], a[148:151], v[172:175]
    ds_read_b128 v[156:159], v1 offset:15360
    v_mul_f32 v237, v237, v77
    v_mfma_f32_16x16x32_bf16 v[172:175], v[140:143], a[156:159], v[172:175]
    v_exp_f32 v237, v237
    v_mfma_f32_16x16x32_bf16 v[164:167], v[140:143], a[152:155], v[164:167]
    ds_read_b128 v[128:131], v1 offset:16384
    v_fma_f32 v237, v237, v221, v221
    v_mfma_f32_16x16x32_bf16 v[164:167], v[136:139], a[144:147], v[164:167]
    s_waitcnt lgkmcnt(3)
    v_rcp_f32 v237, v237
    v_mfma_f32_16x16x32_bf16 v[160:163], v[144:147], a[160:163], v[160:163]
    ds_read_b128 v[132:135], v1 offset:17408
    v_mul_f32 v237, v237, v77
    v_mfma_f32_16x16x32_bf16 v[160:163], v[148:151], a[168:171], v[160:163]
    buffer_load_dwordx4 a[56:59], v12, s[4:7], s71 offen offset:2048 sc1
    v_cvt_pk_bf16_f32 v54, v236, v237
    v_mfma_f32_16x16x32_bf16 v[168:171], v[148:151], a[172:175], v[168:171]
    ds_read_b128 v[136:139], v1 offset:18432
    v_mul_f32 v238, v78, v78
    v_mfma_f32_16x16x32_bf16 v[168:171], v[144:147], a[164:167], v[168:171]
    s_waitcnt lgkmcnt(3)
    v_fma_f32 v238, v238, v111, v109
    v_mul_f32 v239, v79, v79
    v_mfma_f32_16x16x32_bf16 v[172:175], v[152:155], a[164:167], v[172:175]
    ds_read_b128 v[140:143], v1 offset:19456
    v_mul_f32 v238, v238, v78
    v_mfma_f32_16x16x32_bf16 v[172:175], v[156:159], a[172:175], v[172:175]
    buffer_load_dwordx4 a[60:63], v12, s[4:7], s71 offen offset:3072 sc1
    v_fma_f32 v239, v239, v111, v109
    v_mfma_f32_16x16x32_bf16 v[164:167], v[156:159], a[168:171], v[164:167]
    ds_read_b128 v[144:147], v1 offset:20480
    v_mul_f32 v239, v239, v79
    v_mfma_f32_16x16x32_bf16 v[164:167], v[152:155], a[160:163], v[164:167]
    s_waitcnt lgkmcnt(3)
    v_exp_f32 v238, v238
    v_mfma_f32_16x16x32_bf16 v[160:163], v[128:131], a[176:179], v[160:163]
    ds_read_b128 v[148:151], v1 offset:21504
    v_fma_f32 v238, v238, v221, v221
    v_mfma_f32_16x16x32_bf16 v[160:163], v[132:135], a[184:187], v[160:163]
    v_rcp_f32 v238, v238
    v_mfma_f32_16x16x32_bf16 v[168:171], v[132:135], a[188:191], v[168:171]
    ds_read_b128 v[152:155], v1 offset:22528
    v_mul_f32 v238, v238, v78
    v_mfma_f32_16x16x32_bf16 v[168:171], v[128:131], a[180:183], v[168:171]
    s_waitcnt lgkmcnt(3)
    buffer_load_dwordx4 v1, s[4:7], s90 offen offset:0 sc1 lds
    v_mul_f32 v224, v80, v80
    v_mfma_f32_16x16x32_bf16 v[172:175], v[136:139], a[180:183], v[172:175]
    ds_read_b128 v[156:159], v1 offset:23552
    v_fma_f32 v224, v224, v110, v108
    v_mfma_f32_16x16x32_bf16 v[172:175], v[140:143], a[188:191], v[172:175]
    v_exp_f32 v239, v239
    v_mfma_f32_16x16x32_bf16 v[164:167], v[140:143], a[184:187], v[164:167]
    ds_read_b128 v[128:131], v1 offset:24576
    v_fma_f32 v239, v239, v221, v221
    v_mfma_f32_16x16x32_bf16 v[164:167], v[136:139], a[176:179], v[164:167]
    s_waitcnt lgkmcnt(3)
    buffer_load_dwordx4 v1, s[4:7], s90 offen offset:1024 sc1 lds
    v_mul_f32 v224, v224, v80
    v_mfma_f32_16x16x32_bf16 v[160:163], v[144:147], a[192:195], v[160:163]
    ds_read_b128 v[132:135], v1 offset:25600
    v_mul_f32 v225, v81, v81
    v_mfma_f32_16x16x32_bf16 v[160:163], v[148:151], a[200:203], v[160:163]
    v_rcp_f32 v239, v239
    v_mfma_f32_16x16x32_bf16 v[168:171], v[148:151], a[204:207], v[168:171]
    ds_read_b128 v[136:139], v1 offset:26624
    v_mul_f32 v239, v239, v79
    v_mfma_f32_16x16x32_bf16 v[168:171], v[144:147], a[196:199], v[168:171]
    s_waitcnt lgkmcnt(3)
    buffer_load_dwordx4 v1, s[4:7], s90 offen offset:2048 sc1 lds
    v_cvt_pk_bf16_f32 v55, v238, v239
    v_mfma_f32_16x16x32_bf16 v[172:175], v[152:155], a[196:199], v[172:175]
    ds_read_b128 v[140:143], v1 offset:27648
    v_exp_f32 v224, v224
    v_mfma_f32_16x16x32_bf16 v[172:175], v[156:159], a[204:207], v[172:175]
    buffer_store_dwordx4 v[52:55], v1, s[4:7], s93 offen offset:1024 sc1
    v_fma_f32 v224, v224, v220, v220
    v_mfma_f32_16x16x32_bf16 v[164:167], v[156:159], a[200:203], v[164:167]
    ds_read_b128 v[144:147], v1 offset:28672
    v_rcp_f32 v224, v224
    v_mfma_f32_16x16x32_bf16 v[164:167], v[152:155], a[192:195], v[164:167]
    s_waitcnt lgkmcnt(3)
    v_mul_f32 v224, v224, v80
    v_fma_f32 v225, v225, v110, v108
    v_mfma_f32_16x16x32_bf16 v[160:163], v[128:131], a[208:211], v[160:163]
    ds_read_b128 v[148:151], v1 offset:29696
    v_mul_f32 v225, v225, v81
    v_mul_f32 v226, v82, v82
    v_mfma_f32_16x16x32_bf16 v[160:163], v[132:135], a[216:219], v[160:163]
    v_exp_f32 v225, v225
    v_mfma_f32_16x16x32_bf16 v[168:171], v[132:135], a[220:223], v[168:171]
    ds_read_b128 v[152:155], v1 offset:30720
    v_fma_f32 v225, v225, v220, v220
    v_fma_f32 v226, v226, v110, v108
    v_mfma_f32_16x16x32_bf16 v[168:171], v[128:131], a[212:215], v[168:171]
    s_waitcnt lgkmcnt(3)
    v_rcp_f32 v225, v225
    v_mfma_f32_16x16x32_bf16 v[172:175], v[136:139], a[212:215], v[172:175]
    ds_read_b128 v[156:159], v1 offset:31744
    v_mul_f32 v225, v225, v81
    v_mul_f32 v226, v226, v82
    v_mfma_f32_16x16x32_bf16 v[172:175], v[140:143], a[220:223], v[172:175]
    s_waitcnt vmcnt(31)
    s_barrier
    v_mfma_f32_16x16x32_bf16 v[164:167], v[140:143], a[216:219], v[164:167]
    ds_read_b128 v[128:131], v1 offset:32768
    v_exp_f32 v226, v226
    v_mfma_f32_16x16x32_bf16 v[164:167], v[136:139], a[208:211], v[164:167]
    s_waitcnt lgkmcnt(3)
    buffer_load_dwordx4 v1, s[4:7], s90 offen offset:3072 sc1 lds
    v_cvt_pk_bf16_f32 v56, v224, v225
    v_mfma_f32_16x16x32_bf16 v[160:163], v[144:147], a[224:227], v[160:163]
    ds_read_b128 v[132:135], v1 offset:33792
    v_fma_f32 v226, v226, v220, v220
    v_mul_f32 v227, v83, v83
    v_mfma_f32_16x16x32_bf16 v[160:163], v[148:151], a[232:235], v[160:163]
    s_add_u32 m0, s96, 114688
    v_rcp_f32 v226, v226
    v_mfma_f32_16x16x32_bf16 v[168:171], v[148:151], a[236:239], v[168:171]
    ds_read_b128 v[136:139], v1 offset:34816
    v_mul_f32 v226, v226, v82
    v_fma_f32 v227, v227, v110, v108
    v_mfma_f32_16x16x32_bf16 v[168:171], v[144:147], a[228:231], v[168:171]
    s_waitcnt lgkmcnt(3)
    v_mul_f32 v227, v227, v83
    v_mul_f32 v232, v88, v88
    v_mfma_f32_16x16x32_bf16 v[172:175], v[152:155], a[228:231], v[172:175]
    ds_read_b128 v[140:143], v1 offset:35840
    v_exp_f32 v227, v227
    v_mfma_f32_16x16x32_bf16 v[172:175], v[156:159], a[236:239], v[172:175]
    v_add_u32 v12, 4096, v12
    buffer_load_dwordx4 a[64:67], v12, s[4:7], s68 offen offset:0 sc1
    v_fma_f32 v227, v227, v220, v220
    v_mfma_f32_16x16x32_bf16 v[164:167], v[156:159], a[232:235], v[164:167]
    ds_read_b128 v[144:147], v1 offset:36864
    v_rcp_f32 v227, v227
    v_mfma_f32_16x16x32_bf16 v[164:167], v[152:155], a[224:227], v[164:167]
    s_waitcnt vmcnt(19) lgkmcnt(3)
    v_mul_f32 v227, v227, v83
    v_fma_f32 v232, v232, v111, v109
    v_mfma_f32_16x16x32_bf16 v[112:115], v[128:131], a[0:3], 0
    ds_read_b128 v[148:151], v1 offset:37888
    v_cvt_pk_bf16_f32 v57, v226, v227
    v_mul_f32 v232, v232, v88
    v_mfma_f32_16x16x32_bf16 v[112:115], v[132:135], a[8:11], v[112:115]
    buffer_load_dwordx4 a[68:71], v12, s[4:7], s68 offen offset:1024 sc1
    v_mul_f32 v233, v89, v89
    v_mfma_f32_16x16x32_bf16 v[120:123], v[132:135], a[12:15], 0
    ds_read_b128 v[152:155], v1 offset:38912
    v_exp_f32 v232, v232
    v_mfma_f32_16x16x32_bf16 v[120:123], v[128:131], a[4:7], v[120:123]
    s_waitcnt lgkmcnt(3)
    v_fma_f32 v232, v232, v221, v221
    v_fma_f32 v233, v233, v111, v109
    v_mfma_f32_16x16x32_bf16 v[124:127], v[136:139], a[4:7], 0
    ds_read_b128 v[156:159], v1 offset:39936
    v_rcp_f32 v232, v232
    v_mfma_f32_16x16x32_bf16 v[124:127], v[140:143], a[12:15], v[124:127]
    buffer_load_dwordx4 a[72:75], v12, s[4:7], s69 offen offset:0 sc1
    v_mul_f32 v232, v232, v88
    v_mfma_f32_16x16x32_bf16 v[116:119], v[140:143], a[8:11], 0
    ds_read_b128 v[128:131], v1 offset:40960
    v_mul_f32 v233, v233, v89
    v_mul_f32 v234, v90, v90
    v_mfma_f32_16x16x32_bf16 v[116:119], v[136:139], a[0:3], v[116:119]
    s_waitcnt lgkmcnt(3)
    v_exp_f32 v233, v233
    v_mfma_f32_16x16x32_bf16 v[240:243], v[144:147], a[0:3], 0
    ds_read_b128 v[132:135], v1 offset:41984
    v_fma_f32 v233, v233, v221, v221
    v_fma_f32 v234, v234, v111, v109
    v_mfma_f32_16x16x32_bf16 v[240:243], v[148:151], a[8:11], v[240:243]
    s_add_u32 s90, s95, 540672
    v_rcp_f32 v233, v233
    v_mfma_f32_16x16x32_bf16 v[248:251], v[148:151], a[12:15], 0
    ds_read_b128 v[136:139], v1 offset:43008
    v_mul_f32 v233, v233, v89
    v_mul_f32 v234, v234, v90
    v_mfma_f32_16x16x32_bf16 v[248:251], v[144:147], a[4:7], v[248:251]
    s_waitcnt lgkmcnt(3)
    buffer_load_dwordx4 v1, s[4:7], s90 offen offset:0 sc1 lds
    v_cvt_pk_bf16_f32 v60, v232, v233
    v_mfma_f32_16x16x32_bf16 v[252:255], v[152:155], a[4:7], 0
    ds_read_b128 v[140:143], v1 offset:44032
    v_exp_f32 v234, v234
    v_mfma_f32_16x16x32_bf16 v[252:255], v[156:159], a[12:15], v[252:255]
    v_fma_f32 v234, v234, v221, v221
    v_mul_f32 v235, v91, v91
    v_mfma_f32_16x16x32_bf16 v[244:247], v[156:159], a[8:11], 0
    ds_read_b128 v[144:147], v1 offset:45056
    v_rcp_f32 v234, v234
    v_mfma_f32_16x16x32_bf16 v[244:247], v[152:155], a[0:3], v[244:247]
    s_waitcnt lgkmcnt(3)
    buffer_load_dwordx4 v1, s[4:7], s90 offen offset:1024 sc1 lds
    v_mul_f32 v234, v234, v90
    v_mfma_f32_16x16x32_bf16 v[176:179], v[128:131], a[0:3], 0
    ds_read_b128 v[148:151], v1 offset:46080
    v_fma_f32 v235, v235, v111, v109
    v_mul_f32 v228, v84, v84
    v_mfma_f32_16x16x32_bf16 v[176:179], v[132:135], a[8:11], v[176:179]
    v_mul_f32 v235, v235, v91
    v_fma_f32 v228, v228, v110, v108
    v_mfma_f32_16x16x32_bf16 v[184:187], v[132:135], a[12:15], 0
    ds_read_b128 v[152:155], v1 offset:47104
    v_exp_f32 v235, v235
    v_mfma_f32_16x16x32_bf16 v[184:187], v[128:131], a[4:7], v[184:187]
    s_waitcnt lgkmcnt(3)
    buffer_load_dwordx4 v1, s[4:7], s90 offen offset:2048 sc1 lds
    v_fma_f32 v235, v235, v221, v221
    v_mfma_f32_16x16x32_bf16 v[188:191], v[136:139], a[4:7], 0
    ds_read_b128 v[156:159], v1 offset:48128
    v_rcp_f32 v235, v235
    v_mfma_f32_16x16x32_bf16 v[188:191], v[140:143], a[12:15], v[188:191]
    v_mul_f32 v235, v235, v91
    v_mul_f32 v228, v228, v84
    v_mfma_f32_16x16x32_bf16 v[180:183], v[140:143], a[8:11], 0
    ds_read_b128 v[128:131], v1 offset:49152
    v_exp_f32 v228, v228
    v_mfma_f32_16x16x32_bf16 v[180:183], v[136:139], a[0:3], v[180:183]
    s_waitcnt lgkmcnt(3)
    v_cvt_pk_bf16_f32 v61, v234, v235
    v_fma_f32 v228, v228, v220, v220
    v_mfma_f32_16x16x32_bf16 v[64:67], v[144:147], a[0:3], 0
    ds_read_b128 v[132:135], v1 offset:50176
    v_rcp_f32 v228, v228
    v_mfma_f32_16x16x32_bf16 v[64:67], v[148:151], a[8:11], v[64:67]
    buffer_load_dwordx4 v1, s[4:7], s90 offen offset:3072 sc1 lds
    v_mul_f32 v228, v228, v84
    v_mfma_f32_16x16x32_bf16 v[72:75], v[148:151], a[12:15], 0
    ds_read_b128 v[136:139], v1 offset:51200
    v_mul_f32 v229, v85, v85
    v_mul_f32 v230, v86, v86
    v_mfma_f32_16x16x32_bf16 v[72:75], v[144:147], a[4:7], v[72:75]
    s_waitcnt lgkmcnt(3)
    v_fma_f32 v229, v229, v110, v108
    v_fma_f32 v230, v230, v110, v108
    v_mfma_f32_16x16x32_bf16 v[76:79], v[152:155], a[4:7], 0
    ds_read_b128 v[140:143], v1 offset:52224
    v_mul_f32 v229, v229, v85
    v_mul_f32 v230, v230, v86
    v_mfma_f32_16x16x32_bf16 v[76:79], v[156:159], a[12:15], v[76:79]
    buffer_load_dwordx4 a[76:79], v12, s[4:7], s69 offen offset:1024 sc1
    v_mul_f32 v231, v87, v87
    v_mfma_f32_16x16x32_bf16 v[68:71], v[156:159], a[8:11], 0
    ds_read_b128 v[144:147], v1 offset:53248
    v_exp_f32 v229, v229
    v_mfma_f32_16x16x32_bf16 v[68:71], v[152:155], a[0:3], v[68:71]
    s_waitcnt vmcnt(22) lgkmcnt(3)
    v_exp_f32 v230, v230
    v_mfma_f32_16x16x32_bf16 v[112:115], v[128:131], a[16:19], v[112:115]
    ds_read_b128 v[148:151], v1 offset:54272
    v_fma_f32 v229, v229, v220, v220
    v_fma_f32 v230, v230, v220, v220
    v_mfma_f32_16x16x32_bf16 v[112:115], v[132:135], a[24:27], v[112:115]
    s_waitcnt vmcnt(9)
    s_atomic_add s92, s[4:5], s72 offset:136
    v_rcp_f32 v229, v229
    v_mfma_f32_16x16x32_bf16 v[120:123], v[132:135], a[28:31], v[120:123]
    ds_read_b128 v[152:155], v1 offset:55296
    v_rcp_f32 v230, v230
    v_mfma_f32_16x16x32_bf16 v[120:123], v[128:131], a[20:23], v[120:123]
    s_waitcnt lgkmcnt(3)
    buffer_load_dwordx4 a[80:83], v12, s[4:7], s70 offen offset:0 sc1
    v_mul_f32 v229, v229, v85
    v_mfma_f32_16x16x32_bf16 v[124:127], v[136:139], a[20:23], v[124:127]
    ds_read_b128 v[156:159], v1 offset:56320
    v_cvt_pk_bf16_f32 v58, v228, v229
    v_mul_f32 v230, v230, v86
    v_mfma_f32_16x16x32_bf16 v[124:127], v[140:143], a[28:31], v[124:127]
    s_add_u32 m0, s96, 131072
    v_fma_f32 v231, v231, v110, v108
    v_mul_f32 v236, v92, v92
    v_mfma_f32_16x16x32_bf16 v[116:119], v[140:143], a[24:27], v[116:119]
    ds_read_b128 v[128:131], v1 offset:57344
    v_mul_f32 v231, v231, v87
    v_fma_f32 v236, v236, v111, v109
    v_mfma_f32_16x16x32_bf16 v[116:119], v[136:139], a[16:19], v[116:119]
    s_waitcnt lgkmcnt(3)
    buffer_load_dwordx4 a[84:87], v12, s[4:7], s70 offen offset:1024 sc1
    v_mul_f32 v236, v236, v92
    v_mfma_f32_16x16x32_bf16 v[240:243], v[144:147], a[16:19], v[240:243]
    ds_read_b128 v[132:135], v1 offset:58368
    v_exp_f32 v231, v231
    v_mfma_f32_16x16x32_bf16 v[240:243], v[148:151], a[24:27], v[240:243]
    s_add_u32 s90, s95, 557056
    v_exp_f32 v236, v236
    v_mfma_f32_16x16x32_bf16 v[248:251], v[148:151], a[28:31], v[248:251]
    ds_read_b128 v[136:139], v1 offset:59392
    v_fma_f32 v231, v231, v220, v220
    v_fma_f32 v236, v236, v221, v221
    v_mfma_f32_16x16x32_bf16 v[248:251], v[144:147], a[20:23], v[248:251]
L_hop11:
    s_cbranch_execz L_hop15
    s_waitcnt lgkmcnt(3)
    buffer_load_dwordx4 a[88:91], v12, s[4:7], s71 offen offset:0 sc1
    v_mul_f32 v237, v93, v93
    v_mfma_f32_16x16x32_bf16 v[252:255], v[152:155], a[20:23], v[252:255]
    ds_read_b128 v[140:143], v1 offset:60416
    v_rcp_f32 v231, v231
    v_mfma_f32_16x16x32_bf16 v[252:255], v[156:159], a[28:31], v[252:255]
    v_rcp_f32 v236, v236
    v_mfma_f32_16x16x32_bf16 v[244:247], v[156:159], a[24:27], v[244:247]
    ds_read_b128 v[144:147], v1 offset:61440
    v_mul_f32 v231, v231, v87
    v_mul_f32 v236, v236, v92
    v_mfma_f32_16x16x32_bf16 v[244:247], v[152:155], a[16:19], v[244:247]
    s_waitcnt lgkmcnt(3)
    v_cvt_pk_bf16_f32 v59, v230, v231
    v_fma_f32 v237, v237, v111, v109
    v_mfma_f32_16x16x32_bf16 v[176:179], v[128:131], a[16:19], v[176:179]
    ds_read_b128 v[148:151], v1 offset:62464
    v_mul_f32 v237, v237, v93
    v_mul_f32 v238, v94, v94
    v_mfma_f32_16x16x32_bf16 v[176:179], v[132:135], a[24:27], v[176:179]
    buffer_store_dwordx4 v[56:59], v1, s[4:7], s93 offen offset:2048 sc1
    v_fma_f32 v238, v238, v111, v109
    v_mfma_f32_16x16x32_bf16 v[184:187], v[132:135], a[28:31], v[184:187]
    ds_read_b128 v[152:155], v1 offset:63488
    v_exp_f32 v237, v237
    v_mfma_f32_16x16x32_bf16 v[184:187], v[128:131], a[20:23], v[184:187]
    s_waitcnt lgkmcnt(3)
    v_fma_f32 v237, v237, v221, v221
    v_mul_f32 v238, v238, v94
    v_mfma_f32_16x16x32_bf16 v[188:191], v[136:139], a[20:23], v[188:191]
    ds_read_b128 v[156:159], v1 offset:64512
    v_rcp_f32 v237, v237
    v_mfma_f32_16x16x32_bf16 v[188:191], v[140:143], a[28:31], v[188:191]
    s_barrier
    v_mfma_f32_16x16x32_bf16 v[180:183], v[140:143], a[24:27], v[180:183]
    ds_read_b128 v[128:131], v10 offset:0
    v_exp_f32 v238, v238
    v_mfma_f32_16x16x32_bf16 v[180:183], v[136:139], a[16:19], v[180:183]
    s_waitcnt lgkmcnt(3)
    buffer_load_dwordx4 a[92:95], v12, s[4:7], s71 offen offset:1024 sc1
    v_mul_f32 v237, v237, v93
    v_mfma_f32_16x16x32_bf16 v[64:67], v[144:147], a[16:19], v[64:67]
    ds_read_b128 v[132:135], v10 offset:1024
    v_cvt_pk_bf16_f32 v62, v236, v237
    v_fma_f32 v238, v238, v221, v221
    v_mfma_f32_16x16x32_bf16 v[64:67], v[148:151], a[24:27], v[64:67]
    v_rcp_f32 v238, v238
    v_mfma_f32_16x16x32_bf16 v[72:75], v[148:151], a[28:31], v[72:75]
    ds_read_b128 v[136:139], v10 offset:2048
    v_mul_f32 v238, v238, v94
    v_mul_f32 v239, v95, v95
    v_mfma_f32_16x16x32_bf16 v[72:75], v[144:147], a[20:23], v[72:75]
    s_waitcnt lgkmcnt(3)
    buffer_load_dwordx4 v1, s[4:7], s90 offen offset:0 sc1 lds
    v_fma_f32 v239, v239, v111, v109
    v_mfma_f32_16x16x32_bf16 v[76:79], v[152:155], a[20:23], v[76:79]
    ds_read_b128 v[140:143], v10 offset:3072
    v_mul_f32 v239, v239, v95
    v_mfma_f32_16x16x32_bf16 v[76:79], v[156:159], a[28:31], v[76:79]
    v_exp_f32 v239, v239
    v_mfma_f32_16x16x32_bf16 v[68:71], v[156:159], a[24:27], v[68:71]
    ds_read_b128 v[144:147], v10 offset:4096
    v_fma_f32 v239, v239, v221, v221
    v_mfma_f32_16x16x32_bf16 v[68:71], v[152:155], a[16:19], v[68:71]
    s_waitcnt lgkmcnt(3)
    v_rcp_f32 v239, v239
    v_mfma_f32_16x16x32_bf16 v[112:115], v[128:131], a[32:35], v[112:115]
    ds_read_b128 v[148:151], v10 offset:5120
    v_mul_f32 v239, v239, v95
    v_mfma_f32_16x16x32_bf16 v[112:115], v[132:135], a[40:43], v[112:115]
    buffer_load_dwordx4 v1, s[4:7], s90 offen offset:1024 sc1 lds
    v_cvt_pk_bf16_f32 v63, v238, v239
    v_mfma_f32_16x16x32_bf16 v[120:123], v[132:135], a[44:47], v[120:123]
    ds_read_b128 v[152:155], v10 offset:6144
    v_mul_f32 v224, v160, v160
    v_mfma_f32_16x16x32_bf16 v[120:123], v[128:131], a[36:39], v[120:123]
    s_waitcnt lgkmcnt(3)
    buffer_store_dwordx4 v[60:63], v1, s[4:7], s93 offen offset:3072 sc1
    v_fma_f32 v224, v224, v110, v108
    v_mfma_f32_16x16x32_bf16 v[124:127], v[136:139], a[36:39], v[124:127]
    ds_read_b128 v[156:159], v10 offset:7168
    v_mul_f32 v224, v224, v160
    v_mfma_f32_16x16x32_bf16 v[124:127], v[140:143], a[44:47], v[124:127]
    s_mov_b32 s57, 0
    s_atomic_add s57, s[4:5], s72 offset:136 glc
    v_exp_f32 v224, v224
    v_mfma_f32_16x16x32_bf16 v[116:119], v[140:143], a[40:43], v[116:119]
    ds_read_b128 v[128:131], v10 offset:8192
    v_fma_f32 v224, v224, v220, v220
    v_mfma_f32_16x16x32_bf16 v[116:119], v[136:139], a[32:35], v[116:119]
    s_waitcnt lgkmcnt(3)
    v_rcp_f32 v224, v224
    v_mfma_f32_16x16x32_bf16 v[240:243], v[144:147], a[32:35], v[240:243]
    ds_read_b128 v[132:135], v10 offset:9216
    v_mul_f32 v224, v224, v160
    v_mfma_f32_16x16x32_bf16 v[240:243], v[148:151], a[40:43], v[240:243]
    v_mul_f32 v225, v161, v161
    v_mul_f32 v226, v162, v162
    v_mfma_f32_16x16x32_bf16 v[248:251], v[148:151], a[44:47], v[248:251]
    ds_read_b128 v[136:139], v10 offset:10240
    v_fma_f32 v225, v225, v110, v108
    v_mfma_f32_16x16x32_bf16 v[248:251], v[144:147], a[36:39], v[248:251]
    s_waitcnt lgkmcnt(3)
    buffer_load_dwordx4 v1, s[4:7], s90 offen offset:2048 sc1 lds
    v_mul_f32 v225, v225, v161
    v_mfma_f32_16x16x32_bf16 v[252:255], v[152:155], a[36:39], v[252:255]
    ds_read_b128 v[140:143], v10 offset:11264
    v_fma_f32 v226, v226, v110, v108
    v_mfma_f32_16x16x32_bf16 v[252:255], v[156:159], a[44:47], v[252:255]
    v_exp_f32 v225, v225
    v_mfma_f32_16x16x32_bf16 v[244:247], v[156:159], a[40:43], v[244:247]
    ds_read_b128 v[144:147], v10 offset:12288
    v_fma_f32 v225, v225, v220, v220
    v_mfma_f32_16x16x32_bf16 v[244:247], v[152:155], a[32:35], v[244:247]
    s_waitcnt lgkmcnt(3)
    buffer_load_dwordx4 v1, s[4:7], s90 offen offset:3072 sc1 lds
    v_mul_f32 v226, v226, v162
    v_mfma_f32_16x16x32_bf16 v[176:179], v[128:131], a[32:35], v[176:179]
    ds_read_b128 v[148:151], v10 offset:13312
    v_mul_f32 v227, v163, v163
    v_mfma_f32_16x16x32_bf16 v[176:179], v[132:135], a[40:43], v[176:179]
    s_add_u32 m0, s96, 147456
    v_rcp_f32 v225, v225
    v_mfma_f32_16x16x32_bf16 v[184:187], v[132:135], a[44:47], v[184:187]
    ds_read_b128 v[152:155], v10 offset:14336
    v_mul_f32 v225, v225, v161
    v_mfma_f32_16x16x32_bf16 v[184:187], v[128:131], a[36:39], v[184:187]
    s_waitcnt lgkmcnt(3)
    v_exp_f32 v226, v226
    v_mfma_f32_16x16x32_bf16 v[188:191], v[136:139], a[36:39], v[188:191]
    ds_read_b128 v[156:159], v10 offset:15360
    v_cvt_pk_bf16_f32 v48, v224, v225
    v_mfma_f32_16x16x32_bf16 v[188:191], v[140:143], a[44:47], v[188:191]
    s_add_u32 s90, s95, 573440
    v_fma_f32 v226, v226, v220, v220
    v_fma_f32 v227, v227, v110, v108
    v_mfma_f32_16x16x32_bf16 v[180:183], v[140:143], a[40:43], v[180:183]
    ds_read_b128 v[128:131], v10 offset:16384
    v_mul_f32 v227, v227, v163
    v_mfma_f32_16x16x32_bf16 v[180:183], v[136:139], a[32:35], v[180:183]
    s_waitcnt lgkmcnt(3)
    buffer_load_dwordx4 v1, s[4:7], s90 offen offset:0 sc1 lds
    v_mul_f32 v232, v168, v168
    v_mfma_f32_16x16x32_bf16 v[64:67], v[144:147], a[32:35], v[64:67]
    ds_read_b128 v[132:135], v10 offset:17408
    v_fma_f32 v232, v232, v111, v109
    v_mfma_f32_16x16x32_bf16 v[64:67], v[148:151], a[40:43], v[64:67]
    buffer_load_dwordx4 v1, s[4:7], s90 offen offset:1024 sc1 lds
    v_mul_f32 v232, v232, v168
    v_mfma_f32_16x16x32_bf16 v[72:75], v[148:151], a[44:47], v[72:75]
    ds_read_b128 v[136:139], v10 offset:18432
    v_mul_f32 v233, v169, v169
    v_mfma_f32_16x16x32_bf16 v[72:75], v[144:147], a[36:39], v[72:75]
    s_waitcnt lgkmcnt(3)
    v_rcp_f32 v226, v226
    v_mfma_f32_16x16x32_bf16 v[76:79], v[152:155], a[36:39], v[76:79]
    ds_read_b128 v[140:143], v10 offset:19456
    v_mul_f32 v226, v226, v162
    v_mfma_f32_16x16x32_bf16 v[76:79], v[156:159], a[44:47], v[76:79]
    buffer_load_dwordx4 v1, s[4:7], s90 offen offset:2048 sc1 lds
    v_fma_f32 v233, v233, v111, v109
    v_mfma_f32_16x16x32_bf16 v[68:71], v[156:159], a[40:43], v[68:71]
    ds_read_b128 v[144:147], v10 offset:20480
    v_mul_f32 v233, v233, v169
    v_mfma_f32_16x16x32_bf16 v[68:71], v[152:155], a[32:35], v[68:71]
    s_waitcnt lgkmcnt(3)
    v_exp_f32 v227, v227
    v_mfma_f32_16x16x32_bf16 v[112:115], v[128:131], a[48:51], v[112:115]
    ds_read_b128 v[148:151], v10 offset:21504
    v_fma_f32 v227, v227, v220, v220
    v_mfma_f32_16x16x32_bf16 v[112:115], v[132:135], a[56:59], v[112:115]
    v_rcp_f32 v227, v227
    v_mfma_f32_16x16x32_bf16 v[120:123], v[132:135], a[60:63], v[120:123]
    ds_read_b128 v[152:155], v10 offset:22528
    v_mul_f32 v227, v227, v163
    v_mfma_f32_16x16x32_bf16 v[120:123], v[128:131], a[52:55], v[120:123]
    s_waitcnt lgkmcnt(3)
    buffer_load_dwordx4 v1, s[4:7], s90 offen offset:3072 sc1 lds
    v_cvt_pk_bf16_f32 v49, v226, v227
    v_mfma_f32_16x16x32_bf16 v[124:127], v[136:139], a[52:55], v[124:127]
    ds_read_b128 v[156:159], v10 offset:23552
    v_mul_f32 v234, v170, v170
    v_mfma_f32_16x16x32_bf16 v[124:127], v[140:143], a[60:63], v[124:127]
    s_add_u32 m0, s96, 0
    v_exp_f32 v232, v232
    v_mfma_f32_16x16x32_bf16 v[116:119], v[140:143], a[56:59], v[116:119]
    ds_read_b128 v[128:131], v10 offset:24576
    v_fma_f32 v232, v232, v221, v221
    v_mfma_f32_16x16x32_bf16 v[116:119], v[136:139], a[48:51], v[116:119]
    s_waitcnt lgkmcnt(3)
    v_rcp_f32 v232, v232
    v_mfma_f32_16x16x32_bf16 v[240:243], v[144:147], a[48:51], v[240:243]
    ds_read_b128 v[132:135], v10 offset:25600
    v_mul_f32 v232, v232, v168
    v_mfma_f32_16x16x32_bf16 v[240:243], v[148:151], a[56:59], v[240:243]
    s_add_u32 s90, s95, 589824
    v_exp_f32 v233, v233
    v_mfma_f32_16x16x32_bf16 v[248:251], v[148:151], a[60:63], v[248:251]
    ds_read_b128 v[136:139], v10 offset:26624
    v_fma_f32 v233, v233, v221, v221
    v_mfma_f32_16x16x32_bf16 v[248:251], v[144:147], a[52:55], v[248:251]
    s_waitcnt lgkmcnt(3)
    buffer_load_dwordx4 v1, s[4:7], s90 offen offset:0 sc1 lds
    v_fma_f32 v234, v234, v111, v109
    v_mfma_f32_16x16x32_bf16 v[252:255], v[152:155], a[52:55], v[252:255]
    ds_read_b128 v[140:143], v10 offset:27648
    v_mul_f32 v234, v234, v170
    v_mfma_f32_16x16x32_bf16 v[252:255], v[156:159], a[60:63], v[252:255]
    buffer_load_dwordx4 v1, s[4:7], s90 offen offset:1024 sc1 lds
    v_mul_f32 v235, v171, v171
    v_mfma_f32_16x16x32_bf16 v[244:247], v[156:159], a[56:59], v[244:247]
    ds_read_b128 v[144:147], v10 offset:28672
    v_fma_f32 v235, v235, v111, v109
    v_mfma_f32_16x16x32_bf16 v[244:247], v[152:155], a[48:51], v[244:247]
    s_waitcnt lgkmcnt(3)
    v_rcp_f32 v233, v233
    v_mfma_f32_16x16x32_bf16 v[176:179], v[128:131], a[48:51], v[176:179]
    ds_read_b128 v[148:151], v10 offset:29696
    v_mul_f32 v233, v233, v169
    v_mfma_f32_16x16x32_bf16 v[176:179], v[132:135], a[56:59], v[176:179]
    s_cmp_lt_u32 s57, 4
    s_cbranch_scc1 L_slow_19
L_back_20:
    buffer_load_dwordx4 v1, s[4:7], s90 offen offset:2048 sc1 lds
    v_cvt_pk_bf16_f32 v52, v232, v233
    v_mfma_f32_16x16x32_bf16 v[184:187], v[132:135], a[60:63], v[184:187]
    ds_read_b128 v[152:155], v10 offset:30720
    v_mul_f32 v235, v235, v171
    v_mfma_f32_16x16x32_bf16 v[184:187], v[128:131], a[52:55], v[184:187]
    s_waitcnt lgkmcnt(3)
    v_exp_f32 v234, v234
    v_mfma_f32_16x16x32_bf16 v[188:191], v[136:139], a[52:55], v[188:191]
    ds_read_b128 v[156:159], v10 offset:31744
    v_fma_f32 v234, v234, v221, v221
    v_mfma_f32_16x16x32_bf16 v[188:191], v[140:143], a[60:63], v[188:191]
    s_waitcnt vmcnt(18)
    s_barrier
    v_mfma_f32_16x16x32_bf16 v[180:183], v[140:143], a[56:59], v[180:183]
    ds_read_b128 v[128:131], v10 offset:32768
    v_mul_f32 v228, v164, v164
    v_mfma_f32_16x16x32_bf16 v[180:183], v[136:139], a[48:51], v[180:183]
    s_waitcnt lgkmcnt(3)
    buffer_load_dwordx4 a[96:99], v12, s[4:7], s68 offen offset:2048 sc1
    s_waitcnt vmcnt(10)
    s_atomic_add s92, s[4:5], s72 offset:192
    v_fma_f32 v228, v228, v110, v108
    v_mfma_f32_16x16x32_bf16 v[64:67], v[144:147], a[48:51], v[64:67]
    ds_read_b128 v[132:135], v10 offset:33792
    v_mul_f32 v228, v228, v164
    v_mfma_f32_16x16x32_bf16 v[64:67], v[148:151], a[56:59], v[64:67]
    v_rcp_f32 v234, v234
    v_mfma_f32_16x16x32_bf16 v[72:75], v[148:151], a[60:63], v[72:75]
    ds_read_b128 v[136:139], v10 offset:34816
    v_mul_f32 v234, v234, v170
    v_mfma_f32_16x16x32_bf16 v[72:75], v[144:147], a[52:55], v[72:75]
    s_waitcnt lgkmcnt(3)
    v_exp_f32 v235, v235
    v_mfma_f32_16x16x32_bf16 v[76:79], v[152:155], a[52:55], v[76:79]
    ds_read_b128 v[140:143], v10 offset:35840
    v_fma_f32 v235, v235, v221, v221
    v_mfma_f32_16x16x32_bf16 v[76:79], v[156:159], a[60:63], v[76:79]
    buffer_load_dwordx4 a[100:103], v12, s[4:7], s68 offen offset:3072 sc1
    v_mul_f32 v229, v165, v165
    v_mfma_f32_16x16x32_bf16 v[68:71], v[156:159], a[56:59], v[68:71]
    ds_read_b128 v[144:147], v10 offset:36864
    v_fma_f32 v229, v229, v110, v108
    v_mfma_f32_16x16x32_bf16 v[68:71], v[152:155], a[48:51], v[68:71]
    s_waitcnt lgkmcnt(3)
    v_rcp_f32 v235, v235
    v_mfma_f32_16x16x32_bf16 v[112:115], v[128:131], a[64:67], v[112:115]
    ds_read_b128 v[148:151], v10 offset:37888
    v_mul_f32 v235, v235, v171
    v_mfma_f32_16x16x32_bf16 v[112:115], v[132:135], a[72:75], v[112:115]
    buffer_load_dwordx4 a[104:107], v12, s[4:7], s69 offen offset:2048 sc1
    v_cvt_pk_bf16_f32 v53, v234, v235
    v_mfma_f32_16x16x32_bf16 v[120:123], v[132:135], a[76:79], v[120:123]
    ds_read_b128 v[152:155], v10 offset:38912
    v_mul_f32 v229, v229, v165
    v_mfma_f32_16x16x32_bf16 v[120:123], v[128:131], a[68:71], v[120:123]
    s_waitcnt lgkmcnt(3)
    v_exp_f32 v228, v228
    v_mfma_f32_16x16x32_bf16 v[124:127], v[136:139], a[68:71], v[124:127]
    ds_read_b128 v[156:159], v10 offset:39936
    v_fma_f32 v228, v228, v220, v220
    v_mfma_f32_16x16x32_bf16 v[124:127], v[140:143], a[76:79], v[124:127]
    buffer_load_dwordx4 a[108:111], v12, s[4:7], s69 offen offset:3072 sc1
    v_mul_f32 v230, v166, v166
    v_mfma_f32_16x16x32_bf16 v[116:119], v[140:143], a[72:75], v[116:119]
    ds_read_b128 v[128:131], v10 offset:40960
    v_fma_f32 v230, v230, v110, v108
    v_mfma_f32_16x16x32_bf16 v[116:119], v[136:139], a[64:67], v[116:119]
    s_waitcnt lgkmcnt(3)
    v_rcp_f32 v228, v228
    v_mfma_f32_16x16x32_bf16 v[240:243], v[144:147], a[64:67], v[240:243]
    ds_read_b128 v[132:135], v10 offset:41984
    v_mul_f32 v228, v228, v164
    v_mfma_f32_16x16x32_bf16 v[240:243], v[148:151], a[72:75], v[240:243]
    v_exp_f32 v229, v229
    v_mfma_f32_16x16x32_bf16 v[248:251], v[148:151], a[76:79], v[248:251]
    ds_read_b128 v[136:139], v10 offset:43008
    v_fma_f32 v229, v229, v220, v220
    v_mfma_f32_16x16x32_bf16 v[248:251], v[144:147], a[68:71], v[248:251]
    s_waitcnt lgkmcnt(3)
    buffer_load_dwordx4 a[112:115], v12, s[4:7], s70 offen offset:2048 sc1
    v_mul_f32 v230, v230, v166
    v_mfma_f32_16x16x32_bf16 v[252:255], v[152:155], a[68:71], v[252:255]
    ds_read_b128 v[140:143], v10 offset:44032
    v_mul_f32 v231, v167, v167
    v_mfma_f32_16x16x32_bf16 v[252:255], v[156:159], a[76:79], v[252:255]
    v_rcp_f32 v229, v229
    v_mfma_f32_16x16x32_bf16 v[244:247], v[156:159], a[72:75], v[244:247]
    ds_read_b128 v[144:147], v10 offset:45056
    v_mul_f32 v229, v229, v165
    v_mfma_f32_16x16x32_bf16 v[244:247], v[152:155], a[64:67], v[244:247]
    s_waitcnt lgkmcnt(3)
    buffer_load_dwordx4 a[116:119], v12, s[4:7], s70 offen offset:3072 sc1
    v_cvt_pk_bf16_f32 v50, v228, v229
    v_mfma_f32_16x16x32_bf16 v[176:179], v[128:131], a[64:67], v[176:179]
    ds_read_b128 v[148:151], v10 offset:46080
    v_fma_f32 v231, v231, v110, v108
    v_mfma_f32_16x16x32_bf16 v[176:179], v[132:135], a[72:75], v[176:179]
    v_exp_f32 v230, v230
    v_mfma_f32_16x16x32_bf16 v[184:187], v[132:135], a[76:79], v[184:187]
    ds_read_b128 v[152:155], v10 offset:47104
    v_fma_f32 v230, v230, v220, v220
    v_mfma_f32_16x16x32_bf16 v[184:187], v[128:131], a[68:71], v[184:187]
    s_waitcnt lgkmcnt(3)
    v_rcp_f32 v230, v230
    v_mfma_f32_16x16x32_bf16 v[188:191], v[136:139], a[68:71], v[188:191]
    ds_read_b128 v[156:159], v10 offset:48128
    v_mul_f32 v230, v230, v166
    v_mfma_f32_16x16x32_bf16 v[188:191], v[140:143], a[76:79], v[188:191]
    buffer_load_dwordx4 a[120:123], v12, s[4:7], s71 offen offset:2048 sc1
    v_mul_f32 v231, v231, v167
    v_mfma_f32_16x16x32_bf16 v[180:183], v[140:143], a[72:75], v[180:183]
    ds_read_b128 v[128:131], v10 offset:49152
    v_mul_f32 v236, v172, v172
    v_mfma_f32_16x16x32_bf16 v[180:183], v[136:139], a[64:67], v[180:183]
    s_waitcnt lgkmcnt(3)
    v_exp_f32 v231, v231
    v_mfma_f32_16x16x32_bf16 v[64:67], v[144:147], a[64:67], v[64:67]
    ds_read_b128 v[132:135], v10 offset:50176
    v_fma_f32 v231, v231, v220, v220
    v_mfma_f32_16x16x32_bf16 v[64:67], v[148:151], a[72:75], v[64:67]
    buffer_load_dwordx4 a[124:127], v12, s[4:7], s71 offen offset:3072 sc1
    v_fma_f32 v236, v236, v111, v109
    v_mfma_f32_16x16x32_bf16 v[72:75], v[148:151], a[76:79], v[72:75]
    ds_read_b128 v[136:139], v10 offset:51200
    v_mul_f32 v236, v236, v172
    v_mfma_f32_16x16x32_bf16 v[72:75], v[144:147], a[68:71], v[72:75]
    s_waitcnt lgkmcnt(3)
    v_rcp_f32 v231, v231
    v_mfma_f32_16x16x32_bf16 v[76:79], v[152:155], a[68:71], v[76:79]
    ds_read_b128 v[140:143], v10 offset:52224
    v_mul_f32 v231, v231, v167
    v_mfma_f32_16x16x32_bf16 v[76:79], v[156:159], a[76:79], v[76:79]
    buffer_load_dwordx4 v1, s[4:7], s90 offen offset:3072 sc1 lds
    v_cvt_pk_bf16_f32 v51, v230, v231
    v_mfma_f32_16x16x32_bf16 v[68:71], v[156:159], a[72:75], v[68:71]
    ds_read_b128 v[144:147], v10 offset:53248
    v_mul_f32 v237, v173, v173
    v_mfma_f32_16x16x32_bf16 v[68:71], v[152:155], a[64:67], v[68:71]
    s_waitcnt lgkmcnt(3)
    s_add_u32 s93, s93, 4096
    buffer_store_dwordx4 v[48:51], v1, s[4:7], s93 offen offset:0 sc1
    v_fma_f32 v237, v237, v111, v109
    v_mfma_f32_16x16x32_bf16 v[112:115], v[128:131], a[80:83], v[112:115]
    ds_read_b128 v[148:151], v10 offset:54272
    v_mul_f32 v237, v237, v173
    v_mfma_f32_16x16x32_bf16 v[112:115], v[132:135], a[88:91], v[112:115]
    s_add_u32 m0, s96, 16384
    v_exp_f32 v236, v236
    v_mfma_f32_16x16x32_bf16 v[120:123], v[132:135], a[92:95], v[120:123]
    ds_read_b128 v[152:155], v10 offset:55296
    v_fma_f32 v236, v236, v221, v221
    v_mfma_f32_16x16x32_bf16 v[120:123], v[128:131], a[84:87], v[120:123]
    s_waitcnt lgkmcnt(3)
    v_rcp_f32 v236, v236
    v_mfma_f32_16x16x32_bf16 v[124:127], v[136:139], a[84:87], v[124:127]
    ds_read_b128 v[156:159], v10 offset:56320
    v_mul_f32 v236, v236, v172
    v_mfma_f32_16x16x32_bf16 v[124:127], v[140:143], a[92:95], v[124:127]
    s_add_u32 s90, s95, 606208
    v_exp_f32 v237, v237
    v_mfma_f32_16x16x32_bf16 v[116:119], v[140:143], a[88:91], v[116:119]
    ds_read_b128 v[128:131], v10 offset:57344
    v_fma_f32 v237, v237, v221, v221
    v_mfma_f32_16x16x32_bf16 v[116:119], v[136:139], a[80:83], v[116:119]
    s_waitcnt lgkmcnt(3)
    v_add_u32 v12, 4096, v12
    buffer_load_dwordx4 a[128:131], v12, s[4:7], s68 offen offset:0 sc1
    v_mul_f32 v238, v174, v174
    v_mfma_f32_16x16x32_bf16 v[240:243], v[144:147], a[80:83], v[240:243]
    ds_read_b128 v[132:135], v10 offset:58368
    v_fma_f32 v238, v238, v111, v109
    v_mfma_f32_16x16x32_bf16 v[240:243], v[148:151], a[88:91], v[240:243]
    v_rcp_f32 v237, v237
    v_mfma_f32_16x16x32_bf16 v[248:251], v[148:151], a[92:95], v[248:251]
    ds_read_b128 v[136:139], v10 offset:59392
    v_mul_f32 v237, v237, v173
    v_mfma_f32_16x16x32_bf16 v[248:251], v[144:147], a[84:87], v[248:251]
    s_waitcnt lgkmcnt(3)
    buffer_load_dwordx4 v1, s[4:7], s90 offen offset:0 sc1 lds
    v_cvt_pk_bf16_f32 v54, v236, v237
    v_mfma_f32_16x16x32_bf16 v[252:255], v[152:155], a[84:87], v[252:255]
    ds_read_b128 v[140:143], v10 offset:60416
    v_mul_f32 v238, v238, v174
    v_mfma_f32_16x16x32_bf16 v[252:255], v[156:159], a[92:95], v[252:255]
    v_exp_f32 v238, v238
    v_mfma_f32_16x16x32_bf16 v[244:247], v[156:159], a[88:91], v[244:247]
    ds_read_b128 v[144:147], v10 offset:61440
    v_fma_f32 v238, v238, v221, v221
    v_mfma_f32_16x16x32_bf16 v[244:247], v[152:155], a[80:83], v[244:247]
    s_waitcnt lgkmcnt(3)
    v_rcp_f32 v238, v238
    v_mfma_f32_16x16x32_bf16 v[176:179], v[128:131], a[80:83], v[176:179]
    ds_read_b128 v[148:151], v10 offset:62464
    v_mul_f32 v238, v238, v174
    v_mfma_f32_16x16x32_bf16 v[176:179], v[132:135], a[88:91], v[176:179]
    buffer_load_dwordx4 v1, s[4:7], s90 offen offset:1024 sc1 lds
    v_mul_f32 v239, v175, v175
    v_mfma_f32_16x16x32_bf16 v[184:187], v[132:135], a[92:95], v[184:187]
    ds_read_b128 v[152:155], v10 offset:63488
    v_fma_f32 v239, v239, v111, v109
    v_mfma_f32_16x16x32_bf16 v[184:187], v[128:131], a[84:87], v[184:187]
    s_waitcnt lgkmcnt(3)
    v_mul_f32 v239, v239, v175
    v_mfma_f32_16x16x32_bf16 v[188:191], v[136:139], a[84:87], v[188:191]
    ds_read_b128 v[156:159], v10 offset:64512
    v_mfma_f32_16x16x32_bf16 v[188:191], v[140:143], a[92:95], v[188:191]
    s_waitcnt vmcnt(16)
    s_barrier
    v_mfma_f32_16x16x32_bf16 v[180:183], v[140:143], a[88:91], v[180:183]
    ds_read_b128 v[128:131], v11 offset:0
    v_mfma_f32_16x16x32_bf16 v[180:183], v[136:139], a[80:83], v[180:183]
    s_waitcnt lgkmcnt(3)
    s_mov_b32 s57, 0
    s_atomic_add s57, s[4:5], s72 offset:192 glc
    buffer_load_dwordx4 v1, s[4:7], s90 offen offset:2048 sc1 lds
    v_mfma_f32_16x16x32_bf16 v[64:67], v[144:147], a[80:83], v[64:67]
    ds_read_b128 v[132:135], v11 offset:1024
    v_mfma_f32_16x16x32_bf16 v[64:67], v[148:151], a[88:91], v[64:67]
    v_exp_f32 v239, v239
    v_mfma_f32_16x16x32_bf16 v[72:75], v[148:151], a[92:95], v[72:75]
    ds_read_b128 v[136:139], v11 offset:2048
    v_fma_f32 v239, v239, v221, v221
    v_mfma_f32_16x16x32_bf16 v[72:75], v[144:147], a[84:87], v[72:75]
    s_waitcnt lgkmcnt(3)
    v_rcp_f32 v239, v239
    v_mfma_f32_16x16x32_bf16 v[76:79], v[152:155], a[84:87], v[76:79]
    ds_read_b128 v[140:143], v11 offset:3072
    v_mul_f32 v239, v239, v175
    v_mfma_f32_16x16x32_bf16 v[76:79], v[156:159], a[92:95], v[76:79]
    buffer_load_dwordx4 v1, s[4:7], s90 offen offset:3072 sc1 lds
    v_cvt_pk_bf16_f32 v55, v238, v239
    v_mfma_f32_16x16x32_bf16 v[68:71], v[156:159], a[88:91], v[68:71]
    ds_read_b128 v[144:147], v11 offset:4096
    v_mfma_f32_16x16x32_bf16 v[68:71], v[152:155], a[80:83], v[68:71]
    s_waitcnt vmcnt(11) lgkmcnt(3)
    buffer_store_dwordx4 v[52:55], v1, s[4:7], s93 offen offset:1024 sc1
    s_add_u32 m0, s96, 32768
    v_mfma_f32_16x16x32_bf16 v[112:115], v[128:131], a[96:99], v[112:115]
    ds_read_b128 v[148:151], v11 offset:5120
    s_add_u32 s90, s95, 622592
    v_mfma_f32_16x16x32_bf16 v[112:115], v[132:135], a[104:107], v[112:115]
    v_mfma_f32_16x16x32_bf16 v[120:123], v[132:135], a[108:111], v[120:123]
    ds_read_b128 v[152:155], v11 offset:6144
    v_mfma_f32_16x16x32_bf16 v[120:123], v[128:131], a[100:103], v[120:123]
    s_waitcnt lgkmcnt(3)
    v_mfma_f32_16x16x32_bf16 v[124:127], v[136:139], a[100:103], v[124:127]
    ds_read_b128 v[156:159], v11 offset:7168
    v_mfma_f32_16x16x32_bf16 v[124:127], v[140:143], a[108:111], v[124:127]
    buffer_load_dwordx4 a[132:135], v12, s[4:7], s68 offen offset:1024 sc1
    v_mfma_f32_16x16x32_bf16 v[116:119], v[140:143], a[104:107], v[116:119]
    ds_read_b128 v[128:131], v11 offset:8192
    v_mfma_f32_16x16x32_bf16 v[116:119], v[136:139], a[96:99], v[116:119]
    s_waitcnt lgkmcnt(3)
    v_mfma_f32_16x16x32_bf16 v[240:243], v[144:147], a[96:99], v[240:243]
    ds_read_b128 v[132:135], v11 offset:9216
    v_mfma_f32_16x16x32_bf16 v[240:243], v[148:151], a[104:107], v[240:243]
    buffer_load_dwordx4 a[136:139], v12, s[4:7], s69 offen offset:0 sc1
    v_mfma_f32_16x16x32_bf16 v[248:251], v[148:151], a[108:111], v[248:251]
    ds_read_b128 v[136:139], v11 offset:10240
    v_mfma_f32_16x16x32_bf16 v[248:251], v[144:147], a[100:103], v[248:251]
    s_waitcnt lgkmcnt(3)
    v_mfma_f32_16x16x32_bf16 v[252:255], v[152:155], a[100:103], v[252:255]
    ds_read_b128 v[140:143], v11 offset:11264
    v_mfma_f32_16x16x32_bf16 v[252:255], v[156:159], a[108:111], v[252:255]
    buffer_load_dwordx4 a[140:143], v12, s[4:7], s69 offen offset:1024 sc1
    v_mfma_f32_16x16x32_bf16 v[244:247], v[156:159], a[104:107], v[244:247]
    ds_read_b128 v[144:147], v11 offset:12288
    v_mfma_f32_16x16x32_bf16 v[244:247], v[152:155], a[96:99], v[244:247]
    s_waitcnt lgkmcnt(3)
    v_mfma_f32_16x16x32_bf16 v[176:179], v[128:131], a[96:99], v[176:179]
    ds_read_b128 v[148:151], v11 offset:13312
    v_mfma_f32_16x16x32_bf16 v[176:179], v[132:135], a[104:107], v[176:179]
    v_mfma_f32_16x16x32_bf16 v[184:187], v[132:135], a[108:111], v[184:187]
    ds_read_b128 v[152:155], v11 offset:14336
    v_mfma_f32_16x16x32_bf16 v[184:187], v[128:131], a[100:103], v[184:187]
    s_waitcnt lgkmcnt(3)
    buffer_load_dwordx4 a[144:147], v12, s[4:7], s70 offen offset:0 sc1
    v_mfma_f32_16x16x32_bf16 v[188:191], v[136:139], a[100:103], v[188:191]
    ds_read_b128 v[156:159], v11 offset:15360
    v_mfma_f32_16x16x32_bf16 v[188:191], v[140:143], a[108:111], v[188:191]
    v_mfma_f32_16x16x32_bf16 v[180:183], v[140:143], a[104:107], v[180:183]
    ds_read_b128 v[128:131], v11 offset:16384
    v_mfma_f32_16x16x32_bf16 v[180:183], v[136:139], a[96:99], v[180:183]
    s_waitcnt lgkmcnt(3)
    buffer_load_dwordx4 a[148:151], v12, s[4:7], s70 offen offset:1024 sc1
    v_mfma_f32_16x16x32_bf16 v[64:67], v[144:147], a[96:99], v[64:67]
    ds_read_b128 v[132:135], v11 offset:17408
    v_mfma_f32_16x16x32_bf16 v[64:67], v[148:151], a[104:107], v[64:67]
    v_mfma_f32_16x16x32_bf16 v[72:75], v[148:151], a[108:111], v[72:75]
    ds_read_b128 v[136:139], v11 offset:18432
    v_mfma_f32_16x16x32_bf16 v[72:75], v[144:147], a[100:103], v[72:75]
    s_waitcnt lgkmcnt(3)
    buffer_load_dwordx4 a[152:155], v12, s[4:7], s71 offen offset:0 sc1
    v_mfma_f32_16x16x32_bf16 v[76:79], v[152:155], a[100:103], v[76:79]
    ds_read_b128 v[140:143], v11 offset:19456
    v_mfma_f32_16x16x32_bf16 v[76:79], v[156:159], a[108:111], v[76:79]
    v_mfma_f32_16x16x32_bf16 v[68:71], v[156:159], a[104:107], v[68:71]
    ds_read_b128 v[144:147], v11 offset:20480
    v_mfma_f32_16x16x32_bf16 v[68:71], v[152:155], a[96:99], v[68:71]
    s_waitcnt vmcnt(14) lgkmcnt(3)
    buffer_load_dwordx4 a[156:159], v12, s[4:7], s71 offen offset:1024 sc1
    v_mfma_f32_16x16x32_bf16 v[112:115], v[128:131], a[112:115], v[112:115]
    ds_read_b128 v[148:151], v11 offset:21504
    v_mfma_f32_16x16x32_bf16 v[112:115], v[132:135], a[120:123], v[112:115]
    v_mfma_f32_16x16x32_bf16 v[120:123], v[132:135], a[124:127], v[120:123]
    ds_read_b128 v[152:155], v11 offset:22528
    v_mfma_f32_16x16x32_bf16 v[120:123], v[128:131], a[116:119], v[120:123]
    s_waitcnt lgkmcnt(3)
    s_cmp_lt_u32 s57, 4
    s_cbranch_scc1 L_slow_21
L_back_22:
    buffer_load_dwordx4 v1, s[4:7], s90 offen offset:0 sc1 lds
    v_mfma_f32_16x16x32_bf16 v[124:127], v[136:139], a[116:119], v[124:127]
    ds_read_b128 v[156:159], v11 offset:23552
    v_mfma_f32_16x16x32_bf16 v[124:127], v[140:143], a[124:127], v[124:127]
    v_mfma_f32_16x16x32_bf16 v[116:119], v[140:143], a[120:123], v[116:119]
    ds_read_b128 v[128:131], v11 offset:24576
    v_mfma_f32_16x16x32_bf16 v[116:119], v[136:139], a[112:115], v[116:119]
    s_waitcnt lgkmcnt(3)
    v_mfma_f32_16x16x32_bf16 v[240:243], v[144:147], a[112:115], v[240:243]
    ds_read_b128 v[132:135], v11 offset:25600
    v_mfma_f32_16x16x32_bf16 v[240:243], v[148:151], a[120:123], v[240:243]
    buffer_load_dwordx4 v1, s[4:7], s90 offen offset:1024 sc1 lds
    v_mfma_f32_16x16x32_bf16 v[248:251], v[148:151], a[124:127], v[248:251]
    ds_read_b128 v[136:139], v11 offset:26624
    v_mfma_f32_16x16x32_bf16 v[248:251], v[144:147], a[116:119], v[248:251]
    s_waitcnt lgkmcnt(3)
    v_mfma_f32_16x16x32_bf16 v[252:255], v[152:155], a[116:119], v[252:255]
    ds_read_b128 v[140:143], v11 offset:27648
    v_mfma_f32_16x16x32_bf16 v[252:255], v[156:159], a[124:127], v[252:255]
    buffer_load_dwordx4 v1, s[4:7], s90 offen offset:2048 sc1 lds
    v_mfma_f32_16x16x32_bf16 v[244:247], v[156:159], a[120:123], v[244:247]
    ds_read_b128 v[144:147], v11 offset:28672
    v_mfma_f32_16x16x32_bf16 v[244:247], v[152:155], a[112:115], v[244:247]
    s_waitcnt lgkmcnt(3)
    v_mfma_f32_16x16x32_bf16 v[176:179], v[128:131], a[112:115], v[176:179]
    ds_read_b128 v[148:151], v11 offset:29696
    v_mfma_f32_16x16x32_bf16 v[176:179], v[132:135], a[120:123], v[176:179]
    buffer_load_dwordx4 v1, s[4:7], s90 offen offset:3072 sc1 lds
    s_add_u32 m0, s96, 49152
    v_mfma_f32_16x16x32_bf16 v[184:187], v[132:135], a[124:127], v[184:187]
    ds_read_b128 v[152:155], v11 offset:30720
    s_add_u32 s90, s95, 638976
    v_mfma_f32_16x16x32_bf16 v[184:187], v[128:131], a[116:119], v[184:187]
    s_waitcnt lgkmcnt(3)
    s_waitcnt vmcnt(11)
    s_atomic_add s92, s[4:5], s72 offset:200
    v_mfma_f32_16x16x32_bf16 v[188:191], v[136:139], a[116:119], v[188:191]
    ds_read_b128 v[156:159], v11 offset:31744
    v_mfma_f32_16x16x32_bf16 v[188:191], v[140:143], a[124:127], v[188:191]
    s_barrier
    v_mfma_f32_16x16x32_bf16 v[180:183], v[140:143], a[120:123], v[180:183]
    ds_read_b128 v[128:131], v1 offset:0
    v_mfma_f32_16x16x32_bf16 v[180:183], v[136:139], a[112:115], v[180:183]
    s_waitcnt lgkmcnt(3)
    buffer_load_dwordx4 a[160:163], v12, s[4:7], s68 offen offset:2048 sc1
    v_mfma_f32_16x16x32_bf16 v[64:67], v[144:147], a[112:115], v[64:67]
    ds_read_b128 v[132:135], v1 offset:1024
    v_mfma_f32_16x16x32_bf16 v[64:67], v[148:151], a[120:123], v[64:67]
    v_mfma_f32_16x16x32_bf16 v[72:75], v[148:151], a[124:127], v[72:75]
    ds_read_b128 v[136:139], v1 offset:2048
    v_mfma_f32_16x16x32_bf16 v[72:75], v[144:147], a[116:119], v[72:75]
    s_waitcnt lgkmcnt(3)
    buffer_load_dwordx4 v1, s[4:7], s90 offen offset:0 sc1 lds
    v_mfma_f32_16x16x32_bf16 v[76:79], v[152:155], a[116:119], v[76:79]
    ds_read_b128 v[140:143], v1 offset:3072
    v_mfma_f32_16x16x32_bf16 v[76:79], v[156:159], a[124:127], v[76:79]
L_hop12:
    s_cbranch_execz L_hop16
    v_mfma_f32_16x16x32_bf16 v[68:71], v[156:159], a[120:123], v[68:71]
    ds_read_b128 v[144:147], v1 offset:4096
    v_mfma_f32_16x16x32_bf16 v[68:71], v[152:155], a[112:115], v[68:71]
    s_waitcnt vmcnt(10) lgkmcnt(3)
    buffer_load_dwordx4 v1, s[4:7], s90 offen offset:1024 sc1 lds
    v_mfma_f32_16x16x32_bf16 v[112:115], v[128:131], a[128:131], v[112:115]
    ds_read_b128 v[148:151], v1 offset:5120
    v_mfma_f32_16x16x32_bf16 v[112:115], v[132:135], a[136:139], v[112:115]
    v_mfma_f32_16x16x32_bf16 v[120:123], v[132:135], a[140:143], v[120:123]
    ds_read_b128 v[152:155], v1 offset:6144
    v_mfma_f32_16x16x32_bf16 v[120:123], v[128:131], a[132:135], v[120:123]
    s_waitcnt lgkmcnt(3)
    v_mfma_f32_16x16x32_bf16 v[124:127], v[136:139], a[132:135], v[124:127]
    ds_read_b128 v[156:159], v1 offset:7168
    v_mfma_f32_16x16x32_bf16 v[124:127], v[140:143], a[140:143], v[124:127]
    buffer_load_dwordx4 v1, s[4:7], s90 offen offset:2048 sc1 lds
    v_mfma_f32_16x16x32_bf16 v[116:119], v[140:143], a[136:139], v[116:119]
    ds_read_b128 v[128:131], v1 offset:8192
    v_mfma_f32_16x16x32_bf16 v[116:119], v[136:139], a[128:131], v[116:119]
    s_waitcnt lgkmcnt(3)
    v_mfma_f32_16x16x32_bf16 v[240:243], v[144:147], a[128:131], v[240:243]
    ds_read_b128 v[132:135], v1 offset:9216
    v_mfma_f32_16x16x32_bf16 v[240:243], v[148:151], a[136:139], v[240:243]
    buffer_load_dwordx4 v1, s[4:7], s90 offen offset:3072 sc1 lds
    s_add_u32 m0, s96, 65536
    v_mfma_f32_16x16x32_bf16 v[248:251], v[148:151], a[140:143], v[248:251]
    ds_read_b128 v[136:139], v1 offset:10240
    s_add_u32 s90, s95, 655360
    v_mfma_f32_16x16x32_bf16 v[248:251], v[144:147], a[132:135], v[248:251]
    s_waitcnt lgkmcnt(3)
    buffer_load_dwordx4 a[164:167], v12, s[4:7], s68 offen offset:3072 sc1
    v_mfma_f32_16x16x32_bf16 v[252:255], v[152:155], a[132:135], v[252:255]
    ds_read_b128 v[140:143], v1 offset:11264
    v_mfma_f32_16x16x32_bf16 v[252:255], v[156:159], a[140:143], v[252:255]
    s_mov_b32 s57, 0
    s_atomic_add s57, s[4:5], s72 offset:200 glc
    v_mfma_f32_16x16x32_bf16 v[244:247], v[156:159], a[136:139], v[244:247]
    ds_read_b128 v[144:147], v1 offset:12288
    v_mfma_f32_16x16x32_bf16 v[244:247], v[152:155], a[128:131], v[244:247]
    s_waitcnt lgkmcnt(3)
    buffer_load_dwordx4 a[168:171], v12, s[4:7], s69 offen offset:2048 sc1
    v_mfma_f32_16x16x32_bf16 v[176:179], v[128:131], a[128:131], v[176:179]
    ds_read_b128 v[148:151], v1 offset:13312
    v_mfma_f32_16x16x32_bf16 v[176:179], v[132:135], a[136:139], v[176:179]
    v_mfma_f32_16x16x32_bf16 v[184:187], v[132:135], a[140:143], v[184:187]
    ds_read_b128 v[152:155], v1 offset:14336
    v_mfma_f32_16x16x32_bf16 v[184:187], v[128:131], a[132:135], v[184:187]
    s_waitcnt lgkmcnt(3)
    buffer_load_dwordx4 a[172:175], v12, s[4:7], s69 offen offset:3072 sc1
    v_mfma_f32_16x16x32_bf16 v[188:191], v[136:139], a[132:135], v[188:191]
    ds_read_b128 v[156:159], v1 offset:15360
    v_mfma_f32_16x16x32_bf16 v[188:191], v[140:143], a[140:143], v[188:191]
    v_mfma_f32_16x16x32_bf16 v[180:183], v[140:143], a[136:139], v[180:183]
    ds_read_b128 v[128:131], v1 offset:16384
    v_mfma_f32_16x16x32_bf16 v[180:183], v[136:139], a[128:131], v[180:183]
    s_waitcnt lgkmcnt(3)
    v_mfma_f32_16x16x32_bf16 v[64:67], v[144:147], a[128:131], v[64:67]
    ds_read_b128 v[132:135], v1 offset:17408
    v_mfma_f32_16x16x32_bf16 v[64:67], v[148:151], a[136:139], v[64:67]
    buffer_load_dwordx4 a[176:179], v12, s[4:7], s70 offen offset:2048 sc1
    v_mfma_f32_16x16x32_bf16 v[72:75], v[148:151], a[140:143], v[72:75]
    ds_read_b128 v[136:139], v1 offset:18432
    v_mfma_f32_16x16x32_bf16 v[72:75], v[144:147], a[132:135], v[72:75]
    s_waitcnt lgkmcnt(3)
    v_mfma_f32_16x16x32_bf16 v[76:79], v[152:155], a[132:135], v[76:79]
    ds_read_b128 v[140:143], v1 offset:19456
    v_mfma_f32_16x16x32_bf16 v[76:79], v[156:159], a[140:143], v[76:79]
    v_mfma_f32_16x16x32_bf16 v[68:71], v[156:159], a[136:139], v[68:71]
    ds_read_b128 v[144:147], v1 offset:20480
    v_mfma_f32_16x16x32_bf16 v[68:71], v[152:155], a[128:131], v[68:71]
    s_waitcnt vmcnt(13) lgkmcnt(3)
    buffer_load_dwordx4 a[180:183], v12, s[4:7], s70 offen offset:3072 sc1
    v_mfma_f32_16x16x32_bf16 v[112:115], v[128:131], a[144:147], v[112:115]
    ds_read_b128 v[148:151], v1 offset:21504
    v_mfma_f32_16x16x32_bf16 v[112:115], v[132:135], a[152:155], v[112:115]
    v_mfma_f32_16x16x32_bf16 v[120:123], v[132:135], a[156:159], v[120:123]
    ds_read_b128 v[152:155], v1 offset:22528
    v_mfma_f32_16x16x32_bf16 v[120:123], v[128:131], a[148:151], v[120:123]
    s_waitcnt lgkmcnt(3)
    buffer_load_dwordx4 a[184:187], v12, s[4:7], s71 offen offset:2048 sc1
    v_mfma_f32_16x16x32_bf16 v[124:127], v[136:139], a[148:151], v[124:127]
    ds_read_b128 v[156:159], v1 offset:23552
    v_mfma_f32_16x16x32_bf16 v[124:127], v[140:143], a[156:159], v[124:127]
    v_mfma_f32_16x16x32_bf16 v[116:119], v[140:143], a[152:155], v[116:119]
    ds_read_b128 v[128:131], v1 offset:24576
    v_mfma_f32_16x16x32_bf16 v[116:119], v[136:139], a[144:147], v[116:119]
    s_waitcnt lgkmcnt(3)
    buffer_load_dwordx4 a[188:191], v12, s[4:7], s71 offen offset:3072 sc1
    v_mfma_f32_16x16x32_bf16 v[240:243], v[144:147], a[144:147], v[240:243]
    ds_read_b128 v[132:135], v1 offset:25600
    v_mfma_f32_16x16x32_bf16 v[240:243], v[148:151], a[152:155], v[240:243]
    v_mfma_f32_16x16x32_bf16 v[248:251], v[148:151], a[156:159], v[248:251]
    ds_read_b128 v[136:139], v1 offset:26624
    v_mfma_f32_16x16x32_bf16 v[248:251], v[144:147], a[148:151], v[248:251]
    s_waitcnt lgkmcnt(3)
    buffer_load_dwordx4 v1, s[4:7], s90 offen offset:0 sc1 lds
    v_mfma_f32_16x16x32_bf16 v[252:255], v[152:155], a[148:151], v[252:255]
    ds_read_b128 v[140:143], v1 offset:27648
    v_mfma_f32_16x16x32_bf16 v[252:255], v[156:159], a[156:159], v[252:255]
    v_mfma_f32_16x16x32_bf16 v[244:247], v[156:159], a[152:155], v[244:247]
    ds_read_b128 v[144:147], v1 offset:28672
    v_mfma_f32_16x16x32_bf16 v[244:247], v[152:155], a[144:147], v[244:247]
    s_waitcnt lgkmcnt(3)
    buffer_load_dwordx4 v1, s[4:7], s90 offen offset:1024 sc1 lds
    v_mfma_f32_16x16x32_bf16 v[176:179], v[128:131], a[144:147], v[176:179]
    ds_read_b128 v[148:151], v1 offset:29696
    v_mfma_f32_16x16x32_bf16 v[176:179], v[132:135], a[152:155], v[176:179]
    v_mfma_f32_16x16x32_bf16 v[184:187], v[132:135], a[156:159], v[184:187]
    ds_read_b128 v[152:155], v1 offset:30720
    v_mfma_f32_16x16x32_bf16 v[184:187], v[128:131], a[148:151], v[184:187]
    s_waitcnt lgkmcnt(3)
    buffer_load_dwordx4 v1, s[4:7], s90 offen offset:2048 sc1 lds
    v_mfma_f32_16x16x32_bf16 v[188:191], v[136:139], a[148:151], v[188:191]
    ds_read_b128 v[156:159], v1 offset:31744
    v_mfma_f32_16x16x32_bf16 v[188:191], v[140:143], a[156:159], v[188:191]
    s_waitcnt vmcnt(10)
    s_barrier
    v_mfma_f32_16x16x32_bf16 v[180:183], v[140:143], a[152:155], v[180:183]
    ds_read_b128 v[128:131], v1 offset:32768
    v_mfma_f32_16x16x32_bf16 v[180:183], v[136:139], a[144:147], v[180:183]
    s_waitcnt lgkmcnt(3)
    v_mfma_f32_16x16x32_bf16 v[64:67], v[144:147], a[144:147], v[64:67]
    ds_read_b128 v[132:135], v1 offset:33792
    v_mfma_f32_16x16x32_bf16 v[64:67], v[148:151], a[152:155], v[64:67]
    s_cmp_lt_u32 s57, 4
    s_cbranch_scc1 L_slow_23
L_back_24:
    buffer_load_dwordx4 v1, s[4:7], s90 offen offset:3072 sc1 lds
    s_add_u32 m0, s96, 81920
    v_mfma_f32_16x16x32_bf16 v[72:75], v[148:151], a[156:159], v[72:75]
    ds_read_b128 v[136:139], v1 offset:34816
    s_add_u32 s90, s95, 671744
    v_mfma_f32_16x16x32_bf16 v[72:75], v[144:147], a[148:151], v[72:75]
    s_waitcnt lgkmcnt(3)
    v_mfma_f32_16x16x32_bf16 v[76:79], v[152:155], a[148:151], v[76:79]
    ds_read_b128 v[140:143], v1 offset:35840
    v_mfma_f32_16x16x32_bf16 v[76:79], v[156:159], a[156:159], v[76:79]
    v_mfma_f32_16x16x32_bf16 v[68:71], v[156:159], a[152:155], v[68:71]
    ds_read_b128 v[144:147], v1 offset:36864
    v_mfma_f32_16x16x32_bf16 v[68:71], v[152:155], a[144:147], v[68:71]
    s_waitcnt vmcnt(8) lgkmcnt(3)
    v_add_u32 v12, 4096, v12
    buffer_load_dwordx4 a[192:195], v12, s[4:7], s68 offen offset:0 sc1
    v_mfma_f32_16x16x32_bf16 v[112:115], v[128:131], a[160:163], v[112:115]
    ds_read_b128 v[148:151], v1 offset:37888
    v_mfma_f32_16x16x32_bf16 v[112:115], v[132:135], a[168:171], v[112:115]
    v_mfma_f32_16x16x32_bf16 v[120:123], v[132:135], a[172:175], v[120:123]
    ds_read_b128 v[152:155], v1 offset:38912
    v_mfma_f32_16x16x32_bf16 v[120:123], v[128:131], a[164:167], v[120:123]
    s_waitcnt lgkmcnt(3)
    buffer_load_dwordx4 v1, s[4:7], s90 offen offset:0 sc1 lds
    v_mfma_f32_16x16x32_bf16 v[124:127], v[136:139], a[164:167], v[124:127]
    ds_read_b128 v[156:159], v1 offset:39936
    v_mfma_f32_16x16x32_bf16 v[124:127], v[140:143], a[172:175], v[124:127]
    v_mfma_f32_16x16x32_bf16 v[116:119], v[140:143], a[168:171], v[116:119]
    ds_read_b128 v[128:131], v1 offset:40960
    v_mfma_f32_16x16x32_bf16 v[116:119], v[136:139], a[160:163], v[116:119]
    s_waitcnt lgkmcnt(3)
    buffer_load_dwordx4 v1, s[4:7], s90 offen offset:1024 sc1 lds
    v_mfma_f32_16x16x32_bf16 v[240:243], v[144:147], a[160:163], v[240:243]
    ds_read_b128 v[132:135], v1 offset:41984
    v_mfma_f32_16x16x32_bf16 v[240:243], v[148:151], a[168:171], v[240:243]
    buffer_load_dwordx4 v1, s[4:7], s90 offen offset:2048 sc1 lds
    v_mfma_f32_16x16x32_bf16 v[248:251], v[148:151], a[172:175], v[248:251]
    ds_read_b128 v[136:139], v1 offset:43008
    v_mfma_f32_16x16x32_bf16 v[248:251], v[144:147], a[164:167], v[248:251]
    s_waitcnt lgkmcnt(3)
    buffer_load_dwordx4 v1, s[4:7], s90 offen offset:3072 sc1 lds
    s_add_u32 m0, s96, 98304
    v_mfma_f32_16x16x32_bf16 v[252:255], v[152:155], a[164:167], v[252:255]
    ds_read_b128 v[140:143], v1 offset:44032
    s_add_u32 s90, s95, 688128
    v_mfma_f32_16x16x32_bf16 v[252:255], v[156:159], a[172:175], v[252:255]
    buffer_load_dwordx4 a[196:199], v12, s[4:7], s68 offen offset:1024 sc1
    v_mfma_f32_16x16x32_bf16 v[244:247], v[156:159], a[168:171], v[244:247]
    ds_read_b128 v[144:147], v1 offset:45056
    v_mfma_f32_16x16x32_bf16 v[244:247], v[152:155], a[160:163], v[244:247]
    s_waitcnt lgkmcnt(3)
    buffer_load_dwordx4 a[200:203], v12, s[4:7], s69 offen offset:0 sc1
    v_mfma_f32_16x16x32_bf16 v[176:179], v[128:131], a[160:163], v[176:179]
    ds_read_b128 v[148:151], v1 offset:46080
    v_mfma_f32_16x16x32_bf16 v[176:179], v[132:135], a[168:171], v[176:179]
    v_mfma_f32_16x16x32_bf16 v[184:187], v[132:135], a[172:175], v[184:187]
    ds_read_b128 v[152:155], v1 offset:47104
    v_mfma_f32_16x16x32_bf16 v[184:187], v[128:131], a[164:167], v[184:187]
    s_waitcnt lgkmcnt(3)
    buffer_load_dwordx4 a[204:207], v12, s[4:7], s69 offen offset:1024 sc1
    v_mfma_f32_16x16x32_bf16 v[188:191], v[136:139], a[164:167], v[188:191]
    ds_read_b128 v[156:159], v1 offset:48128
    v_mfma_f32_16x16x32_bf16 v[188:191], v[140:143], a[172:175], v[188:191]
    v_mfma_f32_16x16x32_bf16 v[180:183], v[140:143], a[168:171], v[180:183]
    ds_read_b128 v[128:131], v1 offset:49152
    v_mfma_f32_16x16x32_bf16 v[180:183], v[136:139], a[160:163], v[180:183]
    s_waitcnt lgkmcnt(3)
    v_mfma_f32_16x16x32_bf16 v[64:67], v[144:147], a[160:163], v[64:67]
    ds_read_b128 v[132:135], v1 offset:50176
    v_mfma_f32_16x16x32_bf16 v[64:67], v[148:151], a[168:171], v[64:67]
    v_mfma_f32_16x16x32_bf16 v[72:75], v[148:151], a[172:175], v[72:75]
    ds_read_b128 v[136:139], v1 offset:51200
    v_mfma_f32_16x16x32_bf16 v[72:75], v[144:147], a[164:167], v[72:75]
    s_waitcnt lgkmcnt(3)
    v_mfma_f32_16x16x32_bf16 v[76:79], v[152:155], a[164:167], v[76:79]
    ds_read_b128 v[140:143], v1 offset:52224
    v_mfma_f32_16x16x32_bf16 v[76:79], v[156:159], a[172:175], v[76:79]
    buffer_load_dwordx4 a[208:211], v12, s[4:7], s70 offen offset:0 sc1
    v_mfma_f32_16x16x32_bf16 v[68:71], v[156:159], a[168:171], v[68:71]
    ds_read_b128 v[144:147], v1 offset:53248
    v_mfma_f32_16x16x32_bf16 v[68:71], v[152:155], a[160:163], v[68:71]
    s_waitcnt vmcnt(13) lgkmcnt(3)
    v_mfma_f32_16x16x32_bf16 v[112:115], v[128:131], a[176:179], v[112:115]
    ds_read_b128 v[148:151], v1 offset:54272
    v_mfma_f32_16x16x32_bf16 v[112:115], v[132:135], a[184:187], v[112:115]
    buffer_load_dwordx4 a[212:215], v12, s[4:7], s70 offen offset:1024 sc1
    v_mfma_f32_16x16x32_bf16 v[120:123], v[132:135], a[188:191], v[120:123]
    ds_read_b128 v[152:155], v1 offset:55296
    v_mfma_f32_16x16x32_bf16 v[120:123], v[128:131], a[180:183], v[120:123]
    s_waitcnt lgkmcnt(3)
    v_mfma_f32_16x16x32_bf16 v[124:127], v[136:139], a[180:183], v[124:127]
    ds_read_b128 v[156:159], v1 offset:56320
    v_mfma_f32_16x16x32_bf16 v[124:127], v[140:143], a[188:191], v[124:127]
    buffer_load_dwordx4 a[216:219], v12, s[4:7], s71 offen offset:0 sc1
    v_mfma_f32_16x16x32_bf16 v[116:119], v[140:143], a[184:187], v[116:119]
    ds_read_b128 v[128:131], v1 offset:57344
    v_mfma_f32_16x16x32_bf16 v[116:119], v[136:139], a[176:179], v[116:119]
    s_waitcnt lgkmcnt(3)
    v_mfma_f32_16x16x32_bf16 v[240:243], v[144:147], a[176:179], v[240:243]
    ds_read_b128 v[132:135], v1 offset:58368
    v_mfma_f32_16x16x32_bf16 v[240:243], v[148:151], a[184:187], v[240:243]
    buffer_load_dwordx4 a[220:223], v12, s[4:7], s71 offen offset:1024 sc1
    v_mfma_f32_16x16x32_bf16 v[248:251], v[148:151], a[188:191], v[248:251]
    ds_read_b128 v[136:139], v1 offset:59392
    v_mfma_f32_16x16x32_bf16 v[248:251], v[144:147], a[180:183], v[248:251]
    s_waitcnt lgkmcnt(3)
    v_mfma_f32_16x16x32_bf16 v[252:255], v[152:155], a[180:183], v[252:255]
    ds_read_b128 v[140:143], v1 offset:60416
    v_mfma_f32_16x16x32_bf16 v[252:255], v[156:159], a[188:191], v[252:255]
    v_mfma_f32_16x16x32_bf16 v[244:247], v[156:159], a[184:187], v[244:247]
    ds_read_b128 v[144:147], v1 offset:61440
    v_mfma_f32_16x16x32_bf16 v[244:247], v[152:155], a[176:179], v[244:247]
    s_waitcnt lgkmcnt(3)
    buffer_load_dwordx4 v1, s[4:7], s90 offen offset:0 sc1 lds
    v_mfma_f32_16x16x32_bf16 v[176:179], v[128:131], a[176:179], v[176:179]
    ds_read_b128 v[148:151], v1 offset:62464
    v_mfma_f32_16x16x32_bf16 v[176:179], v[132:135], a[184:187], v[176:179]
    v_mfma_f32_16x16x32_bf16 v[184:187], v[132:135], a[188:191], v[184:187]
    ds_read_b128 v[152:155], v1 offset:63488
    v_mfma_f32_16x16x32_bf16 v[184:187], v[128:131], a[180:183], v[184:187]
    s_waitcnt lgkmcnt(3)
    buffer_load_dwordx4 v1, s[4:7], s90 offen offset:1024 sc1 lds
    v_mfma_f32_16x16x32_bf16 v[188:191], v[136:139], a[180:183], v[188:191]
    ds_read_b128 v[156:159], v1 offset:64512
    v_mfma_f32_16x16x32_bf16 v[188:191], v[140:143], a[188:191], v[188:191]
    s_waitcnt vmcnt(9)
    s_barrier
    v_mfma_f32_16x16x32_bf16 v[180:183], v[140:143], a[184:187], v[180:183]
    ds_read_b128 v[128:131], v10 offset:0
    v_mfma_f32_16x16x32_bf16 v[180:183], v[136:139], a[176:179], v[180:183]
    s_waitcnt lgkmcnt(3)
    v_mfma_f32_16x16x32_bf16 v[64:67], v[144:147], a[176:179], v[64:67]
    ds_read_b128 v[132:135], v10 offset:1024
    v_mfma_f32_16x16x32_bf16 v[64:67], v[148:151], a[184:187], v[64:67]
    buffer_load_dwordx4 v1, s[4:7], s90 offen offset:2048 sc1 lds
    v_mfma_f32_16x16x32_bf16 v[72:75], v[148:151], a[188:191], v[72:75]
    ds_read_b128 v[136:139], v10 offset:2048
    v_mfma_f32_16x16x32_bf16 v[72:75], v[144:147], a[180:183], v[72:75]
    s_waitcnt lgkmcnt(3)
    buffer_load_dwordx4 v1, s[4:7], s90 offen offset:3072 sc1 lds
    s_add_u32 m0, s96, 114688
    v_mfma_f32_16x16x32_bf16 v[76:79], v[152:155], a[180:183], v[76:79]
    ds_read_b128 v[140:143], v10 offset:3072
    s_add_u32 s90, s95, 704512
    v_mfma_f32_16x16x32_bf16 v[76:79], v[156:159], a[188:191], v[76:79]
    v_mfma_f32_16x16x32_bf16 v[68:71], v[156:159], a[184:187], v[68:71]
    ds_read_b128 v[144:147], v10 offset:4096
    v_mfma_f32_16x16x32_bf16 v[68:71], v[152:155], a[176:179], v[68:71]
    s_waitcnt vmcnt(8) lgkmcnt(3)
    v_mfma_f32_16x16x32_bf16 v[112:115], v[128:131], a[192:195], v[112:115]
    ds_read_b128 v[148:151], v10 offset:5120
    v_mfma_f32_16x16x32_bf16 v[112:115], v[132:135], a[200:203], v[112:115]
    buffer_load_dwordx4 v1, s[4:7], s90 offen offset:0 sc1 lds
    v_mfma_f32_16x16x32_bf16 v[120:123], v[132:135], a[204:207], v[120:123]
    ds_read_b128 v[152:155], v10 offset:6144
    v_mfma_f32_16x16x32_bf16 v[120:123], v[128:131], a[196:199], v[120:123]
    s_waitcnt lgkmcnt(3)
    v_mfma_f32_16x16x32_bf16 v[124:127], v[136:139], a[196:199], v[124:127]
    ds_read_b128 v[156:159], v10 offset:7168
    v_mfma_f32_16x16x32_bf16 v[124:127], v[140:143], a[204:207], v[124:127]
    buffer_load_dwordx4 v1, s[4:7], s90 offen offset:1024 sc1 lds
    v_mfma_f32_16x16x32_bf16 v[116:119], v[140:143], a[200:203], v[116:119]
    ds_read_b128 v[128:131], v10 offset:8192
    v_mfma_f32_16x16x32_bf16 v[116:119], v[136:139], a[192:195], v[116:119]
    s_waitcnt lgkmcnt(3)
    v_mfma_f32_16x16x32_bf16 v[240:243], v[144:147], a[192:195], v[240:243]
    ds_read_b128 v[132:135], v10 offset:9216
    v_mfma_f32_16x16x32_bf16 v[240:243], v[148:151], a[200:203], v[240:243]
    buffer_load_dwordx4 v1, s[4:7], s90 offen offset:2048 sc1 lds
    v_mfma_f32_16x16x32_bf16 v[248:251], v[148:151], a[204:207], v[248:251]
    ds_read_b128 v[136:139], v10 offset:10240
    v_mfma_f32_16x16x32_bf16 v[248:251], v[144:147], a[196:199], v[248:251]
    s_waitcnt lgkmcnt(3)
    buffer_load_dwordx4 v1, s[4:7], s90 offen offset:3072 sc1 lds
    s_add_u32 m0, s96, 131072
    v_mfma_f32_16x16x32_bf16 v[252:255], v[152:155], a[196:199], v[252:255]
    ds_read_b128 v[140:143], v10 offset:11264
    s_add_u32 s90, s95, 720896
    v_mfma_f32_16x16x32_bf16 v[252:255], v[156:159], a[204:207], v[252:255]
    v_mfma_f32_16x16x32_bf16 v[244:247], v[156:159], a[200:203], v[244:247]
    ds_read_b128 v[144:147], v10 offset:12288
    v_mfma_f32_16x16x32_bf16 v[244:247], v[152:155], a[192:195], v[244:247]
    s_waitcnt lgkmcnt(3)
    v_mfma_f32_16x16x32_bf16 v[176:179], v[128:131], a[192:195], v[176:179]
    ds_read_b128 v[148:151], v10 offset:13312
    v_mfma_f32_16x16x32_bf16 v[176:179], v[132:135], a[200:203], v[176:179]
    v_mfma_f32_16x16x32_bf16 v[184:187], v[132:135], a[204:207], v[184:187]
    ds_read_b128 v[152:155], v10 offset:14336
    v_mfma_f32_16x16x32_bf16 v[184:187], v[128:131], a[196:199], v[184:187]
    s_waitcnt lgkmcnt(3)
    buffer_load_dwordx4 v1, s[4:7], s90 offen offset:0 sc1 lds
    v_mfma_f32_16x16x32_bf16 v[188:191], v[136:139], a[196:199], v[188:191]
    ds_read_b128 v[156:159], v10 offset:15360
    v_mfma_f32_16x16x32_bf16 v[188:191], v[140:143], a[204:207], v[188:191]
    v_mfma_f32_16x16x32_bf16 v[180:183], v[140:143], a[200:203], v[180:183]
    ds_read_b128 v[128:131], v10 offset:16384
    v_mfma_f32_16x16x32_bf16 v[180:183], v[136:139], a[192:195], v[180:183]
    s_waitcnt lgkmcnt(3)
    buffer_load_dwordx4 v1, s[4:7], s90 offen offset:1024 sc1 lds
    v_mfma_f32_16x16x32_bf16 v[64:67], v[144:147], a[192:195], v[64:67]
    ds_read_b128 v[132:135], v10 offset:17408
    v_mfma_f32_16x16x32_bf16 v[64:67], v[148:151], a[200:203], v[64:67]
    v_mfma_f32_16x16x32_bf16 v[72:75], v[148:151], a[204:207], v[72:75]
    ds_read_b128 v[136:139], v10 offset:18432
    v_mfma_f32_16x16x32_bf16 v[72:75], v[144:147], a[196:199], v[72:75]
    s_waitcnt lgkmcnt(3)
    buffer_load_dwordx4 v1, s[4:7], s90 offen offset:2048 sc1 lds
    v_mfma_f32_16x16x32_bf16 v[76:79], v[152:155], a[196:199], v[76:79]
    ds_read_b128 v[140:143], v10 offset:19456
    v_mfma_f32_16x16x32_bf16 v[76:79], v[156:159], a[204:207], v[76:79]
    v_mfma_f32_16x16x32_bf16 v[68:71], v[156:159], a[200:203], v[68:71]
    ds_read_b128 v[144:147], v10 offset:20480
    v_mfma_f32_16x16x32_bf16 v[68:71], v[152:155], a[192:195], v[68:71]
    s_waitcnt vmcnt(11) lgkmcnt(3)
    buffer_load_dwordx4 v1, s[4:7], s90 offen offset:3072 sc1 lds
    s_add_u32 m0, s96, 147456
    v_mfma_f32_16x16x32_bf16 v[112:115], v[128:131], a[208:211], v[112:115]
    ds_read_b128 v[148:151], v10 offset:21504
    s_add_u32 s90, s95, 737280
    v_mfma_f32_16x16x32_bf16 v[112:115], v[132:135], a[216:219], v[112:115]
    v_mfma_f32_16x16x32_bf16 v[120:123], v[132:135], a[220:223], v[120:123]
    ds_read_b128 v[152:155], v10 offset:22528
    v_mfma_f32_16x16x32_bf16 v[120:123], v[128:131], a[212:215], v[120:123]
    s_waitcnt lgkmcnt(3)
    v_mfma_f32_16x16x32_bf16 v[124:127], v[136:139], a[212:215], v[124:127]
    ds_read_b128 v[156:159], v10 offset:23552
    v_mfma_f32_16x16x32_bf16 v[124:127], v[140:143], a[220:223], v[124:127]
    buffer_load_dwordx4 v1, s[4:7], s90 offen offset:0 sc1 lds
    v_mfma_f32_16x16x32_bf16 v[116:119], v[140:143], a[216:219], v[116:119]
    ds_read_b128 v[128:131], v10 offset:24576
    v_mfma_f32_16x16x32_bf16 v[116:119], v[136:139], a[208:211], v[116:119]
    s_waitcnt lgkmcnt(3)
    v_mfma_f32_16x16x32_bf16 v[240:243], v[144:147], a[208:211], v[240:243]
    ds_read_b128 v[132:135], v10 offset:25600
    v_mfma_f32_16x16x32_bf16 v[240:243], v[148:151], a[216:219], v[240:243]
    buffer_load_dwordx4 v1, s[4:7], s90 offen offset:1024 sc1 lds
    v_mfma_f32_16x16x32_bf16 v[248:251], v[148:151], a[220:223], v[248:251]
    ds_read_b128 v[136:139], v10 offset:26624
    v_mfma_f32_16x16x32_bf16 v[248:251], v[144:147], a[212:215], v[248:251]
    s_waitcnt lgkmcnt(3)
    v_mfma_f32_16x16x32_bf16 v[252:255], v[152:155], a[212:215], v[252:255]
    ds_read_b128 v[140:143], v10 offset:27648
    v_mfma_f32_16x16x32_bf16 v[252:255], v[156:159], a[220:223], v[252:255]
    buffer_load_dwordx4 v1, s[4:7], s90 offen offset:2048 sc1 lds
    v_mfma_f32_16x16x32_bf16 v[244:247], v[156:159], a[216:219], v[244:247]
    ds_read_b128 v[144:147], v10 offset:28672
    v_mfma_f32_16x16x32_bf16 v[244:247], v[152:155], a[208:211], v[244:247]
    s_waitcnt lgkmcnt(3)
    v_mfma_f32_16x16x32_bf16 v[176:179], v[128:131], a[208:211], v[176:179]
    ds_read_b128 v[148:151], v10 offset:29696
    v_mfma_f32_16x16x32_bf16 v[176:179], v[132:135], a[216:219], v[176:179]
    buffer_load_dwordx4 v1, s[4:7], s90 offen offset:3072 sc1 lds
    s_add_u32 m0, s96, 0
    v_mfma_f32_16x16x32_bf16 v[184:187], v[132:135], a[220:223], v[184:187]
    ds_read_b128 v[152:155], v10 offset:30720
    s_add_u32 s90, s95, 753664
    v_mfma_f32_16x16x32_bf16 v[184:187], v[128:131], a[212:215], v[184:187]
    s_waitcnt lgkmcnt(3)
    v_mfma_f32_16x16x32_bf16 v[188:191], v[136:139], a[212:215], v[188:191]
    ds_read_b128 v[156:159], v10 offset:31744
    v_mfma_f32_16x16x32_bf16 v[188:191], v[140:143], a[220:223], v[188:191]
    s_waitcnt vmcnt(8)
    s_barrier
    v_mfma_f32_16x16x32_bf16 v[180:183], v[140:143], a[216:219], v[180:183]
    ds_read_b128 v[128:131], v10 offset:32768
    v_mfma_f32_16x16x32_bf16 v[180:183], v[136:139], a[208:211], v[180:183]
    s_waitcnt lgkmcnt(3)
    buffer_load_dwordx4 v1, s[4:7], s90 offen offset:0 sc1 lds
    v_mfma_f32_16x16x32_bf16 v[64:67], v[144:147], a[208:211], v[64:67]
    ds_read_b128 v[132:135], v10 offset:33792
    v_mfma_f32_16x16x32_bf16 v[64:67], v[148:151], a[216:219], v[64:67]
    v_mfma_f32_16x16x32_bf16 v[72:75], v[148:151], a[220:223], v[72:75]
    ds_read_b128 v[136:139], v10 offset:34816
    v_mfma_f32_16x16x32_bf16 v[72:75], v[144:147], a[212:215], v[72:75]
    s_waitcnt lgkmcnt(3)
    v_mfma_f32_16x16x32_bf16 v[76:79], v[152:155], a[212:215], v[76:79]
    ds_read_b128 v[140:143], v10 offset:35840
    v_mfma_f32_16x16x32_bf16 v[76:79], v[156:159], a[220:223], v[76:79]
    buffer_load_dwordx4 v1, s[4:7], s90 offen offset:1024 sc1 lds
    v_mfma_f32_16x16x32_bf16 v[68:71], v[156:159], a[216:219], v[68:71]
    ds_read_b128 v[144:147], v10 offset:36864
    v_mfma_f32_16x16x32_bf16 v[68:71], v[152:155], a[208:211], v[68:71]
    s_waitcnt lgkmcnt(3)
    v_mfma_f32_16x16x32_bf16 v[80:83], v[128:131], a[0:3], 0
    ds_read_b128 v[148:151], v10 offset:37888
    v_mfma_f32_16x16x32_bf16 v[80:83], v[132:135], a[8:11], v[80:83]
    buffer_load_dwordx4 v1, s[4:7], s90 offen offset:2048 sc1 lds
    v_mfma_f32_16x16x32_bf16 v[88:91], v[132:135], a[12:15], 0
    ds_read_b128 v[152:155], v10 offset:38912
    v_mfma_f32_16x16x32_bf16 v[88:91], v[128:131], a[4:7], v[88:91]
    s_waitcnt lgkmcnt(3)
    v_mfma_f32_16x16x32_bf16 v[88:91], v[136:139], a[20:23], v[88:91]
    ds_read_b128 v[156:159], v10 offset:39936
    v_cvt_pk_bf16_f32 v48, v112, v113
    v_mfma_f32_16x16x32_bf16 v[88:91], v[140:143], a[28:31], v[88:91]
    buffer_load_dwordx4 v1, s[4:7], s90 offen offset:3072 sc1 lds
    s_add_u32 m0, s96, 16384
    v_mfma_f32_16x16x32_bf16 v[80:83], v[140:143], a[24:27], v[80:83]
    ds_read_b128 v[128:131], v10 offset:40960
    s_add_u32 s90, s95, 770048
    v_mfma_f32_16x16x32_bf16 v[80:83], v[136:139], a[16:19], v[80:83]
    s_waitcnt lgkmcnt(3)
    v_cvt_pk_bf16_f32 v49, v114, v115
    v_cvt_pk_bf16_f32 v50, v116, v117
    v_mfma_f32_16x16x32_bf16 v[80:83], v[144:147], a[32:35], v[80:83]
    ds_read_b128 v[132:135], v10 offset:41984
    v_cvt_pk_bf16_f32 v51, v118, v119
    v_mfma_f32_16x16x32_bf16 v[80:83], v[148:151], a[40:43], v[80:83]
    buffer_store_dwordx4 v[48:51], v1, s[4:7], s80 offen offset:0 sc1
    v_cvt_pk_bf16_f32 v52, v120, v121
    v_mfma_f32_16x16x32_bf16 v[88:91], v[148:151], a[44:47], v[88:91]
    ds_read_b128 v[136:139], v10 offset:43008
    v_cvt_pk_bf16_f32 v53, v122, v123
    v_mfma_f32_16x16x32_bf16 v[88:91], v[144:147], a[36:39], v[88:91]
    s_waitcnt lgkmcnt(3)
    v_cvt_pk_bf16_f32 v54, v124, v125
    v_cvt_pk_bf16_f32 v55, v126, v127
    v_mfma_f32_16x16x32_bf16 v[88:91], v[152:155], a[52:55], v[88:91]
    ds_read_b128 v[140:143], v10 offset:44032
    v_cvt_pk_bf16_f32 v56, v240, v241
    v_mfma_f32_16x16x32_bf16 v[88:91], v[156:159], a[60:63], v[88:91]
    v_cvt_pk_bf16_f32 v57, v242, v243
    v_cvt_pk_bf16_f32 v58, v244, v245
    v_mfma_f32_16x16x32_bf16 v[80:83], v[156:159], a[56:59], v[80:83]
    ds_read_b128 v[144:147], v10 offset:45056
    v_cvt_pk_bf16_f32 v59, v246, v247
    v_mfma_f32_16x16x32_bf16 v[80:83], v[152:155], a[48:51], v[80:83]
    s_waitcnt lgkmcnt(3)
    buffer_load_dwordx4 v1, s[4:7], s90 offen offset:0 sc1 lds
    v_cvt_pk_bf16_f32 v60, v248, v249
    v_mfma_f32_16x16x32_bf16 v[80:83], v[128:131], a[64:67], v[80:83]
    ds_read_b128 v[148:151], v10 offset:46080
    v_cvt_pk_bf16_f32 v61, v250, v251
    v_mfma_f32_16x16x32_bf16 v[80:83], v[132:135], a[72:75], v[80:83]
    v_cvt_pk_bf16_f32 v62, v252, v253
    v_cvt_pk_bf16_f32 v63, v254, v255
    v_mfma_f32_16x16x32_bf16 v[88:91], v[132:135], a[76:79], v[88:91]
    ds_read_b128 v[152:155], v10 offset:47104
    v_cvt_pk_bf16_f32 v224, v176, v177
    v_mfma_f32_16x16x32_bf16 v[88:91], v[128:131], a[68:71], v[88:91]
    s_waitcnt lgkmcnt(3)
    buffer_load_dwordx4 v1, s[4:7], s90 offen offset:1024 sc1 lds
    v_cvt_pk_bf16_f32 v225, v178, v179
    v_mfma_f32_16x16x32_bf16 v[88:91], v[136:139], a[84:87], v[88:91]
    ds_read_b128 v[156:159], v10 offset:48128
    v_cvt_pk_bf16_f32 v226, v180, v181
    v_mfma_f32_16x16x32_bf16 v[88:91], v[140:143], a[92:95], v[88:91]
    v_cvt_pk_bf16_f32 v227, v182, v183
    v_cvt_pk_bf16_f32 v228, v184, v185
    v_mfma_f32_16x16x32_bf16 v[80:83], v[140:143], a[88:91], v[80:83]
    ds_read_b128 v[128:131], v10 offset:49152
    v_cvt_pk_bf16_f32 v229, v186, v187
    v_mfma_f32_16x16x32_bf16 v[80:83], v[136:139], a[80:83], v[80:83]
    s_waitcnt lgkmcnt(3)
    v_cvt_pk_bf16_f32 v230, v188, v189
    v_cvt_pk_bf16_f32 v231, v190, v191
    v_mfma_f32_16x16x32_bf16 v[80:83], v[144:147], a[96:99], v[80:83]
    ds_read_b128 v[132:135], v10 offset:50176
    v_cvt_pk_bf16_f32 v232, v64, v65
    v_mfma_f32_16x16x32_bf16 v[80:83], v[148:151], a[104:107], v[80:83]
    buffer_load_dwordx4 v1, s[4:7], s90 offen offset:2048 sc1 lds
    v_cvt_pk_bf16_f32 v233, v66, v67
    v_mfma_f32_16x16x32_bf16 v[88:91], v[148:151], a[108:111], v[88:91]
    ds_read_b128 v[136:139], v10 offset:51200
    v_cvt_pk_bf16_f32 v234, v68, v69
    v_mfma_f32_16x16x32_bf16 v[88:91], v[144:147], a[100:103], v[88:91]
    s_waitcnt lgkmcnt(3)
    v_cvt_pk_bf16_f32 v235, v70, v71
    v_cvt_pk_bf16_f32 v236, v72, v73
    v_mfma_f32_16x16x32_bf16 v[88:91], v[152:155], a[116:119], v[88:91]
    ds_read_b128 v[140:143], v10 offset:52224
    v_cvt_pk_bf16_f32 v237, v74, v75
    v_mfma_f32_16x16x32_bf16 v[88:91], v[156:159], a[124:127], v[88:91]
    buffer_load_dwordx4 v1, s[4:7], s90 offen offset:3072 sc1 lds
    s_add_u32 m0, s96, 32768
    v_mfma_f32_16x16x32_bf16 v[80:83], v[156:159], a[120:123], v[80:83]
    ds_read_b128 v[144:147], v10 offset:53248
    s_add_u32 s90, s95, 786432
    v_mfma_f32_16x16x32_bf16 v[80:83], v[152:155], a[112:115], v[80:83]
    s_waitcnt lgkmcnt(3)
    v_cvt_pk_bf16_f32 v238, v76, v77
    v_cvt_pk_bf16_f32 v239, v78, v79
    v_mfma_f32_16x16x32_bf16 v[80:83], v[128:131], a[128:131], v[80:83]
    ds_read_b128 v[148:151], v10 offset:54272
    v_mfma_f32_16x16x32_bf16 v[80:83], v[132:135], a[136:139], v[80:83]
    buffer_store_dwordx4 v[52:55], v1, s[4:7], s80 offen offset:1024 sc1
    v_mfma_f32_16x16x32_bf16 v[88:91], v[132:135], a[140:143], v[88:91]
    ds_read_b128 v[152:155], v10 offset:55296
    v_mfma_f32_16x16x32_bf16 v[88:91], v[128:131], a[132:135], v[88:91]
    s_waitcnt lgkmcnt(3)
    v_mfma_f32_16x16x32_bf16 v[88:91], v[136:139], a[148:151], v[88:91]
    ds_read_b128 v[156:159], v10 offset:56320
    v_mfma_f32_16x16x32_bf16 v[88:91], v[140:143], a[156:159], v[88:91]
    v_mfma_f32_16x16x32_bf16 v[80:83], v[140:143], a[152:155], v[80:83]
    ds_read_b128 v[128:131], v10 offset:57344
    v_mfma_f32_16x16x32_bf16 v[80:83], v[136:139], a[144:147], v[80:83]
    s_waitcnt lgkmcnt(3)
    buffer_load_dwordx4 v1, s[4:7], s90 offen offset:0 sc1 lds
    v_mfma_f32_16x16x32_bf16 v[80:83], v[144:147], a[160:163], v[80:83]
    ds_read_b128 v[132:135], v10 offset:58368
    v_mfma_f32_16x16x32_bf16 v[80:83], v[148:151], a[168:171], v[80:83]
    v_mfma_f32_16x16x32_bf16 v[88:91], v[148:151], a[172:175], v[88:91]
    ds_read_b128 v[136:139], v10 offset:59392
    v_mfma_f32_16x16x32_bf16 v[88:91], v[144:147], a[164:167], v[88:91]
    s_waitcnt lgkmcnt(3)
    buffer_load_dwordx4 v1, s[4:7], s90 offen offset:1024 sc1 lds
    v_mfma_f32_16x16x32_bf16 v[88:91], v[152:155], a[180:183], v[88:91]
    ds_read_b128 v[140:143], v10 offset:60416
    v_mfma_f32_16x16x32_bf16 v[88:91], v[156:159], a[188:191], v[88:91]
    v_mfma_f32_16x16x32_bf16 v[80:83], v[156:159], a[184:187], v[80:83]
    ds_read_b128 v[144:147], v10 offset:61440
    v_mfma_f32_16x16x32_bf16 v[80:83], v[152:155], a[176:179], v[80:83]
    s_waitcnt lgkmcnt(3)
    v_mfma_f32_16x16x32_bf16 v[80:83], v[128:131], a[192:195], v[80:83]
    ds_read_b128 v[148:151], v10 offset:62464
    v_mfma_f32_16x16x32_bf16 v[80:83], v[132:135], a[200:203], v[80:83]
    buffer_load_dwordx4 v1, s[4:7], s90 offen offset:2048 sc1 lds
    v_mfma_f32_16x16x32_bf16 v[88:91], v[132:135], a[204:207], v[88:91]
    ds_read_b128 v[152:155], v10 offset:63488
    v_mfma_f32_16x16x32_bf16 v[88:91], v[128:131], a[196:199], v[88:91]
    s_waitcnt lgkmcnt(3)
    v_mfma_f32_16x16x32_bf16 v[88:91], v[136:139], a[212:215], v[88:91]
    ds_read_b128 v[156:159], v10 offset:64512
    v_mfma_f32_16x16x32_bf16 v[88:91], v[140:143], a[220:223], v[88:91]
    s_waitcnt vmcnt(13)
    s_barrier
    v_mfma_f32_16x16x32_bf16 v[80:83], v[140:143], a[216:219], v[80:83]
    ds_read_b128 v[128:131], v11 offset:0
L_hop13:
    s_cbranch_execz L_hop17
    v_mfma_f32_16x16x32_bf16 v[80:83], v[136:139], a[208:211], v[80:83]
    s_waitcnt lgkmcnt(3)
    buffer_load_dwordx4 v1, s[4:7], s90 offen offset:3072 sc1 lds
    s_add_u32 m0, s96, 49152
    v_mfma_f32_16x16x32_bf16 v[84:87], v[144:147], a[0:3], 0
    ds_read_b128 v[132:135], v11 offset:1024
    s_add_u32 s90, s95, 802816
    v_mfma_f32_16x16x32_bf16 v[84:87], v[148:151], a[8:11], v[84:87]
    buffer_store_dwordx4 v[56:59], v1, s[4:7], s80 offen offset:2048 sc1
    v_mfma_f32_16x16x32_bf16 v[92:95], v[148:151], a[12:15], 0
    ds_read_b128 v[136:139], v11 offset:2048
    v_mfma_f32_16x16x32_bf16 v[92:95], v[144:147], a[4:7], v[92:95]
    s_waitcnt lgkmcnt(3)
    v_mfma_f32_16x16x32_bf16 v[92:95], v[152:155], a[20:23], v[92:95]
    ds_read_b128 v[140:143], v11 offset:3072
    v_mfma_f32_16x16x32_bf16 v[92:95], v[156:159], a[28:31], v[92:95]
    v_mfma_f32_16x16x32_bf16 v[84:87], v[156:159], a[24:27], v[84:87]
    ds_read_b128 v[144:147], v11 offset:4096
    v_mfma_f32_16x16x32_bf16 v[84:87], v[152:155], a[16:19], v[84:87]
    s_waitcnt lgkmcnt(3)
    v_mfma_f32_16x16x32_bf16 v[84:87], v[128:131], a[32:35], v[84:87]
    ds_read_b128 v[148:151], v11 offset:5120
    v_mfma_f32_16x16x32_bf16 v[84:87], v[132:135], a[40:43], v[84:87]
    buffer_load_dwordx4 v1, s[4:7], s90 offen offset:0 sc1 lds
    v_mfma_f32_16x16x32_bf16 v[92:95], v[132:135], a[44:47], v[92:95]
    ds_read_b128 v[152:155], v11 offset:6144
    v_mfma_f32_16x16x32_bf16 v[92:95], v[128:131], a[36:39], v[92:95]
    s_waitcnt lgkmcnt(3)
    v_mfma_f32_16x16x32_bf16 v[92:95], v[136:139], a[52:55], v[92:95]
    ds_read_b128 v[156:159], v11 offset:7168
    v_mfma_f32_16x16x32_bf16 v[92:95], v[140:143], a[60:63], v[92:95]
    buffer_load_dwordx4 v1, s[4:7], s90 offen offset:1024 sc1 lds
    v_mfma_f32_16x16x32_bf16 v[84:87], v[140:143], a[56:59], v[84:87]
    ds_read_b128 v[128:131], v11 offset:8192
    v_mfma_f32_16x16x32_bf16 v[84:87], v[136:139], a[48:51], v[84:87]
    s_waitcnt lgkmcnt(3)
    v_mfma_f32_16x16x32_bf16 v[84:87], v[144:147], a[64:67], v[84:87]
    ds_read_b128 v[132:135], v11 offset:9216
    v_mfma_f32_16x16x32_bf16 v[84:87], v[148:151], a[72:75], v[84:87]
    buffer_load_dwordx4 v1, s[4:7], s90 offen offset:2048 sc1 lds
    v_mfma_f32_16x16x32_bf16 v[92:95], v[148:151], a[76:79], v[92:95]
    ds_read_b128 v[136:139], v11 offset:10240
    v_mfma_f32_16x16x32_bf16 v[92:95], v[144:147], a[68:71], v[92:95]
    s_waitcnt lgkmcnt(3)
    v_mfma_f32_16x16x32_bf16 v[92:95], v[152:155], a[84:87], v[92:95]
    ds_read_b128 v[140:143], v11 offset:11264
    v_mfma_f32_16x16x32_bf16 v[92:95], v[156:159], a[92:95], v[92:95]
    v_mfma_f32_16x16x32_bf16 v[84:87], v[156:159], a[88:91], v[84:87]
    ds_read_b128 v[144:147], v11 offset:12288
    v_mfma_f32_16x16x32_bf16 v[84:87], v[152:155], a[80:83], v[84:87]
    s_waitcnt lgkmcnt(3)
    buffer_load_dwordx4 v1, s[4:7], s90 offen offset:3072 sc1 lds
    s_add_u32 m0, s96, 65536
    v_mfma_f32_16x16x32_bf16 v[84:87], v[128:131], a[96:99], v[84:87]
    ds_read_b128 v[148:151], v11 offset:13312
    s_add_u32 s90, s95, 819200
    v_mfma_f32_16x16x32_bf16 v[84:87], v[132:135], a[104:107], v[84:87]
    buffer_store_dwordx4 v[60:63], v1, s[4:7], s80 offen offset:3072 sc1
    v_mfma_f32_16x16x32_bf16 v[92:95], v[132:135], a[108:111], v[92:95]
    ds_read_b128 v[152:155], v11 offset:14336
    v_mfma_f32_16x16x32_bf16 v[92:95], v[128:131], a[100:103], v[92:95]
    s_waitcnt lgkmcnt(3)
    v_mfma_f32_16x16x32_bf16 v[92:95], v[136:139], a[116:119], v[92:95]
    ds_read_b128 v[156:159], v11 offset:15360
    v_mfma_f32_16x16x32_bf16 v[92:95], v[140:143], a[124:127], v[92:95]
    v_mfma_f32_16x16x32_bf16 v[84:87], v[140:143], a[120:123], v[84:87]
    ds_read_b128 v[128:131], v11 offset:16384
    v_mfma_f32_16x16x32_bf16 v[84:87], v[136:139], a[112:115], v[84:87]
    s_waitcnt lgkmcnt(3)
    v_mfma_f32_16x16x32_bf16 v[84:87], v[144:147], a[128:131], v[84:87]
    ds_read_b128 v[132:135], v11 offset:17408
    v_mfma_f32_16x16x32_bf16 v[84:87], v[148:151], a[136:139], v[84:87]
    buffer_load_dwordx4 v1, s[4:7], s90 offen offset:0 sc1 lds
    v_mfma_f32_16x16x32_bf16 v[92:95], v[148:151], a[140:143], v[92:95]
    ds_read_b128 v[136:139], v11 offset:18432
    v_mfma_f32_16x16x32_bf16 v[92:95], v[144:147], a[132:135], v[92:95]
    s_waitcnt lgkmcnt(3)
    v_mfma_f32_16x16x32_bf16 v[92:95], v[152:155], a[148:151], v[92:95]
    ds_read_b128 v[140:143], v11 offset:19456
    v_mfma_f32_16x16x32_bf16 v[92:95], v[156:159], a[156:159], v[92:95]
    buffer_load_dwordx4 v1, s[4:7], s90 offen offset:1024 sc1 lds
    v_mfma_f32_16x16x32_bf16 v[84:87], v[156:159], a[152:155], v[84:87]
    ds_read_b128 v[144:147], v11 offset:20480
    v_mfma_f32_16x16x32_bf16 v[84:87], v[152:155], a[144:147], v[84:87]
    s_waitcnt lgkmcnt(3)
    v_mfma_f32_16x16x32_bf16 v[84:87], v[128:131], a[160:163], v[84:87]
    ds_read_b128 v[148:151], v11 offset:21504
    v_mfma_f32_16x16x32_bf16 v[84:87], v[132:135], a[168:171], v[84:87]
    buffer_load_dwordx4 v1, s[4:7], s90 offen offset:2048 sc1 lds
    v_mfma_f32_16x16x32_bf16 v[92:95], v[132:135], a[172:175], v[92:95]
    ds_read_b128 v[152:155], v11 offset:22528
    v_mfma_f32_16x16x32_bf16 v[92:95], v[128:131], a[164:167], v[92:95]
    s_waitcnt lgkmcnt(3)
    v_mfma_f32_16x16x32_bf16 v[92:95], v[136:139], a[180:183], v[92:95]
    ds_read_b128 v[156:159], v11 offset:23552
    v_mfma_f32_16x16x32_bf16 v[92:95], v[140:143], a[188:191], v[92:95]
    v_mfma_f32_16x16x32_bf16 v[84:87], v[140:143], a[184:187], v[84:87]
    ds_read_b128 v[128:131], v11 offset:24576
    v_mfma_f32_16x16x32_bf16 v[84:87], v[136:139], a[176:179], v[84:87]
    s_waitcnt lgkmcnt(3)
    buffer_load_dwordx4 v1, s[4:7], s90 offen offset:3072 sc1 lds
    s_add_u32 m0, s96, 81920
    v_mfma_f32_16x16x32_bf16 v[84:87], v[144:147], a[192:195], v[84:87]
    ds_read_b128 v[132:135], v11 offset:25600
    s_add_u32 s90, s95, 835584
    v_mfma_f32_16x16x32_bf16 v[84:87], v[148:151], a[200:203], v[84:87]
    buffer_store_dwordx4 v[224:227], v1, s[4:7], s81 offen offset:0 sc1
    v_mfma_f32_16x16x32_bf16 v[92:95], v[148:151], a[204:207], v[92:95]
    ds_read_b128 v[136:139], v11 offset:26624
    v_mfma_f32_16x16x32_bf16 v[92:95], v[144:147], a[196:199], v[92:95]
    s_waitcnt lgkmcnt(3)
    v_mfma_f32_16x16x32_bf16 v[92:95], v[152:155], a[212:215], v[92:95]
    ds_read_b128 v[140:143], v11 offset:27648
    v_mfma_f32_16x16x32_bf16 v[92:95], v[156:159], a[220:223], v[92:95]
    v_mfma_f32_16x16x32_bf16 v[84:87], v[156:159], a[216:219], v[84:87]
    ds_read_b128 v[144:147], v11 offset:28672
    v_mfma_f32_16x16x32_bf16 v[84:87], v[152:155], a[208:211], v[84:87]
    s_waitcnt lgkmcnt(3)
    buffer_load_dwordx4 v1, s[4:7], s90 offen offset:0 sc1 lds
    v_mfma_f32_16x16x32_bf16 v[160:163], v[128:131], a[0:3], 0
    ds_read_b128 v[148:151], v11 offset:29696
    v_mfma_f32_16x16x32_bf16 v[160:163], v[132:135], a[8:11], v[160:163]
    v_mfma_f32_16x16x32_bf16 v[168:171], v[132:135], a[12:15], 0
    ds_read_b128 v[152:155], v11 offset:30720
    v_mfma_f32_16x16x32_bf16 v[168:171], v[128:131], a[4:7], v[168:171]
    s_waitcnt lgkmcnt(3)
    v_mfma_f32_16x16x32_bf16 v[168:171], v[136:139], a[20:23], v[168:171]
    ds_read_b128 v[156:159], v11 offset:31744
    v_mfma_f32_16x16x32_bf16 v[168:171], v[140:143], a[28:31], v[168:171]
    s_waitcnt vmcnt(17)
    s_barrier
    v_mfma_f32_16x16x32_bf16 v[160:163], v[140:143], a[24:27], v[160:163]
    ds_read_b128 v[128:131], v1 offset:0
    v_mfma_f32_16x16x32_bf16 v[160:163], v[136:139], a[16:19], v[160:163]
    s_waitcnt lgkmcnt(3)
    buffer_load_dwordx4 v1, s[4:7], s90 offen offset:1024 sc1 lds
    v_mfma_f32_16x16x32_bf16 v[160:163], v[144:147], a[32:35], v[160:163]
    ds_read_b128 v[132:135], v1 offset:1024
    v_mfma_f32_16x16x32_bf16 v[160:163], v[148:151], a[40:43], v[160:163]
    v_mfma_f32_16x16x32_bf16 v[168:171], v[148:151], a[44:47], v[168:171]
    ds_read_b128 v[136:139], v1 offset:2048
    v_mfma_f32_16x16x32_bf16 v[168:171], v[144:147], a[36:39], v[168:171]
    s_waitcnt lgkmcnt(3)
    buffer_load_dwordx4 v1, s[4:7], s90 offen offset:2048 sc1 lds
    v_mfma_f32_16x16x32_bf16 v[168:171], v[152:155], a[52:55], v[168:171]
    ds_read_b128 v[140:143], v1 offset:3072
    v_mfma_f32_16x16x32_bf16 v[168:171], v[156:159], a[60:63], v[168:171]
    v_mfma_f32_16x16x32_bf16 v[160:163], v[156:159], a[56:59], v[160:163]
    ds_read_b128 v[144:147], v1 offset:4096
    v_mfma_f32_16x16x32_bf16 v[160:163], v[152:155], a[48:51], v[160:163]
    s_waitcnt lgkmcnt(3)
    v_mfma_f32_16x16x32_bf16 v[160:163], v[128:131], a[64:67], v[160:163]
    ds_read_b128 v[148:151], v1 offset:5120
    v_mfma_f32_16x16x32_bf16 v[160:163], v[132:135], a[72:75], v[160:163]
    buffer_store_dwordx4 v[228:231], v1, s[4:7], s81 offen offset:1024 sc1
    v_mfma_f32_16x16x32_bf16 v[168:171], v[132:135], a[76:79], v[168:171]
    ds_read_b128 v[152:155], v1 offset:6144
    v_mfma_f32_16x16x32_bf16 v[168:171], v[128:131], a[68:71], v[168:171]
    s_waitcnt lgkmcnt(3)
    v_mfma_f32_16x16x32_bf16 v[168:171], v[136:139], a[84:87], v[168:171]
    ds_read_b128 v[156:159], v1 offset:7168
    v_mfma_f32_16x16x32_bf16 v[168:171], v[140:143], a[92:95], v[168:171]
    buffer_load_dwordx4 v1, s[4:7], s90 offen offset:3072 sc1 lds
    s_waitcnt vmcnt(10)
    s_atomic_add s92, s[4:5], s77 offset:256
    s_add_u32 m0, s96, 98304
    v_mfma_f32_16x16x32_bf16 v[160:163], v[140:143], a[88:91], v[160:163]
    ds_read_b128 v[128:131], v1 offset:8192
    s_add_u32 s90, s95, 851968
    v_mfma_f32_16x16x32_bf16 v[160:163], v[136:139], a[80:83], v[160:163]
    s_waitcnt lgkmcnt(3)
    v_mfma_f32_16x16x32_bf16 v[160:163], v[144:147], a[96:99], v[160:163]
    ds_read_b128 v[132:135], v1 offset:9216
    v_mfma_f32_16x16x32_bf16 v[160:163], v[148:151], a[104:107], v[160:163]
    buffer_load_dwordx4 v1, s[4:7], s90 offen offset:0 sc1 lds
    v_mfma_f32_16x16x32_bf16 v[168:171], v[148:151], a[108:111], v[168:171]
    ds_read_b128 v[136:139], v1 offset:10240
    v_mfma_f32_16x16x32_bf16 v[168:171], v[144:147], a[100:103], v[168:171]
    s_waitcnt lgkmcnt(3)
    v_mfma_f32_16x16x32_bf16 v[168:171], v[152:155], a[116:119], v[168:171]
    ds_read_b128 v[140:143], v1 offset:11264
    v_mfma_f32_16x16x32_bf16 v[168:171], v[156:159], a[124:127], v[168:171]
    v_mfma_f32_16x16x32_bf16 v[160:163], v[156:159], a[120:123], v[160:163]
    ds_read_b128 v[144:147], v1 offset:12288
    v_mfma_f32_16x16x32_bf16 v[160:163], v[152:155], a[112:115], v[160:163]
    s_waitcnt lgkmcnt(3)
    buffer_load_dwordx4 v1, s[4:7], s90 offen offset:1024 sc1 lds
    v_mfma_f32_16x16x32_bf16 v[160:163], v[128:131], a[128:131], v[160:163]
    ds_read_b128 v[148:151], v1 offset:13312
    v_mfma_f32_16x16x32_bf16 v[160:163], v[132:135], a[136:139], v[160:163]
    v_mfma_f32_16x16x32_bf16 v[168:171], v[132:135], a[140:143], v[168:171]
    ds_read_b128 v[152:155], v1 offset:14336
    v_mfma_f32_16x16x32_bf16 v[168:171], v[128:131], a[132:135], v[168:171]
    s_waitcnt lgkmcnt(3)
    buffer_load_dwordx4 v1, s[4:7], s90 offen offset:2048 sc1 lds
    v_mfma_f32_16x16x32_bf16 v[168:171], v[136:139], a[148:151], v[168:171]
    ds_read_b128 v[156:159], v1 offset:15360
    v_mfma_f32_16x16x32_bf16 v[168:171], v[140:143], a[156:159], v[168:171]
    v_mfma_f32_16x16x32_bf16 v[160:163], v[140:143], a[152:155], v[160:163]
    ds_read_b128 v[128:131], v1 offset:16384
    v_mfma_f32_16x16x32_bf16 v[160:163], v[136:139], a[144:147], v[160:163]
    s_waitcnt lgkmcnt(3)
    v_mfma_f32_16x16x32_bf16 v[160:163], v[144:147], a[160:163], v[160:163]
    ds_read_b128 v[132:135], v1 offset:17408
    v_mfma_f32_16x16x32_bf16 v[160:163], v[148:151], a[168:171], v[160:163]
    buffer_store_dwordx4 v[232:235], v1, s[4:7], s81 offen offset:2048 sc1
    v_mfma_f32_16x16x32_bf16 v[168:171], v[148:151], a[172:175], v[168:171]
    ds_read_b128 v[136:139], v1 offset:18432
    v_mfma_f32_16x16x32_bf16 v[168:171], v[144:147], a[164:167], v[168:171]
    s_waitcnt lgkmcnt(3)
    v_mfma_f32_16x16x32_bf16 v[168:171], v[152:155], a[180:183], v[168:171]
    ds_read_b128 v[140:143], v1 offset:19456
    v_mfma_f32_16x16x32_bf16 v[168:171], v[156:159], a[188:191], v[168:171]
    s_mov_b32 s57, 0
    s_atomic_add s57, s[4:5], s73 offset:256 glc
    buffer_load_dwordx4 v1, s[4:7], s90 offen offset:3072 sc1 lds
    s_add_u32 m0, s96, 114688
    v_mfma_f32_16x16x32_bf16 v[160:163], v[156:159], a[184:187], v[160:163]
    ds_read_b128 v[144:147], v1 offset:20480
    s_add_u32 s90, s95, 868352
    v_mfma_f32_16x16x32_bf16 v[160:163], v[152:155], a[176:179], v[160:163]
    s_waitcnt lgkmcnt(3)
    v_mfma_f32_16x16x32_bf16 v[160:163], v[128:131], a[192:195], v[160:163]
    ds_read_b128 v[148:151], v1 offset:21504
    v_mfma_f32_16x16x32_bf16 v[160:163], v[132:135], a[200:203], v[160:163]
    buffer_load_dwordx4 v1, s[4:7], s90 offen offset:0 sc1 lds
    v_mfma_f32_16x16x32_bf16 v[168:171], v[132:135], a[204:207], v[168:171]
    ds_read_b128 v[152:155], v1 offset:22528
    v_mfma_f32_16x16x32_bf16 v[168:171], v[128:131], a[196:199], v[168:171]
    s_waitcnt lgkmcnt(3)
    v_mfma_f32_16x16x32_bf16 v[168:171], v[136:139], a[212:215], v[168:171]
    ds_read_b128 v[156:159], v1 offset:23552
    v_mfma_f32_16x16x32_bf16 v[168:171], v[140:143], a[220:223], v[168:171]
    v_mfma_f32_16x16x32_bf16 v[160:163], v[140:143], a[216:219], v[160:163]
    ds_read_b128 v[128:131], v1 offset:24576
    v_mfma_f32_16x16x32_bf16 v[160:163], v[136:139], a[208:211], v[160:163]
    s_waitcnt lgkmcnt(3)
    buffer_load_dwordx4 v1, s[4:7], s90 offen offset:1024 sc1 lds
    v_mfma_f32_16x16x32_bf16 v[164:167], v[144:147], a[0:3], 0
    ds_read_b128 v[132:135], v1 offset:25600
    v_mfma_f32_16x16x32_bf16 v[164:167], v[148:151], a[8:11], v[164:167]
    v_mfma_f32_16x16x32_bf16 v[172:175], v[148:151], a[12:15], 0
    ds_read_b128 v[136:139], v1 offset:26624
    v_mfma_f32_16x16x32_bf16 v[172:175], v[144:147], a[4:7], v[172:175]
    s_waitcnt lgkmcnt(3)
    buffer_load_dwordx4 v1, s[4:7], s90 offen offset:2048 sc1 lds
    v_mfma_f32_16x16x32_bf16 v[172:175], v[152:155], a[20:23], v[172:175]
    ds_read_b128 v[140:143], v1 offset:27648
    v_mfma_f32_16x16x32_bf16 v[172:175], v[156:159], a[28:31], v[172:175]
    v_mfma_f32_16x16x32_bf16 v[164:167], v[156:159], a[24:27], v[164:167]
    ds_read_b128 v[144:147], v1 offset:28672
    v_mfma_f32_16x16x32_bf16 v[164:167], v[152:155], a[16:19], v[164:167]
    s_waitcnt lgkmcnt(3)
    buffer_load_dwordx4 v1, s[4:7], s90 offen offset:3072 sc1 lds
    s_add_u32 m0, s96, 131072
    v_mfma_f32_16x16x32_bf16 v[164:167], v[128:131], a[32:35], v[164:167]
    ds_read_b128 v[148:151], v1 offset:29696
    s_add_u32 s90, s95, 884736
    v_mfma_f32_16x16x32_bf16 v[164:167], v[132:135], a[40:43], v[164:167]
    buffer_store_dwordx4 v[236:239], v1, s[4:7], s81 offen offset:3072 sc1
    v_mfma_f32_16x16x32_bf16 v[172:175], v[132:135], a[44:47], v[172:175]
    ds_read_b128 v[152:155], v1 offset:30720
    v_mfma_f32_16x16x32_bf16 v[172:175], v[128:131], a[36:39], v[172:175]
    s_waitcnt lgkmcnt(3)
    v_mfma_f32_16x16x32_bf16 v[172:175], v[136:139], a[52:55], v[172:175]
    ds_read_b128 v[156:159], v1 offset:31744
    v_mfma_f32_16x16x32_bf16 v[172:175], v[140:143], a[60:63], v[172:175]
    s_barrier
    v_mfma_f32_16x16x32_bf16 v[164:167], v[140:143], a[56:59], v[164:167]
    ds_read_b128 v[128:131], v1 offset:32768
    v_mfma_f32_16x16x32_bf16 v[164:167], v[136:139], a[48:51], v[164:167]
    s_waitcnt lgkmcnt(3)
    v_mfma_f32_16x16x32_bf16 v[164:167], v[144:147], a[64:67], v[164:167]
    ds_read_b128 v[132:135], v1 offset:33792
    v_mfma_f32_16x16x32_bf16 v[164:167], v[148:151], a[72:75], v[164:167]
    v_mfma_f32_16x16x32_bf16 v[172:175], v[148:151], a[76:79], v[172:175]
    ds_read_b128 v[136:139], v1 offset:34816
    v_mfma_f32_16x16x32_bf16 v[172:175], v[144:147], a[68:71], v[172:175]
    s_waitcnt lgkmcnt(3)
    buffer_load_dwordx4 v1, s[4:7], s90 offen offset:0 sc1 lds
    v_mfma_f32_16x16x32_bf16 v[172:175], v[152:155], a[84:87], v[172:175]
    ds_read_b128 v[140:143], v1 offset:35840
    v_mfma_f32_16x16x32_bf16 v[172:175], v[156:159], a[92:95], v[172:175]
    v_mfma_f32_16x16x32_bf16 v[164:167], v[156:159], a[88:91], v[164:167]
    ds_read_b128 v[144:147], v1 offset:36864
    v_mfma_f32_16x16x32_bf16 v[164:167], v[152:155], a[80:83], v[164:167]
    s_waitcnt lgkmcnt(3)
    v_mfma_f32_16x16x32_bf16 v[164:167], v[128:131], a[96:99], v[164:167]
    ds_read_b128 v[148:151], v1 offset:37888
    v_mfma_f32_16x16x32_bf16 v[164:167], v[132:135], a[104:107], v[164:167]
    buffer_load_dwordx4 v1, s[4:7], s90 offen offset:1024 sc1 lds
    v_mfma_f32_16x16x32_bf16 v[172:175], v[132:135], a[108:111], v[172:175]
    ds_read_b128 v[152:155], v1 offset:38912
    v_mfma_f32_16x16x32_bf16 v[172:175], v[128:131], a[100:103], v[172:175]
    s_waitcnt lgkmcnt(3)
    v_mfma_f32_16x16x32_bf16 v[172:175], v[136:139], a[116:119], v[172:175]
    ds_read_b128 v[156:159], v1 offset:39936
    v_mfma_f32_16x16x32_bf16 v[172:175], v[140:143], a[124:127], v[172:175]
    buffer_load_dwordx4 v1, s[4:7], s90 offen offset:2048 sc1 lds
    v_mfma_f32_16x16x32_bf16 v[164:167], v[140:143], a[120:123], v[164:167]
    ds_read_b128 v[128:131], v1 offset:40960
    v_mfma_f32_16x16x32_bf16 v[164:167], v[136:139], a[112:115], v[164:167]
    s_waitcnt lgkmcnt(3)
    v_mfma_f32_16x16x32_bf16 v[164:167], v[144:147], a[128:131], v[164:167]
    ds_read_b128 v[132:135], v1 offset:41984
    v_lshlrev_b32 v14, 10, v0
    v_mfma_f32_16x16x32_bf16 v[164:167], v[148:151], a[136:139], v[164:167]
    s_bitcmp0_b32 s57, 0
    s_cbranch_scc1 L_slow_25
L_back_26:
    buffer_load_dwordx4 v1, s[4:7], s90 offen offset:3072 sc1 lds
    s_lshl2_add_u32 s86, s96, 0
    v_mfma_f32_16x16x32_bf16 v[172:175], v[148:151], a[140:143], v[172:175]
    ds_read_b128 v[136:139], v1 offset:43008
    s_add_u32 m0, s96, 0
    v_mfma_f32_16x16x32_bf16 v[172:175], v[144:147], a[132:135], v[172:175]
    s_waitcnt lgkmcnt(3)
    buffer_load_dwordx4 v[176:179], v1, s[4:7], s74 offen offset:0 sc1
    v_lshrrev_b32 v15, 4, v0
    v_mfma_f32_16x16x32_bf16 v[172:175], v[152:155], a[148:151], v[172:175]
    ds_read_b128 v[140:143], v1 offset:44032
    v_lshl_or_b32 v14, v15, 28, v14
    v_mfma_f32_16x16x32_bf16 v[172:175], v[156:159], a[156:159], v[172:175]
    s_lshr_b32 s60, s2, 3
    v_mfma_f32_16x16x32_bf16 v[164:167], v[156:159], a[152:155], v[164:167]
    ds_read_b128 v[144:147], v1 offset:45056
    s_lshl2_add_u32 s60, s60, s48
    v_mfma_f32_16x16x32_bf16 v[164:167], v[152:155], a[144:147], v[164:167]
    s_waitcnt lgkmcnt(3)
    s_lshl_b32 s60, s60, 14
    v_mfma_f32_16x16x32_bf16 v[164:167], v[128:131], a[160:163], v[164:167]
    ds_read_b128 v[148:151], v1 offset:46080
    s_andn2_b32 s61, 8, s52
    v_mfma_f32_16x16x32_bf16 v[164:167], v[132:135], a[168:171], v[164:167]
    s_lshl_b32 s61, s61, 27
    v_mfma_f32_16x16x32_bf16 v[172:175], v[132:135], a[172:175], v[172:175]
    ds_read_b128 v[152:155], v1 offset:47104
    s_or_b32 s60, s60, s61
    v_mfma_f32_16x16x32_bf16 v[172:175], v[128:131], a[164:167], v[172:175]
    s_waitcnt lgkmcnt(3)
    buffer_load_dwordx4 v1, s[16:19], s86 offen offset:0 lds
    v_mfma_f32_16x16x32_bf16 v[172:175], v[136:139], a[180:183], v[172:175]
    ds_read_b128 v[156:159], v1 offset:48128
    v_mfma_f32_16x16x32_bf16 v[172:175], v[140:143], a[188:191], v[172:175]
    v_mfma_f32_16x16x32_bf16 v[164:167], v[140:143], a[184:187], v[164:167]
    ds_read_b128 v[128:131], v1 offset:49152
    v_mfma_f32_16x16x32_bf16 v[164:167], v[136:139], a[176:179], v[164:167]
    s_waitcnt lgkmcnt(3)
    buffer_load_dwordx4 v1, s[16:19], s86 offen offset:1024 lds
    v_mfma_f32_16x16x32_bf16 v[164:167], v[144:147], a[192:195], v[164:167]
    ds_read_b128 v[132:135], v1 offset:50176
    v_mfma_f32_16x16x32_bf16 v[164:167], v[148:151], a[200:203], v[164:167]
    v_mfma_f32_16x16x32_bf16 v[172:175], v[148:151], a[204:207], v[172:175]
    ds_read_b128 v[136:139], v1 offset:51200
    v_mfma_f32_16x16x32_bf16 v[172:175], v[144:147], a[196:199], v[172:175]
    s_waitcnt lgkmcnt(3)
    buffer_load_dwordx4 v[180:183], v1, s[4:7], s74 offen offset:1024 sc1
    v_mfma_f32_16x16x32_bf16 v[172:175], v[152:155], a[212:215], v[172:175]
    ds_read_b128 v[140:143], v1 offset:52224
    v_mfma_f32_16x16x32_bf16 v[172:175], v[156:159], a[220:223], v[172:175]
    v_mfma_f32_16x16x32_bf16 v[164:167], v[156:159], a[216:219], v[164:167]
    ds_read_b128 v[144:147], v1 offset:53248
    v_mfma_f32_16x16x32_bf16 v[164:167], v[152:155], a[208:211], v[164:167]
    s_waitcnt lgkmcnt(3)
    v_mfma_f32_16x16x32_bf16 v[16:19], v[128:131], a[0:3], v[16:19]
    ds_read_b128 v[148:151], v1 offset:54272
    v_mfma_f32_16x16x32_bf16 v[16:19], v[132:135], a[8:11], v[16:19]
    buffer_load_dword v15, v14, s[12:15], s60 offen offset:384
    v_mfma_f32_16x16x32_bf16 v[24:27], v[132:135], a[12:15], v[24:27]
    ds_read_b128 v[152:155], v1 offset:55296
    v_mfma_f32_16x16x32_bf16 v[24:27], v[128:131], a[4:7], v[24:27]
    s_waitcnt lgkmcnt(3)
    v_mfma_f32_16x16x32_bf16 v[24:27], v[136:139], a[20:23], v[24:27]
    ds_read_b128 v[156:159], v1 offset:56320
    v_cvt_pk_bf16_f32 v48, v80, v81
    v_mfma_f32_16x16x32_bf16 v[24:27], v[140:143], a[28:31], v[24:27]
    s_waitcnt vmcnt(9)
    s_atomic_add s75, s[4:5], s78 offset:256
    v_cvt_pk_bf16_f32 v49, v82, v83
    v_cvt_pk_bf16_f32 v50, v84, v85
    v_mfma_f32_16x16x32_bf16 v[16:19], v[140:143], a[24:27], v[16:19]
    ds_read_b128 v[128:131], v1 offset:57344
    v_cvt_pk_bf16_f32 v51, v86, v87
    v_mfma_f32_16x16x32_bf16 v[16:19], v[136:139], a[16:19], v[16:19]
    s_waitcnt lgkmcnt(3)
    buffer_load_dwordx4 v1, s[16:19], s86 offen offset:2048 lds
    v_cvt_pk_bf16_f32 v52, v88, v89
    v_mfma_f32_16x16x32_bf16 v[16:19], v[144:147], a[32:35], v[16:19]
    ds_read_b128 v[132:135], v1 offset:58368
    v_cvt_pk_bf16_f32 v53, v90, v91
    v_mfma_f32_16x16x32_bf16 v[16:19], v[148:151], a[40:43], v[16:19]
    buffer_store_dwordx4 v[48:51], v1, s[4:7], s82 offen offset:0 sc1
    v_cvt_pk_bf16_f32 v54, v92, v93
    v_mfma_f32_16x16x32_bf16 v[24:27], v[148:151], a[44:47], v[24:27]
    ds_read_b128 v[136:139], v1 offset:59392
    v_cvt_pk_bf16_f32 v55, v94, v95
    v_mfma_f32_16x16x32_bf16 v[24:27], v[144:147], a[36:39], v[24:27]
    s_waitcnt lgkmcnt(3)
    buffer_load_dwordx4 v[184:187], v1, s[4:7], s74 offen offset:2048 sc1
    v_cvt_pk_bf16_f32 v56, v160, v161
    v_mfma_f32_16x16x32_bf16 v[24:27], v[152:155], a[52:55], v[24:27]
    ds_read_b128 v[140:143], v1 offset:60416
    v_cvt_pk_bf16_f32 v57, v162, v163
    v_mfma_f32_16x16x32_bf16 v[24:27], v[156:159], a[60:63], v[24:27]
    v_cvt_pk_bf16_f32 v58, v164, v165
    v_cvt_pk_bf16_f32 v59, v166, v167
    v_mfma_f32_16x16x32_bf16 v[16:19], v[156:159], a[56:59], v[16:19]
    ds_read_b128 v[144:147], v1 offset:61440
    v_cvt_pk_bf16_f32 v60, v168, v169
    v_mfma_f32_16x16x32_bf16 v[16:19], v[152:155], a[48:51], v[16:19]
    s_waitcnt lgkmcnt(3)
    v_cvt_pk_bf16_f32 v61, v170, v171
    v_cvt_pk_bf16_f32 v62, v172, v173
    v_mfma_f32_16x16x32_bf16 v[16:19], v[128:131], a[64:67], v[16:19]
    ds_read_b128 v[148:151], v1 offset:62464
    v_cvt_pk_bf16_f32 v63, v174, v175
    v_mfma_f32_16x16x32_bf16 v[16:19], v[132:135], a[72:75], v[16:19]
    v_mfma_f32_16x16x32_bf16 v[24:27], v[132:135], a[76:79], v[24:27]
    ds_read_b128 v[152:155], v1 offset:63488
    v_mfma_f32_16x16x32_bf16 v[24:27], v[128:131], a[68:71], v[24:27]
    s_waitcnt lgkmcnt(3)
    v_mfma_f32_16x16x32_bf16 v[24:27], v[136:139], a[84:87], v[24:27]
    ds_read_b128 v[156:159], v1 offset:64512
    v_mfma_f32_16x16x32_bf16 v[24:27], v[140:143], a[92:95], v[24:27]
    s_barrier
    v_mfma_f32_16x16x32_bf16 v[16:19], v[140:143], a[88:91], v[16:19]
    ds_read_b128 v[128:131], v10 offset:0
    v_mfma_f32_16x16x32_bf16 v[16:19], v[136:139], a[80:83], v[16:19]
    s_waitcnt lgkmcnt(3)
    buffer_store_dwordx4 v[52:55], v1, s[4:7], s82 offen offset:1024 sc1
    v_mfma_f32_16x16x32_bf16 v[16:19], v[144:147], a[96:99], v[16:19]
    ds_read_b128 v[132:135], v10 offset:1024
    v_mfma_f32_16x16x32_bf16 v[16:19], v[148:151], a[104:107], v[16:19]
    v_mfma_f32_16x16x32_bf16 v[24:27], v[148:151], a[108:111], v[24:27]
    ds_read_b128 v[136:139], v10 offset:2048
    v_mfma_f32_16x16x32_bf16 v[24:27], v[144:147], a[100:103], v[24:27]
    s_waitcnt lgkmcnt(3)
    buffer_load_dwordx4 v[188:191], v1, s[4:7], s74 offen offset:3072 sc1
    v_mfma_f32_16x16x32_bf16 v[24:27], v[152:155], a[116:119], v[24:27]
    ds_read_b128 v[140:143], v10 offset:3072
    v_mfma_f32_16x16x32_bf16 v[24:27], v[156:159], a[124:127], v[24:27]
    s_mov_b32 s57, 0
    s_atomic_add s57, s[4:5], s73 offset:256 glc
    v_mfma_f32_16x16x32_bf16 v[16:19], v[156:159], a[120:123], v[16:19]
    ds_read_b128 v[144:147], v10 offset:4096
    v_mfma_f32_16x16x32_bf16 v[16:19], v[152:155], a[112:115], v[16:19]
    s_waitcnt lgkmcnt(3)
    v_mfma_f32_16x16x32_bf16 v[16:19], v[128:131], a[128:131], v[16:19]
    ds_read_b128 v[148:151], v10 offset:5120
    v_mfma_f32_16x16x32_bf16 v[16:19], v[132:135], a[136:139], v[16:19]
    buffer_store_dwordx4 v[56:59], v1, s[4:7], s82 offen offset:2048 sc1
    v_mfma_f32_16x16x32_bf16 v[24:27], v[132:135], a[140:143], v[24:27]
    ds_read_b128 v[152:155], v10 offset:6144
    v_mfma_f32_16x16x32_bf16 v[24:27], v[128:131], a[132:135], v[24:27]
    s_waitcnt lgkmcnt(3)
    buffer_load_dwordx4 v1, s[16:19], s86 offen offset:3072 lds
    s_lshl2_add_u32 s86, s96, 4096
    v_mfma_f32_16x16x32_bf16 v[24:27], v[136:139], a[148:151], v[24:27]
    ds_read_b128 v[156:159], v10 offset:7168
    s_add_u32 m0, s96, 16384
    v_mfma_f32_16x16x32_bf16 v[24:27], v[140:143], a[156:159], v[24:27]
    v_mfma_f32_16x16x32_bf16 v[16:19], v[140:143], a[152:155], v[16:19]
    ds_read_b128 v[128:131], v10 offset:8192
    v_mfma_f32_16x16x32_bf16 v[16:19], v[136:139], a[144:147], v[16:19]
    s_waitcnt lgkmcnt(3)
    v_mfma_f32_16x16x32_bf16 v[16:19], v[144:147], a[160:163], v[16:19]
    ds_read_b128 v[132:135], v10 offset:9216
    v_mfma_f32_16x16x32_bf16 v[16:19], v[148:151], a[168:171], v[16:19]
    buffer_load_dwordx4 v1, s[16:19], s86 offen offset:0 lds
    v_mfma_f32_16x16x32_bf16 v[24:27], v[148:151], a[172:175], v[24:27]
    ds_read_b128 v[136:139], v10 offset:10240
    v_mfma_f32_16x16x32_bf16 v[24:27], v[144:147], a[164:167], v[24:27]
    s_waitcnt lgkmcnt(3)
    v_mfma_f32_16x16x32_bf16 v[24:27], v[152:155], a[180:183], v[24:27]
    ds_read_b128 v[140:143], v10 offset:11264
    v_mfma_f32_16x16x32_bf16 v[24:27], v[156:159], a[188:191], v[24:27]
    buffer_store_dwordx4 v[60:63], v1, s[4:7], s82 offen offset:3072 sc1
    v_mfma_f32_16x16x32_bf16 v[16:19], v[156:159], a[184:187], v[16:19]
    ds_read_b128 v[144:147], v10 offset:12288
    v_mfma_f32_16x16x32_bf16 v[16:19], v[152:155], a[176:179], v[16:19]
    s_waitcnt lgkmcnt(3)
    v_mfma_f32_16x16x32_bf16 v[16:19], v[128:131], a[192:195], v[16:19]
    ds_read_b128 v[148:151], v10 offset:13312
    v_mfma_f32_16x16x32_bf16 v[16:19], v[132:135], a[200:203], v[16:19]
    buffer_load_dwordx4 v1, s[16:19], s86 offen offset:1024 lds
    v_mfma_f32_16x16x32_bf16 v[24:27], v[132:135], a[204:207], v[24:27]
    ds_read_b128 v[152:155], v10 offset:14336
    v_mfma_f32_16x16x32_bf16 v[24:27], v[128:131], a[196:199], v[24:27]
    s_waitcnt lgkmcnt(3)
    buffer_load_dwordx4 v1, s[16:19], s86 offen offset:2048 lds
    v_mfma_f32_16x16x32_bf16 v[24:27], v[136:139], a[212:215], v[24:27]
    ds_read_b128 v[156:159], v10 offset:15360
    v_mfma_f32_16x16x32_bf16 v[24:27], v[140:143], a[220:223], v[24:27]
    buffer_load_dwordx4 v1, s[16:19], s86 offen offset:3072 lds
    s_lshl2_add_u32 s86, s96, 8192
    v_mfma_f32_16x16x32_bf16 v[16:19], v[140:143], a[216:219], v[16:19]
    ds_read_b128 v[128:131], v10 offset:16384
    s_add_u32 m0, s96, 32768
    v_mfma_f32_16x16x32_bf16 v[16:19], v[136:139], a[208:211], v[16:19]
    s_waitcnt lgkmcnt(3)
    v_mfma_f32_16x16x32_bf16 v[20:23], v[144:147], a[0:3], v[20:23]
    ds_read_b128 v[132:135], v10 offset:17408
    v_mfma_f32_16x16x32_bf16 v[20:23], v[148:151], a[8:11], v[20:23]
    v_mfma_f32_16x16x32_bf16 v[28:31], v[148:151], a[12:15], v[28:31]
    ds_read_b128 v[136:139], v10 offset:18432
    v_mfma_f32_16x16x32_bf16 v[28:31], v[144:147], a[4:7], v[28:31]
    s_waitcnt lgkmcnt(3)
    v_mfma_f32_16x16x32_bf16 v[28:31], v[152:155], a[20:23], v[28:31]
    ds_read_b128 v[140:143], v10 offset:19456
    v_mfma_f32_16x16x32_bf16 v[28:31], v[156:159], a[28:31], v[28:31]
    v_mfma_f32_16x16x32_bf16 v[20:23], v[156:159], a[24:27], v[20:23]
    ds_read_b128 v[144:147], v10 offset:20480
    v_mfma_f32_16x16x32_bf16 v[20:23], v[152:155], a[16:19], v[20:23]
    s_waitcnt lgkmcnt(3)
    buffer_load_dwordx4 v1, s[16:19], s86 offen offset:0 lds
    v_mfma_f32_16x16x32_bf16 v[20:23], v[128:131], a[32:35], v[20:23]
    ds_read_b128 v[148:151], v10 offset:21504
    v_mfma_f32_16x16x32_bf16 v[20:23], v[132:135], a[40:43], v[20:23]
    v_mfma_f32_16x16x32_bf16 v[28:31], v[132:135], a[44:47], v[28:31]
    ds_read_b128 v[152:155], v10 offset:22528
    v_mfma_f32_16x16x32_bf16 v[28:31], v[128:131], a[36:39], v[28:31]
    s_waitcnt lgkmcnt(3)
    v_mfma_f32_16x16x32_bf16 v[28:31], v[136:139], a[52:55], v[28:31]
    ds_read_b128 v[156:159], v10 offset:23552
    v_mfma_f32_16x16x32_bf16 v[28:31], v[140:143], a[60:63], v[28:31]
    buffer_load_dwordx4 v1, s[16:19], s86 offen offset:1024 lds
    v_mfma_f32_16x16x32_bf16 v[20:23], v[140:143], a[56:59], v[20:23]
    ds_read_b128 v[128:131], v10 offset:24576
    v_mfma_f32_16x16x32_bf16 v[20:23], v[136:139], a[48:51], v[20:23]
    s_waitcnt lgkmcnt(3)
    v_mfma_f32_16x16x32_bf16 v[20:23], v[144:147], a[64:67], v[20:23]
    ds_read_b128 v[132:135], v10 offset:25600
    v_mfma_f32_16x16x32_bf16 v[20:23], v[148:151], a[72:75], v[20:23]
    s_bitcmp0_b32 s57, 1
    s_cbranch_scc1 L_slow_27
L_back_28:
    buffer_load_dwordx4 v1, s[16:19], s86 offen offset:2048 lds
    v_mfma_f32_16x16x32_bf16 v[28:31], v[148:151], a[76:79], v[28:31]
    ds_read_b128 v[136:139], v10 offset:26624
    v_mfma_f32_16x16x32_bf16 v[28:31], v[144:147], a[68:71], v[28:31]
    s_waitcnt lgkmcnt(3)
    s_add_u32 s74, s74, 5242880
    buffer_load_dwordx4 v[224:227], v1, s[4:7], s74 offen offset:0 sc1
    v_mfma_f32_16x16x32_bf16 v[28:31], v[152:155], a[84:87], v[28:31]
    ds_read_b128 v[140:143], v10 offset:27648
    v_mfma_f32_16x16x32_bf16 v[28:31], v[156:159], a[92:95], v[28:31]
    v_mfma_f32_16x16x32_bf16 v[20:23], v[156:159], a[88:91], v[20:23]
    ds_read_b128 v[144:147], v10 offset:28672
    v_mfma_f32_16x16x32_bf16 v[20:23], v[152:155], a[80:83], v[20:23]
    s_waitcnt lgkmcnt(3)
    v_mfma_f32_16x16x32_bf16 v[20:23], v[128:131], a[96:99], v[20:23]
    ds_read_b128 v[148:151], v10 offset:29696
    v_mfma_f32_16x16x32_bf16 v[20:23], v[132:135], a[104:107], v[20:23]
L_hop14:
    s_cbranch_execz L_hop18
    v_mfma_f32_16x16x32_bf16 v[28:31], v[132:135], a[108:111], v[28:31]
    ds_read_b128 v[152:155], v10 offset:30720
    v_mfma_f32_16x16x32_bf16 v[28:31], v[128:131], a[100:103], v[28:31]
    s_waitcnt lgkmcnt(3)
    buffer_load_dwordx4 v1, s[16:19], s86 offen offset:3072 lds
    s_lshl2_add_u32 s86, s96, 12288
    v_mfma_f32_16x16x32_bf16 v[28:31], v[136:139], a[116:119], v[28:31]
    ds_read_b128 v[156:159], v10 offset:31744
    s_add_u32 m0, s96, 49152
    v_mfma_f32_16x16x32_bf16 v[28:31], v[140:143], a[124:127], v[28:31]
    s_barrier
    v_mfma_f32_16x16x32_bf16 v[20:23], v[140:143], a[120:123], v[20:23]
    ds_read_b128 v[128:131], v10 offset:32768
    v_mfma_f32_16x16x32_bf16 v[20:23], v[136:139], a[112:115], v[20:23]
    s_waitcnt vmcnt(12) lgkmcnt(3)
    buffer_load_dwordx4 v[228:231], v1, s[4:7], s74 offen offset:1024 sc1
    v_mfma_f32_16x16x32_bf16 v[20:23], v[144:147], a[128:131], v[20:23]
    ds_read_b128 v[132:135], v10 offset:33792
    v_lshlrev_b32 v112, 16, v176
    v_mfma_f32_16x16x32_bf16 v[20:23], v[148:151], a[136:139], v[20:23]
    v_and_b32 v113, 0xffff0000, v176
    v_lshlrev_b32 v114, 16, v177
    v_mfma_f32_16x16x32_bf16 v[28:31], v[148:151], a[140:143], v[28:31]
    ds_read_b128 v[136:139], v10 offset:34816
    v_and_b32 v115, 0xffff0000, v177
    v_mfma_f32_16x16x32_bf16 v[28:31], v[144:147], a[132:135], v[28:31]
    s_waitcnt lgkmcnt(3)
    v_lshlrev_b32 v116, 16, v178
    v_and_b32 v117, 0xffff0000, v178
    v_mfma_f32_16x16x32_bf16 v[28:31], v[152:155], a[148:151], v[28:31]
    ds_read_b128 v[140:143], v10 offset:35840
    v_lshlrev_b32 v118, 16, v179
    v_mfma_f32_16x16x32_bf16 v[28:31], v[156:159], a[156:159], v[28:31]
    v_and_b32 v119, 0xffff0000, v179
    v_lshlrev_b32 v120, 16, v180
    v_mfma_f32_16x16x32_bf16 v[20:23], v[156:159], a[152:155], v[20:23]
    ds_read_b128 v[144:147], v10 offset:36864
    v_and_b32 v121, 0xffff0000, v180
    v_mfma_f32_16x16x32_bf16 v[20:23], v[152:155], a[144:147], v[20:23]
    s_waitcnt lgkmcnt(3)
    buffer_load_dwordx4 v1, s[16:19], s86 offen offset:0 lds
    v_lshlrev_b32 v122, 16, v181
    v_mfma_f32_16x16x32_bf16 v[20:23], v[128:131], a[160:163], v[20:23]
    ds_read_b128 v[148:151], v10 offset:37888
    v_and_b32 v123, 0xffff0000, v181
    v_mfma_f32_16x16x32_bf16 v[20:23], v[132:135], a[168:171], v[20:23]
    s_waitcnt vmcnt(10)
    s_atomic_add s76, s[4:5], s79 offset:256
    v_lshlrev_b32 v124, 16, v182
    v_and_b32 v125, 0xffff0000, v182
    v_mfma_f32_16x16x32_bf16 v[28:31], v[132:135], a[172:175], v[28:31]
    ds_read_b128 v[152:155], v10 offset:38912
    v_lshlrev_b32 v126, 16, v183
    v_mfma_f32_16x16x32_bf16 v[28:31], v[128:131], a[164:167], v[28:31]
    s_waitcnt lgkmcnt(3)
    buffer_load_dwordx4 v[232:235], v1, s[4:7], s74 offen offset:2048 sc1
    v_and_b32 v127, 0xffff0000, v183
    v_mfma_f32_16x16x32_bf16 v[28:31], v[136:139], a[180:183], v[28:31]
    ds_read_b128 v[156:159], v10 offset:39936
    v_lshlrev_b32 v240, 16, v184
    v_mfma_f32_16x16x32_bf16 v[28:31], v[140:143], a[188:191], v[28:31]
    v_and_b32 v241, 0xffff0000, v184
    v_lshlrev_b32 v242, 16, v185
    v_mfma_f32_16x16x32_bf16 v[20:23], v[140:143], a[184:187], v[20:23]
    ds_read_b128 v[128:131], v10 offset:40960
    v_and_b32 v243, 0xffff0000, v185
    v_mfma_f32_16x16x32_bf16 v[20:23], v[136:139], a[176:179], v[20:23]
    s_waitcnt lgkmcnt(3)
    buffer_load_dwordx4 v1, s[16:19], s86 offen offset:1024 lds
    v_lshlrev_b32 v244, 16, v186
    v_mfma_f32_16x16x32_bf16 v[20:23], v[144:147], a[192:195], v[20:23]
    ds_read_b128 v[132:135], v10 offset:41984
    v_and_b32 v245, 0xffff0000, v186
    v_mfma_f32_16x16x32_bf16 v[20:23], v[148:151], a[200:203], v[20:23]
    v_lshlrev_b32 v246, 16, v187
    v_and_b32 v247, 0xffff0000, v187
    v_mfma_f32_16x16x32_bf16 v[28:31], v[148:151], a[204:207], v[28:31]
    ds_read_b128 v[136:139], v10 offset:43008
    v_lshlrev_b32 v248, 16, v188
    v_mfma_f32_16x16x32_bf16 v[28:31], v[144:147], a[196:199], v[28:31]
    s_waitcnt lgkmcnt(3)
    v_and_b32 v249, 0xffff0000, v188
    v_lshlrev_b32 v250, 16, v189
    v_mfma_f32_16x16x32_bf16 v[28:31], v[152:155], a[212:215], v[28:31]
    ds_read_b128 v[140:143], v10 offset:44032
    v_and_b32 v251, 0xffff0000, v189
    v_mfma_f32_16x16x32_bf16 v[28:31], v[156:159], a[220:223], v[28:31]
    buffer_load_dwordx4 v1, s[16:19], s86 offen offset:2048 lds
    v_lshlrev_b32 v252, 16, v190
    v_mfma_f32_16x16x32_bf16 v[20:23], v[156:159], a[216:219], v[20:23]
    ds_read_b128 v[144:147], v10 offset:45056
    v_and_b32 v253, 0xffff0000, v190
    v_mfma_f32_16x16x32_bf16 v[20:23], v[152:155], a[208:211], v[20:23]
    s_waitcnt lgkmcnt(3)
    buffer_load_dwordx4 v[236:239], v1, s[4:7], s74 offen offset:3072 sc1
    v_lshlrev_b32 v254, 16, v191
    v_mfma_f32_16x16x32_bf16 v[32:35], v[128:131], a[0:3], v[32:35]
    ds_read_b128 v[148:151], v10 offset:46080
    v_and_b32 v255, 0xffff0000, v191
    v_mfma_f32_16x16x32_bf16 v[32:35], v[132:135], a[8:11], v[32:35]
    s_waitcnt vmcnt(11)
    buffer_load_dwordx4 v1, s[16:19], s86 offen offset:3072 lds
    s_add_u32 m0, s96, 147456
    v_mfma_f32_16x16x32_bf16 v[40:43], v[132:135], a[12:15], v[40:43]
    ds_read_b128 v[152:155], v10 offset:47104
    s_add_u32 s90, s95, 901120
    v_mfma_f32_16x16x32_bf16 v[40:43], v[128:131], a[4:7], v[40:43]
    s_waitcnt lgkmcnt(3)
    ds_read_b64_tr_b16 a[224:225], v13 offset:0
    v_mfma_f32_16x16x32_bf16 v[40:43], v[136:139], a[20:23], v[40:43]
    ds_read_b128 v[156:159], v10 offset:48128
    v_mfma_f32_16x16x32_bf16 v[40:43], v[140:143], a[28:31], v[40:43]
    ds_read_b64_tr_b16 a[226:227], v13 offset:1024
    v_mfma_f32_16x16x32_bf16 v[32:35], v[140:143], a[24:27], v[32:35]
    ds_read_b128 v[128:131], v10 offset:49152
    v_mfma_f32_16x16x32_bf16 v[32:35], v[136:139], a[16:19], v[32:35]
    s_waitcnt lgkmcnt(5)
    ds_read_b64_tr_b16 a[228:229], v13 offset:32
    v_mfma_f32_16x16x32_bf16 v[32:35], v[144:147], a[32:35], v[32:35]
    ds_read_b128 v[132:135], v10 offset:50176
    v_mfma_f32_16x16x32_bf16 v[32:35], v[148:151], a[40:43], v[32:35]
    ds_read_b64_tr_b16 a[230:231], v13 offset:1056
    v_mfma_f32_16x16x32_bf16 v[40:43], v[148:151], a[44:47], v[40:43]
    ds_read_b128 v[136:139], v10 offset:51200
    v_mfma_f32_16x16x32_bf16 v[40:43], v[144:147], a[36:39], v[40:43]
    s_waitcnt lgkmcnt(6)
    buffer_load_dwordx4 v1, s[4:7], s90 offen offset:0 sc1 lds
    v_mfma_f32_16x16x32_bf16 v[40:43], v[152:155], a[52:55], v[40:43]
    ds_read_b128 v[140:143], v10 offset:52224
    v_mfma_f32_16x16x32_bf16 v[40:43], v[156:159], a[60:63], v[40:43]
    s_mov_b32 s57, 0
    s_atomic_add s57, s[4:5], s73 offset:256 glc
    ds_read_b64_tr_b16 a[232:233], v13 offset:2048
    v_mfma_f32_16x16x32_bf16 v[32:35], v[156:159], a[56:59], v[32:35]
    ds_read_b128 v[144:147], v10 offset:53248
    v_mfma_f32_16x16x32_bf16 v[32:35], v[152:155], a[48:51], v[32:35]
    s_waitcnt lgkmcnt(5)
    buffer_load_dwordx4 v1, s[4:7], s90 offen offset:1024 sc1 lds
    v_mfma_f32_16x16x32_bf16 v[32:35], v[128:131], a[64:67], v[32:35]
    ds_read_b128 v[148:151], v10 offset:54272
    v_mfma_f32_16x16x32_bf16 v[32:35], v[132:135], a[72:75], v[32:35]
    ds_read_b64_tr_b16 a[234:235], v13 offset:3072
    v_mfma_f32_16x16x32_bf16 v[40:43], v[132:135], a[76:79], v[40:43]
    ds_read_b128 v[152:155], v10 offset:55296
    v_mfma_f32_16x16x32_bf16 v[40:43], v[128:131], a[68:71], v[40:43]
    s_waitcnt lgkmcnt(5)
    ds_read_b64_tr_b16 a[236:237], v13 offset:2080
    v_mfma_f32_16x16x32_bf16 v[40:43], v[136:139], a[84:87], v[40:43]
    ds_read_b128 v[156:159], v10 offset:56320
    v_mfma_f32_16x16x32_bf16 v[40:43], v[140:143], a[92:95], v[40:43]
    buffer_load_dwordx4 v1, s[4:7], s90 offen offset:2048 sc1 lds
    v_mfma_f32_16x16x32_bf16 v[32:35], v[140:143], a[88:91], v[32:35]
    ds_read_b128 v[128:131], v10 offset:57344
    v_mfma_f32_16x16x32_bf16 v[32:35], v[136:139], a[80:83], v[32:35]
    s_waitcnt lgkmcnt(5)
    ds_read_b64_tr_b16 a[238:239], v13 offset:3104
    v_mfma_f32_16x16x32_bf16 v[32:35], v[144:147], a[96:99], v[32:35]
    ds_read_b128 v[132:135], v10 offset:58368
    v_mfma_f32_16x16x32_bf16 v[32:35], v[148:151], a[104:107], v[32:35]
    buffer_load_dwordx4 v1, s[4:7], s90 offen offset:3072 sc1 lds
    s_add_u32 s86, s3, 4
    v_mfma_f32_16x16x32_bf16 v[40:43], v[148:151], a[108:111], v[40:43]
    ds_read_b128 v[136:139], v10 offset:59392
    s_and_b32 s86, s86, 7
    v_mfma_f32_16x16x32_bf16 v[40:43], v[144:147], a[100:103], v[40:43]
    s_waitcnt lgkmcnt(4)
    s_lshl_b32 s86, s86, 18
    s_add_u32 s86, s86, s88
    v_mfma_f32_16x16x32_bf16 v[40:43], v[152:155], a[116:119], v[40:43]
    ds_read_b128 v[140:143], v10 offset:60416
    s_add_u32 m0, s96, 65536
    v_mfma_f32_16x16x32_bf16 v[40:43], v[156:159], a[124:127], v[40:43]
    buffer_load_dwordx4 v5, s[12:15], s86 offen offset:0 lds
    s_add_u32 s86, s86, 15360
    v_mfma_f32_16x16x32_bf16 v[32:35], v[156:159], a[120:123], v[32:35]
    ds_read_b128 v[144:147], v10 offset:61440
    v_mfma_f32_16x16x32_bf16 v[32:35], v[152:155], a[112:115], v[32:35]
    s_waitcnt lgkmcnt(3)
    ds_read_b64_tr_b16 a[240:241], v13 offset:16384
    v_mfma_f32_16x16x32_bf16 v[32:35], v[128:131], a[128:131], v[32:35]
    ds_read_b128 v[148:151], v10 offset:62464
    v_mfma_f32_16x16x32_bf16 v[32:35], v[132:135], a[136:139], v[32:35]
    ds_read_b64_tr_b16 a[242:243], v13 offset:17408
    v_mfma_f32_16x16x32_bf16 v[40:43], v[132:135], a[140:143], v[40:43]
    ds_read_b128 v[152:155], v10 offset:63488
    v_mfma_f32_16x16x32_bf16 v[40:43], v[128:131], a[132:135], v[40:43]
    s_waitcnt lgkmcnt(5)
    buffer_load_dwordx4 v5, s[12:15], s86 offen offset:1024 lds
    s_add_u32 s86, s86, 15360
    v_mfma_f32_16x16x32_bf16 v[40:43], v[136:139], a[148:151], v[40:43]
    ds_read_b128 v[156:159], v10 offset:64512
    v_mfma_f32_16x16x32_bf16 v[40:43], v[140:143], a[156:159], v[40:43]
    s_barrier
    v_mfma_f32_16x16x32_bf16 v[32:35], v[140:143], a[152:155], v[32:35]
    ds_read_b128 v[128:131], v11 offset:0
    v_mfma_f32_16x16x32_bf16 v[32:35], v[136:139], a[144:147], v[32:35]
    s_waitcnt lgkmcnt(4)
    ds_read_b64_tr_b16 a[244:245], v13 offset:16416
    v_mfma_f32_16x16x32_bf16 v[32:35], v[144:147], a[160:163], v[32:35]
    ds_read_b128 v[132:135], v11 offset:1024
    v_mfma_f32_16x16x32_bf16 v[32:35], v[148:151], a[168:171], v[32:35]
    buffer_load_dwordx4 v5, s[12:15], s86 offen offset:2048 lds
    s_add_u32 s86, s86, 15360
    v_mfma_f32_16x16x32_bf16 v[40:43], v[148:151], a[172:175], v[40:43]
    ds_read_b128 v[136:139], v11 offset:2048
    v_mfma_f32_16x16x32_bf16 v[40:43], v[144:147], a[164:167], v[40:43]
    s_waitcnt lgkmcnt(4)
    ds_read_b64_tr_b16 a[246:247], v13 offset:17440
    v_mfma_f32_16x16x32_bf16 v[40:43], v[152:155], a[180:183], v[40:43]
    ds_read_b128 v[140:143], v11 offset:3072
    v_mfma_f32_16x16x32_bf16 v[40:43], v[156:159], a[188:191], v[40:43]
    ds_read_b64_tr_b16 a[248:249], v13 offset:18432
    v_mfma_f32_16x16x32_bf16 v[32:35], v[156:159], a[184:187], v[32:35]
    ds_read_b128 v[144:147], v11 offset:4096
    v_mfma_f32_16x16x32_bf16 v[32:35], v[152:155], a[176:179], v[32:35]
    s_waitcnt lgkmcnt(5)
    buffer_load_dwordx4 v5, s[12:15], s86 offen offset:3072 lds
    s_add_u32 s86, s3, 5
    v_mfma_f32_16x16x32_bf16 v[32:35], v[128:131], a[192:195], v[32:35]
    ds_read_b128 v[148:151], v11 offset:5120
    s_and_b32 s86, s86, 7
    v_mfma_f32_16x16x32_bf16 v[32:35], v[132:135], a[200:203], v[32:35]
    s_waitcnt vmcnt(9)
    s_lshl_b32 s86, s86, 18
    s_add_u32 s86, s86, s88
    v_mfma_f32_16x16x32_bf16 v[40:43], v[132:135], a[204:207], v[40:43]
    ds_read_b128 v[152:155], v11 offset:6144
    s_add_u32 m0, s96, 81920
    v_mfma_f32_16x16x32_bf16 v[40:43], v[128:131], a[196:199], v[40:43]
    s_waitcnt lgkmcnt(4)
    buffer_load_dwordx4 v5, s[12:15], s86 offen offset:0 lds
    s_add_u32 s86, s86, 15360
    v_mfma_f32_16x16x32_bf16 v[40:43], v[136:139], a[212:215], v[40:43]
    ds_read_b128 v[156:159], v11 offset:7168
    v_lshlrev_b32 v104, 16, v224
    v_mfma_f32_16x16x32_bf16 v[40:43], v[140:143], a[220:223], v[40:43]
    ds_read_b64_tr_b16 a[250:251], v13 offset:19456
    v_add_f32 v112, v112, v104
    v_mfma_f32_16x16x32_bf16 v[32:35], v[140:143], a[216:219], v[32:35]
    ds_read_b128 v[128:131], v11 offset:8192
    v_and_b32 v105, 0xffff0000, v224
    v_mfma_f32_16x16x32_bf16 v[32:35], v[136:139], a[208:211], v[32:35]
    s_waitcnt lgkmcnt(4)
    buffer_load_dwordx4 v5, s[12:15], s86 offen offset:1024 lds
    s_add_u32 s86, s86, 15360
    v_mfma_f32_16x16x32_bf16 v[36:39], v[144:147], a[0:3], v[36:39]
    ds_read_b128 v[132:135], v11 offset:9216
    v_add_f32 v113, v113, v105
    v_mfma_f32_16x16x32_bf16 v[36:39], v[148:151], a[8:11], v[36:39]
    s_bitcmp0_b32 s57, 2
    s_cbranch_scc1 L_slow_29
L_back_30:
    ds_read_b64_tr_b16 a[252:253], v13 offset:18464
    v_lshlrev_b32 v106, 16, v225
    v_mfma_f32_16x16x32_bf16 v[44:47], v[148:151], a[12:15], v[44:47]
    ds_read_b128 v[136:139], v11 offset:10240
    v_add_f32 v114, v114, v106
    v_mfma_f32_16x16x32_bf16 v[44:47], v[144:147], a[4:7], v[44:47]
    s_waitcnt lgkmcnt(5)
    s_add_u32 s74, s74, 5242880
    buffer_load_dwordx4 v[160:163], v1, s[4:7], s74 offen offset:0 sc1
    v_and_b32 v107, 0xffff0000, v225
    v_mfma_f32_16x16x32_bf16 v[44:47], v[152:155], a[20:23], v[44:47]
    ds_read_b128 v[140:143], v11 offset:11264
    v_add_f32 v115, v115, v107
    v_mfma_f32_16x16x32_bf16 v[44:47], v[156:159], a[28:31], v[44:47]
    s_waitcnt vmcnt(11)
    ds_read_b64_tr_b16 a[254:255], v13 offset:19488
    v_lshlrev_b32 v108, 16, v226
    v_mfma_f32_16x16x32_bf16 v[36:39], v[156:159], a[24:27], v[36:39]
    ds_read_b128 v[144:147], v11 offset:12288
    v_add_f32 v116, v116, v108
    v_mfma_f32_16x16x32_bf16 v[36:39], v[152:155], a[16:19], v[36:39]
    s_waitcnt lgkmcnt(5)
    buffer_load_dwordx4 v[164:167], v1, s[4:7], s74 offen offset:1024 sc1
    v_and_b32 v109, 0xffff0000, v226
    v_mfma_f32_16x16x32_bf16 v[36:39], v[128:131], a[32:35], v[36:39]
    ds_read_b128 v[148:151], v11 offset:13312
    v_add_f32 v117, v117, v109
    v_mfma_f32_16x16x32_bf16 v[36:39], v[132:135], a[40:43], v[36:39]
    ds_read_b64_tr_b16 v[64:65], v13 offset:32768
    v_lshlrev_b32 v110, 16, v227
    v_mfma_f32_16x16x32_bf16 v[44:47], v[132:135], a[44:47], v[44:47]
    ds_read_b128 v[152:155], v11 offset:14336
    v_add_f32 v118, v118, v110
    v_mfma_f32_16x16x32_bf16 v[44:47], v[128:131], a[36:39], v[44:47]
    s_waitcnt lgkmcnt(5)
    buffer_load_dwordx4 v[168:171], v1, s[4:7], s74 offen offset:2048 sc1
    v_and_b32 v111, 0xffff0000, v227
    v_mfma_f32_16x16x32_bf16 v[44:47], v[136:139], a[52:55], v[44:47]
    ds_read_b128 v[156:159], v11 offset:15360
    v_add_f32 v119, v119, v111
    v_mfma_f32_16x16x32_bf16 v[44:47], v[140:143], a[60:63], v[44:47]
    s_waitcnt vmcnt(9)
    s_barrier
    v_mfma_f32_16x16x32_bf16 v[36:39], v[140:143], a[56:59], v[36:39]
    ds_read_b128 v[128:131], v11 offset:16384
    v_lshlrev_b32 v104, 16, v228
    v_mfma_f32_16x16x32_bf16 v[36:39], v[136:139], a[48:51], v[36:39]
    s_waitcnt lgkmcnt(4)
    buffer_load_dwordx4 v[172:175], v1, s[4:7], s74 offen offset:3072 sc1
    v_add_f32 v120, v120, v104
    v_mfma_f32_16x16x32_bf16 v[36:39], v[144:147], a[64:67], v[36:39]
    ds_read_b128 v[132:135], v11 offset:17408
    v_and_b32 v105, 0xffff0000, v228
    v_mfma_f32_16x16x32_bf16 v[36:39], v[148:151], a[72:75], v[36:39]
    ds_read_b64_tr_b16 v[66:67], v13 offset:33792
    v_add_f32 v121, v121, v105
    v_mfma_f32_16x16x32_bf16 v[44:47], v[148:151], a[76:79], v[44:47]
    ds_read_b128 v[136:139], v11 offset:18432
    v_lshlrev_b32 v106, 16, v229
    v_mfma_f32_16x16x32_bf16 v[44:47], v[144:147], a[68:71], v[44:47]
    s_waitcnt lgkmcnt(4)
    ds_read_b64_tr_b16 v[68:69], v13 offset:32800
    v_add_f32 v122, v122, v106
    v_mfma_f32_16x16x32_bf16 v[44:47], v[152:155], a[84:87], v[44:47]
    ds_read_b128 v[140:143], v11 offset:19456
    v_and_b32 v107, 0xffff0000, v229
    v_mfma_f32_16x16x32_bf16 v[44:47], v[156:159], a[92:95], v[44:47]
    ds_read_b64_tr_b16 v[70:71], v13 offset:33824
    v_add_f32 v123, v123, v107
    v_mfma_f32_16x16x32_bf16 v[36:39], v[156:159], a[88:91], v[36:39]
    ds_read_b128 v[144:147], v11 offset:20480
    v_lshlrev_b32 v108, 16, v230
    v_mfma_f32_16x16x32_bf16 v[36:39], v[152:155], a[80:83], v[36:39]
    s_waitcnt lgkmcnt(6)
    ds_read_b64_tr_b16 v[72:73], v13 offset:34816
    v_add_f32 v124, v124, v108
    v_mfma_f32_16x16x32_bf16 v[36:39], v[128:131], a[96:99], v[36:39]
    ds_read_b128 v[148:151], v11 offset:21504
    v_and_b32 v109, 0xffff0000, v230
    v_mfma_f32_16x16x32_bf16 v[36:39], v[132:135], a[104:107], v[36:39]
    buffer_load_dwordx4 v5, s[12:15], s86 offen offset:2048 lds
    s_add_u32 s86, s86, 15360
    v_mfma_f32_16x16x32_bf16 v[44:47], v[132:135], a[108:111], v[44:47]
    ds_read_b128 v[152:155], v11 offset:22528
    v_add_f32 v125, v125, v109
    v_mfma_f32_16x16x32_bf16 v[44:47], v[128:131], a[100:103], v[44:47]
    s_waitcnt lgkmcnt(5)
    ds_read_b64_tr_b16 v[74:75], v13 offset:35840
    v_lshlrev_b32 v110, 16, v231
    v_mfma_f32_16x16x32_bf16 v[44:47], v[136:139], a[116:119], v[44:47]
    ds_read_b128 v[156:159], v11 offset:23552
    v_add_f32 v126, v126, v110
    v_mfma_f32_16x16x32_bf16 v[44:47], v[140:143], a[124:127], v[44:47]
    ds_read_b64_tr_b16 v[76:77], v13 offset:34848
    v_and_b32 v111, 0xffff0000, v231
    v_mfma_f32_16x16x32_bf16 v[36:39], v[140:143], a[120:123], v[36:39]
    ds_read_b128 v[128:131], v11 offset:24576
    v_add_f32 v127, v127, v111
    v_mfma_f32_16x16x32_bf16 v[36:39], v[136:139], a[112:115], v[36:39]
    s_waitcnt lgkmcnt(5)
    buffer_load_dwordx4 v5, s[12:15], s86 offen offset:3072 lds
    v_lshlrev_b32 v104, 16, v232
    v_mfma_f32_16x16x32_bf16 v[36:39], v[144:147], a[128:131], v[36:39]
    ds_read_b128 v[132:135], v11 offset:25600
    v_add_f32 v240, v240, v104
    v_mfma_f32_16x16x32_bf16 v[36:39], v[148:151], a[136:139], v[36:39]
    ds_read_b64_tr_b16 v[78:79], v13 offset:35872
    v_and_b32 v105, 0xffff0000, v232
    v_mfma_f32_16x16x32_bf16 v[44:47], v[148:151], a[140:143], v[44:47]
    ds_read_b128 v[136:139], v11 offset:26624
    v_add_f32 v241, v241, v105
    v_mfma_f32_16x16x32_bf16 v[44:47], v[144:147], a[132:135], v[44:47]
    s_waitcnt lgkmcnt(5)
    ds_read_b64_tr_b16 v[80:81], v13 offset:49152
    v_lshlrev_b32 v106, 16, v233
    v_mfma_f32_16x16x32_bf16 v[44:47], v[152:155], a[148:151], v[44:47]
    ds_read_b128 v[140:143], v11 offset:27648
    v_add_f32 v242, v242, v106
    v_mfma_f32_16x16x32_bf16 v[44:47], v[156:159], a[156:159], v[44:47]
    ds_read_b64_tr_b16 v[82:83], v13 offset:50176
    v_and_b32 v107, 0xffff0000, v233
    v_mfma_f32_16x16x32_bf16 v[36:39], v[156:159], a[152:155], v[36:39]
    ds_read_b128 v[144:147], v11 offset:28672
    v_add_f32 v243, v243, v107
    v_mfma_f32_16x16x32_bf16 v[36:39], v[152:155], a[144:147], v[36:39]
    s_waitcnt lgkmcnt(6)
    ds_read_b64_tr_b16 v[84:85], v13 offset:49184
    v_lshlrev_b32 v108, 16, v234
    v_mfma_f32_16x16x32_bf16 v[36:39], v[128:131], a[160:163], v[36:39]
    ds_read_b128 v[148:151], v11 offset:29696
    v_add_f32 v244, v244, v108
    v_mfma_f32_16x16x32_bf16 v[36:39], v[132:135], a[168:171], v[36:39]
    ds_read_b64_tr_b16 v[86:87], v13 offset:50208
    v_and_b32 v109, 0xffff0000, v234
    v_mfma_f32_16x16x32_bf16 v[44:47], v[132:135], a[172:175], v[44:47]
    ds_read_b128 v[152:155], v11 offset:30720
    v_add_f32 v245, v245, v109
    v_mfma_f32_16x16x32_bf16 v[44:47], v[128:131], a[164:167], v[44:47]
    s_waitcnt lgkmcnt(6)
    ds_read_b64_tr_b16 v[88:89], v13 offset:51200
    v_lshlrev_b32 v110, 16, v235
    v_mfma_f32_16x16x32_bf16 v[44:47], v[136:139], a[180:183], v[44:47]
    ds_read_b128 v[156:159], v11 offset:31744
    v_add_f32 v246, v246, v110
    v_mfma_f32_16x16x32_bf16 v[44:47], v[140:143], a[188:191], v[44:47]
    ds_read_b64_tr_b16 v[90:91], v13 offset:52224
    v_and_b32 v111, 0xffff0000, v235
    v_mfma_f32_16x16x32_bf16 v[36:39], v[140:143], a[184:187], v[36:39]
    ds_read_b64_tr_b16 v[92:93], v13 offset:51232
    v_add_f32 v247, v247, v111
    v_mfma_f32_16x16x32_bf16 v[36:39], v[136:139], a[176:179], v[36:39]
    s_waitcnt lgkmcnt(6)
    ds_read_b64_tr_b16 v[94:95], v13 offset:52256
    v_lshlrev_b32 v104, 16, v236
    v_mfma_f32_16x16x32_bf16 v[36:39], v[144:147], a[192:195], v[36:39]
    v_add_f32 v248, v248, v104
    v_and_b32 v105, 0xffff0000, v236
    v_mfma_f32_16x16x32_bf16 v[36:39], v[148:151], a[200:203], v[36:39]
    v_add_f32 v249, v249, v105
    v_lshlrev_b32 v106, 16, v237
    v_mfma_f32_16x16x32_bf16 v[44:47], v[148:151], a[204:207], v[44:47]
    v_add_f32 v250, v250, v106
    v_and_b32 v107, 0xffff0000, v237
    v_mfma_f32_16x16x32_bf16 v[44:47], v[144:147], a[196:199], v[44:47]
    s_waitcnt lgkmcnt(3)
    v_add_f32 v251, v251, v107
    v_lshlrev_b32 v108, 16, v238
    v_mfma_f32_16x16x32_bf16 v[44:47], v[152:155], a[212:215], v[44:47]
    v_add_f32 v252, v252, v108
    v_and_b32 v109, 0xffff0000, v238
    v_mfma_f32_16x16x32_bf16 v[44:47], v[156:159], a[220:223], v[44:47]
    v_add_f32 v253, v253, v109
    v_lshlrev_b32 v110, 16, v239
    v_mfma_f32_16x16x32_bf16 v[36:39], v[156:159], a[216:219], v[36:39]
    v_add_f32 v254, v254, v110
    v_and_b32 v111, 0xffff0000, v239
    v_mfma_f32_16x16x32_bf16 v[36:39], v[152:155], a[208:211], v[36:39]
    v_add_f32 v255, v255, v111
    s_add_u32 s67, s56, 50331648
    s_lshl_b32 s93, s54, 16
    s_lshl_b32 s60, s53, 12
    s_add_u32 s93, s93, s60
    s_lshr_b32 s94, s93, 4
    s_add_u32 s93, s93, s67
    s_add_u32 s94, s94, s67
    s_add_u32 s94, s94, 47185920
    s_waitcnt lgkmcnt(0)
    s_mov_b32 s61, 0x00003f80
    s_mov_b32 s62, 0x3f800000
    v_pk_add_f32 v[16:17], v[16:17], v[112:113]
    v_pk_add_f32 v[18:19], v[18:19], v[114:115]
    v_pk_add_f32 v[20:21], v[20:21], v[116:117]
    v_pk_add_f32 v[22:23], v[22:23], v[118:119]
    v_pk_add_f32 v[24:25], v[24:25], v[120:121]
    v_pk_add_f32 v[26:27], v[26:27], v[122:123]
    v_pk_add_f32 v[28:29], v[28:29], v[124:125]
    v_pk_add_f32 v[30:31], v[30:31], v[126:127]
    v_pk_add_f32 v[32:33], v[32:33], v[240:241]
    v_pk_add_f32 v[34:35], v[34:35], v[242:243]
    v_pk_add_f32 v[36:37], v[36:37], v[244:245]
    v_pk_add_f32 v[38:39], v[38:39], v[246:247]
    v_pk_add_f32 v[40:41], v[40:41], v[248:249]
    v_pk_add_f32 v[42:43], v[42:43], v[250:251]
    v_pk_add_f32 v[44:45], v[44:45], v[252:253]
    v_pk_add_f32 v[46:47], v[46:47], v[254:255]
    s_waitcnt vmcnt(2)
    v_dot2_f32_bf16 v16, v160, s61, v16
    v_dot2_f32_bf16 v17, v160, s62, v17
    v_dot2_f32_bf16 v18, v161, s61, v18
    v_dot2_f32_bf16 v19, v161, s62, v19
    v_dot2_f32_bf16 v20, v162, s61, v20
    v_dot2_f32_bf16 v21, v162, s62, v21
    v_dot2_f32_bf16 v22, v163, s61, v22
    v_dot2_f32_bf16 v23, v163, s62, v23
    v_dot2_f32_bf16 v24, v164, s61, v24
    v_dot2_f32_bf16 v25, v164, s62, v25
    v_dot2_f32_bf16 v26, v165, s61, v26
    v_dot2_f32_bf16 v27, v165, s62, v27
    v_dot2_f32_bf16 v28, v166, s61, v28
    v_dot2_f32_bf16 v29, v166, s62, v29
    v_dot2_f32_bf16 v30, v167, s61, v30
    v_dot2_f32_bf16 v31, v167, s62, v31
    v_dot2_f32_bf16 v32, v168, s61, v32
    v_dot2_f32_bf16 v33, v168, s62, v33
    v_dot2_f32_bf16 v34, v169, s61, v34
    v_dot2_f32_bf16 v35, v169, s62, v35
    v_dot2_f32_bf16 v36, v170, s61, v36
    v_dot2_f32_bf16 v37, v170, s62, v37
    v_dot2_f32_bf16 v38, v171, s61, v38
    v_dot2_f32_bf16 v39, v171, s62, v39
    v_dot2_f32_bf16 v40, v172, s61, v40
    v_dot2_f32_bf16 v41, v172, s62, v41
    v_dot2_f32_bf16 v42, v173, s61, v42
    v_dot2_f32_bf16 v43, v173, s62, v43
    v_dot2_f32_bf16 v44, v174, s61, v44
    v_dot2_f32_bf16 v45, v174, s62, v45
    v_dot2_f32_bf16 v46, v175, s61, v46
    v_dot2_f32_bf16 v47, v175, s62, v47
    v_cvt_pk_bf16_f32 v48, v16, v17
    v_cvt_pk_bf16_f32 v49, v18, v19
    v_cvt_pk_bf16_f32 v50, v20, v21
    v_cvt_pk_bf16_f32 v51, v22, v23
    v_cvt_pk_bf16_f32 v52, v24, v25
    v_cvt_pk_bf16_f32 v53, v26, v27
    v_cvt_pk_bf16_f32 v54, v28, v29
    v_cvt_pk_bf16_f32 v55, v30, v31
    v_cvt_pk_bf16_f32 v56, v32, v33
    v_cvt_pk_bf16_f32 v57, v34, v35
    v_cvt_pk_bf16_f32 v58, v36, v37
    v_cvt_pk_bf16_f32 v59, v38, v39
    v_cvt_pk_bf16_f32 v60, v40, v41
    v_cvt_pk_bf16_f32 v61, v42, v43
    v_cvt_pk_bf16_f32 v62, v44, v45
    v_cvt_pk_bf16_f32 v63, v46, v47
    s_cmp_lg_u32 s55, 0
    s_cbranch_scc1 L_out
    buffer_store_dwordx4 v[48:51], v1, s[4:7], s93 offen offset:0 sc1
    buffer_store_dwordx4 v[52:55], v1, s[4:7], s93 offen offset:1024 sc1
    buffer_store_dwordx4 v[56:59], v1, s[4:7], s93 offen offset:2048 sc1
    buffer_store_dwordx4 v[60:63], v1, s[4:7], s93 offen offset:3072 sc1
    s_mov_b32 s66, 0x3f803f80
    v_and_b32 v107, 0xf0, v1
    v_lshrrev_b32 v106, 4, v0
    v_lshl_or_b32 v107, v106, 2, v107
    v_dot2_f32_bf16 v108, v48, s66, 0
    v_dot2_f32_bf16 v110, v48, v48, 0
    v_dot2_f32_bf16 v109, v52, s66, 0
    v_dot2_f32_bf16 v111, v52, v52, 0
    v_dot2_f32_bf16 v108, v49, s66, v108
    v_dot2_f32_bf16 v110, v49, v49, v110
    v_dot2_f32_bf16 v109, v53, s66, v109
    v_dot2_f32_bf16 v111, v53, v53, v111
    v_dot2_f32_bf16 v108, v50, s66, v108
    v_dot2_f32_bf16 v110, v50, v50, v110
    v_dot2_f32_bf16 v109, v54, s66, v109
    v_dot2_f32_bf16 v111, v54, v54, v111
    v_dot2_f32_bf16 v108, v51, s66, v108
    v_dot2_f32_bf16 v110, v51, v51, v110
    v_dot2_f32_bf16 v109, v55, s66, v109
    v_dot2_f32_bf16 v111, v55, v55, v111
    v_dot2_f32_bf16 v108, v56, s66, v108
    v_dot2_f32_bf16 v110, v56, v56, v110
    v_dot2_f32_bf16 v109, v60, s66, v109
    v_dot2_f32_bf16 v111, v60, v60, v111
    v_dot2_f32_bf16 v108, v57, s66, v108
    v_dot2_f32_bf16 v110, v57, v57, v110
    v_dot2_f32_bf16 v109, v61, s66, v109
    v_dot2_f32_bf16 v111, v61, v61, v111
    v_dot2_f32_bf16 v108, v58, s66, v108
    v_dot2_f32_bf16 v110, v58, v58, v110
    v_dot2_f32_bf16 v109, v62, s66, v109
    v_dot2_f32_bf16 v111, v62, v62, v111
    v_dot2_f32_bf16 v108, v59, s66, v108
    v_dot2_f32_bf16 v110, v59, v59, v110
    v_dot2_f32_bf16 v109, v63, s66, v109
    v_dot2_f32_bf16 v111, v63, v63, v111
    s_nop 0
    v_permlane32_swap_b32 v108, v110
    s_nop 0
    v_permlane32_swap_b32 v109, v111
    v_add_f32 v108, v108, v110
    v_add_f32 v109, v109, v111
    s_nop 1
    v_permlane16_swap_b32 v108, v109
    v_add_f32 v108, v108, v109
    buffer_store_dword v108, v107, s[4:7], s94 offen sc1
    s_add_u32 s87, s49, 0
    s_and_b32 s87, s87, 3
    s_add_u32 s86, s87, s3
    s_lshl_b32 s87, s87, 14
    s_add_u32 m0, s87, s96
    s_and_b32 s86, s86, 7
    s_lshl_b32 s86, s86, 18
    s_add_u32 s86, s86, s88
    buffer_load_dwordx4 v5, s[12:15], s86 offen offset:0 lds
    s_add_u32 s86, s86, 15360
    buffer_load_dwordx4 v5, s[12:15], s86 offen offset:1024 lds
    s_add_u32 s86, s86, 15360
    buffer_load_dwordx4 v5, s[12:15], s86 offen offset:2048 lds
    s_add_u32 s86, s86, 15360
    buffer_load_dwordx4 v5, s[12:15], s86 offen offset:3072 lds
    s_add_u32 s87, s49, 1
    s_and_b32 s87, s87, 3
    s_add_u32 s86, s87, s3
    s_lshl_b32 s87, s87, 14
    s_add_u32 m0, s87, s96
    s_and_b32 s86, s86, 7
    s_lshl_b32 s86, s86, 18
    s_add_u32 s86, s86, s88
    buffer_load_dwordx4 v5, s[12:15], s86 offen offset:0 lds
    s_add_u32 s86, s86, 15360
    buffer_load_dwordx4 v5, s[12:15], s86 offen offset:1024 lds
    s_add_u32 s86, s86, 15360
    buffer_load_dwordx4 v5, s[12:15], s86 offen offset:2048 lds
    s_add_u32 s86, s86, 15360
    buffer_load_dwordx4 v5, s[12:15], s86 offen offset:3072 lds
    s_mov_b32 s55, 1
    s_add_u32 s56, s56, 50331648
    s_add_u32 s59, s59, 4
    s_add_u32 s91, s91, 4
    s_lshr_b32 s64, s50, 1
    s_lshl2_add_u32 s64, s49, s64
    s_and_b32 s65, s50, 1
    v_mov_b32 v184, 0x3f803f80
L_hop15:
    s_cbranch_execz L_hop19
    v_mov_b32 v185, 0x3f803f80
    v_mov_b32 v186, 0x3f803f80
    v_mov_b32 v187, 0x3f803f80
    s_nop 1
    v_mfma_f32_16x16x32_bf16 v[168:171], a[224:227], v[184:187], 0
    v_lshlrev_b32 v16, 16, v48
    v_and_b32 v17, 0xffff0000, v48
    v_mfma_f32_16x16x32_bf16 v[172:175], a[228:231], v[184:187], 0
    v_lshlrev_b32 v18, 16, v49
    v_and_b32 v19, 0xffff0000, v49
    v_mfma_f32_16x16x32_bf16 v[168:171], a[232:235], v[184:187], v[168:171]
    v_lshlrev_b32 v20, 16, v50
    v_and_b32 v21, 0xffff0000, v50
    v_mfma_f32_16x16x32_bf16 v[172:175], a[236:239], v[184:187], v[172:175]
    v_lshlrev_b32 v22, 16, v51
    v_and_b32 v23, 0xffff0000, v51
    v_mfma_f32_16x16x32_bf16 v[168:171], a[240:243], v[184:187], v[168:171]
    v_lshlrev_b32 v24, 16, v52
    v_and_b32 v25, 0xffff0000, v52
    v_mfma_f32_16x16x32_bf16 v[172:175], a[244:247], v[184:187], v[172:175]
    v_lshlrev_b32 v26, 16, v53
    v_and_b32 v27, 0xffff0000, v53
    v_mfma_f32_16x16x32_bf16 v[168:171], a[248:251], v[184:187], v[168:171]
    v_lshlrev_b32 v28, 16, v54
    v_and_b32 v29, 0xffff0000, v54
    v_mfma_f32_16x16x32_bf16 v[172:175], a[252:255], v[184:187], v[172:175]
    v_lshlrev_b32 v30, 16, v55
    v_and_b32 v31, 0xffff0000, v55
    v_mfma_f32_16x16x32_bf16 v[168:171], v[64:67], v[184:187], v[168:171]
    v_lshlrev_b32 v32, 16, v56
    v_and_b32 v33, 0xffff0000, v56
    v_mfma_f32_16x16x32_bf16 v[172:175], v[68:71], v[184:187], v[172:175]
    v_lshlrev_b32 v34, 16, v57
    v_and_b32 v35, 0xffff0000, v57
    v_mfma_f32_16x16x32_bf16 v[168:171], v[72:75], v[184:187], v[168:171]
    v_lshlrev_b32 v36, 16, v58
    v_and_b32 v37, 0xffff0000, v58
    v_mfma_f32_16x16x32_bf16 v[172:175], v[76:79], v[184:187], v[172:175]
    v_lshlrev_b32 v38, 16, v59
    v_and_b32 v39, 0xffff0000, v59
    v_mfma_f32_16x16x32_bf16 v[168:171], v[80:83], v[184:187], v[168:171]
    v_lshlrev_b32 v40, 16, v60
    v_and_b32 v41, 0xffff0000, v60
    v_mfma_f32_16x16x32_bf16 v[172:175], v[84:87], v[184:187], v[172:175]
    v_lshlrev_b32 v42, 16, v61
    v_and_b32 v43, 0xffff0000, v61
    v_mfma_f32_16x16x32_bf16 v[168:171], v[88:91], v[184:187], v[168:171]
    v_lshlrev_b32 v44, 16, v62
    v_and_b32 v45, 0xffff0000, v62
    v_mfma_f32_16x16x32_bf16 v[172:175], v[92:95], v[184:187], v[172:175]
    v_lshlrev_b32 v46, 16, v63
    v_and_b32 v47, 0xffff0000, v63
    s_mul_i32 s85, s54, 65536
    s_add_u32 s85, s85, s56
    v_add_u32 v8, s85, v1
    v_add_u32 v124, 4096, v8
    s_xor_b32 s85, s48, 0
    s_waitcnt vmcnt(8)
    s_atomic_add s92, s[4:5], s59 offset:0
    s_add_u32 s87, s49, 2
    s_and_b32 s87, s87, 3
    s_add_u32 s86, s87, s3
    s_lshl_b32 s87, s87, 14
    s_add_u32 m0, s87, s96
    s_and_b32 s86, s86, 7
    s_lshl_b32 s86, s86, 18
    s_add_u32 s86, s86, s88
    buffer_load_dwordx4 v5, s[12:15], s86 offen offset:0 lds
    s_add_u32 s86, s86, 15360
    buffer_load_dwordx4 v5, s[12:15], s86 offen offset:1024 lds
    s_add_u32 s86, s86, 15360
    buffer_load_dwordx4 v5, s[12:15], s86 offen offset:2048 lds
    s_add_u32 s86, s86, 15360
    buffer_load_dwordx4 v5, s[12:15], s86 offen offset:3072 lds
    s_add_u32 s87, s49, 3
    s_and_b32 s87, s87, 3
    s_add_u32 s86, s87, s3
    s_lshl_b32 s87, s87, 14
    s_add_u32 m0, s87, s96
    s_and_b32 s86, s86, 7
    s_lshl_b32 s86, s86, 18
    s_add_u32 s86, s86, s88
    buffer_load_dwordx4 v5, s[12:15], s86 offen offset:0 lds
    s_add_u32 s86, s86, 15360
    buffer_load_dwordx4 v5, s[12:15], s86 offen offset:1024 lds
    s_add_u32 s86, s86, 15360
    buffer_load_dwordx4 v5, s[12:15], s86 offen offset:2048 lds
    s_add_u32 s86, s86, 15360
    buffer_load_dwordx4 v5, s[12:15], s86 offen offset:3072 lds
    s_add_u32 s86, s3, 6
    s_and_b32 s86, s86, 7
    s_lshl_b32 s86, s86, 18
    s_add_u32 s86, s86, s88
    s_add_u32 m0, s96, 98304
    s_nop 0
    buffer_load_dwordx4 v5, s[12:15], s86 offen offset:0 lds
    s_add_u32 s86, s86, 15360
    buffer_load_dwordx4 v5, s[12:15], s86 offen offset:1024 lds
    s_add_u32 s86, s86, 15360
    buffer_load_dwordx4 v5, s[12:15], s86 offen offset:2048 lds
    s_add_u32 s86, s86, 15360
    buffer_load_dwordx4 v5, s[12:15], s86 offen offset:3072 lds
    s_mov_b32 s57, 0
    s_atomic_add s57, s[4:5], s59 offset:0 glc
    s_add_u32 s86, s3, 7
    s_and_b32 s86, s86, 7
    s_lshl_b32 s86, s86, 18
    s_add_u32 s86, s86, s88
    s_add_u32 m0, s96, 114688
    s_nop 0
    buffer_load_dwordx4 v5, s[12:15], s86 offen offset:0 lds
    s_add_u32 s86, s86, 15360
    buffer_load_dwordx4 v5, s[12:15], s86 offen offset:1024 lds
    s_add_u32 s86, s86, 15360
    buffer_load_dwordx4 v5, s[12:15], s86 offen offset:2048 lds
    s_add_u32 s86, s86, 15360
    buffer_load_dwordx4 v5, s[12:15], s86 offen offset:3072 lds
    s_lshl1_add_u32 s85, s85, s3
    s_lshl_b32 s85, s85, 13
    s_and_b32 s68, s85, 0xffff
    s_add_u32 s85, s85, 8192
    s_and_b32 s69, s85, 0xffff
    s_xor_b32 s85, s48, 1
    s_lshl1_add_u32 s85, s85, s3
    s_lshl_b32 s85, s85, 13
    s_and_b32 s70, s85, 0xffff
    s_add_u32 s85, s85, 8192
    s_and_b32 s71, s85, 0xffff
    s_xor_b32 s85, s48, 3
    s_lshl1_add_u32 s85, s85, s3
    s_lshl_b32 s85, s85, 13
    s_and_b32 s72, s85, 0xffff
    s_add_u32 s85, s85, 8192
    s_and_b32 s73, s85, 0xffff
    s_xor_b32 s85, s48, 2
    s_lshl1_add_u32 s85, s85, s3
    s_lshl_b32 s85, s85, 13
    s_and_b32 s74, s85, 0xffff
    s_add_u32 s85, s85, 8192
    s_and_b32 s75, s85, 0xffff
    v_xor_b32 v9, 0, v3
    v_xor_b32 v10, 32, v3
    v_xor_b32 v11, 64, v3
    v_xor_b32 v12, 96, v3
    s_mul_i32 s60, s64, 65536
    s_lshl_b32 s61, s65, 10
    s_add_u32 s60, s60, s61
    s_lshl2_add_u32 s60, s96, s60
    s_add_u32 s60, s60, s56
    s_lshl_b32 s61, s64, 12
    s_add_u32 s61, s61, s56
    s_add_u32 s62, s61, 47185920
    s_cmp_lg_u32 s65, 0
    s_cselect_b64 vcc, -1, 0
    v_and_b32 v160, 15, v0
    v_bfe_u32 v161, v0, 4, 1
    v_lshrrev_b32 v162, 5, v0
    s_mul_i32 s66, s48, 2112
    s_add_u32 s66, s66, 147456
    v_mul_u32_u24 v163, 1056, v162
    s_add_u32 s61, s61, 46137344
    s_cmp_lg_u32 s51, 0
    s_cbranch_scc1 L_vaddrb
    v_and_b32 v13, 0x1f0, v1
    v_add_u32 v13, v13, v163
    v_mov_b32 v14, v13
    v_lshlrev_b32 v15, 4, v160
    v_lshl_or_b32 v15, v161, 10, v15
    v_lshl_or_b32 v15, v162, 9, v15
    s_lshl_b32 s65, s65, 8
    s_branch L_kvaddrb
L_vaddrb:
    v_bfe_u32 v13, v0, 2, 2
    v_mul_u32_u24 v13, 528, v13
    v_and_b32 v14, 0xcc, v2
    v_add_u32 v13, v13, v14
    v_and_b32 v14, 7, v0
    v_lshl_or_b32 v14, v161, 3, v14
    v_bfe_u32 v15, v0, 3, 1
    v_lshl_or_b32 v14, v15, 4, v14
    v_lshl_add_u32 v14, v14, 4, v163
    v_mov_b32 v15, v1
    s_lshl_b32 s65, s65, 10
    s_add_u32 s65, s65, 2048
L_kvaddrb:
    s_add_u32 s61, s61, s65
    s_cmp_eq_u32 s48, 0
    s_cselect_b32 s61, s61, 1073741824
    s_add_u32 s76, s91, 131072
    s_add_u32 s77, s91, 163840
    s_add_u32 s78, s59, 384
    s_cmp_eq_u32 s48, 0
    s_cselect_b32 s76, s76, s78
    s_cselect_b32 s77, s77, s78
    s_cselect_b32 s78, 16, 0
    s_cselect_b32 s79, 1, 0
    s_lshl_b32 s80, s54, 12
    s_add_u32 s80, s80, s56
    s_add_u32 s80, s80, 47185920
    s_lshl_b32 s81, s49, 14
    s_lshr_b32 s89, s96, 1
    s_add_u32 s90, s81, s89
    s_add_u32 s90, s90, 2048
    s_add_u32 s89, s89, 131072
    s_add_u32 s82, s56, 46137344
    v_add_u32 v13, s66, v13
    v_add_u32 v14, 147456, v14
    s_branch L_layer
L_pack_a:
L_hop16:
    s_cbranch_execz L_hopdone
    s_cmp_lg_u32 s84, 2
    s_cbranch_scc1 L_pack_a3
    ds_read_b64_tr_b16 a[0:1], v9 offset:0
    ds_read_b64_tr_b16 a[2:3], v9 offset:2048
    ds_read_b64_tr_b16 a[4:5], v10 offset:0
    ds_read_b64_tr_b16 a[6:7], v10 offset:2048
    ds_read_b64_tr_b16 a[8:9], v11 offset:0
    ds_read_b64_tr_b16 a[10:11], v11 offset:2048
    ds_read_b64_tr_b16 a[12:13], v12 offset:0
    ds_read_b64_tr_b16 a[14:15], v12 offset:2048
    s_branch L_att_a
L_pack_a3:
    s_cmp_lg_u32 s84, 3
    s_cbranch_scc1 L_pack_a4
    v_mfma_f32_16x16x32_bf16 v[192:195], v[184:187], a[0:3], 0
    buffer_store_dwordx4 a[0:3], v1, s[4:7], s44 offen sc1
    ds_read_b64_tr_b16 a[16:17], v9 offset:4096
    ds_read_b64_tr_b16 a[18:19], v9 offset:6144
    v_mfma_f32_16x16x32_bf16 v[196:199], v[184:187], a[4:7], 0
    buffer_store_dwordx4 a[4:7], v1, s[4:7], s45 offen sc1
    ds_read_b64_tr_b16 a[20:21], v10 offset:4096
    ds_read_b64_tr_b16 a[22:23], v10 offset:6144
    v_mfma_f32_16x16x32_bf16 v[200:203], v[184:187], a[8:11], 0
    buffer_store_dwordx4 a[8:11], v1, s[4:7], s46 offen sc1
    ds_read_b64_tr_b16 a[24:25], v11 offset:4096
    ds_read_b64_tr_b16 a[26:27], v11 offset:6144
    v_mfma_f32_16x16x32_bf16 v[204:207], v[184:187], a[12:15], 0
    buffer_store_dwordx4 a[12:15], v1, s[4:7], s47 offen sc1
    ds_read_b64_tr_b16 a[28:29], v12 offset:4096
    ds_read_b64_tr_b16 a[30:31], v12 offset:6144
    s_branch L_att_a
L_pack_a4:
    v_mfma_f32_16x16x32_bf16 v[192:195], v[184:187], a[16:19], v[192:195]
    buffer_store_dwordx4 a[16:19], v213, s[4:7], s44 offen sc1
    ds_read_b64_tr_b16 a[32:33], v9 offset:8192
    ds_read_b64_tr_b16 a[34:35], v9 offset:10240
    v_mfma_f32_16x16x32_bf16 v[196:199], v[184:187], a[20:23], v[196:199]
    buffer_store_dwordx4 a[20:23], v213, s[4:7], s45 offen sc1
    ds_read_b64_tr_b16 a[36:37], v10 offset:8192
    ds_read_b64_tr_b16 a[38:39], v10 offset:10240
    v_mfma_f32_16x16x32_bf16 v[200:203], v[184:187], a[24:27], v[200:203]
    buffer_store_dwordx4 a[24:27], v213, s[4:7], s46 offen sc1
    ds_read_b64_tr_b16 a[40:41], v11 offset:8192
    ds_read_b64_tr_b16 a[42:43], v11 offset:10240
    v_mfma_f32_16x16x32_bf16 v[204:207], v[184:187], a[28:31], v[204:207]
    buffer_store_dwordx4 a[28:31], v213, s[4:7], s47 offen sc1
    ds_read_b64_tr_b16 a[44:45], v12 offset:8192
    ds_read_b64_tr_b16 a[46:47], v12 offset:10240
    s_lshl1_add_u32 s86, s48, s3
    s_lshl_b32 s86, s86, 18
    s_mov_b32 s88, 16384
    s_lshl_b32 s60, s53, 7
    v_add_u32 v8, s60, v5
    s_lshl_b32 s87, s48, 15
.p2align 3
L_att_c:
    v_mfma_f32_32x32x16_bf16 v[224:239], v[168:171], v[48:51], 0
    v_exp_f32 v80, v80
    v_exp_f32 v81, v81
    v_exp_f32 v82, v82
    v_mfma_f32_32x32x16_bf16 v[224:239], v[172:175], v[52:55], v[224:239]
    s_waitcnt lgkmcnt(0)
    s_barrier
    v_exp_f32 v83, v83
    v_exp_f32 v84, v84
    v_exp_f32 v85, v85
    v_smfmac_f32_16x16x64_bf16 v[160:163], v[188:191], v[64:71], v15
    ds_read_b128 v[176:179], v14 offset:2048
    v_exp_f32 v86, v86
    v_exp_f32 v87, v87
    v_smfmac_f32_16x16x64_bf16 v[160:163], v[188:191], v[72:79], v15
    ds_read_b128 v[180:183], v14 offset:3072
    v_exp_f32 v88, v88
    v_exp_f32 v89, v89
    v_smfmac_f32_32x32x32_bf16 v[128:143], v[112:115], v[64:71], v15
    s_and_b32 s90, s90, 0x3ffff
    buffer_load_dwordx4 v13, s[4:7], s90 offen offset:0 sc1 lds
    v_exp_f32 v90, v90
    v_exp_f32 v91, v91
    v_exp_f32 v92, v92
    v_smfmac_f32_32x32x32_bf16 v[128:143], v[116:119], v[72:79], v15
    buffer_load_dwordx4 v13, s[4:7], s90 offen offset:1024 sc1 lds
    s_add_u32 s90, s90, 8192
    v_exp_f32 v93, v93
    v_exp_f32 v94, v94
    v_exp_f32 v95, v95
    v_mfma_f32_32x32x16_bf16 v[240:255], v[168:171], v[56:59], 0
    s_add_u32 m0, s89, 24576
    v_exp_f32 v224, v224
    v_exp_f32 v225, v225
    v_exp_f32 v226, v226
    v_mfma_f32_32x32x16_bf16 v[240:255], v[172:175], v[60:63], v[240:255]
    s_waitcnt lgkmcnt(0)
    v_exp_f32 v227, v227
    v_exp_f32 v228, v228
    v_exp_f32 v229, v229
    v_smfmac_f32_16x16x64_bf16 v[164:167], v[188:191], v[80:87], v15
    ds_read_b128 v[104:107], v14 offset:0
    v_exp_f32 v230, v230
    v_exp_f32 v231, v231
    v_smfmac_f32_16x16x64_bf16 v[164:167], v[188:191], v[88:95], v15
    ds_read_b128 v[108:111], v14 offset:1024
    v_exp_f32 v232, v232
    v_exp_f32 v233, v233
    v_smfmac_f32_32x32x32_bf16 v[144:159], v[112:115], v[80:87], v15
    s_and_b32 s90, s90, 0x3ffff
    buffer_load_dwordx4 v13, s[4:7], s90 offen offset:0 sc1 lds
    v_exp_f32 v234, v234
    v_exp_f32 v235, v235
    v_exp_f32 v236, v236
    v_smfmac_f32_32x32x32_bf16 v[144:159], v[116:119], v[88:95], v15
    buffer_load_dwordx4 v13, s[4:7], s90 offen offset:1024 sc1 lds
    s_add_u32 s90, s90, 8192
    v_exp_f32 v237, v237
    v_exp_f32 v238, v238
    v_exp_f32 v239, v239
    v_mfma_f32_32x32x16_bf16 v[64:79], v[176:179], v[48:51], 0
    s_mov_b32 m0, s87
    v_exp_f32 v240, v240
    v_exp_f32 v241, v241
    v_exp_f32 v242, v242
    v_mfma_f32_32x32x16_bf16 v[64:79], v[180:183], v[52:55], v[64:79]
    s_waitcnt lgkmcnt(0)
    v_exp_f32 v243, v243
    v_exp_f32 v244, v244
    v_exp_f32 v245, v245
    v_smfmac_f32_16x16x64_bf16 v[160:163], v[188:191], v[224:231], v15
    ds_read_b128 v[168:171], v14 offset:6144
    v_exp_f32 v246, v246
    v_exp_f32 v247, v247
    v_smfmac_f32_16x16x64_bf16 v[160:163], v[188:191], v[232:239], v15
    ds_read_b128 v[172:175], v14 offset:7168
    v_exp_f32 v248, v248
    v_exp_f32 v249, v249
    v_smfmac_f32_32x32x32_bf16 v[128:143], v[104:107], v[224:231], v15
    s_and_b32 s86, s86, 2097151
    buffer_load_dwordx4 v8, s[20:23], s86 offen lds
    v_exp_f32 v250, v250
    v_exp_f32 v251, v251
    v_exp_f32 v252, v252
    v_smfmac_f32_32x32x32_bf16 v[128:143], v[108:111], v[232:239], v15
    s_add_u32 s86, s86, s88
    s_add_u32 s87, s87, 1024
    v_exp_f32 v253, v253
    v_exp_f32 v254, v254
    v_exp_f32 v255, v255
    v_mfma_f32_32x32x16_bf16 v[80:95], v[176:179], v[56:59], 0
    s_mov_b32 m0, s87
    v_exp_f32 v64, v64
    v_exp_f32 v65, v65
    v_exp_f32 v66, v66
    v_mfma_f32_32x32x16_bf16 v[80:95], v[180:183], v[60:63], v[80:95]
    s_waitcnt lgkmcnt(0)
    v_exp_f32 v67, v67
    v_exp_f32 v68, v68
    v_exp_f32 v69, v69
    v_smfmac_f32_16x16x64_bf16 v[164:167], v[188:191], v[240:247], v15
    ds_read_b128 v[112:115], v14 offset:4096
    v_exp_f32 v70, v70
    v_exp_f32 v71, v71
    v_smfmac_f32_16x16x64_bf16 v[164:167], v[188:191], v[248:255], v15
    ds_read_b128 v[116:119], v14 offset:5120
    v_exp_f32 v72, v72
    v_exp_f32 v73, v73
    v_smfmac_f32_32x32x32_bf16 v[144:159], v[104:107], v[240:247], v15
    s_and_b32 s86, s86, 2097151
    buffer_load_dwordx4 v8, s[20:23], s86 offen lds
    v_exp_f32 v74, v74
    v_exp_f32 v75, v75
    v_exp_f32 v76, v76
    v_smfmac_f32_32x32x32_bf16 v[144:159], v[108:111], v[248:255], v15
    s_add_u32 s86, s86, s88
    s_add_u32 s87, s87, 1024
    v_exp_f32 v77, v77
    v_exp_f32 v78, v78
    v_exp_f32 v79, v79
    v_mfma_f32_32x32x16_bf16 v[224:239], v[168:171], v[48:51], 0
    s_mov_b32 m0, s87
    v_exp_f32 v80, v80
    v_exp_f32 v81, v81
    v_exp_f32 v82, v82
    v_mfma_f32_32x32x16_bf16 v[224:239], v[172:175], v[52:55], v[224:239]
    s_waitcnt lgkmcnt(0)
    v_exp_f32 v83, v83
    v_exp_f32 v84, v84
    v_exp_f32 v85, v85
    v_smfmac_f32_16x16x64_bf16 v[160:163], v[188:191], v[64:71], v15
    ds_read_b128 v[176:179], v14 offset:10240
    v_exp_f32 v86, v86
    v_exp_f32 v87, v87
    v_smfmac_f32_16x16x64_bf16 v[160:163], v[188:191], v[72:79], v15
    ds_read_b128 v[180:183], v14 offset:11264
    v_exp_f32 v88, v88
    v_exp_f32 v89, v89
    v_smfmac_f32_32x32x32_bf16 v[128:143], v[112:115], v[64:71], v15
    s_and_b32 s86, s86, 2097151
    buffer_load_dwordx4 v8, s[20:23], s86 offen lds
    v_exp_f32 v90, v90
    v_exp_f32 v91, v91
    v_exp_f32 v92, v92
    v_smfmac_f32_32x32x32_bf16 v[128:143], v[116:119], v[72:79], v15
    s_add_u32 s86, s86, s88
    s_add_u32 s87, s87, 1024
    v_exp_f32 v93, v93
    v_exp_f32 v94, v94
    v_exp_f32 v95, v95
    v_mfma_f32_32x32x16_bf16 v[240:255], v[168:171], v[56:59], 0
    s_mov_b32 m0, s87
    v_exp_f32 v224, v224
    v_exp_f32 v225, v225
    v_exp_f32 v226, v226
    v_mfma_f32_32x32x16_bf16 v[240:255], v[172:175], v[60:63], v[240:255]
    s_waitcnt lgkmcnt(0)
    v_exp_f32 v227, v227
    v_exp_f32 v228, v228
    v_exp_f32 v229, v229
    v_smfmac_f32_16x16x64_bf16 v[164:167], v[188:191], v[80:87], v15
    ds_read_b128 v[104:107], v14 offset:8192
    v_exp_f32 v230, v230
    v_exp_f32 v231, v231
    v_smfmac_f32_16x16x64_bf16 v[164:167], v[188:191], v[88:95], v15
    ds_read_b128 v[108:111], v14 offset:9216
    v_exp_f32 v232, v232
    v_exp_f32 v233, v233
    v_smfmac_f32_32x32x32_bf16 v[144:159], v[112:115], v[80:87], v15
    s_and_b32 s86, s86, 2097151
    buffer_load_dwordx4 v8, s[20:23], s86 offen lds
    v_exp_f32 v234, v234
    v_exp_f32 v235, v235
    v_exp_f32 v236, v236
    v_smfmac_f32_32x32x32_bf16 v[144:159], v[116:119], v[88:95], v15
    s_add_u32 s86, s86, s88
    s_add_u32 s87, s87, 1024
    v_exp_f32 v237, v237
    v_exp_f32 v238, v238
    v_exp_f32 v239, v239
    v_mfma_f32_32x32x16_bf16 v[64:79], v[176:179], v[48:51], 0
    v_exp_f32 v240, v240
    v_exp_f32 v241, v241
    v_exp_f32 v242, v242
    v_mfma_f32_32x32x16_bf16 v[64:79], v[180:183], v[52:55], v[64:79]
    s_waitcnt lgkmcnt(0)
    v_exp_f32 v243, v243
    v_exp_f32 v244, v244
    v_exp_f32 v245, v245
    v_smfmac_f32_16x16x64_bf16 v[160:163], v[188:191], v[224:231], v15
    ds_read_b128 v[168:171], v14 offset:14336
    v_exp_f32 v246, v246
    v_exp_f32 v247, v247
    v_smfmac_f32_16x16x64_bf16 v[160:163], v[188:191], v[232:239], v15
    ds_read_b128 v[172:175], v14 offset:15360
    v_exp_f32 v248, v248
    v_exp_f32 v249, v249
    v_smfmac_f32_32x32x32_bf16 v[128:143], v[104:107], v[224:231], v15
    v_exp_f32 v250, v250
    v_exp_f32 v251, v251
    v_exp_f32 v252, v252
    v_smfmac_f32_32x32x32_bf16 v[128:143], v[108:111], v[232:239], v15
    v_exp_f32 v253, v253
    v_exp_f32 v254, v254
    v_exp_f32 v255, v255
    v_mfma_f32_32x32x16_bf16 v[80:95], v[176:179], v[56:59], 0
    v_exp_f32 v64, v64
    v_exp_f32 v65, v65
    v_exp_f32 v66, v66
    v_mfma_f32_32x32x16_bf16 v[80:95], v[180:183], v[60:63], v[80:95]
    s_waitcnt lgkmcnt(0)
    v_exp_f32 v67, v67
    v_exp_f32 v68, v68
    v_exp_f32 v69, v69
    v_smfmac_f32_16x16x64_bf16 v[164:167], v[188:191], v[240:247], v15
    ds_read_b128 v[112:115], v14 offset:12288
    v_exp_f32 v70, v70
    v_exp_f32 v71, v71
    v_smfmac_f32_16x16x64_bf16 v[164:167], v[188:191], v[248:255], v15
    ds_read_b128 v[116:119], v14 offset:13312
    v_exp_f32 v72, v72
    v_exp_f32 v73, v73
    v_smfmac_f32_32x32x32_bf16 v[144:159], v[104:107], v[240:247], v15
    s_add_u32 m0, s89, 0
    v_exp_f32 v74, v74
    v_exp_f32 v75, v75
    v_exp_f32 v76, v76
    v_smfmac_f32_32x32x32_bf16 v[144:159], v[108:111], v[248:255], v15
    s_waitcnt vmcnt(4)
    v_exp_f32 v77, v77
    v_exp_f32 v78, v78
    v_exp_f32 v79, v79
    v_mfma_f32_32x32x16_bf16 v[224:239], v[168:171], v[48:51], 0
    v_exp_f32 v80, v80
    v_exp_f32 v81, v81
    v_exp_f32 v82, v82
    v_mfma_f32_32x32x16_bf16 v[224:239], v[172:175], v[52:55], v[224:239]
    s_waitcnt lgkmcnt(0)
    s_barrier
    v_exp_f32 v83, v83
    v_exp_f32 v84, v84
    v_exp_f32 v85, v85
    v_smfmac_f32_16x16x64_bf16 v[160:163], v[188:191], v[64:71], v15
    ds_read_b128 v[176:179], v14 offset:18432
    v_exp_f32 v86, v86
    v_exp_f32 v87, v87
    v_smfmac_f32_16x16x64_bf16 v[160:163], v[188:191], v[72:79], v15
    ds_read_b128 v[180:183], v14 offset:19456
    v_exp_f32 v88, v88
    v_exp_f32 v89, v89
    v_smfmac_f32_32x32x32_bf16 v[128:143], v[112:115], v[64:71], v15
    s_and_b32 s90, s90, 0x3ffff
    buffer_load_dwordx4 v13, s[4:7], s90 offen offset:0 sc1 lds
    v_exp_f32 v90, v90
    v_exp_f32 v91, v91
    v_exp_f32 v92, v92
    v_smfmac_f32_32x32x32_bf16 v[128:143], v[116:119], v[72:79], v15
    buffer_load_dwordx4 v13, s[4:7], s90 offen offset:1024 sc1 lds
    s_add_u32 s90, s90, 8192
    v_exp_f32 v93, v93
    v_exp_f32 v94, v94
    v_exp_f32 v95, v95
    v_mfma_f32_32x32x16_bf16 v[240:255], v[168:171], v[56:59], 0
    s_add_u32 m0, s89, 8192
    v_exp_f32 v224, v224
    v_exp_f32 v225, v225
    v_exp_f32 v226, v226
    v_mfma_f32_32x32x16_bf16 v[240:255], v[172:175], v[60:63], v[240:255]
    s_waitcnt lgkmcnt(0)
    v_exp_f32 v227, v227
    v_exp_f32 v228, v228
    v_exp_f32 v229, v229
    v_smfmac_f32_16x16x64_bf16 v[164:167], v[188:191], v[80:87], v15
    ds_read_b128 v[104:107], v14 offset:16384
    v_exp_f32 v230, v230
    v_exp_f32 v231, v231
    v_smfmac_f32_16x16x64_bf16 v[164:167], v[188:191], v[88:95], v15
    ds_read_b128 v[108:111], v14 offset:17408
    v_exp_f32 v232, v232
    v_exp_f32 v233, v233
    v_smfmac_f32_32x32x32_bf16 v[144:159], v[112:115], v[80:87], v15
    s_and_b32 s90, s90, 0x3ffff
    buffer_load_dwordx4 v13, s[4:7], s90 offen offset:0 sc1 lds
    v_exp_f32 v234, v234
    v_exp_f32 v235, v235
    v_exp_f32 v236, v236
    v_smfmac_f32_32x32x32_bf16 v[144:159], v[116:119], v[88:95], v15
    buffer_load_dwordx4 v13, s[4:7], s90 offen offset:1024 sc1 lds
    s_add_u32 s90, s90, 8192
    v_exp_f32 v237, v237
    v_exp_f32 v238, v238
    v_exp_f32 v239, v239
    v_mfma_f32_32x32x16_bf16 v[64:79], v[176:179], v[48:51], 0
    s_mov_b32 m0, s87
    v_exp_f32 v240, v240
    v_exp_f32 v241, v241
    v_exp_f32 v242, v242
    v_mfma_f32_32x32x16_bf16 v[64:79], v[180:183], v[52:55], v[64:79]
    s_waitcnt lgkmcnt(0)
    v_exp_f32 v243, v243
    v_exp_f32 v244, v244
    v_exp_f32 v245, v245
    v_smfmac_f32_16x16x64_bf16 v[160:163], v[188:191], v[224:231], v15
    ds_read_b128 v[168:171], v14 offset:22528
    v_exp_f32 v246, v246
    v_exp_f32 v247, v247
    v_smfmac_f32_16x16x64_bf16 v[160:163], v[188:191], v[232:239], v15
    ds_read_b128 v[172:175], v14 offset:23552
    v_exp_f32 v248, v248
    v_exp_f32 v249, v249
    v_smfmac_f32_32x32x32_bf16 v[128:143], v[104:107], v[224:231], v15
    s_and_b32 s86, s86, 2097151
    buffer_load_dwordx4 v8, s[20:23], s86 offen lds
    v_exp_f32 v250, v250
    v_exp_f32 v251, v251
    v_exp_f32 v252, v252
    v_smfmac_f32_32x32x32_bf16 v[128:143], v[108:111], v[232:239], v15
    s_add_u32 s86, s86, s88
    s_add_u32 s87, s87, 1024
    v_exp_f32 v253, v253
    v_exp_f32 v254, v254
    v_exp_f32 v255, v255
    v_mfma_f32_32x32x16_bf16 v[80:95], v[176:179], v[56:59], 0
    s_mov_b32 m0, s87
    v_exp_f32 v64, v64
    v_exp_f32 v65, v65
    v_exp_f32 v66, v66
    v_mfma_f32_32x32x16_bf16 v[80:95], v[180:183], v[60:63], v[80:95]
    s_waitcnt lgkmcnt(0)
    v_exp_f32 v67, v67
    v_exp_f32 v68, v68
    v_exp_f32 v69, v69
    v_smfmac_f32_16x16x64_bf16 v[164:167], v[188:191], v[240:247], v15
    ds_read_b128 v[112:115], v14 offset:20480
    v_exp_f32 v70, v70
    v_exp_f32 v71, v71
    v_smfmac_f32_16x16x64_bf16 v[164:167], v[188:191], v[248:255], v15
    ds_read_b128 v[116:119], v14 offset:21504
    v_exp_f32 v72, v72
    v_exp_f32 v73, v73
    v_smfmac_f32_32x32x32_bf16 v[144:159], v[104:107], v[240:247], v15
    s_and_b32 s86, s86, 2097151
    buffer_load_dwordx4 v8, s[20:23], s86 offen lds
    v_exp_f32 v74, v74
    v_exp_f32 v75, v75
    v_exp_f32 v76, v76
    v_smfmac_f32_32x32x32_bf16 v[144:159], v[108:111], v[248:255], v15
    s_add_u32 s86, s86, s88
    s_add_u32 s87, s87, 1024
    v_exp_f32 v77, v77
    v_exp_f32 v78, v78
    v_exp_f32 v79, v79
    v_mfma_f32_32x32x16_bf16 v[224:239], v[168:171], v[48:51], 0
    s_mov_b32 m0, s87
    v_exp_f32 v80, v80
    v_exp_f32 v81, v81
    v_exp_f32 v82, v82
    v_mfma_f32_32x32x16_bf16 v[224:239], v[172:175], v[52:55], v[224:239]
    s_waitcnt lgkmcnt(0)
    v_exp_f32 v83, v83
    v_exp_f32 v84, v84
    v_exp_f32 v85, v85
    v_smfmac_f32_16x16x64_bf16 v[160:163], v[188:191], v[64:71], v15
    ds_read_b128 v[176:179], v14 offset:26624
    v_exp_f32 v86, v86
    v_exp_f32 v87, v87
    v_smfmac_f32_16x16x64_bf16 v[160:163], v[188:191], v[72:79], v15
    ds_read_b128 v[180:183], v14 offset:27648
    v_exp_f32 v88, v88
    v_exp_f32 v89, v89
    v_smfmac_f32_32x32x32_bf16 v[128:143], v[112:115], v[64:71], v15
    s_and_b32 s86, s86, 2097151
    buffer_load_dwordx4 v8, s[20:23], s86 offen lds
    v_exp_f32 v90, v90
    v_exp_f32 v91, v91
    v_exp_f32 v92, v92
    v_smfmac_f32_32x32x32_bf16 v[128:143], v[116:119], v[72:79], v15
    s_add_u32 s86, s86, s88
    s_add_u32 s87, s87, 1024
    v_exp_f32 v93, v93
    v_exp_f32 v94, v94
    v_exp_f32 v95, v95
    v_mfma_f32_32x32x16_bf16 v[240:255], v[168:171], v[56:59], 0
    s_mov_b32 m0, s87
    v_exp_f32 v224, v224
    v_exp_f32 v225, v225
    v_exp_f32 v226, v226
    v_mfma_f32_32x32x16_bf16 v[240:255], v[172:175], v[60:63], v[240:255]
    s_waitcnt lgkmcnt(0)
    v_exp_f32 v227, v227
    v_exp_f32 v228, v228
    v_exp_f32 v229, v229
    v_smfmac_f32_16x16x64_bf16 v[164:167], v[188:191], v[80:87], v15
    ds_read_b128 v[104:107], v14 offset:24576
    v_exp_f32 v230, v230
    v_exp_f32 v231, v231
    v_smfmac_f32_16x16x64_bf16 v[164:167], v[188:191], v[88:95], v15
    ds_read_b128 v[108:111], v14 offset:25600
    v_exp_f32 v232, v232
    v_exp_f32 v233, v233
    v_smfmac_f32_32x32x32_bf16 v[144:159], v[112:115], v[80:87], v15
    s_and_b32 s86, s86, 2097151
    buffer_load_dwordx4 v8, s[20:23], s86 offen lds
    v_exp_f32 v234, v234
    v_exp_f32 v235, v235
    v_exp_f32 v236, v236
    v_smfmac_f32_32x32x32_bf16 v[144:159], v[116:119], v[88:95], v15
    s_add_u32 s86, s86, s88
    s_add_u32 s87, s87, 1024
    v_exp_f32 v237, v237
    v_exp_f32 v238, v238
    v_exp_f32 v239, v239
    v_mfma_f32_32x32x16_bf16 v[64:79], v[176:179], v[48:51], 0
    v_exp_f32 v240, v240
    v_exp_f32 v241, v241
    v_exp_f32 v242, v242
    v_mfma_f32_32x32x16_bf16 v[64:79], v[180:183], v[52:55], v[64:79]
    s_waitcnt lgkmcnt(0)
    v_exp_f32 v243, v243
    v_exp_f32 v244, v244
    v_exp_f32 v245, v245
    v_smfmac_f32_16x16x64_bf16 v[160:163], v[188:191], v[224:231], v15
    ds_read_b128 v[168:171], v14 offset:30720
    v_exp_f32 v246, v246
    v_exp_f32 v247, v247
    v_smfmac_f32_16x16x64_bf16 v[160:163], v[188:191], v[232:239], v15
    ds_read_b128 v[172:175], v14 offset:31744
    v_exp_f32 v248, v248
    v_exp_f32 v249, v249
    v_smfmac_f32_32x32x32_bf16 v[128:143], v[104:107], v[224:231], v15
    s_add_u32 s84, s84, 1
    v_exp_f32 v250, v250
    v_exp_f32 v251, v251
    v_exp_f32 v252, v252
    v_smfmac_f32_32x32x32_bf16 v[128:143], v[108:111], v[232:239], v15
    v_exp_f32 v253, v253
    v_exp_f32 v254, v254
    v_exp_f32 v255, v255
    v_mfma_f32_32x32x16_bf16 v[80:95], v[176:179], v[56:59], 0
L_hop17:
    s_cbranch_execz L_hopdone
    v_exp_f32 v64, v64
    v_exp_f32 v65, v65
    v_exp_f32 v66, v66
    v_mfma_f32_32x32x16_bf16 v[80:95], v[180:183], v[60:63], v[80:95]
    s_waitcnt lgkmcnt(0)
    v_exp_f32 v67, v67
    v_exp_f32 v68, v68
    v_exp_f32 v69, v69
    v_smfmac_f32_16x16x64_bf16 v[164:167], v[188:191], v[240:247], v15
    ds_read_b128 v[112:115], v14 offset:28672
    v_exp_f32 v70, v70
    v_exp_f32 v71, v71
    v_smfmac_f32_16x16x64_bf16 v[164:167], v[188:191], v[248:255], v15
    ds_read_b128 v[116:119], v14 offset:29696
    v_exp_f32 v72, v72
    v_exp_f32 v73, v73
    v_smfmac_f32_32x32x32_bf16 v[144:159], v[104:107], v[240:247], v15
    s_add_u32 m0, s89, 16384
    v_exp_f32 v74, v74
    v_exp_f32 v75, v75
    v_exp_f32 v76, v76
    v_smfmac_f32_32x32x32_bf16 v[144:159], v[108:111], v[248:255], v15
    s_waitcnt vmcnt(4)
    s_cmp_lt_u32 s84, s85
    v_exp_f32 v77, v77
    v_exp_f32 v78, v78
    v_exp_f32 v79, v79
    s_cmp_eq_u32 s84, 8
    s_cbranch_scc1 L_att_tail
    s_cmp_lg_u32 s84, 5
    s_cbranch_scc1 L_pack_c6
    v_mfma_f32_16x16x32_bf16 v[192:195], v[184:187], a[32:35], v[192:195]
    buffer_store_dwordx4 a[32:35], v1, s[4:7], s8 offen sc1
    ds_read_b64_tr_b16 a[48:49], v9 offset:12288
    ds_read_b64_tr_b16 a[50:51], v9 offset:14336
    v_mfma_f32_16x16x32_bf16 v[196:199], v[184:187], a[36:39], v[196:199]
    buffer_store_dwordx4 a[36:39], v1, s[4:7], s9 offen sc1
    ds_read_b64_tr_b16 a[52:53], v10 offset:12288
    ds_read_b64_tr_b16 a[54:55], v10 offset:14336
    v_mfma_f32_16x16x32_bf16 v[200:203], v[184:187], a[40:43], v[200:203]
    buffer_store_dwordx4 a[40:43], v1, s[4:7], s10 offen sc1
    ds_read_b64_tr_b16 a[56:57], v11 offset:12288
    ds_read_b64_tr_b16 a[58:59], v11 offset:14336
    v_mfma_f32_16x16x32_bf16 v[204:207], v[184:187], a[44:47], v[204:207]
    buffer_store_dwordx4 a[44:47], v1, s[4:7], s11 offen sc1
    ds_read_b64_tr_b16 a[60:61], v12 offset:12288
    ds_read_b64_tr_b16 a[62:63], v12 offset:14336
    s_branch L_att_c
L_pack_c6:
L_hop18:
    s_cbranch_execz L_hopdone
    s_cmp_lg_u32 s84, 6
    s_cbranch_scc1 L_pack_c7
    v_mfma_f32_16x16x32_bf16 v[192:195], v[184:187], a[48:51], v[192:195]
    buffer_store_dwordx4 a[48:51], v214, s[4:7], s8 offen sc1
    v_mfma_f32_16x16x32_bf16 v[196:199], v[184:187], a[52:55], v[196:199]
    buffer_store_dwordx4 a[52:55], v214, s[4:7], s9 offen sc1
    v_mfma_f32_16x16x32_bf16 v[200:203], v[184:187], a[56:59], v[200:203]
    buffer_store_dwordx4 a[56:59], v214, s[4:7], s10 offen sc1
    v_mfma_f32_16x16x32_bf16 v[204:207], v[184:187], a[60:63], v[204:207]
    buffer_store_dwordx4 a[60:63], v214, s[4:7], s11 offen sc1
    s_nop 2
    v_permlane16_swap_b32 v192, v196
    s_nop 2
    v_permlane16_swap_b32 v200, v204
    s_nop 1
    v_permlane32_swap_b32 v192, v200
    s_lshl3_add_u32 s60, s96, 31744
    v_add_u32 v209, s60, v2
    ds_write_b32 v209, v192
    s_branch L_att_c
L_pack_c7:
    v_xor_b32 v209, 0x8000, v209
    ds_read_b32 v193, v209
    v_lshlrev_b32 v208, 16, v208
    v_and_b32 v210, 0xf0, v1
    v_bfe_u32 v211, v0, 4, 1
    v_lshl_or_b32 v210, v211, 3, v210
    v_lshrrev_b32 v211, 5, v0
    v_lshl_or_b32 v210, v211, 10, v210
    s_waitcnt lgkmcnt(0)
    v_add_f32 v192, v192, v193
    v_cvt_pk_bf16_f32 v194, v192, v192
    v_and_b32 v193, 0xffff0000, v194
    v_sub_f32 v193, v192, v193
    v_cvt_pk_bf16_f32 v195, v193, v208
    buffer_store_dwordx2 v[194:195], v210, s[4:7], s95 offen sc1
    s_branch L_att_c
L_slow_3:
    s_waitcnt lgkmcnt(0)
    s_cmp_lg_u32 s79, 15
    s_cbranch_scc1 L_tl_31
    s_lshl2_add_u32 s67, s55, 163840
    v_lshrrev_b32 v126, 4, v0
    v_mul_u32_u24 v125, 2048, v0
    v_lshl_or_b32 v125, v126, 29, v125
    v_mov_b32 v126, 1
    buffer_atomic_add v126, v125, s[4:7], s67 offen sc1
L_tl_31:
    s_branch L_back_4
L_slow_5:
    s_waitcnt lgkmcnt(0)
    s_cmp_lg_u32 s79, 15
    s_cbranch_scc1 L_tl_32
    s_lshl2_add_u32 s67, s55, 163840
    v_lshrrev_b32 v126, 4, v0
    v_mul_u32_u24 v125, 2048, v0
    v_lshl_or_b32 v125, v126, 29, v125
    v_mov_b32 v126, 1
    buffer_atomic_add v126, v125, s[4:7], s67 offen sc1
L_tl_32:
    s_branch L_back_6
L_slow_7:
    s_mov_b32 s58, 0
L_poll_33:
    s_waitcnt lgkmcnt(0)
    s_cmp_ge_u32 s57, s78
    s_cbranch_scc1 L_polled_34
    s_add_u32 s58, s58, 1
    s_cmp_ge_u32 s58, 0x20000
    s_cbranch_scc1 L_polled_34
    s_mov_b32 s57, 0
    s_atomic_add s57, s[4:5], s77 offset:0 glc
    s_branch L_poll_33
L_polled_34:
    s_branch L_back_8
L_slow_11:
    s_waitcnt lgkmcnt(0)
    s_cmp_lg_u32 s97, 15
    s_cbranch_scc1 L_tl_35
    s_lshl2_add_u32 s67, s55, 163848
    v_lshrrev_b32 v126, 4, v0
    v_mul_u32_u24 v125, 2048, v0
    v_lshl_or_b32 v125, v126, 29, v125
    v_mov_b32 v126, 1
    buffer_atomic_add v126, v125, s[4:7], s67 offen sc1
L_tl_35:
    s_branch L_back_12
L_slow_13:
    s_mov_b32 s58, 0
L_poll_36:
    s_waitcnt lgkmcnt(0)
    s_cmp_ge_u32 s97, 16
    s_cbranch_scc1 L_polled_37
    s_add_u32 s58, s58, 1
    s_cmp_ge_u32 s58, 0x20000
    s_cbranch_scc1 L_polled_37
    s_mov_b32 s97, 0
    s_atomic_add s97, s[4:5], s62 offset:163848 glc
    s_branch L_poll_36
L_polled_37:
    s_branch L_back_14
L_slow_17:
    s_mov_b32 s58, 0
L_poll_38:
    s_waitcnt lgkmcnt(0)
    s_cmp_ge_u32 s57, 4
    s_cbranch_scc1 L_polled_39
    s_add_u32 s58, s58, 1
    s_cmp_ge_u32 s58, 0x20000
    s_cbranch_scc1 L_polled_39
    s_mov_b32 s57, 0
    s_atomic_add s57, s[4:5], s72 offset:128 glc
    s_branch L_poll_38
L_polled_39:
    s_branch L_back_18
L_slow_19:
    s_mov_b32 s58, 0
L_poll_40:
    s_waitcnt lgkmcnt(0)
    s_cmp_ge_u32 s57, 4
    s_cbranch_scc1 L_polled_41
    s_add_u32 s58, s58, 1
    s_cmp_ge_u32 s58, 0x20000
    s_cbranch_scc1 L_polled_41
    s_mov_b32 s57, 0
    s_atomic_add s57, s[4:5], s72 offset:136 glc
    s_branch L_poll_40
L_polled_41:
    s_branch L_back_20
L_slow_21:
    s_mov_b32 s58, 0
L_poll_42:
    s_waitcnt lgkmcnt(0)
    s_cmp_ge_u32 s57, 4
    s_cbranch_scc1 L_polled_43
    s_add_u32 s58, s58, 1
    s_cmp_ge_u32 s58, 0x20000
    s_cbranch_scc1 L_polled_43
    s_mov_b32 s57, 0
    s_atomic_add s57, s[4:5], s72 offset:192 glc
    s_branch L_poll_42
L_polled_43:
    s_branch L_back_22
L_slow_23:
    s_mov_b32 s58, 0
L_poll_44:
    s_waitcnt lgkmcnt(0)
    s_cmp_ge_u32 s57, 4
    s_cbranch_scc1 L_polled_45
    s_add_u32 s58, s58, 1
    s_cmp_ge_u32 s58, 0x20000
    s_cbranch_scc1 L_polled_45
    s_mov_b32 s57, 0
    s_atomic_add s57, s[4:5], s72 offset:200 glc
    s_branch L_poll_44
L_polled_45:
    s_branch L_back_24
L_slow_25:
    s_mov_b32 s58, 0
L_poll_46:
    s_waitcnt lgkmcnt(0)
    s_bitcmp1_b32 s57, 0
    s_cbranch_scc1 L_polled_47
    s_add_u32 s58, s58, 1
    s_cmp_ge_u32 s58, 0x20000
    s_cbranch_scc1 L_polled_47
    s_mov_b32 s57, 0
    s_atomic_add s57, s[4:5], s73 offset:256 glc
    s_branch L_poll_46
L_polled_47:
    s_branch L_back_26
L_slow_27:
    s_mov_b32 s58, 0
L_poll_48:
    s_waitcnt lgkmcnt(0)
    s_bitcmp1_b32 s57, 1
    s_cbranch_scc1 L_polled_49
    s_add_u32 s58, s58, 1
    s_cmp_ge_u32 s58, 0x20000
    s_cbranch_scc1 L_polled_49
    s_mov_b32 s57, 0
    s_atomic_add s57, s[4:5], s73 offset:256 glc
    s_branch L_poll_48
L_polled_49:
    s_branch L_back_28
L_slow_29:
    s_mov_b32 s58, 0
L_poll_50:
    s_waitcnt lgkmcnt(0)
    s_bitcmp1_b32 s57, 2
    s_cbranch_scc1 L_polled_51
    s_add_u32 s58, s58, 1
    s_cmp_ge_u32 s58, 0x20000
    s_cbranch_scc1 L_polled_51
    s_mov_b32 s57, 0
    s_atomic_add s57, s[4:5], s73 offset:256 glc
    s_branch L_poll_50
L_polled_51:
    s_branch L_back_30
L_fallback:
    s_waitcnt vmcnt(0) lgkmcnt(0)
    v_mov_b32 v120, 0xff800000
    s_mov_b32 s60, 0
L_fb_52:
    buffer_load_dwordx4 v[168:171], v13, s[4:7], s60 offen offset:0 sc1
    buffer_load_dwordx4 v[172:175], v13, s[4:7], s60 offen offset:1024 sc1
    s_waitcnt vmcnt(0)
    v_mfma_f32_32x32x16_bf16 v[224:239], v[168:171], v[48:51], 0
    v_mfma_f32_32x32x16_bf16 v[224:239], v[172:175], v[52:55], v[224:239]
    s_nop 11
    v_max3_f32 v120, v224, v225, v120
    v_max3_f32 v120, v226, v227, v120
    v_max3_f32 v120, v228, v229, v120
    v_max3_f32 v120, v230, v231, v120
    v_max3_f32 v120, v232, v233, v120
    v_max3_f32 v120, v234, v235, v120
    v_max3_f32 v120, v236, v237, v120
    v_max3_f32 v120, v238, v239, v120
    s_add_u32 s60, s60, 4096
    s_cmp_lt_u32 s60, 0x40000
    s_cbranch_scc1 L_fb_52
    v_mov_b32 v7, v120
    s_nop 1
    v_permlane32_swap_b32 v120, v7
    v_max_f32 v120, v120, v7
    v_sub_f32 v64, 0, v120
    v_mov_b32 v128, 0
    v_sub_f32 v65, 0, v120
    v_mov_b32 v129, 0
    v_sub_f32 v66, 0, v120
    v_mov_b32 v130, 0
    v_sub_f32 v67, 0, v120
    v_mov_b32 v131, 0
    v_sub_f32 v68, 0, v120
    v_mov_b32 v132, 0
    v_sub_f32 v69, 0, v120
    v_mov_b32 v133, 0
    v_sub_f32 v70, 0, v120
    v_mov_b32 v134, 0
    v_sub_f32 v71, 0, v120
    v_mov_b32 v135, 0
    v_sub_f32 v72, 0, v120
    v_mov_b32 v136, 0
    v_sub_f32 v73, 0, v120
    v_mov_b32 v137, 0
    v_sub_f32 v74, 0, v120
    v_mov_b32 v138, 0
    v_sub_f32 v75, 0, v120
    v_mov_b32 v139, 0
    v_sub_f32 v76, 0, v120
    v_mov_b32 v140, 0
    v_sub_f32 v77, 0, v120
    v_mov_b32 v141, 0
    v_sub_f32 v78, 0, v120
    v_mov_b32 v142, 0
    v_sub_f32 v79, 0, v120
    v_mov_b32 v143, 0
    v_mov_b32 v160, 0
    v_mov_b32 v161, 0
    v_mov_b32 v162, 0
    v_mov_b32 v163, 0
    s_mov_b32 s60, 0
L_fb_53:
    buffer_load_dwordx4 v[168:171], v13, s[4:7], s60 offen offset:0 sc1
    buffer_load_dwordx4 v[104:107], v13, s[4:7], s60 offen offset:2048 sc1
    buffer_load_dwordx4 v[172:175], v13, s[4:7], s60 offen offset:1024 sc1
    buffer_load_dwordx4 v[108:111], v13, s[4:7], s60 offen offset:3072 sc1
    s_waitcnt vmcnt(0)
    v_mfma_f32_32x32x16_bf16 v[224:239], v[168:171], v[48:51], v[64:79]
    v_mfma_f32_32x32x16_bf16 v[224:239], v[172:175], v[52:55], v[224:239]
    s_nop 11
    v_exp_f32 v224, v224
    v_exp_f32 v225, v225
    v_exp_f32 v226, v226
    v_exp_f32 v227, v227
    v_exp_f32 v228, v228
    v_exp_f32 v229, v229
    v_exp_f32 v230, v230
    v_exp_f32 v231, v231
    v_exp_f32 v232, v232
    v_exp_f32 v233, v233
    v_exp_f32 v234, v234
    v_exp_f32 v235, v235
    v_exp_f32 v236, v236
    v_exp_f32 v237, v237
    v_exp_f32 v238, v238
    v_exp_f32 v239, v239
    v_smfmac_f32_32x32x32_bf16 v[128:143], v[104:107], v[224:231], v15
    v_smfmac_f32_16x16x64_bf16 v[160:163], v[188:191], v[224:231], v15
    v_smfmac_f32_32x32x32_bf16 v[128:143], v[108:111], v[232:239], v15
    v_smfmac_f32_16x16x64_bf16 v[160:163], v[188:191], v[232:239], v15
    s_add_u32 s60, s60, 4096
    s_cmp_lt_u32 s60, 0x40000
    s_cbranch_scc1 L_fb_53
    s_nop 11
    v_mov_b32 v120, 0xff800000
    s_mov_b32 s60, 0
L_fb_54:
    buffer_load_dwordx4 v[168:171], v13, s[4:7], s60 offen offset:0 sc1
    buffer_load_dwordx4 v[172:175], v13, s[4:7], s60 offen offset:1024 sc1
    s_waitcnt vmcnt(0)
    v_mfma_f32_32x32x16_bf16 v[240:255], v[168:171], v[56:59], 0
    v_mfma_f32_32x32x16_bf16 v[240:255], v[172:175], v[60:63], v[240:255]
    s_nop 11
    v_max3_f32 v120, v240, v241, v120
    v_max3_f32 v120, v242, v243, v120
    v_max3_f32 v120, v244, v245, v120
    v_max3_f32 v120, v246, v247, v120
    v_max3_f32 v120, v248, v249, v120
    v_max3_f32 v120, v250, v251, v120
    v_max3_f32 v120, v252, v253, v120
    v_max3_f32 v120, v254, v255, v120
    s_add_u32 s60, s60, 4096
    s_cmp_lt_u32 s60, 0x40000
    s_cbranch_scc1 L_fb_54
    v_mov_b32 v7, v120
    s_nop 1
    v_permlane32_swap_b32 v120, v7
    v_max_f32 v120, v120, v7
    v_sub_f32 v64, 0, v120
    v_mov_b32 v144, 0
    v_sub_f32 v65, 0, v120
    v_mov_b32 v145, 0
    v_sub_f32 v66, 0, v120
    v_mov_b32 v146, 0
    v_sub_f32 v67, 0, v120
    v_mov_b32 v147, 0
    v_sub_f32 v68, 0, v120
    v_mov_b32 v148, 0
    v_sub_f32 v69, 0, v120
    v_mov_b32 v149, 0
    v_sub_f32 v70, 0, v120
    v_mov_b32 v150, 0
    v_sub_f32 v71, 0, v120
    v_mov_b32 v151, 0
    v_sub_f32 v72, 0, v120
    v_mov_b32 v152, 0
    v_sub_f32 v73, 0, v120
    v_mov_b32 v153, 0
    v_sub_f32 v74, 0, v120
    v_mov_b32 v154, 0
    v_sub_f32 v75, 0, v120
    v_mov_b32 v155, 0
    v_sub_f32 v76, 0, v120
    v_mov_b32 v156, 0
    v_sub_f32 v77, 0, v120
    v_mov_b32 v157, 0
    v_sub_f32 v78, 0, v120
    v_mov_b32 v158, 0
    v_sub_f32 v79, 0, v120
    v_mov_b32 v159, 0
    v_mov_b32 v164, 0
    v_mov_b32 v165, 0
    v_mov_b32 v166, 0
    v_mov_b32 v167, 0
    s_mov_b32 s60, 0
L_fb_55:
    buffer_load_dwordx4 v[168:171], v13, s[4:7], s60 offen offset:0 sc1
    buffer_load_dwordx4 v[104:107], v13, s[4:7], s60 offen offset:2048 sc1
    buffer_load_dwordx4 v[172:175], v13, s[4:7], s60 offen offset:1024 sc1
    buffer_load_dwordx4 v[108:111], v13, s[4:7], s60 offen offset:3072 sc1
    s_waitcnt vmcnt(0)
    v_mfma_f32_32x32x16_bf16 v[240:255], v[168:171], v[56:59], v[64:79]
    v_mfma_f32_32x32x16_bf16 v[240:255], v[172:175], v[60:63], v[240:255]
    s_nop 11
    v_exp_f32 v240, v240
    v_exp_f32 v241, v241
    v_exp_f32 v242, v242
    v_exp_f32 v243, v243
    v_exp_f32 v244, v244
    v_exp_f32 v245, v245
    v_exp_f32 v246, v246
    v_exp_f32 v247, v247
    v_exp_f32 v248, v248
    v_exp_f32 v249, v249
    v_exp_f32 v250, v250
    v_exp_f32 v251, v251
    v_exp_f32 v252, v252
    v_exp_f32 v253, v253
    v_exp_f32 v254, v254
    v_exp_f32 v255, v255
    v_smfmac_f32_32x32x32_bf16 v[144:159], v[104:107], v[240:247], v15
    v_smfmac_f32_16x16x64_bf16 v[164:167], v[188:191], v[240:247], v15
    v_smfmac_f32_32x32x32_bf16 v[144:159], v[108:111], v[248:255], v15
    v_smfmac_f32_16x16x64_bf16 v[164:167], v[188:191], v[248:255], v15
    s_add_u32 s60, s60, 4096
    s_cmp_lt_u32 s60, 0x40000
    s_cbranch_scc1 L_fb_55
    s_nop 11
    s_branch L_att_fin
L_out:
L_hop19:
    s_cbranch_execz L_hopdone
    s_lshl_b32 s93, s54, 16
    s_lshl_b32 s94, s53, 7
    s_add_u32 s93, s93, s94
    s_add_u32 s94, s93, 32768
    v_permlane16_swap_b32 v48, v50
    v_permlane16_swap_b32 v49, v51
    v_permlane16_swap_b32 v52, v54
    v_permlane16_swap_b32 v53, v55
    v_permlane16_swap_b32 v56, v58
    v_permlane16_swap_b32 v57, v59
    v_permlane16_swap_b32 v60, v62
    v_permlane16_swap_b32 v61, v63
    buffer_store_dwordx4 v[48:51], v4, s[36:39], s93 offen offset:0 sc1
    buffer_store_dwordx4 v[52:55], v4, s[36:39], s94 offen offset:0 sc1
    buffer_store_dwordx4 v[56:59], v4, s[36:39], s93 offen offset:64 sc1
    buffer_store_dwordx4 v[60:63], v4, s[36:39], s94 offen offset:64 sc1
L_fin:
L_end:
    s_endpgm
.section .rodata,"a"
.p2align 6
.amdhsa_kernel interleave_layers__grouped_kv_mqa__mixer_channel_mlp__prompt_kernel
  .amdhsa_next_free_vgpr 512
  .amdhsa_next_free_sgpr 102
  .amdhsa_accum_offset 256
  .amdhsa_group_segment_fixed_size 0
  .amdhsa_kernarg_size 104
  .amdhsa_user_sgpr_count 2
  .amdhsa_user_sgpr_kernarg_segment_ptr 1
  .amdhsa_system_sgpr_workgroup_id_x 1
.end_amdhsa_kernel
```
